```python
import torch

def _softmax(x, axis=-1):
    return torch.softmax(x, dim=axis)
def _gelu(x):
    return torch.nn.functional.gelu(x, approximate="tanh")
def _silu(x):
    return torch.nn.functional.silu(x)
def _sigmoid(x):
    return torch.sigmoid(x)
def _layernorm(x, axis=-1, eps=1e-5):
    m = x.mean(dim=axis, keepdim=True)
    v = x.var(dim=axis, keepdim=True, unbiased=False)
    return (x - m) / torch.sqrt(v + eps)
def _scatter_add(tgt, idx, src, axis=0):
    return tgt.clone().index_add_(axis, idx, src)
def _segment_sum(src, seg, n):
    out = torch.zeros((n,) + src.shape[1:], dtype=src.dtype)
    return out.index_add_(0, seg, src)
def _pad(x, pw):
    flat = tuple(v for pair in reversed(pw) for v in pair)
    return torch.nn.functional.pad(x, flat)

kernel_name = 'concat_heads__gqa_block_cached__mha_block_cached__near_ridge'

def setup_inputs():

    _w = (lambda a: (lambda t: t.to(torch.bfloat16) if t.is_floating_point() else t)(torch.as_tensor(a)))
    def _A_setup():
        B, Sq, D = 8, 64, 576
        Hq, Hkv, Sk, Dh = 32, 16, 1024, 128
        assert Hq % Hkv == 0, (Hq, Hkv)
        return {
            "x": _w((lambda *s: torch.randn(*s, dtype=torch.bfloat16) * 0.8)(B, Sq, D)),
            "k_cache": _w((lambda *s: torch.randn(*s, dtype=torch.bfloat16) * 0.8)(B, Hkv, Sk, Dh)),
            "v_cache": _w((lambda *s: torch.randn(*s, dtype=torch.bfloat16) * 0.05)(B, Hkv, Sk, Dh)),
            "wq": _w((lambda *s: torch.randn(*s, dtype=torch.bfloat16) * 0.8)(D, Hq * Dh) * (D ** -0.5)),
            "wo": _w((lambda *s: torch.randn(*s, dtype=torch.bfloat16) * 0.05)(Hq * Dh, D) * ((Hq * Dh) ** -0.5)),
        }
    _A_in = _A_setup()

    def _B_setup():
        B, Sq, D = 8, 64, 576
        H, Sk, Dh = 32, 1024, 128
        return {
            "x": _w((lambda *s: torch.randn(*s, dtype=torch.bfloat16) * 0.8)(B, Sq, D)),
            "k_cache": _w((lambda *s: torch.randn(*s, dtype=torch.bfloat16) * 0.8)(B, H, Sk, Dh)),
            "v_cache": _w((lambda *s: torch.randn(*s, dtype=torch.bfloat16) * 0.05)(B, H, Sk, Dh)),
            "wq": _w((lambda *s: torch.randn(*s, dtype=torch.bfloat16) * 0.8)(D, H * Dh) * (D ** -0.5)),
            "wo": _w((lambda *s: torch.randn(*s, dtype=torch.bfloat16) * 0.05)(H * Dh, D) * ((H * Dh) ** -0.5)),
        }
    _B_in = _B_setup()

    return {
        "A_x": _A_in["x"],
        "A_k_cache": _A_in["k_cache"],
        "A_v_cache": _A_in["v_cache"],
        "A_wq": _A_in["wq"],
        "A_wo": _A_in["wo"],
        "B_x": _B_in["x"],
        "B_k_cache": _B_in["k_cache"],
        "B_v_cache": _B_in["v_cache"],
        "B_wq": _B_in["wq"],
        "B_wo": _B_in["wo"],
    }

def reference(A_x, A_k_cache, A_v_cache, A_wq, A_wo, B_x, B_k_cache, B_v_cache, B_wq, B_wo):
    def _A_ref(x, k_cache, v_cache, wq, wo):
        B, Sq, D = x.shape
        Hq, Dh = 32, 128
        Hkv = k_cache.shape[1]
        rep = Hq // Hkv
        q = (lambda x, *d: x.permute(*d))((x @ wq).reshape(B, Sq, Hq, Dh), 0, 2, 1, 3)
        k = (lambda x, n, axis: torch.repeat_interleave(x, n, dim=axis))(k_cache, rep, axis=1)
        v = (lambda x, n, axis: torch.repeat_interleave(x, n, dim=axis))(v_cache, rep, axis=1)
        scores = torch.einsum("bhqd,bhkd->bhqk", q, k) * (Dh ** -0.5)
        p = _softmax(scores, axis=-1)
        o = torch.einsum("bhqk,bhkd->bhqd", p, v)
        return (lambda x, *d: x.permute(*d))(o, 0, 2, 1, 3).reshape(B, Sq, Hq * Dh) @ wo

    def _B_ref(x, k_cache, v_cache, wq, wo):
        B, Sq, D = x.shape
        H, Dh = 32, 128
        q = (lambda x, *d: x.permute(*d))((x @ wq).reshape(B, Sq, H, Dh), 0, 2, 1, 3)
        scores = torch.einsum("bhqd,bhkd->bhqk", q, k_cache) * (Dh ** -0.5)
        p = _softmax(scores, axis=-1)
        o = torch.einsum("bhqk,bhkd->bhqd", p, v_cache)
        return (lambda x, *d: x.permute(*d))(o, 0, 2, 1, 3).reshape(B, Sq, H * Dh) @ wo

    a = _A_ref(A_x, A_k_cache, A_v_cache, A_wq, A_wo)
    b = _B_ref(B_x, B_k_cache, B_v_cache, B_wq, B_wo)
    return torch.concatenate([a, b], axis=-1)
```

```asm
; @launch grid=(256,1,1) block=(256,1,1) lds=163840
.amdgcn_target "amdgcn-amd-amdhsa--gfx950"
.text
.globl concat_heads__gqa_block_cached__mha_block_cached__near_ridge_kernel
.p2align 8
.type concat_heads__gqa_block_cached__mha_block_cached__near_ridge_kernel,@function
concat_heads__gqa_block_cached__mha_block_cached__near_ridge_kernel:
  s_cmp_ge_u32 s2, 256
  s_cbranch_scc1 L_end
  s_bitcmp1_b32 s2, 3
  s_cbranch_scc1 L_roleB
L_roleA:
  s_load_dwordx8 s[36:43], s[0:1], 0
  s_load_dwordx2 s[44:45], s[0:1], 96
  s_load_dwordx2 s[34:35], s[0:1], 88
  v_and_b32 v1, 63, v0
  v_lshrrev_b32 v2, 6, v0
  s_nop 0
  v_readfirstlane_b32 s6, v2
  s_and_b32 s4, s2, 7
  s_lshr_b32 s5, s2, 4
  v_lshrrev_b32 v2, 4, v1
  v_and_b32 v3, 15, v1
  v_lshlrev_b32 v6, 2, v2
  v_xor_b32 v6, v6, v3
  v_lshlrev_b32 v7, 13, v2
  v_lshl_add_u32 v21, v6, 4, v7
  v_lshlrev_b32 v5, 8, v2
  v_lshl_add_u32 v20, v6, 4, v5
  v_lshrrev_b32 v6, 3, v1
  v_and_b32 v7, 7, v1
  v_lshrrev_b32 v8, 1, v6
  v_xor_b32 v7, v7, v8
  v_mul_u32_u24 v6, 1152, v6
  v_lshl_add_u32 v22, v7, 4, v6
  v_xor_b32 v7, 4, v7
  v_lshl_add_u32 v23, v7, 4, v6
  s_lshr_b32 s53, s6, 1
  s_and_b32 s54, s6, 1
  s_and_b32 s3, s5, 1
  s_lshl_b32 s3, s3, 3
  s_add_u32 s3, s3, s4
  s_lshr_b32 s7, s5, 1
  s_lshl_b32 s56, s3, 1
  s_add_u32 s56, s56, s53
  s_lshl_b32 s30, s54, 18
  s_lshl_b32 s55, s56, 8
  s_add_u32 s30, s30, s55
  s_lshl_b32 s31, s53, 14
  s_lshl_b32 s55, s54, 13
  s_add_u32 s31, s31, s55
  s_lshl_b32 s55, s7, 6
  s_lshl_b32 s57, s6, 4
  s_add_u32 s55, s55, s57
  s_mul_i32 s32, s55, 1152
  s_lshl_b32 s55, s6, 11
  s_add_u32 s33, s55, 32768
  s_and_b32 s57, s5, 1
  s_lshl_b32 s57, s57, 2
  s_add_u32 s55, s7, s57
  s_cmp_ge_u32 s55, 9
  s_cselect_b32 s57, 9, 0
  s_sub_u32 s94, s55, s57
  s_waitcnt lgkmcnt(0)
  s_mov_b32 s16, s42
  s_and_b32 s17, s43, 0xffff
  s_mov_b32 s18, 0x480000
  s_mov_b32 s19, 0x20000
  s_mov_b32 s20, s36
  s_and_b32 s21, s37, 0xffff
  s_mov_b32 s22, 0x90000
  s_mov_b32 s23, 0x20000
  s_lshl_b32 s95, s94, 19
  s_add_u32 s95, s95, s30
  s_lshl_b32 s96, s94, 7
  s_add_u32 s96, s96, s32
  s_add_u32 s94, s94, 1
  s_cmp_eq_u32 s94, 9
  s_cselect_b32 s94, 0, s94
  s_add_u32 m0, s31, 0
  s_add_u32 s51, s95, 0
  buffer_load_dwordx4 v21, s[16:19], s51 offen offset:0 lds
  s_add_u32 s51, s95, 31744
  buffer_load_dwordx4 v21, s[16:19], s51 offen offset:1024 lds
  s_add_u32 s51, s95, 63488
  buffer_load_dwordx4 v21, s[16:19], s51 offen offset:2048 lds
  s_add_u32 s51, s95, 95232
  buffer_load_dwordx4 v21, s[16:19], s51 offen offset:3072 lds
  s_add_u32 m0, s31, 4096
  s_add_u32 s51, s95, 131072
  buffer_load_dwordx4 v21, s[16:19], s51 offen offset:0 lds
  s_add_u32 s51, s95, 162816
  buffer_load_dwordx4 v21, s[16:19], s51 offen offset:1024 lds
  s_add_u32 s51, s95, 194560
  buffer_load_dwordx4 v21, s[16:19], s51 offen offset:2048 lds
  s_add_u32 s51, s95, 226304
  buffer_load_dwordx4 v21, s[16:19], s51 offen offset:3072 lds
  s_add_u32 m0, s33, 0
  s_add_u32 s51, s96, 0
  buffer_load_dwordx4 v22, s[20:23], s51 offen offset:0 lds
  s_add_u32 s51, s96, 8192
  buffer_load_dwordx4 v23, s[20:23], s51 offen offset:1024 lds
  s_lshl_b32 s95, s94, 19
  s_add_u32 s95, s95, s30
  s_lshl_b32 s96, s94, 7
  s_add_u32 s96, s96, s32
  s_add_u32 s94, s94, 1
  s_cmp_eq_u32 s94, 9
  s_cselect_b32 s94, 0, s94
  s_add_u32 m0, s31, 40960
  s_add_u32 s51, s95, 0
  buffer_load_dwordx4 v21, s[16:19], s51 offen offset:0 lds
  s_add_u32 s51, s95, 31744
  buffer_load_dwordx4 v21, s[16:19], s51 offen offset:1024 lds
  s_add_u32 s51, s95, 63488
  buffer_load_dwordx4 v21, s[16:19], s51 offen offset:2048 lds
  s_add_u32 s51, s95, 95232
  buffer_load_dwordx4 v21, s[16:19], s51 offen offset:3072 lds
  s_add_u32 m0, s31, 45056
  s_add_u32 s51, s95, 131072
  buffer_load_dwordx4 v21, s[16:19], s51 offen offset:0 lds
  s_add_u32 s51, s95, 162816
  buffer_load_dwordx4 v21, s[16:19], s51 offen offset:1024 lds
  s_add_u32 s51, s95, 194560
  buffer_load_dwordx4 v21, s[16:19], s51 offen offset:2048 lds
  s_add_u32 s51, s95, 226304
  buffer_load_dwordx4 v21, s[16:19], s51 offen offset:3072 lds
  s_add_u32 m0, s33, 40960
  s_add_u32 s51, s96, 0
  buffer_load_dwordx4 v22, s[20:23], s51 offen offset:0 lds
  s_add_u32 s51, s96, 8192
  buffer_load_dwordx4 v23, s[20:23], s51 offen offset:1024 lds
  s_mov_b32 s8, s38
  s_and_b32 s9, s39, 0xffff
  s_mov_b32 s10, 0x2000000
  s_mov_b32 s11, 0x20000
  s_mov_b32 s12, s40
  s_and_b32 s13, s41, 0xffff
  s_mov_b32 s14, 0x2000000
  s_mov_b32 s15, 0x20000
  s_mov_b32 s24, s44
  s_and_b32 s25, s45, 0xffff
  s_mov_b32 s26, 0x10000000
  s_mov_b32 s27, 0x20000
  s_load_dwordx2 s[36:37], s[0:1], 32
  s_load_dwordx2 s[42:43], s[0:1], 72
  s_load_dwordx2 s[38:39], s[0:1], 80
  s_load_dwordx2 s[40:41], s[0:1], 32
  s_mov_b32 s90, 0
  s_or_b32 s55, s2, s6
  s_cmp_eq_u32 s55, 0
  s_cbranch_scc0 L_nonon_1
  s_memrealtime s[58:59]
  s_waitcnt lgkmcnt(0)
  s_or_b32 s58, s58, 1
  v_mov_b32 v4, s58
  v_mov_b32 v5, s59
  v_mov_b32 v6, 0
  s_mov_b64 exec, 1
  global_store_dwordx2 v6, v[4:5], s[34:35] sc1
  s_mov_b64 exec, -1
L_nonon_1:
  s_lshl_b32 s51, s7, 4
  s_add_u32 s51, s51, s3
  s_lshl_b32 s51, s51, 18
  s_lshl_b32 s55, s6, 11
  s_add_u32 s28, s51, s55
  s_mov_b32 s29, s55
  s_lshl_b32 s55, s7, 5
  s_add_u32 s55, s55, s56
  s_lshl_b32 s55, s55, 14
  s_lshl_b32 s57, s54, 13
  s_add_u32 s52, s55, s57
  s_add_u32 s97, s29, 122880
  s_add_u32 s98, s29, 131072
  s_add_u32 s99, s29, 139264
  s_add_u32 s100, s29, 147456
  s_sub_u32 s47, s28, 8192
  s_sub_u32 s48, s28, 8192
  s_mov_b32 s50, 0x41000000
  v_lshrrev_b32 v2, 4, v1
  v_and_b32 v3, 15, v1
  v_xor_b32 v4, v3, v2
  v_lshlrev_b32 v5, 8, v2
  s_lshl_b32 s55, s54, 1
  s_add_u32 s55, s55, 0
  s_lshl_b32 s55, s55, 2
  v_xor_b32 v6, s55, v4
  v_lshl_add_u32 v16, v6, 4, v5
  s_lshl_b32 s55, s54, 1
  s_add_u32 s55, s55, 1
  s_lshl_b32 s55, s55, 2
  v_xor_b32 v6, s55, v4
  v_lshl_add_u32 v17, v6, 4, v5
  v_and_b32 v2, 31, v1
  v_lshrrev_b32 v3, 5, v1
  v_and_b32 v4, 15, v2
  v_xor_b32 v4, v4, v3
  v_lshlrev_b32 v4, 4, v4
  v_lshl_add_u32 v4, v2, 8, v4
  v_xor_b32 v24, 0, v4
  v_add_u32 v36, 81920, v24
  v_xor_b32 v25, 32, v4
  v_add_u32 v37, 81920, v25
  v_xor_b32 v26, 64, v4
  v_add_u32 v38, 81920, v26
  v_xor_b32 v27, 96, v4
  v_add_u32 v39, 81920, v27
  v_xor_b32 v28, 128, v4
  v_add_u32 v40, 81920, v28
  v_xor_b32 v29, 160, v4
  v_add_u32 v41, 81920, v29
  v_xor_b32 v30, 192, v4
  v_add_u32 v42, 81920, v30
  v_xor_b32 v31, 224, v4
  v_add_u32 v43, 81920, v31
  v_lshrrev_b32 v5, 1, v2
  v_and_b32 v5, 7, v5
  v_xor_b32 v5, v5, v3
  v_lshlrev_b32 v5, 4, v5
  v_lshl_add_u32 v5, v2, 7, v5
  s_lshl_b32 s55, s54, 12
  s_add_u32 s55, s55, 32768
  v_add_u32 v5, s55, v5
  v_xor_b32 v52, 0, v5
  v_add_u32 v60, 81920, v52
  v_xor_b32 v53, 32, v5
  v_add_u32 v61, 81920, v53
  v_xor_b32 v54, 64, v5
  v_add_u32 v62, 81920, v54
  v_xor_b32 v55, 96, v5
  v_add_u32 v63, 81920, v55
  v_lshrrev_b32 v2, 5, v1
  v_bfe_u32 v3, v1, 4, 1
  v_bfe_u32 v4, v1, 2, 2
  v_and_b32 v5, 3, v1
  v_lshl_add_u32 v6, v2, 2, v4
  v_lshlrev_b32 v6, 8, v6
  v_lshl_add_u32 v6, v4, 6, v6
  v_lshl_add_u32 v6, v3, 5, v6
  v_lshl_add_u32 v6, v5, 3, v6
  v_add_u32 v6, 8192, v6
  v_xor_b32 v32, 0, v6
  v_add_u32 v44, 81920, v32
  v_xor_b32 v33, 64, v6
  v_add_u32 v45, 81920, v33
  v_xor_b32 v34, 128, v6
  v_add_u32 v46, 81920, v34
  v_xor_b32 v35, 192, v6
  v_add_u32 v47, 81920, v35
  v_and_b32 v7, 1, v5
  v_lshlrev_b32 v7, 1, v7
  v_lshrrev_b32 v8, 1, v5
  v_or_b32 v7, v7, v8
  v_lshl_add_u32 v6, v2, 3, v4
  v_lshlrev_b32 v6, 8, v6
  v_lshl_add_u32 v6, v4, 6, v6
  v_lshl_add_u32 v6, v3, 5, v6
  v_lshl_add_u32 v6, v7, 3, v6
  s_lshl_b32 s55, s53, 14
  v_add_u32 v6, s55, v6
  v_xor_b32 v48, 0, v6
  v_add_u32 v56, 81920, v48
  v_xor_b32 v49, 64, v6
  v_add_u32 v57, 81920, v49
  v_xor_b32 v50, 128, v6
  v_add_u32 v58, 81920, v50
  v_xor_b32 v51, 192, v6
  v_add_u32 v59, 81920, v51
  v_mov_b32 v10, 0
  v_mov_b32 v208, 0
  v_mov_b32 v209, 0
  v_mov_b32 v210, 0
  v_mov_b32 v211, 0
  v_mov_b32 v212, 0
  v_mov_b32 v213, 0
  v_mov_b32 v214, 0
  v_mov_b32 v215, 0
  v_mov_b32 v216, 0
  v_mov_b32 v217, 0
  v_mov_b32 v218, 0
  v_mov_b32 v219, 0
  v_mov_b32 v220, 0
  v_mov_b32 v221, 0
  v_mov_b32 v222, 0
  v_mov_b32 v223, 0
  s_mov_b32 s55, 3641
  v_add_u32 v2, 0, v1
  v_mul_lo_u32 v3, v2, s55
  v_lshrrev_b32 v3, 16, v3
  v_mul_u32_u24 v4, 18, v3
  v_sub_u32 v4, v2, v4
  v_mul_u32_u24 v3, 1152, v3
  v_lshl_add_u32 v224, v4, 4, v3
  v_add_u32 v2, 64, v1
  v_mul_lo_u32 v3, v2, s55
  v_lshrrev_b32 v3, 16, v3
  v_mul_u32_u24 v4, 18, v3
  v_sub_u32 v4, v2, v4
  v_mul_u32_u24 v3, 1152, v3
  v_lshl_add_u32 v225, v4, 4, v3
  v_add_u32 v2, 128, v1
  v_mul_lo_u32 v3, v2, s55
  v_lshrrev_b32 v3, 16, v3
  v_mul_u32_u24 v4, 18, v3
  v_sub_u32 v4, v2, v4
  v_mul_u32_u24 v3, 1152, v3
  v_lshl_add_u32 v226, v4, 4, v3
  v_add_u32 v2, 192, v1
  v_mul_lo_u32 v3, v2, s55
  v_lshrrev_b32 v3, 16, v3
  v_mul_u32_u24 v4, 18, v3
  v_sub_u32 v4, v2, v4
  v_mul_u32_u24 v3, 1152, v3
  v_lshl_add_u32 v227, v4, 4, v3
  v_add_u32 v2, 256, v1
  v_mul_lo_u32 v3, v2, s55
  v_lshrrev_b32 v3, 16, v3
  v_mul_u32_u24 v4, 18, v3
  v_sub_u32 v4, v2, v4
  v_mul_u32_u24 v3, 1152, v3
  v_lshl_add_u32 v228, v4, 4, v3
  v_add_u32 v2, 320, v1
  v_mul_lo_u32 v3, v2, s55
  v_lshrrev_b32 v3, 16, v3
  v_mul_u32_u24 v4, 18, v3
  v_sub_u32 v4, v2, v4
  v_mul_u32_u24 v3, 1152, v3
  v_lshl_add_u32 v229, v4, 4, v3
  v_add_u32 v2, 384, v1
  v_mul_lo_u32 v3, v2, s55
  v_lshrrev_b32 v3, 16, v3
  v_mul_u32_u24 v4, 18, v3
  v_sub_u32 v4, v2, v4
  v_mul_u32_u24 v3, 1152, v3
  v_lshl_add_u32 v230, v4, 4, v3
  v_add_u32 v2, 448, v1
  v_mul_lo_u32 v3, v2, s55
  v_lshrrev_b32 v3, 16, v3
  v_mul_u32_u24 v4, 18, v3
  v_sub_u32 v4, v2, v4
  v_mul_u32_u24 v3, 1152, v3
  v_lshl_add_u32 v231, v4, 4, v3
  v_add_u32 v2, 512, v1
  v_mul_lo_u32 v3, v2, s55
  v_lshrrev_b32 v3, 16, v3
  v_mul_u32_u24 v4, 18, v3
  v_sub_u32 v4, v2, v4
  v_mul_u32_u24 v3, 1152, v3
  v_lshl_add_u32 v232, v4, 4, v3
  s_waitcnt lgkmcnt(0)
  s_mov_b32 s84, s40
  s_and_b32 s85, s41, 0xffff
  s_mov_b32 s86, 0x480000
  s_mov_b32 s87, 0x20000
  s_and_b32 s58, s5, 3
  s_lshr_b32 s57, s58, 1
  s_lshl_b32 s57, s57, 4
  s_and_b32 s59, s58, 1
  s_add_u32 s57, s57, s59
  s_lshl_b32 s59, s4, 1
  s_add_u32 s57, s57, s59
  s_mul_i32 s57, s57, 147456
  s_lshr_b32 s58, s5, 2
  s_mul_i32 s58, s58, 288
  s_mul_i32 s56, s6, 72
  s_add_u32 s58, s58, s56
  s_lshl_b32 s58, s58, 7
  s_add_u32 s91, s57, s58
  v_lshlrev_b32 v245, 7, v1
  s_waitcnt vmcnt(10) lgkmcnt(0)
  s_barrier
  ds_read_b128 a[96:99], v52 offset:0
  ds_read_b64_tr_b16 a[32:33], v48 offset:0
  ds_read_b64_tr_b16 a[34:35], v48 offset:1024
  ds_read_b64_tr_b16 a[36:37], v49 offset:0
  ds_read_b64_tr_b16 a[38:39], v49 offset:1024
  ds_read_b64_tr_b16 a[40:41], v50 offset:0
  ds_read_b64_tr_b16 a[42:43], v50 offset:1024
  ds_read_b64_tr_b16 a[44:45], v51 offset:0
  ds_read_b64_tr_b16 a[46:47], v51 offset:1024
  ds_read_b128 a[100:103], v53 offset:0
  ds_read_b64_tr_b16 a[48:49], v48 offset:4096
  ds_read_b64_tr_b16 a[50:51], v48 offset:5120
  ds_read_b64_tr_b16 a[52:53], v49 offset:4096
  ds_read_b64_tr_b16 a[54:55], v49 offset:5120
  s_waitcnt lgkmcnt(13)
  ds_read_b64_tr_b16 a[56:57], v50 offset:4096
  ds_read_b64_tr_b16 a[58:59], v50 offset:5120
  s_waitcnt lgkmcnt(13)
  v_mfma_f32_32x32x16_bf16 v[64:79], a[32:35], a[96:99], 0
  s_lshl_b32 s95, s94, 19
  s_add_u32 s95, s95, s30
  s_lshl_b32 s96, s94, 7
  ds_read_b64_tr_b16 a[60:61], v51 offset:4096
  ds_read_b64_tr_b16 a[62:63], v51 offset:5120
  s_waitcnt lgkmcnt(13)
  v_mfma_f32_32x32x16_bf16 v[80:95], a[36:39], a[96:99], 0
  s_add_u32 s96, s96, s32
  s_add_u32 s94, s94, 1
  s_cmp_eq_u32 s94, 9
  s_waitcnt lgkmcnt(12)
  ds_read_b128 a[104:107], v54 offset:0
  ds_read_b64_tr_b16 a[64:65], v48 offset:8192
  ds_read_b64_tr_b16 a[66:67], v48 offset:9216
  s_waitcnt lgkmcnt(14)
  v_mfma_f32_32x32x16_bf16 v[96:111], a[40:43], a[96:99], 0
  s_cselect_b32 s94, 0, s94
  s_add_u32 m0, s31, 81920
  s_add_u32 s51, s95, 0
  s_waitcnt lgkmcnt(13)
  ds_read_b64_tr_b16 a[68:69], v49 offset:8192
  ds_read_b64_tr_b16 a[70:71], v49 offset:9216
  s_waitcnt lgkmcnt(14)
  v_mfma_f32_32x32x16_bf16 v[112:127], a[44:47], a[96:99], 0
  buffer_load_dwordx4 v21, s[16:19], s51 offen offset:0 lds
  s_add_u32 s51, s95, 31744
  buffer_load_dwordx4 v21, s[16:19], s51 offen offset:1024 lds
  s_waitcnt lgkmcnt(13)
  ds_read_b64_tr_b16 a[72:73], v50 offset:8192
  ds_read_b64_tr_b16 a[74:75], v50 offset:9216
  s_waitcnt lgkmcnt(13)
  v_mfma_f32_32x32x16_bf16 v[64:79], a[48:51], a[100:103], v[64:79]
  s_add_u32 s51, s95, 63488
  buffer_load_dwordx4 v21, s[16:19], s51 offen offset:2048 lds
  s_add_u32 s51, s95, 95232
  ds_read_b64_tr_b16 a[76:77], v51 offset:8192
  ds_read_b64_tr_b16 a[78:79], v51 offset:9216
  s_waitcnt lgkmcnt(13)
  v_mfma_f32_32x32x16_bf16 v[80:95], a[52:55], a[100:103], v[80:95]
  buffer_load_dwordx4 v21, s[16:19], s51 offen offset:3072 lds
  s_add_u32 m0, s31, 86016
  s_add_u32 s51, s95, 131072
  s_waitcnt lgkmcnt(12)
  ds_read_b128 a[108:111], v55 offset:0
  ds_read_b64_tr_b16 a[80:81], v48 offset:12288
  ds_read_b64_tr_b16 a[82:83], v48 offset:13312
  s_waitcnt lgkmcnt(14)
  v_mfma_f32_32x32x16_bf16 v[96:111], a[56:59], a[100:103], v[96:111]
  buffer_load_dwordx4 v21, s[16:19], s51 offen offset:0 lds
  s_add_u32 s51, s95, 162816
  s_waitcnt lgkmcnt(13)
  ds_read_b64_tr_b16 a[84:85], v49 offset:12288
  ds_read_b64_tr_b16 a[86:87], v49 offset:13312
  s_waitcnt lgkmcnt(14)
  v_mfma_f32_32x32x16_bf16 v[112:127], a[60:63], a[100:103], v[112:127]
  buffer_load_dwordx4 v21, s[16:19], s51 offen offset:1024 lds
  s_add_u32 s51, s95, 194560
  s_waitcnt lgkmcnt(13)
  ds_read_b64_tr_b16 a[88:89], v50 offset:12288
  ds_read_b64_tr_b16 a[90:91], v50 offset:13312
  s_waitcnt lgkmcnt(13)
  v_mfma_f32_32x32x16_bf16 v[64:79], a[64:67], a[104:107], v[64:79]
  buffer_load_dwordx4 v21, s[16:19], s51 offen offset:2048 lds
  s_add_u32 s51, s95, 226304
  ds_read_b64_tr_b16 a[92:93], v51 offset:12288
  ds_read_b64_tr_b16 a[94:95], v51 offset:13312
  s_waitcnt lgkmcnt(13)
  v_mfma_f32_32x32x16_bf16 v[80:95], a[68:71], a[104:107], v[80:95]
  buffer_load_dwordx4 v21, s[16:19], s51 offen offset:3072 lds
  s_add_u32 m0, s33, 81920
  s_waitcnt lgkmcnt(11)
  v_mfma_f32_32x32x16_bf16 v[96:111], a[72:75], a[104:107], v[96:111]
  s_add_u32 s51, s96, 0
  buffer_load_dwordx4 v22, s[20:23], s51 offen offset:0 lds
  s_waitcnt lgkmcnt(9)
  v_mfma_f32_32x32x16_bf16 v[112:127], a[76:79], a[104:107], v[112:127]
  s_add_u32 s51, s96, 8192
  buffer_load_dwordx4 v23, s[20:23], s51 offen offset:1024 lds
  s_waitcnt vmcnt(10) lgkmcnt(0)
  s_barrier
  ds_read_b128 a[96:99], v52 offset:40960
  ds_read_b64_tr_b16 a[32:33], v48 offset:40960
  ds_read_b64_tr_b16 a[34:35], v48 offset:41984
  ds_read_b64_tr_b16 a[36:37], v49 offset:40960
  ds_read_b64_tr_b16 a[38:39], v49 offset:41984
  ds_read_b64_tr_b16 a[40:41], v50 offset:40960
  ds_read_b64_tr_b16 a[42:43], v50 offset:41984
  ds_read_b64_tr_b16 a[44:45], v51 offset:40960
  ds_read_b64_tr_b16 a[46:47], v51 offset:41984
  v_mfma_f32_32x32x16_bf16 v[64:79], a[80:83], a[108:111], v[64:79]
  s_lshl_b32 s95, s94, 19
  s_add_u32 s95, s95, s30
  v_mfma_f32_32x32x16_bf16 v[80:95], a[84:87], a[108:111], v[80:95]
  s_lshl_b32 s96, s94, 7
  s_add_u32 s96, s96, s32
  ds_read_b128 a[100:103], v53 offset:40960
  ds_read_b64_tr_b16 a[48:49], v48 offset:45056
  ds_read_b64_tr_b16 a[50:51], v48 offset:46080
  v_mfma_f32_32x32x16_bf16 v[96:111], a[88:91], a[108:111], v[96:111]
  s_add_u32 s94, s94, 1
  s_cmp_eq_u32 s94, 9
  ds_read_b64_tr_b16 a[52:53], v49 offset:45056
  ds_read_b64_tr_b16 a[54:55], v49 offset:46080
  v_mfma_f32_32x32x16_bf16 v[112:127], a[92:95], a[108:111], v[112:127]
  s_cselect_b32 s94, 0, s94
  s_add_u32 m0, s31, 0
  s_waitcnt lgkmcnt(13)
  ds_read_b64_tr_b16 a[56:57], v50 offset:45056
  ds_read_b64_tr_b16 a[58:59], v50 offset:46080
  s_waitcnt lgkmcnt(13)
  v_mfma_f32_32x32x16_bf16 v[64:79], a[32:35], a[96:99], v[64:79]
  s_add_u32 s51, s95, 0
  buffer_load_dwordx4 v21, s[16:19], s51 offen offset:0 lds
  ds_read_b64_tr_b16 a[60:61], v51 offset:45056
  ds_read_b64_tr_b16 a[62:63], v51 offset:46080
  s_waitcnt lgkmcnt(13)
  v_mfma_f32_32x32x16_bf16 v[80:95], a[36:39], a[96:99], v[80:95]
  s_add_u32 s51, s95, 31744
  buffer_load_dwordx4 v21, s[16:19], s51 offen offset:1024 lds
  s_waitcnt lgkmcnt(12)
  ds_read_b128 a[104:107], v54 offset:40960
  ds_read_b64_tr_b16 a[64:65], v48 offset:49152
  ds_read_b64_tr_b16 a[66:67], v48 offset:50176
  s_waitcnt lgkmcnt(14)
  v_mfma_f32_32x32x16_bf16 v[96:111], a[40:43], a[96:99], v[96:111]
  s_add_u32 s51, s95, 63488
  buffer_load_dwordx4 v21, s[16:19], s51 offen offset:2048 lds
  s_waitcnt lgkmcnt(13)
  ds_read_b64_tr_b16 a[68:69], v49 offset:49152
  ds_read_b64_tr_b16 a[70:71], v49 offset:50176
  s_waitcnt lgkmcnt(14)
  v_mfma_f32_32x32x16_bf16 v[112:127], a[44:47], a[96:99], v[112:127]
  s_add_u32 s51, s95, 95232
  buffer_load_dwordx4 v21, s[16:19], s51 offen offset:3072 lds
  s_waitcnt lgkmcnt(13)
  ds_read_b64_tr_b16 a[72:73], v50 offset:49152
  ds_read_b64_tr_b16 a[74:75], v50 offset:50176
  s_waitcnt lgkmcnt(13)
  v_mfma_f32_32x32x16_bf16 v[64:79], a[48:51], a[100:103], v[64:79]
  s_add_u32 m0, s31, 4096
  s_add_u32 s51, s95, 131072
  ds_read_b64_tr_b16 a[76:77], v51 offset:49152
  ds_read_b64_tr_b16 a[78:79], v51 offset:50176
  s_waitcnt lgkmcnt(13)
  v_mfma_f32_32x32x16_bf16 v[80:95], a[52:55], a[100:103], v[80:95]
  buffer_load_dwordx4 v21, s[16:19], s51 offen offset:0 lds
  s_add_u32 s51, s95, 162816
  s_waitcnt lgkmcnt(12)
  ds_read_b128 a[108:111], v55 offset:40960
  ds_read_b64_tr_b16 a[80:81], v48 offset:53248
  ds_read_b64_tr_b16 a[82:83], v48 offset:54272
  s_waitcnt lgkmcnt(14)
  v_mfma_f32_32x32x16_bf16 v[96:111], a[56:59], a[100:103], v[96:111]
  buffer_load_dwordx4 v21, s[16:19], s51 offen offset:1024 lds
  s_add_u32 s51, s95, 194560
  s_waitcnt lgkmcnt(13)
  ds_read_b64_tr_b16 a[84:85], v49 offset:53248
  ds_read_b64_tr_b16 a[86:87], v49 offset:54272
  s_waitcnt lgkmcnt(14)
  v_mfma_f32_32x32x16_bf16 v[112:127], a[60:63], a[100:103], v[112:127]
  buffer_load_dwordx4 v21, s[16:19], s51 offen offset:2048 lds
  s_add_u32 s51, s95, 226304
  s_waitcnt lgkmcnt(13)
  ds_read_b64_tr_b16 a[88:89], v50 offset:53248
  ds_read_b64_tr_b16 a[90:91], v50 offset:54272
  s_waitcnt lgkmcnt(13)
  v_mfma_f32_32x32x16_bf16 v[64:79], a[64:67], a[104:107], v[64:79]
  buffer_load_dwordx4 v21, s[16:19], s51 offen offset:3072 lds
  s_add_u32 m0, s33, 0
  ds_read_b64_tr_b16 a[92:93], v51 offset:53248
  ds_read_b64_tr_b16 a[94:95], v51 offset:54272
  s_waitcnt lgkmcnt(13)
  v_mfma_f32_32x32x16_bf16 v[80:95], a[68:71], a[104:107], v[80:95]
  s_add_u32 s51, s96, 0
  buffer_load_dwordx4 v22, s[20:23], s51 offen offset:0 lds
  s_waitcnt lgkmcnt(11)
  v_mfma_f32_32x32x16_bf16 v[96:111], a[72:75], a[104:107], v[96:111]
  s_add_u32 s51, s96, 8192
  s_waitcnt lgkmcnt(9)
  v_mfma_f32_32x32x16_bf16 v[112:127], a[76:79], a[104:107], v[112:127]
  buffer_load_dwordx4 v23, s[20:23], s51 offen offset:1024 lds
  s_waitcnt vmcnt(10) lgkmcnt(0)
  s_barrier
  ds_read_b128 a[96:99], v60 offset:0
  ds_read_b64_tr_b16 a[32:33], v56 offset:0
  ds_read_b64_tr_b16 a[34:35], v56 offset:1024
  ds_read_b64_tr_b16 a[36:37], v57 offset:0
  ds_read_b64_tr_b16 a[38:39], v57 offset:1024
  ds_read_b64_tr_b16 a[40:41], v58 offset:0
  ds_read_b64_tr_b16 a[42:43], v58 offset:1024
  ds_read_b64_tr_b16 a[44:45], v59 offset:0
  ds_read_b64_tr_b16 a[46:47], v59 offset:1024
  v_mfma_f32_32x32x16_bf16 v[64:79], a[80:83], a[108:111], v[64:79]
  s_lshl_b32 s95, s94, 19
  s_add_u32 s95, s95, s30
  s_lshl_b32 s96, s94, 7
  v_mfma_f32_32x32x16_bf16 v[80:95], a[84:87], a[108:111], v[80:95]
  s_add_u32 s96, s96, s32
  s_add_u32 s94, s94, 1
  s_cmp_eq_u32 s94, 9
  ds_read_b128 a[100:103], v61 offset:0
  ds_read_b64_tr_b16 a[48:49], v56 offset:4096
  ds_read_b64_tr_b16 a[50:51], v56 offset:5120
  v_mfma_f32_32x32x16_bf16 v[96:111], a[88:91], a[108:111], v[96:111]
  s_cselect_b32 s94, 0, s94
  s_add_u32 m0, s31, 40960
  ds_read_b64_tr_b16 a[52:53], v57 offset:4096
  ds_read_b64_tr_b16 a[54:55], v57 offset:5120
  v_mfma_f32_32x32x16_bf16 v[112:127], a[92:95], a[108:111], v[112:127]
  s_add_u32 s51, s95, 0
  buffer_load_dwordx4 v21, s[16:19], s51 offen offset:0 lds
  s_waitcnt lgkmcnt(13)
  ds_read_b64_tr_b16 a[56:57], v58 offset:4096
  ds_read_b64_tr_b16 a[58:59], v58 offset:5120
  s_waitcnt lgkmcnt(13)
  v_mfma_f32_32x32x16_bf16 v[64:79], a[32:35], a[96:99], v[64:79]
  s_add_u32 s51, s95, 31744
  buffer_load_dwordx4 v21, s[16:19], s51 offen offset:1024 lds
  ds_read_b64_tr_b16 a[60:61], v59 offset:4096
  ds_read_b64_tr_b16 a[62:63], v59 offset:5120
  s_waitcnt lgkmcnt(13)
  v_mfma_f32_32x32x16_bf16 v[80:95], a[36:39], a[96:99], v[80:95]
  s_add_u32 s51, s95, 63488
  buffer_load_dwordx4 v21, s[16:19], s51 offen offset:2048 lds
  s_waitcnt lgkmcnt(12)
  ds_read_b128 a[104:107], v62 offset:0
  ds_read_b64_tr_b16 a[64:65], v56 offset:8192
  ds_read_b64_tr_b16 a[66:67], v56 offset:9216
  s_waitcnt lgkmcnt(14)
  v_mfma_f32_32x32x16_bf16 v[96:111], a[40:43], a[96:99], v[96:111]
  s_add_u32 s51, s95, 95232
  buffer_load_dwordx4 v21, s[16:19], s51 offen offset:3072 lds
  s_waitcnt lgkmcnt(13)
  ds_read_b64_tr_b16 a[68:69], v57 offset:8192
  ds_read_b64_tr_b16 a[70:71], v57 offset:9216
  s_waitcnt lgkmcnt(14)
  v_mfma_f32_32x32x16_bf16 v[112:127], a[44:47], a[96:99], v[112:127]
  s_add_u32 m0, s31, 45056
  s_add_u32 s51, s95, 131072
  s_waitcnt lgkmcnt(13)
  ds_read_b64_tr_b16 a[72:73], v58 offset:8192
  ds_read_b64_tr_b16 a[74:75], v58 offset:9216
  s_waitcnt lgkmcnt(13)
  v_mfma_f32_32x32x16_bf16 v[64:79], a[48:51], a[100:103], v[64:79]
  buffer_load_dwordx4 v21, s[16:19], s51 offen offset:0 lds
  s_add_u32 s51, s95, 162816
  ds_read_b64_tr_b16 a[76:77], v59 offset:8192
  ds_read_b64_tr_b16 a[78:79], v59 offset:9216
  s_waitcnt lgkmcnt(13)
  v_mfma_f32_32x32x16_bf16 v[80:95], a[52:55], a[100:103], v[80:95]
  buffer_load_dwordx4 v21, s[16:19], s51 offen offset:1024 lds
  s_add_u32 s51, s95, 194560
  s_waitcnt lgkmcnt(12)
  ds_read_b128 a[108:111], v63 offset:0
  ds_read_b64_tr_b16 a[80:81], v56 offset:12288
  ds_read_b64_tr_b16 a[82:83], v56 offset:13312
  s_waitcnt lgkmcnt(14)
  v_mfma_f32_32x32x16_bf16 v[96:111], a[56:59], a[100:103], v[96:111]
  buffer_load_dwordx4 v21, s[16:19], s51 offen offset:2048 lds
  s_add_u32 s51, s95, 226304
  s_waitcnt lgkmcnt(13)
  ds_read_b64_tr_b16 a[84:85], v57 offset:12288
  ds_read_b64_tr_b16 a[86:87], v57 offset:13312
  s_waitcnt lgkmcnt(14)
  v_mfma_f32_32x32x16_bf16 v[112:127], a[60:63], a[100:103], v[112:127]
  buffer_load_dwordx4 v21, s[16:19], s51 offen offset:3072 lds
  s_add_u32 m0, s33, 40960
  s_waitcnt lgkmcnt(13)
  ds_read_b64_tr_b16 a[88:89], v58 offset:12288
  ds_read_b64_tr_b16 a[90:91], v58 offset:13312
  s_waitcnt lgkmcnt(13)
  v_mfma_f32_32x32x16_bf16 v[64:79], a[64:67], a[104:107], v[64:79]
  s_add_u32 s51, s96, 0
  buffer_load_dwordx4 v22, s[20:23], s51 offen offset:0 lds
  ds_read_b64_tr_b16 a[92:93], v59 offset:12288
  ds_read_b64_tr_b16 a[94:95], v59 offset:13312
  s_waitcnt lgkmcnt(13)
  v_mfma_f32_32x32x16_bf16 v[80:95], a[68:71], a[104:107], v[80:95]
  s_add_u32 s51, s96, 8192
  buffer_load_dwordx4 v23, s[20:23], s51 offen offset:1024 lds
  s_waitcnt lgkmcnt(11)
  v_mfma_f32_32x32x16_bf16 v[96:111], a[72:75], a[104:107], v[96:111]
  s_mov_b32 m0, s97
  s_add_u32 s47, s47, 8192
  s_waitcnt lgkmcnt(9)
  v_mfma_f32_32x32x16_bf16 v[112:127], a[76:79], a[104:107], v[112:127]
  buffer_load_dwordx4 v16, s[8:11], s47 offen offset:0 nt lds
  buffer_load_dwordx4 v17, s[8:11], s47 offen offset:1024 nt lds
  s_waitcnt vmcnt(12) lgkmcnt(0)
  s_barrier
  ds_read_b128 a[96:99], v52 offset:0
  ds_read_b64_tr_b16 a[32:33], v48 offset:0
  ds_read_b64_tr_b16 a[34:35], v48 offset:1024
  ds_read_b64_tr_b16 a[36:37], v49 offset:0
  ds_read_b64_tr_b16 a[38:39], v49 offset:1024
  ds_read_b64_tr_b16 a[40:41], v50 offset:0
  ds_read_b64_tr_b16 a[42:43], v50 offset:1024
  ds_read_b64_tr_b16 a[44:45], v51 offset:0
  ds_read_b64_tr_b16 a[46:47], v51 offset:1024
  v_mfma_f32_32x32x16_bf16 v[64:79], a[80:83], a[108:111], v[64:79]
  s_lshl_b32 s95, s94, 19
  s_add_u32 s95, s95, s30
  s_lshl_b32 s96, s94, 7
  v_mfma_f32_32x32x16_bf16 v[80:95], a[84:87], a[108:111], v[80:95]
  s_add_u32 s96, s96, s32
  s_add_u32 s94, s94, 1
  s_cmp_eq_u32 s94, 9
  ds_read_b128 a[100:103], v53 offset:0
  ds_read_b64_tr_b16 a[48:49], v48 offset:4096
  ds_read_b64_tr_b16 a[50:51], v48 offset:5120
  v_mfma_f32_32x32x16_bf16 v[96:111], a[88:91], a[108:111], v[96:111]
  s_cselect_b32 s94, 0, s94
  s_add_u32 m0, s31, 81920
  ds_read_b64_tr_b16 a[52:53], v49 offset:4096
  ds_read_b64_tr_b16 a[54:55], v49 offset:5120
  v_mfma_f32_32x32x16_bf16 v[112:127], a[92:95], a[108:111], v[112:127]
  s_add_u32 s51, s95, 0
  buffer_load_dwordx4 v21, s[16:19], s51 offen offset:0 lds
  s_waitcnt lgkmcnt(13)
  ds_read_b64_tr_b16 a[56:57], v50 offset:4096
  ds_read_b64_tr_b16 a[58:59], v50 offset:5120
  s_waitcnt lgkmcnt(13)
  v_mfma_f32_32x32x16_bf16 v[64:79], a[32:35], a[96:99], v[64:79]
  s_add_u32 s51, s95, 31744
  buffer_load_dwordx4 v21, s[16:19], s51 offen offset:1024 lds
  ds_read_b64_tr_b16 a[60:61], v51 offset:4096
  ds_read_b64_tr_b16 a[62:63], v51 offset:5120
  s_waitcnt lgkmcnt(13)
  v_mfma_f32_32x32x16_bf16 v[80:95], a[36:39], a[96:99], v[80:95]
  s_add_u32 s51, s95, 63488
  buffer_load_dwordx4 v21, s[16:19], s51 offen offset:2048 lds
  s_waitcnt lgkmcnt(12)
  ds_read_b128 a[104:107], v54 offset:0
  ds_read_b64_tr_b16 a[64:65], v48 offset:8192
  ds_read_b64_tr_b16 a[66:67], v48 offset:9216
  s_waitcnt lgkmcnt(14)
  v_mfma_f32_32x32x16_bf16 v[96:111], a[40:43], a[96:99], v[96:111]
  s_add_u32 s51, s95, 95232
  buffer_load_dwordx4 v21, s[16:19], s51 offen offset:3072 lds
  s_waitcnt lgkmcnt(13)
  ds_read_b64_tr_b16 a[68:69], v49 offset:8192
  ds_read_b64_tr_b16 a[70:71], v49 offset:9216
  s_waitcnt lgkmcnt(14)
  v_mfma_f32_32x32x16_bf16 v[112:127], a[44:47], a[96:99], v[112:127]
  s_add_u32 m0, s31, 86016
  s_add_u32 s51, s95, 131072
  s_waitcnt lgkmcnt(13)
  ds_read_b64_tr_b16 a[72:73], v50 offset:8192
  ds_read_b64_tr_b16 a[74:75], v50 offset:9216
  s_waitcnt lgkmcnt(13)
  v_mfma_f32_32x32x16_bf16 v[64:79], a[48:51], a[100:103], v[64:79]
  buffer_load_dwordx4 v21, s[16:19], s51 offen offset:0 lds
  s_add_u32 s51, s95, 162816
  ds_read_b64_tr_b16 a[76:77], v51 offset:8192
  ds_read_b64_tr_b16 a[78:79], v51 offset:9216
  s_waitcnt lgkmcnt(13)
  v_mfma_f32_32x32x16_bf16 v[80:95], a[52:55], a[100:103], v[80:95]
  buffer_load_dwordx4 v21, s[16:19], s51 offen offset:1024 lds
  s_add_u32 s51, s95, 194560
  s_waitcnt lgkmcnt(12)
  ds_read_b128 a[108:111], v55 offset:0
  ds_read_b64_tr_b16 a[80:81], v48 offset:12288
  ds_read_b64_tr_b16 a[82:83], v48 offset:13312
  s_waitcnt lgkmcnt(14)
  v_mfma_f32_32x32x16_bf16 v[96:111], a[56:59], a[100:103], v[96:111]
  buffer_load_dwordx4 v21, s[16:19], s51 offen offset:2048 lds
  s_add_u32 s51, s95, 226304
  s_waitcnt lgkmcnt(13)
  ds_read_b64_tr_b16 a[84:85], v49 offset:12288
  ds_read_b64_tr_b16 a[86:87], v49 offset:13312
  s_waitcnt lgkmcnt(14)
  v_mfma_f32_32x32x16_bf16 v[112:127], a[60:63], a[100:103], v[112:127]
  buffer_load_dwordx4 v21, s[16:19], s51 offen offset:3072 lds
  s_add_u32 m0, s33, 81920
  s_waitcnt lgkmcnt(13)
  ds_read_b64_tr_b16 a[88:89], v50 offset:12288
  ds_read_b64_tr_b16 a[90:91], v50 offset:13312
  s_waitcnt lgkmcnt(13)
  v_mfma_f32_32x32x16_bf16 v[64:79], a[64:67], a[104:107], v[64:79]
  s_add_u32 s51, s96, 0
  buffer_load_dwordx4 v22, s[20:23], s51 offen offset:0 lds
  ds_read_b64_tr_b16 a[92:93], v51 offset:12288
  ds_read_b64_tr_b16 a[94:95], v51 offset:13312
  s_waitcnt lgkmcnt(13)
  v_mfma_f32_32x32x16_bf16 v[80:95], a[68:71], a[104:107], v[80:95]
  s_add_u32 s51, s96, 8192
  buffer_load_dwordx4 v23, s[20:23], s51 offen offset:1024 lds
  s_waitcnt lgkmcnt(11)
  v_mfma_f32_32x32x16_bf16 v[96:111], a[72:75], a[104:107], v[96:111]
  s_mov_b32 m0, s98
  s_add_u32 s47, s47, 8192
  s_waitcnt lgkmcnt(9)
  v_mfma_f32_32x32x16_bf16 v[112:127], a[76:79], a[104:107], v[112:127]
  buffer_load_dwordx4 v16, s[8:11], s47 offen offset:0 nt lds
  buffer_load_dwordx4 v17, s[8:11], s47 offen offset:1024 nt lds
  s_mov_b32 exec_lo, 0x3ffff
  s_mov_b32 exec_hi, 0x0
  buffer_load_dword v246, v245, s[84:87], s91 offen
  s_mov_b64 exec, -1
  s_add_u32 s91, s91, 2304
  s_waitcnt vmcnt(15) lgkmcnt(0)
  s_barrier
  ds_read_b128 a[96:99], v52 offset:40960
  ds_read_b64_tr_b16 a[32:33], v48 offset:40960
  ds_read_b64_tr_b16 a[34:35], v48 offset:41984
  ds_read_b64_tr_b16 a[36:37], v49 offset:40960
  ds_read_b64_tr_b16 a[38:39], v49 offset:41984
  ds_read_b64_tr_b16 a[40:41], v50 offset:40960
  ds_read_b64_tr_b16 a[42:43], v50 offset:41984
  ds_read_b64_tr_b16 a[44:45], v51 offset:40960
  ds_read_b64_tr_b16 a[46:47], v51 offset:41984
  v_mfma_f32_32x32x16_bf16 v[64:79], a[80:83], a[108:111], v[64:79]
  s_lshl_b32 s95, s94, 19
  s_add_u32 s95, s95, s30
  s_lshl_b32 s96, s94, 7
  v_mfma_f32_32x32x16_bf16 v[80:95], a[84:87], a[108:111], v[80:95]
  s_add_u32 s96, s96, s32
  s_add_u32 s94, s94, 1
  s_cmp_eq_u32 s94, 9
  ds_read_b128 a[100:103], v53 offset:40960
  ds_read_b64_tr_b16 a[48:49], v48 offset:45056
  ds_read_b64_tr_b16 a[50:51], v48 offset:46080
  v_mfma_f32_32x32x16_bf16 v[96:111], a[88:91], a[108:111], v[96:111]
  s_cselect_b32 s94, 0, s94
  s_add_u32 m0, s31, 0
  ds_read_b64_tr_b16 a[52:53], v49 offset:45056
  ds_read_b64_tr_b16 a[54:55], v49 offset:46080
  v_mfma_f32_32x32x16_bf16 v[112:127], a[92:95], a[108:111], v[112:127]
  s_add_u32 s51, s95, 0
  buffer_load_dwordx4 v21, s[16:19], s51 offen offset:0 lds
  s_waitcnt lgkmcnt(13)
  ds_read_b64_tr_b16 a[56:57], v50 offset:45056
  ds_read_b64_tr_b16 a[58:59], v50 offset:46080
  s_waitcnt lgkmcnt(13)
  v_mfma_f32_32x32x16_bf16 v[64:79], a[32:35], a[96:99], v[64:79]
  s_add_u32 s51, s95, 31744
  buffer_load_dwordx4 v21, s[16:19], s51 offen offset:1024 lds
  ds_read_b64_tr_b16 a[60:61], v51 offset:45056
  ds_read_b64_tr_b16 a[62:63], v51 offset:46080
  s_waitcnt lgkmcnt(13)
  v_mfma_f32_32x32x16_bf16 v[80:95], a[36:39], a[96:99], v[80:95]
  s_add_u32 s51, s95, 63488
  buffer_load_dwordx4 v21, s[16:19], s51 offen offset:2048 lds
  s_waitcnt lgkmcnt(12)
  ds_read_b128 a[104:107], v54 offset:40960
  ds_read_b64_tr_b16 a[64:65], v48 offset:49152
  ds_read_b64_tr_b16 a[66:67], v48 offset:50176
  s_waitcnt lgkmcnt(14)
  v_mfma_f32_32x32x16_bf16 v[96:111], a[40:43], a[96:99], v[96:111]
  s_add_u32 s51, s95, 95232
  buffer_load_dwordx4 v21, s[16:19], s51 offen offset:3072 lds
  s_waitcnt lgkmcnt(13)
  ds_read_b64_tr_b16 a[68:69], v49 offset:49152
  ds_read_b64_tr_b16 a[70:71], v49 offset:50176
  s_waitcnt lgkmcnt(14)
  v_mfma_f32_32x32x16_bf16 v[112:127], a[44:47], a[96:99], v[112:127]
  s_add_u32 m0, s31, 4096
  s_add_u32 s51, s95, 131072
  s_waitcnt lgkmcnt(13)
  ds_read_b64_tr_b16 a[72:73], v50 offset:49152
  ds_read_b64_tr_b16 a[74:75], v50 offset:50176
  s_waitcnt lgkmcnt(13)
  v_mfma_f32_32x32x16_bf16 v[64:79], a[48:51], a[100:103], v[64:79]
  buffer_load_dwordx4 v21, s[16:19], s51 offen offset:0 lds
  s_add_u32 s51, s95, 162816
  ds_read_b64_tr_b16 a[76:77], v51 offset:49152
  ds_read_b64_tr_b16 a[78:79], v51 offset:50176
  s_waitcnt lgkmcnt(13)
  v_mfma_f32_32x32x16_bf16 v[80:95], a[52:55], a[100:103], v[80:95]
  buffer_load_dwordx4 v21, s[16:19], s51 offen offset:1024 lds
  s_add_u32 s51, s95, 194560
  s_waitcnt lgkmcnt(12)
  ds_read_b128 a[108:111], v55 offset:40960
  ds_read_b64_tr_b16 a[80:81], v48 offset:53248
  ds_read_b64_tr_b16 a[82:83], v48 offset:54272
  s_waitcnt lgkmcnt(14)
  v_mfma_f32_32x32x16_bf16 v[96:111], a[56:59], a[100:103], v[96:111]
  buffer_load_dwordx4 v21, s[16:19], s51 offen offset:2048 lds
  s_add_u32 s51, s95, 226304
  s_waitcnt lgkmcnt(13)
  ds_read_b64_tr_b16 a[84:85], v49 offset:53248
  ds_read_b64_tr_b16 a[86:87], v49 offset:54272
  s_waitcnt lgkmcnt(14)
  v_mfma_f32_32x32x16_bf16 v[112:127], a[60:63], a[100:103], v[112:127]
  buffer_load_dwordx4 v21, s[16:19], s51 offen offset:3072 lds
  s_add_u32 m0, s33, 0
  s_waitcnt lgkmcnt(13)
  ds_read_b64_tr_b16 a[88:89], v50 offset:53248
  ds_read_b64_tr_b16 a[90:91], v50 offset:54272
  s_waitcnt lgkmcnt(13)
  v_mfma_f32_32x32x16_bf16 v[64:79], a[64:67], a[104:107], v[64:79]
  s_add_u32 s51, s96, 0
  buffer_load_dwordx4 v22, s[20:23], s51 offen offset:0 lds
  ds_read_b64_tr_b16 a[92:93], v51 offset:53248
  ds_read_b64_tr_b16 a[94:95], v51 offset:54272
  s_waitcnt lgkmcnt(13)
  v_mfma_f32_32x32x16_bf16 v[80:95], a[68:71], a[104:107], v[80:95]
  s_add_u32 s51, s96, 8192
  buffer_load_dwordx4 v23, s[20:23], s51 offen offset:1024 lds
  s_waitcnt lgkmcnt(11)
  v_mfma_f32_32x32x16_bf16 v[96:111], a[72:75], a[104:107], v[96:111]
  s_mov_b32 m0, s99
  s_add_u32 s47, s47, 8192
  s_waitcnt lgkmcnt(9)
  v_mfma_f32_32x32x16_bf16 v[112:127], a[76:79], a[104:107], v[112:127]
  buffer_load_dwordx4 v16, s[8:11], s47 offen offset:0 nt lds
  buffer_load_dwordx4 v17, s[8:11], s47 offen offset:1024 nt lds
  s_mov_b32 exec_lo, 0x3ffff
  s_mov_b32 exec_hi, 0x0
  buffer_load_dword v246, v245, s[84:87], s91 offen
  s_mov_b64 exec, -1
  s_add_u32 s91, s91, 2304
  s_waitcnt vmcnt(16) lgkmcnt(0)
  s_barrier
  ds_read_b128 a[96:99], v60 offset:0
  ds_read_b64_tr_b16 a[32:33], v56 offset:0
  ds_read_b64_tr_b16 a[34:35], v56 offset:1024
  ds_read_b64_tr_b16 a[36:37], v57 offset:0
  ds_read_b64_tr_b16 a[38:39], v57 offset:1024
  ds_read_b64_tr_b16 a[40:41], v58 offset:0
  ds_read_b64_tr_b16 a[42:43], v58 offset:1024
  ds_read_b64_tr_b16 a[44:45], v59 offset:0
  ds_read_b64_tr_b16 a[46:47], v59 offset:1024
  v_mfma_f32_32x32x16_bf16 v[64:79], a[80:83], a[108:111], v[64:79]
  s_lshl_b32 s95, s94, 19
  s_add_u32 s95, s95, s30
  s_lshl_b32 s96, s94, 7
  v_mfma_f32_32x32x16_bf16 v[80:95], a[84:87], a[108:111], v[80:95]
  s_add_u32 s96, s96, s32
  s_add_u32 s94, s94, 1
  s_cmp_eq_u32 s94, 9
  ds_read_b128 a[100:103], v61 offset:0
  ds_read_b64_tr_b16 a[48:49], v56 offset:4096
  ds_read_b64_tr_b16 a[50:51], v56 offset:5120
  v_mfma_f32_32x32x16_bf16 v[96:111], a[88:91], a[108:111], v[96:111]
  s_cselect_b32 s94, 0, s94
  s_add_u32 m0, s31, 40960
  ds_read_b64_tr_b16 a[52:53], v57 offset:4096
  ds_read_b64_tr_b16 a[54:55], v57 offset:5120
  v_mfma_f32_32x32x16_bf16 v[112:127], a[92:95], a[108:111], v[112:127]
  s_add_u32 s51, s95, 0
  buffer_load_dwordx4 v21, s[16:19], s51 offen offset:0 lds
  s_waitcnt lgkmcnt(13)
  ds_read_b64_tr_b16 a[56:57], v58 offset:4096
  ds_read_b64_tr_b16 a[58:59], v58 offset:5120
  s_waitcnt lgkmcnt(13)
  v_mfma_f32_32x32x16_bf16 v[64:79], a[32:35], a[96:99], v[64:79]
  s_add_u32 s51, s95, 31744
  buffer_load_dwordx4 v21, s[16:19], s51 offen offset:1024 lds
  ds_read_b64_tr_b16 a[60:61], v59 offset:4096
  ds_read_b64_tr_b16 a[62:63], v59 offset:5120
  s_waitcnt lgkmcnt(13)
  v_mfma_f32_32x32x16_bf16 v[80:95], a[36:39], a[96:99], v[80:95]
  s_add_u32 s51, s95, 63488
  buffer_load_dwordx4 v21, s[16:19], s51 offen offset:2048 lds
  s_waitcnt lgkmcnt(12)
  ds_read_b128 a[104:107], v62 offset:0
  ds_read_b64_tr_b16 a[64:65], v56 offset:8192
  ds_read_b64_tr_b16 a[66:67], v56 offset:9216
  s_waitcnt lgkmcnt(14)
  v_mfma_f32_32x32x16_bf16 v[96:111], a[40:43], a[96:99], v[96:111]
  s_add_u32 s51, s95, 95232
  buffer_load_dwordx4 v21, s[16:19], s51 offen offset:3072 lds
  s_waitcnt lgkmcnt(13)
  ds_read_b64_tr_b16 a[68:69], v57 offset:8192
  ds_read_b64_tr_b16 a[70:71], v57 offset:9216
  s_waitcnt lgkmcnt(14)
  v_mfma_f32_32x32x16_bf16 v[112:127], a[44:47], a[96:99], v[112:127]
  s_add_u32 m0, s31, 45056
  s_add_u32 s51, s95, 131072
  s_waitcnt lgkmcnt(13)
  ds_read_b64_tr_b16 a[72:73], v58 offset:8192
  ds_read_b64_tr_b16 a[74:75], v58 offset:9216
  s_waitcnt lgkmcnt(13)
  v_mfma_f32_32x32x16_bf16 v[64:79], a[48:51], a[100:103], v[64:79]
  buffer_load_dwordx4 v21, s[16:19], s51 offen offset:0 lds
  s_add_u32 s51, s95, 162816
  ds_read_b64_tr_b16 a[76:77], v59 offset:8192
  ds_read_b64_tr_b16 a[78:79], v59 offset:9216
  s_waitcnt lgkmcnt(13)
  v_mfma_f32_32x32x16_bf16 v[80:95], a[52:55], a[100:103], v[80:95]
  buffer_load_dwordx4 v21, s[16:19], s51 offen offset:1024 lds
  s_add_u32 s51, s95, 194560
  s_waitcnt lgkmcnt(12)
  ds_read_b128 a[108:111], v63 offset:0
  ds_read_b64_tr_b16 a[80:81], v56 offset:12288
  ds_read_b64_tr_b16 a[82:83], v56 offset:13312
  s_waitcnt lgkmcnt(14)
  v_mfma_f32_32x32x16_bf16 v[96:111], a[56:59], a[100:103], v[96:111]
  buffer_load_dwordx4 v21, s[16:19], s51 offen offset:2048 lds
  s_add_u32 s51, s95, 226304
  s_waitcnt lgkmcnt(13)
  ds_read_b64_tr_b16 a[84:85], v57 offset:12288
  ds_read_b64_tr_b16 a[86:87], v57 offset:13312
  s_waitcnt lgkmcnt(14)
  v_mfma_f32_32x32x16_bf16 v[112:127], a[60:63], a[100:103], v[112:127]
  buffer_load_dwordx4 v21, s[16:19], s51 offen offset:3072 lds
  s_add_u32 m0, s33, 40960
  s_waitcnt lgkmcnt(13)
  ds_read_b64_tr_b16 a[88:89], v58 offset:12288
  ds_read_b64_tr_b16 a[90:91], v58 offset:13312
  s_waitcnt lgkmcnt(13)
  v_mfma_f32_32x32x16_bf16 v[64:79], a[64:67], a[104:107], v[64:79]
  s_add_u32 s51, s96, 0
  buffer_load_dwordx4 v22, s[20:23], s51 offen offset:0 lds
  ds_read_b64_tr_b16 a[92:93], v59 offset:12288
  ds_read_b64_tr_b16 a[94:95], v59 offset:13312
  s_waitcnt lgkmcnt(13)
  v_mfma_f32_32x32x16_bf16 v[80:95], a[68:71], a[104:107], v[80:95]
  s_add_u32 s51, s96, 8192
  buffer_load_dwordx4 v23, s[20:23], s51 offen offset:1024 lds
  s_waitcnt lgkmcnt(11)
  v_mfma_f32_32x32x16_bf16 v[96:111], a[72:75], a[104:107], v[96:111]
  s_mov_b32 m0, s100
  s_add_u32 s48, s48, 8192
  s_waitcnt lgkmcnt(9)
  v_mfma_f32_32x32x16_bf16 v[112:127], a[76:79], a[104:107], v[112:127]
  buffer_load_dwordx4 v20, s[12:15], s48 offen offset:0 nt lds
  buffer_load_dwordx4 v20, s[12:15], s48 offen offset:1024 nt lds
  s_mov_b32 exec_lo, 0x3ffff
  s_mov_b32 exec_hi, 0x0
  buffer_load_dword v246, v245, s[84:87], s91 offen
  s_mov_b64 exec, -1
  s_add_u32 s91, s91, 2304
  s_waitcnt vmcnt(16) lgkmcnt(0)
  s_barrier
  ds_read_b128 a[96:99], v52 offset:0
  ds_read_b64_tr_b16 a[32:33], v48 offset:0
  ds_read_b64_tr_b16 a[34:35], v48 offset:1024
  ds_read_b64_tr_b16 a[36:37], v49 offset:0
  ds_read_b64_tr_b16 a[38:39], v49 offset:1024
  ds_read_b64_tr_b16 a[40:41], v50 offset:0
  ds_read_b64_tr_b16 a[42:43], v50 offset:1024
  ds_read_b64_tr_b16 a[44:45], v51 offset:0
  ds_read_b64_tr_b16 a[46:47], v51 offset:1024
  v_mfma_f32_32x32x16_bf16 v[64:79], a[80:83], a[108:111], v[64:79]
  s_lshl_b32 s95, s94, 19
  s_add_u32 s95, s95, s30
  v_mfma_f32_32x32x16_bf16 v[80:95], a[84:87], a[108:111], v[80:95]
  s_lshl_b32 s96, s94, 7
  s_add_u32 s96, s96, s32
  ds_read_b128 a[100:103], v53 offset:0
  ds_read_b64_tr_b16 a[48:49], v48 offset:4096
  ds_read_b64_tr_b16 a[50:51], v48 offset:5120
  v_mfma_f32_32x32x16_bf16 v[96:111], a[88:91], a[108:111], v[96:111]
  s_add_u32 s94, s94, 1
  s_cmp_eq_u32 s94, 9
  ds_read_b64_tr_b16 a[52:53], v49 offset:4096
  ds_read_b64_tr_b16 a[54:55], v49 offset:5120
  v_mfma_f32_32x32x16_bf16 v[112:127], a[92:95], a[108:111], v[112:127]
  s_cselect_b32 s94, 0, s94
  s_add_u32 m0, s31, 81920
  s_waitcnt lgkmcnt(13)
  ds_read_b64_tr_b16 a[56:57], v50 offset:4096
  ds_read_b64_tr_b16 a[58:59], v50 offset:5120
  s_waitcnt lgkmcnt(13)
  v_mfma_f32_32x32x16_bf16 v[64:79], a[32:35], a[96:99], v[64:79]
  s_add_u32 s51, s95, 0
  buffer_load_dwordx4 v21, s[16:19], s51 offen offset:0 lds
  ds_read_b64_tr_b16 a[60:61], v51 offset:4096
  ds_read_b64_tr_b16 a[62:63], v51 offset:5120
  s_waitcnt lgkmcnt(13)
  v_mfma_f32_32x32x16_bf16 v[80:95], a[36:39], a[96:99], v[80:95]
  s_add_u32 s51, s95, 31744
  buffer_load_dwordx4 v21, s[16:19], s51 offen offset:1024 lds
  s_waitcnt lgkmcnt(12)
  ds_read_b128 a[104:107], v54 offset:0
  ds_read_b64_tr_b16 a[64:65], v48 offset:8192
  ds_read_b64_tr_b16 a[66:67], v48 offset:9216
  s_waitcnt lgkmcnt(14)
  v_mfma_f32_32x32x16_bf16 v[96:111], a[40:43], a[96:99], v[96:111]
  s_add_u32 s51, s95, 63488
  buffer_load_dwordx4 v21, s[16:19], s51 offen offset:2048 lds
  s_waitcnt lgkmcnt(13)
  ds_read_b64_tr_b16 a[68:69], v49 offset:8192
  ds_read_b64_tr_b16 a[70:71], v49 offset:9216
  s_waitcnt lgkmcnt(14)
  v_mfma_f32_32x32x16_bf16 v[112:127], a[44:47], a[96:99], v[112:127]
  s_add_u32 s51, s95, 95232
  buffer_load_dwordx4 v21, s[16:19], s51 offen offset:3072 lds
  s_waitcnt lgkmcnt(13)
  ds_read_b64_tr_b16 a[72:73], v50 offset:8192
  ds_read_b64_tr_b16 a[74:75], v50 offset:9216
  s_waitcnt lgkmcnt(13)
  v_mfma_f32_32x32x16_bf16 v[64:79], a[48:51], a[100:103], v[64:79]
  s_add_u32 m0, s31, 86016
  s_add_u32 s51, s95, 131072
  ds_read_b64_tr_b16 a[76:77], v51 offset:8192
  ds_read_b64_tr_b16 a[78:79], v51 offset:9216
  s_waitcnt lgkmcnt(13)
  v_mfma_f32_32x32x16_bf16 v[80:95], a[52:55], a[100:103], v[80:95]
  buffer_load_dwordx4 v21, s[16:19], s51 offen offset:0 lds
  s_add_u32 s51, s95, 162816
  s_waitcnt lgkmcnt(12)
  ds_read_b128 a[108:111], v55 offset:0
  ds_read_b64_tr_b16 a[80:81], v48 offset:12288
  ds_read_b64_tr_b16 a[82:83], v48 offset:13312
  s_waitcnt lgkmcnt(14)
  v_mfma_f32_32x32x16_bf16 v[96:111], a[56:59], a[100:103], v[96:111]
  buffer_load_dwordx4 v21, s[16:19], s51 offen offset:1024 lds
  s_add_u32 s51, s95, 194560
  s_waitcnt lgkmcnt(13)
  ds_read_b64_tr_b16 a[84:85], v49 offset:12288
  ds_read_b64_tr_b16 a[86:87], v49 offset:13312
  s_waitcnt lgkmcnt(14)
  v_mfma_f32_32x32x16_bf16 v[112:127], a[60:63], a[100:103], v[112:127]
  buffer_load_dwordx4 v21, s[16:19], s51 offen offset:2048 lds
  s_add_u32 s51, s95, 226304
  s_waitcnt lgkmcnt(13)
  ds_read_b64_tr_b16 a[88:89], v50 offset:12288
  ds_read_b64_tr_b16 a[90:91], v50 offset:13312
  s_waitcnt lgkmcnt(13)
  v_mfma_f32_32x32x16_bf16 v[64:79], a[64:67], a[104:107], v[64:79]
  buffer_load_dwordx4 v21, s[16:19], s51 offen offset:3072 lds
  s_add_u32 m0, s33, 81920
  ds_read_b64_tr_b16 a[92:93], v51 offset:12288
  ds_read_b64_tr_b16 a[94:95], v51 offset:13312
  s_waitcnt lgkmcnt(13)
  v_mfma_f32_32x32x16_bf16 v[80:95], a[68:71], a[104:107], v[80:95]
  s_add_u32 s51, s96, 0
  buffer_load_dwordx4 v22, s[20:23], s51 offen offset:0 lds
  s_waitcnt lgkmcnt(11)
  v_mfma_f32_32x32x16_bf16 v[96:111], a[72:75], a[104:107], v[96:111]
  s_add_u32 s51, s96, 8192
  s_waitcnt lgkmcnt(9)
  v_mfma_f32_32x32x16_bf16 v[112:127], a[76:79], a[104:107], v[112:127]
  buffer_load_dwordx4 v23, s[20:23], s51 offen offset:1024 lds
  s_mov_b32 exec_lo, 0x3ffff
  s_mov_b32 exec_hi, 0x0
  buffer_load_dword v246, v245, s[84:87], s91 offen
  s_mov_b64 exec, -1
  s_add_u32 s91, s91, 2304
  s_waitcnt vmcnt(14) lgkmcnt(0)
  s_barrier
  ds_read_b128 a[96:99], v52 offset:40960
  ds_read_b64_tr_b16 a[32:33], v48 offset:40960
  ds_read_b64_tr_b16 a[34:35], v48 offset:41984
  ds_read_b64_tr_b16 a[36:37], v49 offset:40960
  ds_read_b64_tr_b16 a[38:39], v49 offset:41984
  ds_read_b64_tr_b16 a[40:41], v50 offset:40960
  ds_read_b64_tr_b16 a[42:43], v50 offset:41984
  ds_read_b64_tr_b16 a[44:45], v51 offset:40960
  ds_read_b64_tr_b16 a[46:47], v51 offset:41984
  v_mfma_f32_32x32x16_bf16 v[64:79], a[80:83], a[108:111], v[64:79]
  s_add_u32 m0, s29, 0
  v_mfma_f32_32x32x16_bf16 v[80:95], a[84:87], a[108:111], v[80:95]
  s_add_u32 s47, s47, 8192
  ds_read_b128 a[100:103], v53 offset:40960
  ds_read_b64_tr_b16 a[48:49], v48 offset:45056
  ds_read_b64_tr_b16 a[50:51], v48 offset:46080
  v_mfma_f32_32x32x16_bf16 v[96:111], a[88:91], a[108:111], v[96:111]
  buffer_load_dwordx4 v16, s[8:11], s47 offen offset:0 nt lds
  ds_read_b64_tr_b16 a[52:53], v49 offset:45056
  ds_read_b64_tr_b16 a[54:55], v49 offset:46080
  v_mfma_f32_32x32x16_bf16 v[112:127], a[92:95], a[108:111], v[112:127]
  buffer_load_dwordx4 v17, s[8:11], s47 offen offset:1024 nt lds
  s_waitcnt lgkmcnt(13)
  ds_read_b64_tr_b16 a[56:57], v50 offset:45056
  ds_read_b64_tr_b16 a[58:59], v50 offset:46080
  s_waitcnt lgkmcnt(13)
  v_mfma_f32_32x32x16_bf16 v[64:79], a[32:35], a[96:99], v[64:79]
  s_add_u32 m0, s29, 8192
  ds_read_b64_tr_b16 a[60:61], v51 offset:45056
  ds_read_b64_tr_b16 a[62:63], v51 offset:46080
  s_waitcnt lgkmcnt(13)
  v_mfma_f32_32x32x16_bf16 v[80:95], a[36:39], a[96:99], v[80:95]
  s_add_u32 s48, s48, 8192
  s_waitcnt lgkmcnt(12)
  ds_read_b128 a[104:107], v54 offset:40960
  ds_read_b64_tr_b16 a[64:65], v48 offset:49152
  ds_read_b64_tr_b16 a[66:67], v48 offset:50176
  s_waitcnt lgkmcnt(14)
  v_mfma_f32_32x32x16_bf16 v[96:111], a[40:43], a[96:99], v[96:111]
  buffer_load_dwordx4 v20, s[12:15], s48 offen offset:0 nt lds
  s_waitcnt lgkmcnt(13)
  ds_read_b64_tr_b16 a[68:69], v49 offset:49152
  ds_read_b64_tr_b16 a[70:71], v49 offset:50176
  s_waitcnt lgkmcnt(14)
  v_mfma_f32_32x32x16_bf16 v[112:127], a[44:47], a[96:99], v[112:127]
  buffer_load_dwordx4 v20, s[12:15], s48 offen offset:1024 nt lds
  s_waitcnt lgkmcnt(13)
  ds_read_b64_tr_b16 a[72:73], v50 offset:49152
  ds_read_b64_tr_b16 a[74:75], v50 offset:50176
  s_waitcnt lgkmcnt(13)
  v_mfma_f32_32x32x16_bf16 v[64:79], a[48:51], a[100:103], v[64:79]
  ds_read_b64_tr_b16 a[76:77], v51 offset:49152
  ds_read_b64_tr_b16 a[78:79], v51 offset:50176
  s_waitcnt lgkmcnt(13)
  v_mfma_f32_32x32x16_bf16 v[80:95], a[52:55], a[100:103], v[80:95]
  s_waitcnt lgkmcnt(12)
  ds_read_b128 a[108:111], v55 offset:40960
  ds_read_b64_tr_b16 a[80:81], v48 offset:53248
  ds_read_b64_tr_b16 a[82:83], v48 offset:54272
  s_waitcnt lgkmcnt(14)
  v_mfma_f32_32x32x16_bf16 v[96:111], a[56:59], a[100:103], v[96:111]
  s_waitcnt lgkmcnt(13)
  ds_read_b64_tr_b16 a[84:85], v49 offset:53248
  ds_read_b64_tr_b16 a[86:87], v49 offset:54272
  s_waitcnt lgkmcnt(14)
  v_mfma_f32_32x32x16_bf16 v[112:127], a[60:63], a[100:103], v[112:127]
  s_waitcnt lgkmcnt(13)
  ds_read_b64_tr_b16 a[88:89], v50 offset:53248
  ds_read_b64_tr_b16 a[90:91], v50 offset:54272
  s_waitcnt lgkmcnt(13)
  v_mfma_f32_32x32x16_bf16 v[64:79], a[64:67], a[104:107], v[64:79]
  ds_read_b64_tr_b16 a[92:93], v51 offset:53248
  ds_read_b64_tr_b16 a[94:95], v51 offset:54272
  s_waitcnt lgkmcnt(13)
  v_mfma_f32_32x32x16_bf16 v[80:95], a[68:71], a[104:107], v[80:95]
  s_waitcnt lgkmcnt(11)
  v_mfma_f32_32x32x16_bf16 v[96:111], a[72:75], a[104:107], v[96:111]
  s_waitcnt lgkmcnt(9)
  v_mfma_f32_32x32x16_bf16 v[112:127], a[76:79], a[104:107], v[112:127]
  s_waitcnt vmcnt(5) lgkmcnt(0)
  s_barrier
  ds_read_b128 a[96:99], v60 offset:0
  ds_read_b64_tr_b16 a[32:33], v56 offset:0
  ds_read_b64_tr_b16 a[34:35], v56 offset:1024
  ds_read_b64_tr_b16 a[36:37], v57 offset:0
  ds_read_b64_tr_b16 a[38:39], v57 offset:1024
  ds_read_b64_tr_b16 a[40:41], v58 offset:0
  ds_read_b64_tr_b16 a[42:43], v58 offset:1024
  ds_read_b64_tr_b16 a[44:45], v59 offset:0
  ds_read_b64_tr_b16 a[46:47], v59 offset:1024
  v_mfma_f32_32x32x16_bf16 v[64:79], a[80:83], a[108:111], v[64:79]
  s_add_u32 m0, s29, 40960
  v_mfma_f32_32x32x16_bf16 v[80:95], a[84:87], a[108:111], v[80:95]
  s_add_u32 s47, s47, 8192
  ds_read_b128 a[100:103], v61 offset:0
  ds_read_b64_tr_b16 a[48:49], v56 offset:4096
  ds_read_b64_tr_b16 a[50:51], v56 offset:5120
  v_mfma_f32_32x32x16_bf16 v[96:111], a[88:91], a[108:111], v[96:111]
  buffer_load_dwordx4 v16, s[8:11], s47 offen offset:0 nt lds
  ds_read_b64_tr_b16 a[52:53], v57 offset:4096
  ds_read_b64_tr_b16 a[54:55], v57 offset:5120
  v_mfma_f32_32x32x16_bf16 v[112:127], a[92:95], a[108:111], v[112:127]
  buffer_load_dwordx4 v17, s[8:11], s47 offen offset:1024 nt lds
  s_waitcnt lgkmcnt(13)
  ds_read_b64_tr_b16 a[56:57], v58 offset:4096
  ds_read_b64_tr_b16 a[58:59], v58 offset:5120
  s_waitcnt lgkmcnt(13)
  v_mfma_f32_32x32x16_bf16 v[64:79], a[32:35], a[96:99], v[64:79]
  s_add_u32 m0, s29, 49152
  ds_read_b64_tr_b16 a[60:61], v59 offset:4096
  ds_read_b64_tr_b16 a[62:63], v59 offset:5120
  s_waitcnt lgkmcnt(13)
  v_mfma_f32_32x32x16_bf16 v[80:95], a[36:39], a[96:99], v[80:95]
  s_add_u32 s48, s48, 8192
  s_waitcnt lgkmcnt(12)
  ds_read_b128 a[104:107], v62 offset:0
  ds_read_b64_tr_b16 a[64:65], v56 offset:8192
  ds_read_b64_tr_b16 a[66:67], v56 offset:9216
  s_waitcnt lgkmcnt(14)
  v_mfma_f32_32x32x16_bf16 v[96:111], a[40:43], a[96:99], v[96:111]
  buffer_load_dwordx4 v20, s[12:15], s48 offen offset:0 nt lds
  s_waitcnt lgkmcnt(13)
  ds_read_b64_tr_b16 a[68:69], v57 offset:8192
  ds_read_b64_tr_b16 a[70:71], v57 offset:9216
  s_waitcnt lgkmcnt(14)
  v_mfma_f32_32x32x16_bf16 v[112:127], a[44:47], a[96:99], v[112:127]
  buffer_load_dwordx4 v20, s[12:15], s48 offen offset:1024 nt lds
  s_waitcnt lgkmcnt(13)
  ds_read_b64_tr_b16 a[72:73], v58 offset:8192
  ds_read_b64_tr_b16 a[74:75], v58 offset:9216
  s_waitcnt lgkmcnt(13)
  v_mfma_f32_32x32x16_bf16 v[64:79], a[48:51], a[100:103], v[64:79]
  ds_read_b64_tr_b16 a[76:77], v59 offset:8192
  ds_read_b64_tr_b16 a[78:79], v59 offset:9216
  s_waitcnt lgkmcnt(13)
  v_mfma_f32_32x32x16_bf16 v[80:95], a[52:55], a[100:103], v[80:95]
  s_waitcnt lgkmcnt(12)
  ds_read_b128 a[108:111], v63 offset:0
  ds_read_b64_tr_b16 a[80:81], v56 offset:12288
  ds_read_b64_tr_b16 a[82:83], v56 offset:13312
  s_waitcnt lgkmcnt(14)
  v_mfma_f32_32x32x16_bf16 v[96:111], a[56:59], a[100:103], v[96:111]
  s_waitcnt lgkmcnt(13)
  ds_read_b64_tr_b16 a[84:85], v57 offset:12288
  ds_read_b64_tr_b16 a[86:87], v57 offset:13312
  s_waitcnt lgkmcnt(14)
  v_mfma_f32_32x32x16_bf16 v[112:127], a[60:63], a[100:103], v[112:127]
  s_waitcnt lgkmcnt(13)
  ds_read_b64_tr_b16 a[88:89], v58 offset:12288
  ds_read_b64_tr_b16 a[90:91], v58 offset:13312
  s_waitcnt lgkmcnt(13)
  v_mfma_f32_32x32x16_bf16 v[64:79], a[64:67], a[104:107], v[64:79]
  ds_read_b64_tr_b16 a[92:93], v59 offset:12288
  ds_read_b64_tr_b16 a[94:95], v59 offset:13312
  s_waitcnt lgkmcnt(13)
  v_mfma_f32_32x32x16_bf16 v[80:95], a[68:71], a[104:107], v[80:95]
  s_waitcnt lgkmcnt(11)
  v_mfma_f32_32x32x16_bf16 v[96:111], a[72:75], a[104:107], v[96:111]
  s_waitcnt lgkmcnt(9)
  v_mfma_f32_32x32x16_bf16 v[112:127], a[76:79], a[104:107], v[112:127]
  s_sub_u32 s55, s97, s29
  v_add_u32 v233, s55, v24
  v_add_u32 v234, s55, v25
  v_add_u32 v235, s55, v26
  v_add_u32 v236, s55, v27
  v_add_u32 v237, s55, v28
  v_add_u32 v238, s55, v29
  v_add_u32 v239, s55, v30
  v_add_u32 v240, s55, v31
  s_waitcnt vmcnt(58) lgkmcnt(0)
  s_barrier
  ds_read_b128 a[32:35], v233
  ds_read_b128 a[36:39], v234
  ds_read_b128 a[40:43], v235
  ds_read_b128 a[44:47], v236
  ds_read_b128 a[48:51], v237
  ds_read_b128 a[52:55], v238
  ds_read_b128 a[56:59], v239
  ds_read_b128 a[60:63], v240
  v_mfma_f32_32x32x16_bf16 v[64:79], a[80:83], a[108:111], v[64:79]
  s_add_u32 m0, s29, 81920
  s_add_u32 s47, s47, 8192
  v_mfma_f32_32x32x16_bf16 v[80:95], a[84:87], a[108:111], v[80:95]
  buffer_load_dwordx4 v16, s[8:11], s47 offen offset:0 nt lds
  buffer_load_dwordx4 v17, s[8:11], s47 offen offset:1024 nt lds
  v_mfma_f32_32x32x16_bf16 v[96:111], a[88:91], a[108:111], v[96:111]
  s_add_u32 m0, s29, 90112
  s_add_u32 s48, s48, 8192
  v_mfma_f32_32x32x16_bf16 v[112:127], a[92:95], a[108:111], v[112:127]
  buffer_load_dwordx4 v20, s[12:15], s48 offen offset:0 nt lds
  buffer_load_dwordx4 v20, s[12:15], s48 offen offset:1024 nt lds
  s_mov_b32 s16, s36
  s_and_b32 s17, s37, 0xffff
  s_mov_b32 s18, 0x480000
  s_mov_b32 s19, 0x20000
  s_mov_b32 s20, s38
  s_and_b32 s21, s39, 0xffff
  s_mov_b32 s22, 0x120000
  s_mov_b32 s23, 0x20000
  v_mov_b32 v2, 0x3e0293ee
  v_mov_b32 v3, 0x3e0293ee
  s_sub_u32 s55, s98, s29
  v_add_u32 v233, s55, v24
  v_add_u32 v234, s55, v25
  v_add_u32 v235, s55, v26
  v_add_u32 v236, s55, v27
  v_add_u32 v237, s55, v28
  v_add_u32 v238, s55, v29
  v_add_u32 v239, s55, v30
  v_add_u32 v240, s55, v31
  s_nop 1
  v_pk_mul_f32 v[64:65], v[64:65], v[2:3]
  v_pk_mul_f32 v[66:67], v[66:67], v[2:3]
  v_pk_mul_f32 v[68:69], v[68:69], v[2:3]
  v_pk_mul_f32 v[70:71], v[70:71], v[2:3]
  v_cvt_pk_bf16_f32 v176, v64, v65
  v_cvt_pk_bf16_f32 v177, v66, v67
  v_cvt_pk_bf16_f32 v178, v68, v69
  v_cvt_pk_bf16_f32 v179, v70, v71
  v_pk_mul_f32 v[72:73], v[72:73], v[2:3]
  v_pk_mul_f32 v[74:75], v[74:75], v[2:3]
  v_pk_mul_f32 v[76:77], v[76:77], v[2:3]
  v_pk_mul_f32 v[78:79], v[78:79], v[2:3]
  v_cvt_pk_bf16_f32 v180, v72, v73
  v_cvt_pk_bf16_f32 v181, v74, v75
  v_cvt_pk_bf16_f32 v182, v76, v77
  v_cvt_pk_bf16_f32 v183, v78, v79
  v_pk_mul_f32 v[80:81], v[80:81], v[2:3]
  v_pk_mul_f32 v[82:83], v[82:83], v[2:3]
  v_pk_mul_f32 v[84:85], v[84:85], v[2:3]
  v_pk_mul_f32 v[86:87], v[86:87], v[2:3]
  v_cvt_pk_bf16_f32 v184, v80, v81
  v_cvt_pk_bf16_f32 v185, v82, v83
  v_cvt_pk_bf16_f32 v186, v84, v85
  v_cvt_pk_bf16_f32 v187, v86, v87
  v_pk_mul_f32 v[88:89], v[88:89], v[2:3]
  v_pk_mul_f32 v[90:91], v[90:91], v[2:3]
  v_pk_mul_f32 v[92:93], v[92:93], v[2:3]
  v_pk_mul_f32 v[94:95], v[94:95], v[2:3]
  v_cvt_pk_bf16_f32 v188, v88, v89
  v_cvt_pk_bf16_f32 v189, v90, v91
  v_cvt_pk_bf16_f32 v190, v92, v93
  v_cvt_pk_bf16_f32 v191, v94, v95
  v_pk_mul_f32 v[96:97], v[96:97], v[2:3]
  v_pk_mul_f32 v[98:99], v[98:99], v[2:3]
  v_pk_mul_f32 v[100:101], v[100:101], v[2:3]
  v_pk_mul_f32 v[102:103], v[102:103], v[2:3]
  v_cvt_pk_bf16_f32 v192, v96, v97
  v_cvt_pk_bf16_f32 v193, v98, v99
  v_cvt_pk_bf16_f32 v194, v100, v101
  v_cvt_pk_bf16_f32 v195, v102, v103
  v_pk_mul_f32 v[104:105], v[104:105], v[2:3]
  v_pk_mul_f32 v[106:107], v[106:107], v[2:3]
  v_pk_mul_f32 v[108:109], v[108:109], v[2:3]
  v_pk_mul_f32 v[110:111], v[110:111], v[2:3]
  v_cvt_pk_bf16_f32 v196, v104, v105
  v_cvt_pk_bf16_f32 v197, v106, v107
  v_cvt_pk_bf16_f32 v198, v108, v109
  v_cvt_pk_bf16_f32 v199, v110, v111
  v_pk_mul_f32 v[112:113], v[112:113], v[2:3]
  v_pk_mul_f32 v[114:115], v[114:115], v[2:3]
  v_pk_mul_f32 v[116:117], v[116:117], v[2:3]
  v_pk_mul_f32 v[118:119], v[118:119], v[2:3]
  v_cvt_pk_bf16_f32 v200, v112, v113
  v_cvt_pk_bf16_f32 v201, v114, v115
  v_cvt_pk_bf16_f32 v202, v116, v117
  v_cvt_pk_bf16_f32 v203, v118, v119
  v_pk_mul_f32 v[120:121], v[120:121], v[2:3]
  v_pk_mul_f32 v[122:123], v[122:123], v[2:3]
  v_pk_mul_f32 v[124:125], v[124:125], v[2:3]
  v_pk_mul_f32 v[126:127], v[126:127], v[2:3]
  v_cvt_pk_bf16_f32 v204, v120, v121
  v_cvt_pk_bf16_f32 v205, v122, v123
  v_cvt_pk_bf16_f32 v206, v124, v125
  v_cvt_pk_bf16_f32 v207, v126, v127
  s_waitcnt vmcnt(50) lgkmcnt(0)
  s_barrier
  v_mfma_f32_32x32x16_bf16 v[128:143], a[32:35], v[176:179], v[208:223]
  v_mfma_f32_32x32x16_bf16 v[128:143], a[36:39], v[180:183], v[128:143]
  v_mfma_f32_32x32x16_bf16 v[128:143], a[40:43], v[184:187], v[128:143]
  v_mfma_f32_32x32x16_bf16 v[128:143], a[44:47], v[188:191], v[128:143]
  v_mfma_f32_32x32x16_bf16 v[128:143], a[48:51], v[192:195], v[128:143]
  v_mfma_f32_32x32x16_bf16 v[128:143], a[52:55], v[196:199], v[128:143]
  v_mfma_f32_32x32x16_bf16 v[128:143], a[56:59], v[200:203], v[128:143]
  v_mfma_f32_32x32x16_bf16 v[128:143], a[60:63], v[204:207], v[128:143]
  ds_read_b128 a[32:35], v233 offset:0
  ds_read_b128 a[36:39], v234 offset:0
  ds_read_b128 a[40:43], v235 offset:0
  ds_read_b128 a[44:47], v236 offset:0
  ds_read_b128 a[48:51], v237 offset:0
  ds_read_b128 a[52:55], v238 offset:0
  ds_read_b128 a[56:59], v239 offset:0
  ds_read_b128 a[60:63], v240 offset:0
  s_sub_u32 s55, s99, s29
  v_add_u32 v233, s55, v24
  v_add_u32 v234, s55, v25
  v_add_u32 v235, s55, v26
  v_add_u32 v236, s55, v27
  v_add_u32 v237, s55, v28
  v_add_u32 v238, s55, v29
  v_add_u32 v239, s55, v30
  v_add_u32 v240, s55, v31
  s_sub_u32 s55, s100, s29
  s_sub_u32 s55, s55, 8192
  v_add_u32 v241, s55, v32
  v_add_u32 v242, s55, v33
  v_add_u32 v243, s55, v34
  v_add_u32 v244, s55, v35
  v_max3_f32 v168, v128, v129, v130
  v_max3_f32 v169, v131, v132, v133
  v_max3_f32 v170, v134, v135, v136
  v_max3_f32 v171, v137, v138, v139
  v_max3_f32 v172, v140, v141, v142
  v_max3_f32 v168, v168, v169, v170
  v_max3_f32 v171, v171, v172, v143
  v_max_f32 v168, v168, v171
  v_mov_b32 v169, v168
  s_nop 1
  v_permlane32_swap_b32 v168, v169
  v_max_f32 v168, v168, v169
  v_sub_f32 v208, v208, v168
  v_sub_f32 v128, v128, v168
  v_sub_f32 v129, v129, v168
  v_sub_f32 v130, v130, v168
  v_sub_f32 v131, v131, v168
  v_sub_f32 v132, v132, v168
  v_sub_f32 v133, v133, v168
  v_sub_f32 v134, v134, v168
  v_sub_f32 v135, v135, v168
  v_sub_f32 v136, v136, v168
  v_sub_f32 v137, v137, v168
  v_sub_f32 v138, v138, v168
  v_sub_f32 v139, v139, v168
  v_sub_f32 v140, v140, v168
  v_sub_f32 v141, v141, v168
  v_sub_f32 v142, v142, v168
  v_sub_f32 v143, v143, v168
  v_mov_b32 v209, v208
  v_mov_b32 v210, v208
  v_mov_b32 v211, v208
  v_mov_b32 v212, v208
  v_mov_b32 v213, v208
  v_mov_b32 v214, v208
  v_mov_b32 v215, v208
  v_mov_b32 v216, v208
  v_mov_b32 v217, v208
  v_mov_b32 v218, v208
  v_mov_b32 v219, v208
  v_mov_b32 v220, v208
  v_mov_b32 v221, v208
  v_mov_b32 v222, v208
  v_mov_b32 v223, v208
  s_nop 1
  s_waitcnt vmcnt(24) lgkmcnt(0)
  s_barrier
  v_mfma_f32_32x32x16_bf16 v[144:159], a[32:35], v[176:179], v[208:223]
  ds_read_b64_tr_b16 a[64:65], v241 offset:0
  ds_read_b64_tr_b16 a[66:67], v241 offset:2048
  ds_read_b64_tr_b16 a[68:69], v242 offset:0
  ds_read_b64_tr_b16 a[70:71], v242 offset:2048
  v_exp_f32 v128, v128
  v_exp_f32 v129, v129
  v_mfma_f32_32x32x16_bf16 v[144:159], a[36:39], v[180:183], v[144:159]
  ds_read_b64_tr_b16 a[72:73], v243 offset:0
  ds_read_b64_tr_b16 a[74:75], v243 offset:2048
  ds_read_b64_tr_b16 a[76:77], v244 offset:0
  ds_read_b64_tr_b16 a[78:79], v244 offset:2048
  v_exp_f32 v130, v130
  v_exp_f32 v131, v131
  v_mfma_f32_32x32x16_bf16 v[144:159], a[40:43], v[184:187], v[144:159]
  ds_read_b64_tr_b16 a[80:81], v241 offset:4096
  ds_read_b64_tr_b16 a[82:83], v241 offset:6144
  ds_read_b64_tr_b16 a[84:85], v242 offset:4096
  ds_read_b64_tr_b16 a[86:87], v242 offset:6144
  v_cvt_pk_bf16_f32 v160, v128, v129
  v_exp_f32 v132, v132
  v_mfma_f32_32x32x16_bf16 v[144:159], a[44:47], v[188:191], v[144:159]
  s_waitcnt lgkmcnt(8)
  ds_read_b64_tr_b16 a[88:89], v243 offset:4096
  ds_read_b64_tr_b16 a[90:91], v243 offset:6144
  ds_read_b64_tr_b16 a[92:93], v244 offset:4096
  ds_read_b64_tr_b16 a[94:95], v244 offset:6144
  v_exp_f32 v133, v133
  v_mfma_f32_32x32x16_bf16 v[144:159], a[48:51], v[192:195], v[144:159]
  v_cvt_pk_bf16_f32 v161, v130, v131
  v_exp_f32 v134, v134
  v_exp_f32 v135, v135
  v_cvt_pk_bf16_f32 v162, v132, v133
  v_exp_f32 v136, v136
  v_mfma_f32_32x32x16_bf16 v[144:159], a[52:55], v[196:199], v[144:159]
  v_exp_f32 v137, v137
  v_cvt_pk_bf16_f32 v163, v134, v135
  v_exp_f32 v138, v138
  v_exp_f32 v139, v139
  v_mfma_f32_32x32x16_bf16 v[144:159], a[56:59], v[200:203], v[144:159]
  v_cvt_pk_bf16_f32 v164, v136, v137
  v_exp_f32 v140, v140
  v_exp_f32 v141, v141
  v_cvt_pk_bf16_f32 v165, v138, v139
  v_mfma_f32_32x32x16_bf16 v[144:159], a[60:63], v[204:207], v[144:159]
  v_exp_f32 v142, v142
  v_exp_f32 v143, v143
  v_cvt_pk_bf16_f32 v166, v140, v141
  s_nop 0
  v_cvt_pk_bf16_f32 v167, v142, v143
  s_waitcnt lgkmcnt(8)
  v_mfma_f32_32x32x16_bf16 v[64:79], a[64:67], v[160:163], 0
  ds_read_b128 a[32:35], v233 offset:0
  ds_read_b128 a[36:39], v234 offset:0
  v_add_f32 v10, v10, v128
  v_add_f32 v10, v10, v129
  v_add_f32 v10, v10, v130
  v_mfma_f32_32x32x16_bf16 v[80:95], a[68:71], v[160:163], 0
  ds_read_b128 a[40:43], v235 offset:0
  ds_read_b128 a[44:47], v236 offset:0
  v_add_f32 v10, v10, v131
  v_add_f32 v10, v10, v132
  v_mfma_f32_32x32x16_bf16 v[96:111], a[72:75], v[160:163], 0
  v_add_f32 v10, v10, v133
  v_add_f32 v10, v10, v134
  v_add_f32 v10, v10, v135
  v_add_f32 v10, v10, v136
  v_add_f32 v10, v10, v137
  v_mfma_f32_32x32x16_bf16 v[112:127], a[76:79], v[160:163], 0
  v_max3_f32 v168, v144, v145, v146
  v_add_f32 v10, v10, v138
  v_max3_f32 v169, v147, v148, v149
  v_add_f32 v10, v10, v139
  v_add_f32 v10, v10, v140
  s_waitcnt lgkmcnt(4)
  v_mfma_f32_32x32x16_bf16 v[64:79], a[80:83], v[164:167], v[64:79]
  ds_read_b128 a[48:51], v237 offset:0
  ds_read_b128 a[52:55], v238 offset:0
  v_add_f32 v10, v10, v141
  v_add_f32 v10, v10, v142
  v_add_f32 v10, v10, v143
  v_mfma_f32_32x32x16_bf16 v[80:95], a[84:87], v[164:167], v[80:95]
  ds_read_b128 a[56:59], v239 offset:0
  ds_read_b128 a[60:63], v240 offset:0
  v_max3_f32 v170, v150, v151, v152
  v_max3_f32 v171, v153, v154, v155
  v_mfma_f32_32x32x16_bf16 v[96:111], a[88:91], v[164:167], v[96:111]
  v_max3_f32 v172, v156, v157, v158
  v_max3_f32 v168, v168, v169, v170
  v_max3_f32 v171, v171, v172, v159
  v_max_f32 v168, v168, v171
  v_mov_b32 v169, v168
  v_mfma_f32_32x32x16_bf16 v[112:127], a[92:95], v[164:167], v[112:127]
  s_nop 1
  v_permlane32_swap_b32 v168, v169
  v_max_f32 v168, v168, v169
  v_cmp_lt_f32 vcc, s50, v168
  s_cbranch_vccnz L_resc_2
L_back_3:
  s_mov_b32 s46, 6
L_loopA:
  s_waitcnt vmcnt(8) lgkmcnt(0)
  s_barrier
  v_mfma_f32_32x32x16_bf16 v[128:143], a[32:35], v[176:179], v[208:223]
  ds_read_b64_tr_b16 a[64:65], v32 offset:0
  ds_read_b64_tr_b16 a[66:67], v32 offset:2048
  ds_read_b64_tr_b16 a[68:69], v33 offset:0
  ds_read_b64_tr_b16 a[70:71], v33 offset:2048
  v_exp_f32 v144, v144
  s_add_u32 m0, s29, 122880
  v_exp_f32 v145, v145
  v_mfma_f32_32x32x16_bf16 v[128:143], a[36:39], v[180:183], v[128:143]
  ds_read_b64_tr_b16 a[72:73], v34 offset:0
  ds_read_b64_tr_b16 a[74:75], v34 offset:2048
  ds_read_b64_tr_b16 a[76:77], v35 offset:0
  ds_read_b64_tr_b16 a[78:79], v35 offset:2048
  v_exp_f32 v146, v146
  v_exp_f32 v147, v147
  v_mfma_f32_32x32x16_bf16 v[128:143], a[40:43], v[184:187], v[128:143]
  ds_read_b64_tr_b16 a[80:81], v32 offset:4096
  ds_read_b64_tr_b16 a[82:83], v32 offset:6144
  ds_read_b64_tr_b16 a[84:85], v33 offset:4096
  ds_read_b64_tr_b16 a[86:87], v33 offset:6144
  v_cvt_pk_bf16_f32 v160, v144, v145
  v_exp_f32 v148, v148
  v_mfma_f32_32x32x16_bf16 v[128:143], a[44:47], v[188:191], v[128:143]
  s_waitcnt lgkmcnt(8)
  ds_read_b64_tr_b16 a[88:89], v34 offset:4096
  ds_read_b64_tr_b16 a[90:91], v34 offset:6144
  ds_read_b64_tr_b16 a[92:93], v35 offset:4096
  ds_read_b64_tr_b16 a[94:95], v35 offset:6144
  v_exp_f32 v149, v149
  v_mfma_f32_32x32x16_bf16 v[128:143], a[48:51], v[192:195], v[128:143]
  s_add_u32 s47, s47, 8192
  v_cvt_pk_bf16_f32 v161, v146, v147
  v_exp_f32 v150, v150
  v_exp_f32 v151, v151
  v_cvt_pk_bf16_f32 v162, v148, v149
  v_exp_f32 v152, v152
  v_mfma_f32_32x32x16_bf16 v[128:143], a[52:55], v[196:199], v[128:143]
  v_exp_f32 v153, v153
  buffer_load_dwordx4 v16, s[8:11], s47 offen offset:0 nt lds
  v_cvt_pk_bf16_f32 v163, v150, v151
  v_exp_f32 v154, v154
  v_exp_f32 v155, v155
  v_mfma_f32_32x32x16_bf16 v[128:143], a[56:59], v[200:203], v[128:143]
  v_cvt_pk_bf16_f32 v164, v152, v153
  v_exp_f32 v156, v156
  v_exp_f32 v157, v157
  buffer_load_dwordx4 v17, s[8:11], s47 offen offset:1024 nt lds
  v_cvt_pk_bf16_f32 v165, v154, v155
  v_mfma_f32_32x32x16_bf16 v[128:143], a[60:63], v[204:207], v[128:143]
  v_exp_f32 v158, v158
  v_exp_f32 v159, v159
  v_cvt_pk_bf16_f32 v166, v156, v157
  s_nop 0
  v_cvt_pk_bf16_f32 v167, v158, v159
  s_waitcnt lgkmcnt(8)
  v_mfma_f32_32x32x16_bf16 v[64:79], a[64:67], v[160:163], v[64:79]
  ds_read_b128 a[32:35], v24 offset:0
  ds_read_b128 a[36:39], v25 offset:0
  v_add_f32 v10, v10, v144
  v_add_f32 v10, v10, v145
  s_add_u32 m0, s29, 131072
  v_mfma_f32_32x32x16_bf16 v[80:95], a[68:71], v[160:163], v[80:95]
  ds_read_b128 a[40:43], v26 offset:0
  ds_read_b128 a[44:47], v27 offset:0
  v_add_f32 v10, v10, v146
  v_add_f32 v10, v10, v147
  v_add_f32 v10, v10, v148
  v_mfma_f32_32x32x16_bf16 v[96:111], a[72:75], v[160:163], v[96:111]
  v_add_f32 v10, v10, v149
  v_add_f32 v10, v10, v150
  v_add_f32 v10, v10, v151
  s_add_u32 s48, s48, 8192
  v_add_f32 v10, v10, v152
  v_add_f32 v10, v10, v153
  v_mfma_f32_32x32x16_bf16 v[112:127], a[76:79], v[160:163], v[112:127]
  v_max3_f32 v168, v128, v129, v130
  v_add_f32 v10, v10, v154
  v_max3_f32 v169, v131, v132, v133
  v_add_f32 v10, v10, v155
  v_add_f32 v10, v10, v156
  s_waitcnt lgkmcnt(4)
  v_mfma_f32_32x32x16_bf16 v[64:79], a[80:83], v[164:167], v[64:79]
  ds_read_b128 a[48:51], v28 offset:0
  ds_read_b128 a[52:55], v29 offset:0
  v_add_f32 v10, v10, v157
  v_add_f32 v10, v10, v158
  v_add_f32 v10, v10, v159
  v_mfma_f32_32x32x16_bf16 v[80:95], a[84:87], v[164:167], v[80:95]
  ds_read_b128 a[56:59], v30 offset:0
  ds_read_b128 a[60:63], v31 offset:0
  v_max3_f32 v170, v134, v135, v136
  v_max3_f32 v171, v137, v138, v139
  v_max3_f32 v172, v140, v141, v142
  v_mfma_f32_32x32x16_bf16 v[96:111], a[88:91], v[164:167], v[96:111]
  v_max3_f32 v168, v168, v169, v170
  buffer_load_dwordx4 v20, s[12:15], s48 offen offset:0 nt lds
  v_max3_f32 v171, v171, v172, v143
  v_max_f32 v168, v168, v171
  v_mov_b32 v169, v168
  v_mfma_f32_32x32x16_bf16 v[112:127], a[92:95], v[164:167], v[112:127]
  buffer_load_dwordx4 v20, s[12:15], s48 offen offset:1024 nt lds
  s_nop 1
  v_permlane32_swap_b32 v168, v169
  v_max_f32 v168, v168, v169
  v_cmp_lt_f32 vcc, s50, v168
  s_cbranch_vccnz L_resc_4
L_back_5:
  s_waitcnt vmcnt(8) lgkmcnt(0)
  s_barrier
  v_mfma_f32_32x32x16_bf16 v[144:159], a[32:35], v[176:179], v[208:223]
  ds_read_b64_tr_b16 a[64:65], v32 offset:40960
  ds_read_b64_tr_b16 a[66:67], v32 offset:43008
  ds_read_b64_tr_b16 a[68:69], v33 offset:40960
  ds_read_b64_tr_b16 a[70:71], v33 offset:43008
  v_exp_f32 v128, v128
  s_add_u32 m0, s29, 0
  v_exp_f32 v129, v129
  v_mfma_f32_32x32x16_bf16 v[144:159], a[36:39], v[180:183], v[144:159]
  ds_read_b64_tr_b16 a[72:73], v34 offset:40960
  ds_read_b64_tr_b16 a[74:75], v34 offset:43008
  ds_read_b64_tr_b16 a[76:77], v35 offset:40960
  ds_read_b64_tr_b16 a[78:79], v35 offset:43008
  v_exp_f32 v130, v130
  v_exp_f32 v131, v131
  v_mfma_f32_32x32x16_bf16 v[144:159], a[40:43], v[184:187], v[144:159]
  ds_read_b64_tr_b16 a[80:81], v32 offset:45056
  ds_read_b64_tr_b16 a[82:83], v32 offset:47104
  ds_read_b64_tr_b16 a[84:85], v33 offset:45056
  ds_read_b64_tr_b16 a[86:87], v33 offset:47104
  v_cvt_pk_bf16_f32 v160, v128, v129
  v_exp_f32 v132, v132
  v_mfma_f32_32x32x16_bf16 v[144:159], a[44:47], v[188:191], v[144:159]
  s_waitcnt lgkmcnt(8)
  ds_read_b64_tr_b16 a[88:89], v34 offset:45056
  ds_read_b64_tr_b16 a[90:91], v34 offset:47104
  ds_read_b64_tr_b16 a[92:93], v35 offset:45056
  ds_read_b64_tr_b16 a[94:95], v35 offset:47104
  v_exp_f32 v133, v133
  v_mfma_f32_32x32x16_bf16 v[144:159], a[48:51], v[192:195], v[144:159]
  s_add_u32 s47, s47, 8192
  v_cvt_pk_bf16_f32 v161, v130, v131
  v_exp_f32 v134, v134
  v_exp_f32 v135, v135
  v_cvt_pk_bf16_f32 v162, v132, v133
  v_exp_f32 v136, v136
  v_mfma_f32_32x32x16_bf16 v[144:159], a[52:55], v[196:199], v[144:159]
  v_exp_f32 v137, v137
  buffer_load_dwordx4 v16, s[8:11], s47 offen offset:0 nt lds
  v_cvt_pk_bf16_f32 v163, v134, v135
  v_exp_f32 v138, v138
  v_exp_f32 v139, v139
  v_mfma_f32_32x32x16_bf16 v[144:159], a[56:59], v[200:203], v[144:159]
  v_cvt_pk_bf16_f32 v164, v136, v137
  v_exp_f32 v140, v140
  v_exp_f32 v141, v141
  buffer_load_dwordx4 v17, s[8:11], s47 offen offset:1024 nt lds
  v_cvt_pk_bf16_f32 v165, v138, v139
  v_mfma_f32_32x32x16_bf16 v[144:159], a[60:63], v[204:207], v[144:159]
  v_exp_f32 v142, v142
  v_exp_f32 v143, v143
  v_cvt_pk_bf16_f32 v166, v140, v141
  s_nop 0
  v_cvt_pk_bf16_f32 v167, v142, v143
  s_waitcnt lgkmcnt(8)
  v_mfma_f32_32x32x16_bf16 v[64:79], a[64:67], v[160:163], v[64:79]
  ds_read_b128 a[32:35], v24 offset:40960
  ds_read_b128 a[36:39], v25 offset:40960
  v_add_f32 v10, v10, v128
  v_add_f32 v10, v10, v129
  s_add_u32 m0, s29, 8192
  v_mfma_f32_32x32x16_bf16 v[80:95], a[68:71], v[160:163], v[80:95]
  ds_read_b128 a[40:43], v26 offset:40960
  ds_read_b128 a[44:47], v27 offset:40960
  v_add_f32 v10, v10, v130
  v_add_f32 v10, v10, v131
  v_add_f32 v10, v10, v132
  v_mfma_f32_32x32x16_bf16 v[96:111], a[72:75], v[160:163], v[96:111]
  v_add_f32 v10, v10, v133
  v_add_f32 v10, v10, v134
  v_add_f32 v10, v10, v135
  s_add_u32 s48, s48, 8192
  v_add_f32 v10, v10, v136
  v_add_f32 v10, v10, v137
  v_mfma_f32_32x32x16_bf16 v[112:127], a[76:79], v[160:163], v[112:127]
  v_max3_f32 v168, v144, v145, v146
  v_add_f32 v10, v10, v138
  v_max3_f32 v169, v147, v148, v149
  v_add_f32 v10, v10, v139
  v_add_f32 v10, v10, v140
  s_waitcnt lgkmcnt(4)
  v_mfma_f32_32x32x16_bf16 v[64:79], a[80:83], v[164:167], v[64:79]
  ds_read_b128 a[48:51], v28 offset:40960
  ds_read_b128 a[52:55], v29 offset:40960
  v_add_f32 v10, v10, v141
  v_add_f32 v10, v10, v142
  v_add_f32 v10, v10, v143
  v_mfma_f32_32x32x16_bf16 v[80:95], a[84:87], v[164:167], v[80:95]
  ds_read_b128 a[56:59], v30 offset:40960
  ds_read_b128 a[60:63], v31 offset:40960
  v_max3_f32 v170, v150, v151, v152
  v_max3_f32 v171, v153, v154, v155
  v_max3_f32 v172, v156, v157, v158
  v_mfma_f32_32x32x16_bf16 v[96:111], a[88:91], v[164:167], v[96:111]
  v_max3_f32 v168, v168, v169, v170
  buffer_load_dwordx4 v20, s[12:15], s48 offen offset:0 nt lds
  v_max3_f32 v171, v171, v172, v159
  v_max_f32 v168, v168, v171
  v_mov_b32 v169, v168
  v_mfma_f32_32x32x16_bf16 v[112:127], a[92:95], v[164:167], v[112:127]
  buffer_load_dwordx4 v20, s[12:15], s48 offen offset:1024 nt lds
  s_nop 1
  v_permlane32_swap_b32 v168, v169
  v_max_f32 v168, v168, v169
  v_cmp_lt_f32 vcc, s50, v168
  s_cbranch_vccnz L_resc_6
L_back_7:
  s_waitcnt vmcnt(8) lgkmcnt(0)
  s_barrier
  v_mfma_f32_32x32x16_bf16 v[128:143], a[32:35], v[176:179], v[208:223]
  ds_read_b64_tr_b16 a[64:65], v44 offset:0
  ds_read_b64_tr_b16 a[66:67], v44 offset:2048
  ds_read_b64_tr_b16 a[68:69], v45 offset:0
  ds_read_b64_tr_b16 a[70:71], v45 offset:2048
  v_exp_f32 v144, v144
  s_add_u32 m0, s29, 40960
  v_exp_f32 v145, v145
  v_mfma_f32_32x32x16_bf16 v[128:143], a[36:39], v[180:183], v[128:143]
  ds_read_b64_tr_b16 a[72:73], v46 offset:0
  ds_read_b64_tr_b16 a[74:75], v46 offset:2048
  ds_read_b64_tr_b16 a[76:77], v47 offset:0
  ds_read_b64_tr_b16 a[78:79], v47 offset:2048
  v_exp_f32 v146, v146
  v_exp_f32 v147, v147
  v_mfma_f32_32x32x16_bf16 v[128:143], a[40:43], v[184:187], v[128:143]
  ds_read_b64_tr_b16 a[80:81], v44 offset:4096
  ds_read_b64_tr_b16 a[82:83], v44 offset:6144
  ds_read_b64_tr_b16 a[84:85], v45 offset:4096
  ds_read_b64_tr_b16 a[86:87], v45 offset:6144
  v_cvt_pk_bf16_f32 v160, v144, v145
  v_exp_f32 v148, v148
  v_mfma_f32_32x32x16_bf16 v[128:143], a[44:47], v[188:191], v[128:143]
  s_waitcnt lgkmcnt(8)
  ds_read_b64_tr_b16 a[88:89], v46 offset:4096
  ds_read_b64_tr_b16 a[90:91], v46 offset:6144
  ds_read_b64_tr_b16 a[92:93], v47 offset:4096
  ds_read_b64_tr_b16 a[94:95], v47 offset:6144
  v_exp_f32 v149, v149
  v_mfma_f32_32x32x16_bf16 v[128:143], a[48:51], v[192:195], v[128:143]
  s_add_u32 s47, s47, 8192
  v_cvt_pk_bf16_f32 v161, v146, v147
  v_exp_f32 v150, v150
  v_exp_f32 v151, v151
  v_cvt_pk_bf16_f32 v162, v148, v149
  v_exp_f32 v152, v152
  v_mfma_f32_32x32x16_bf16 v[128:143], a[52:55], v[196:199], v[128:143]
  v_exp_f32 v153, v153
  buffer_load_dwordx4 v16, s[8:11], s47 offen offset:0 nt lds
  v_cvt_pk_bf16_f32 v163, v150, v151
  v_exp_f32 v154, v154
  v_exp_f32 v155, v155
  v_mfma_f32_32x32x16_bf16 v[128:143], a[56:59], v[200:203], v[128:143]
  v_cvt_pk_bf16_f32 v164, v152, v153
  v_exp_f32 v156, v156
  v_exp_f32 v157, v157
  buffer_load_dwordx4 v17, s[8:11], s47 offen offset:1024 nt lds
  v_cvt_pk_bf16_f32 v165, v154, v155
  v_mfma_f32_32x32x16_bf16 v[128:143], a[60:63], v[204:207], v[128:143]
  v_exp_f32 v158, v158
  v_exp_f32 v159, v159
  v_cvt_pk_bf16_f32 v166, v156, v157
  s_nop 0
  v_cvt_pk_bf16_f32 v167, v158, v159
  s_waitcnt lgkmcnt(8)
  v_mfma_f32_32x32x16_bf16 v[64:79], a[64:67], v[160:163], v[64:79]
  ds_read_b128 a[32:35], v36 offset:0
  ds_read_b128 a[36:39], v37 offset:0
  v_add_f32 v10, v10, v144
  v_add_f32 v10, v10, v145
  s_add_u32 m0, s29, 49152
  v_mfma_f32_32x32x16_bf16 v[80:95], a[68:71], v[160:163], v[80:95]
  ds_read_b128 a[40:43], v38 offset:0
  ds_read_b128 a[44:47], v39 offset:0
  v_add_f32 v10, v10, v146
  v_add_f32 v10, v10, v147
  v_add_f32 v10, v10, v148
  v_mfma_f32_32x32x16_bf16 v[96:111], a[72:75], v[160:163], v[96:111]
  v_add_f32 v10, v10, v149
  v_add_f32 v10, v10, v150
  v_add_f32 v10, v10, v151
  s_add_u32 s48, s48, 8192
  v_add_f32 v10, v10, v152
  v_add_f32 v10, v10, v153
  v_mfma_f32_32x32x16_bf16 v[112:127], a[76:79], v[160:163], v[112:127]
  v_max3_f32 v168, v128, v129, v130
  v_add_f32 v10, v10, v154
  v_max3_f32 v169, v131, v132, v133
  v_add_f32 v10, v10, v155
  v_add_f32 v10, v10, v156
  s_waitcnt lgkmcnt(4)
  v_mfma_f32_32x32x16_bf16 v[64:79], a[80:83], v[164:167], v[64:79]
  ds_read_b128 a[48:51], v40 offset:0
  ds_read_b128 a[52:55], v41 offset:0
  v_add_f32 v10, v10, v157
  v_add_f32 v10, v10, v158
  v_add_f32 v10, v10, v159
  v_mfma_f32_32x32x16_bf16 v[80:95], a[84:87], v[164:167], v[80:95]
  ds_read_b128 a[56:59], v42 offset:0
  ds_read_b128 a[60:63], v43 offset:0
  v_max3_f32 v170, v134, v135, v136
  v_max3_f32 v171, v137, v138, v139
  v_max3_f32 v172, v140, v141, v142
  v_mfma_f32_32x32x16_bf16 v[96:111], a[88:91], v[164:167], v[96:111]
  v_max3_f32 v168, v168, v169, v170
  buffer_load_dwordx4 v20, s[12:15], s48 offen offset:0 nt lds
  v_max3_f32 v171, v171, v172, v143
  v_max_f32 v168, v168, v171
  v_mov_b32 v169, v168
  v_mfma_f32_32x32x16_bf16 v[112:127], a[92:95], v[164:167], v[112:127]
  buffer_load_dwordx4 v20, s[12:15], s48 offen offset:1024 nt lds
  s_nop 1
  v_permlane32_swap_b32 v168, v169
  v_max_f32 v168, v168, v169
  v_cmp_lt_f32 vcc, s50, v168
  s_cbranch_vccnz L_resc_8
L_back_9:
  s_waitcnt vmcnt(8) lgkmcnt(0)
  s_barrier
  v_mfma_f32_32x32x16_bf16 v[144:159], a[32:35], v[176:179], v[208:223]
  ds_read_b64_tr_b16 a[64:65], v44 offset:40960
  ds_read_b64_tr_b16 a[66:67], v44 offset:43008
  ds_read_b64_tr_b16 a[68:69], v45 offset:40960
  ds_read_b64_tr_b16 a[70:71], v45 offset:43008
  v_exp_f32 v128, v128
  s_add_u32 m0, s29, 81920
  v_exp_f32 v129, v129
  v_mfma_f32_32x32x16_bf16 v[144:159], a[36:39], v[180:183], v[144:159]
  ds_read_b64_tr_b16 a[72:73], v46 offset:40960
  ds_read_b64_tr_b16 a[74:75], v46 offset:43008
  ds_read_b64_tr_b16 a[76:77], v47 offset:40960
  ds_read_b64_tr_b16 a[78:79], v47 offset:43008
  v_exp_f32 v130, v130
  v_exp_f32 v131, v131
  v_mfma_f32_32x32x16_bf16 v[144:159], a[40:43], v[184:187], v[144:159]
  ds_read_b64_tr_b16 a[80:81], v44 offset:45056
  ds_read_b64_tr_b16 a[82:83], v44 offset:47104
  ds_read_b64_tr_b16 a[84:85], v45 offset:45056
  ds_read_b64_tr_b16 a[86:87], v45 offset:47104
  v_cvt_pk_bf16_f32 v160, v128, v129
  v_exp_f32 v132, v132
  v_mfma_f32_32x32x16_bf16 v[144:159], a[44:47], v[188:191], v[144:159]
  s_waitcnt lgkmcnt(8)
  ds_read_b64_tr_b16 a[88:89], v46 offset:45056
  ds_read_b64_tr_b16 a[90:91], v46 offset:47104
  ds_read_b64_tr_b16 a[92:93], v47 offset:45056
  ds_read_b64_tr_b16 a[94:95], v47 offset:47104
  v_exp_f32 v133, v133
  v_mfma_f32_32x32x16_bf16 v[144:159], a[48:51], v[192:195], v[144:159]
  s_add_u32 s47, s47, 8192
  v_cvt_pk_bf16_f32 v161, v130, v131
  v_exp_f32 v134, v134
  v_exp_f32 v135, v135
  v_cvt_pk_bf16_f32 v162, v132, v133
  v_exp_f32 v136, v136
  v_mfma_f32_32x32x16_bf16 v[144:159], a[52:55], v[196:199], v[144:159]
  v_exp_f32 v137, v137
  buffer_load_dwordx4 v16, s[8:11], s47 offen offset:0 nt lds
  v_cvt_pk_bf16_f32 v163, v134, v135
  v_exp_f32 v138, v138
  v_exp_f32 v139, v139
  v_mfma_f32_32x32x16_bf16 v[144:159], a[56:59], v[200:203], v[144:159]
  v_cvt_pk_bf16_f32 v164, v136, v137
  v_exp_f32 v140, v140
  v_exp_f32 v141, v141
  buffer_load_dwordx4 v17, s[8:11], s47 offen offset:1024 nt lds
  v_cvt_pk_bf16_f32 v165, v138, v139
  v_mfma_f32_32x32x16_bf16 v[144:159], a[60:63], v[204:207], v[144:159]
  v_exp_f32 v142, v142
  v_exp_f32 v143, v143
  v_cvt_pk_bf16_f32 v166, v140, v141
  s_nop 0
  v_cvt_pk_bf16_f32 v167, v142, v143
  s_waitcnt lgkmcnt(8)
  v_mfma_f32_32x32x16_bf16 v[64:79], a[64:67], v[160:163], v[64:79]
  ds_read_b128 a[32:35], v36 offset:40960
  ds_read_b128 a[36:39], v37 offset:40960
  v_add_f32 v10, v10, v128
  v_add_f32 v10, v10, v129
  s_add_u32 m0, s29, 90112
  v_mfma_f32_32x32x16_bf16 v[80:95], a[68:71], v[160:163], v[80:95]
  ds_read_b128 a[40:43], v38 offset:40960
  ds_read_b128 a[44:47], v39 offset:40960
  v_add_f32 v10, v10, v130
  v_add_f32 v10, v10, v131
  v_add_f32 v10, v10, v132
  v_mfma_f32_32x32x16_bf16 v[96:111], a[72:75], v[160:163], v[96:111]
  v_add_f32 v10, v10, v133
  v_add_f32 v10, v10, v134
  v_add_f32 v10, v10, v135
  s_add_u32 s48, s48, 8192
  v_add_f32 v10, v10, v136
  v_add_f32 v10, v10, v137
  v_mfma_f32_32x32x16_bf16 v[112:127], a[76:79], v[160:163], v[112:127]
  v_max3_f32 v168, v144, v145, v146
  v_add_f32 v10, v10, v138
  v_max3_f32 v169, v147, v148, v149
  v_add_f32 v10, v10, v139
  v_add_f32 v10, v10, v140
  s_waitcnt lgkmcnt(4)
  v_mfma_f32_32x32x16_bf16 v[64:79], a[80:83], v[164:167], v[64:79]
  ds_read_b128 a[48:51], v40 offset:40960
  ds_read_b128 a[52:55], v41 offset:40960
  v_add_f32 v10, v10, v141
  v_add_f32 v10, v10, v142
  v_add_f32 v10, v10, v143
  v_mfma_f32_32x32x16_bf16 v[80:95], a[84:87], v[164:167], v[80:95]
  ds_read_b128 a[56:59], v42 offset:40960
  ds_read_b128 a[60:63], v43 offset:40960
  v_max3_f32 v170, v150, v151, v152
  v_max3_f32 v171, v153, v154, v155
  v_max3_f32 v172, v156, v157, v158
  v_mfma_f32_32x32x16_bf16 v[96:111], a[88:91], v[164:167], v[96:111]
  v_max3_f32 v168, v168, v169, v170
  buffer_load_dwordx4 v20, s[12:15], s48 offen offset:0 nt lds
  v_max3_f32 v171, v171, v172, v159
  v_max_f32 v168, v168, v171
  v_mov_b32 v169, v168
  v_mfma_f32_32x32x16_bf16 v[112:127], a[92:95], v[164:167], v[112:127]
  buffer_load_dwordx4 v20, s[12:15], s48 offen offset:1024 nt lds
  s_nop 1
  v_permlane32_swap_b32 v168, v169
  v_max_f32 v168, v168, v169
  v_cmp_lt_f32 vcc, s50, v168
  s_cbranch_vccnz L_resc_10
L_back_11:
  s_sub_u32 s46, s46, 1
  s_cmp_lg_u32 s46, 0
  s_cbranch_scc1 L_loopA
  s_waitcnt vmcnt(8) lgkmcnt(0)
  s_barrier
  v_mfma_f32_32x32x16_bf16 v[128:143], a[32:35], v[176:179], v[208:223]
  ds_read_b64_tr_b16 a[64:65], v32 offset:0
  ds_read_b64_tr_b16 a[66:67], v32 offset:2048
  ds_read_b64_tr_b16 a[68:69], v33 offset:0
  ds_read_b64_tr_b16 a[70:71], v33 offset:2048
  v_exp_f32 v144, v144
  s_add_u32 m0, s29, 122880
  v_exp_f32 v145, v145
  v_mfma_f32_32x32x16_bf16 v[128:143], a[36:39], v[180:183], v[128:143]
  ds_read_b64_tr_b16 a[72:73], v34 offset:0
  ds_read_b64_tr_b16 a[74:75], v34 offset:2048
  ds_read_b64_tr_b16 a[76:77], v35 offset:0
  ds_read_b64_tr_b16 a[78:79], v35 offset:2048
  v_exp_f32 v146, v146
  v_exp_f32 v147, v147
  v_mfma_f32_32x32x16_bf16 v[128:143], a[40:43], v[184:187], v[128:143]
  ds_read_b64_tr_b16 a[80:81], v32 offset:4096
  ds_read_b64_tr_b16 a[82:83], v32 offset:6144
  ds_read_b64_tr_b16 a[84:85], v33 offset:4096
  ds_read_b64_tr_b16 a[86:87], v33 offset:6144
  v_cvt_pk_bf16_f32 v160, v144, v145
  v_exp_f32 v148, v148
  v_mfma_f32_32x32x16_bf16 v[128:143], a[44:47], v[188:191], v[128:143]
  s_waitcnt lgkmcnt(8)
  ds_read_b64_tr_b16 a[88:89], v34 offset:4096
  ds_read_b64_tr_b16 a[90:91], v34 offset:6144
  ds_read_b64_tr_b16 a[92:93], v35 offset:4096
  ds_read_b64_tr_b16 a[94:95], v35 offset:6144
  s_add_u32 s47, s47, 8192
  v_exp_f32 v149, v149
  v_mfma_f32_32x32x16_bf16 v[128:143], a[48:51], v[192:195], v[128:143]
  v_cvt_pk_bf16_f32 v161, v146, v147
  v_exp_f32 v150, v150
  v_exp_f32 v151, v151
  v_cvt_pk_bf16_f32 v162, v148, v149
  buffer_load_dwordx4 v16, s[8:11], s47 offen offset:0 nt lds
  v_exp_f32 v152, v152
  v_mfma_f32_32x32x16_bf16 v[128:143], a[52:55], v[196:199], v[128:143]
  v_exp_f32 v153, v153
  v_cvt_pk_bf16_f32 v163, v150, v151
  v_exp_f32 v154, v154
  v_exp_f32 v155, v155
  v_mfma_f32_32x32x16_bf16 v[128:143], a[56:59], v[200:203], v[128:143]
  buffer_load_dwordx4 v17, s[8:11], s47 offen offset:1024 nt lds
  v_cvt_pk_bf16_f32 v164, v152, v153
  v_exp_f32 v156, v156
  v_exp_f32 v157, v157
  v_cvt_pk_bf16_f32 v165, v154, v155
  v_mfma_f32_32x32x16_bf16 v[128:143], a[60:63], v[204:207], v[128:143]
  v_exp_f32 v158, v158
  s_add_u32 m0, s29, 131072
  v_exp_f32 v159, v159
  v_cvt_pk_bf16_f32 v166, v156, v157
  s_nop 0
  v_cvt_pk_bf16_f32 v167, v158, v159
  s_waitcnt lgkmcnt(8)
  v_mfma_f32_32x32x16_bf16 v[64:79], a[64:67], v[160:163], v[64:79]
  ds_read_b128 a[32:35], v24 offset:0
  ds_read_b128 a[36:39], v25 offset:0
  v_add_f32 v10, v10, v144
  v_add_f32 v10, v10, v145
  s_add_u32 s48, s48, 8192
  v_mfma_f32_32x32x16_bf16 v[80:95], a[68:71], v[160:163], v[80:95]
  ds_read_b128 a[40:43], v26 offset:0
  ds_read_b128 a[44:47], v27 offset:0
  v_add_f32 v10, v10, v146
  v_add_f32 v10, v10, v147
  v_add_f32 v10, v10, v148
  v_add_f32 v10, v10, v149
  v_mfma_f32_32x32x16_bf16 v[96:111], a[72:75], v[160:163], v[96:111]
  v_add_f32 v10, v10, v150
  buffer_load_dwordx4 v20, s[12:15], s48 offen offset:0 nt lds
  v_add_f32 v10, v10, v151
  v_add_f32 v10, v10, v152
  v_add_f32 v10, v10, v153
  v_mfma_f32_32x32x16_bf16 v[112:127], a[76:79], v[160:163], v[112:127]
  v_max3_f32 v168, v128, v129, v130
  v_add_f32 v10, v10, v154
  v_max3_f32 v169, v131, v132, v133
  v_add_f32 v10, v10, v155
  buffer_load_dwordx4 v20, s[12:15], s48 offen offset:1024 nt lds
  s_waitcnt lgkmcnt(4)
  v_mfma_f32_32x32x16_bf16 v[64:79], a[80:83], v[164:167], v[64:79]
  ds_read_b128 a[48:51], v28 offset:0
  ds_read_b128 a[52:55], v29 offset:0
  v_add_f32 v10, v10, v156
  v_add_f32 v10, v10, v157
  v_add_f32 v10, v10, v158
  v_add_f32 v10, v10, v159
  v_mfma_f32_32x32x16_bf16 v[80:95], a[84:87], v[164:167], v[80:95]
  ds_read_b128 a[56:59], v30 offset:0
  ds_read_b128 a[60:63], v31 offset:0
  v_max3_f32 v170, v134, v135, v136
  v_max3_f32 v171, v137, v138, v139
  v_max3_f32 v172, v140, v141, v142
  v_mfma_f32_32x32x16_bf16 v[96:111], a[88:91], v[164:167], v[96:111]
  v_max3_f32 v168, v168, v169, v170
  v_max3_f32 v171, v171, v172, v143
  v_mov_b32 v14, 0
  v_max_f32 v168, v168, v171
  v_mov_b32 v169, v168
  v_mfma_f32_32x32x16_bf16 v[112:127], a[92:95], v[164:167], v[112:127]
  global_load_dwordx2 v[4:5], v14, s[34:35] sc1
  s_nop 1
  v_permlane32_swap_b32 v168, v169
  v_max_f32 v168, v168, v169
  v_cmp_lt_f32 vcc, s50, v168
  s_cbranch_vccnz L_resc_12
L_back_13:
  s_waitcnt vmcnt(9) lgkmcnt(0)
  s_barrier
  v_mfma_f32_32x32x16_bf16 v[144:159], a[32:35], v[176:179], v[208:223]
  ds_read_b64_tr_b16 a[64:65], v32 offset:40960
  ds_read_b64_tr_b16 a[66:67], v32 offset:43008
  ds_read_b64_tr_b16 a[68:69], v33 offset:40960
  ds_read_b64_tr_b16 a[70:71], v33 offset:43008
  v_exp_f32 v128, v128
  s_add_u32 m0, s29, 0
  v_exp_f32 v129, v129
  v_mfma_f32_32x32x16_bf16 v[144:159], a[36:39], v[180:183], v[144:159]
  ds_read_b64_tr_b16 a[72:73], v34 offset:40960
  ds_read_b64_tr_b16 a[74:75], v34 offset:43008
  ds_read_b64_tr_b16 a[76:77], v35 offset:40960
  ds_read_b64_tr_b16 a[78:79], v35 offset:43008
  v_exp_f32 v130, v130
  v_exp_f32 v131, v131
  v_mfma_f32_32x32x16_bf16 v[144:159], a[40:43], v[184:187], v[144:159]
  ds_read_b64_tr_b16 a[80:81], v32 offset:45056
  ds_read_b64_tr_b16 a[82:83], v32 offset:47104
  ds_read_b64_tr_b16 a[84:85], v33 offset:45056
  ds_read_b64_tr_b16 a[86:87], v33 offset:47104
  v_cvt_pk_bf16_f32 v160, v128, v129
  v_exp_f32 v132, v132
  v_mfma_f32_32x32x16_bf16 v[144:159], a[44:47], v[188:191], v[144:159]
  s_waitcnt lgkmcnt(8)
  ds_read_b64_tr_b16 a[88:89], v34 offset:45056
  ds_read_b64_tr_b16 a[90:91], v34 offset:47104
  ds_read_b64_tr_b16 a[92:93], v35 offset:45056
  ds_read_b64_tr_b16 a[94:95], v35 offset:47104
  v_exp_f32 v133, v133
  v_mfma_f32_32x32x16_bf16 v[144:159], a[48:51], v[192:195], v[144:159]
  s_add_u32 s47, s47, 8192
  v_cvt_pk_bf16_f32 v161, v130, v131
  v_exp_f32 v134, v134
  v_exp_f32 v135, v135
  v_cvt_pk_bf16_f32 v162, v132, v133
  v_exp_f32 v136, v136
  v_mfma_f32_32x32x16_bf16 v[144:159], a[52:55], v[196:199], v[144:159]
  v_exp_f32 v137, v137
  buffer_load_dwordx4 v16, s[8:11], s47 offen offset:0 nt lds
  v_cvt_pk_bf16_f32 v163, v134, v135
  v_exp_f32 v138, v138
  v_exp_f32 v139, v139
  v_mfma_f32_32x32x16_bf16 v[144:159], a[56:59], v[200:203], v[144:159]
  v_cvt_pk_bf16_f32 v164, v136, v137
  v_exp_f32 v140, v140
  v_exp_f32 v141, v141
  buffer_load_dwordx4 v17, s[8:11], s47 offen offset:1024 nt lds
  v_cvt_pk_bf16_f32 v165, v138, v139
  v_mfma_f32_32x32x16_bf16 v[144:159], a[60:63], v[204:207], v[144:159]
  v_exp_f32 v142, v142
  v_exp_f32 v143, v143
  v_cvt_pk_bf16_f32 v166, v140, v141
  s_nop 0
  v_cvt_pk_bf16_f32 v167, v142, v143
  s_waitcnt lgkmcnt(8)
  v_mfma_f32_32x32x16_bf16 v[64:79], a[64:67], v[160:163], v[64:79]
  ds_read_b128 a[32:35], v24 offset:40960
  ds_read_b128 a[36:39], v25 offset:40960
  v_add_f32 v10, v10, v128
  v_add_f32 v10, v10, v129
  s_add_u32 m0, s29, 8192
  v_mfma_f32_32x32x16_bf16 v[80:95], a[68:71], v[160:163], v[80:95]
  ds_read_b128 a[40:43], v26 offset:40960
  ds_read_b128 a[44:47], v27 offset:40960
  v_add_f32 v10, v10, v130
  v_add_f32 v10, v10, v131
  v_add_f32 v10, v10, v132
  v_mfma_f32_32x32x16_bf16 v[96:111], a[72:75], v[160:163], v[96:111]
  v_add_f32 v10, v10, v133
  v_add_f32 v10, v10, v134
  v_add_f32 v10, v10, v135
  s_add_u32 s48, s48, 8192
  v_add_f32 v10, v10, v136
  v_add_f32 v10, v10, v137
  v_mfma_f32_32x32x16_bf16 v[112:127], a[76:79], v[160:163], v[112:127]
  v_max3_f32 v168, v144, v145, v146
  v_add_f32 v10, v10, v138
  v_max3_f32 v169, v147, v148, v149
  v_add_f32 v10, v10, v139
  v_add_f32 v10, v10, v140
  s_waitcnt lgkmcnt(4)
  v_mfma_f32_32x32x16_bf16 v[64:79], a[80:83], v[164:167], v[64:79]
  ds_read_b128 a[48:51], v28 offset:40960
  ds_read_b128 a[52:55], v29 offset:40960
  v_add_f32 v10, v10, v141
  v_add_f32 v10, v10, v142
  v_add_f32 v10, v10, v143
  v_mfma_f32_32x32x16_bf16 v[80:95], a[84:87], v[164:167], v[80:95]
  ds_read_b128 a[56:59], v30 offset:40960
  ds_read_b128 a[60:63], v31 offset:40960
  v_max3_f32 v170, v150, v151, v152
  v_max3_f32 v171, v153, v154, v155
  v_max3_f32 v172, v156, v157, v158
  v_mfma_f32_32x32x16_bf16 v[96:111], a[88:91], v[164:167], v[96:111]
  v_max3_f32 v168, v168, v169, v170
  buffer_load_dwordx4 v20, s[12:15], s48 offen offset:0 nt lds
  v_max3_f32 v171, v171, v172, v159
  v_max_f32 v168, v168, v171
  v_mov_b32 v169, v168
  v_mfma_f32_32x32x16_bf16 v[112:127], a[92:95], v[164:167], v[112:127]
  buffer_load_dwordx4 v20, s[12:15], s48 offen offset:1024 nt lds
  s_nop 1
  v_permlane32_swap_b32 v168, v169
  v_max_f32 v168, v168, v169
  v_cmp_lt_f32 vcc, s50, v168
  s_cbranch_vccnz L_resc_14
L_back_15:
  s_waitcnt vmcnt(9) lgkmcnt(0)
  s_barrier
  v_mfma_f32_32x32x16_bf16 v[128:143], a[32:35], v[176:179], v[208:223]
  ds_read_b64_tr_b16 a[64:65], v44 offset:0
  ds_read_b64_tr_b16 a[66:67], v44 offset:2048
  ds_read_b64_tr_b16 a[68:69], v45 offset:0
  ds_read_b64_tr_b16 a[70:71], v45 offset:2048
  v_exp_f32 v144, v144
  s_add_u32 m0, s29, 49152
  v_exp_f32 v145, v145
  v_mfma_f32_32x32x16_bf16 v[128:143], a[36:39], v[180:183], v[128:143]
  ds_read_b64_tr_b16 a[72:73], v46 offset:0
  ds_read_b64_tr_b16 a[74:75], v46 offset:2048
  ds_read_b64_tr_b16 a[76:77], v47 offset:0
  ds_read_b64_tr_b16 a[78:79], v47 offset:2048
  v_exp_f32 v146, v146
  v_mfma_f32_32x32x16_bf16 v[128:143], a[40:43], v[184:187], v[128:143]
  ds_read_b64_tr_b16 a[80:81], v44 offset:4096
  ds_read_b64_tr_b16 a[82:83], v44 offset:6144
  ds_read_b64_tr_b16 a[84:85], v45 offset:4096
  ds_read_b64_tr_b16 a[86:87], v45 offset:6144
  v_exp_f32 v147, v147
  v_cvt_pk_bf16_f32 v160, v144, v145
  v_exp_f32 v148, v148
  v_mfma_f32_32x32x16_bf16 v[128:143], a[44:47], v[188:191], v[128:143]
  s_waitcnt lgkmcnt(8)
  ds_read_b64_tr_b16 a[88:89], v46 offset:4096
  ds_read_b64_tr_b16 a[90:91], v46 offset:6144
  ds_read_b64_tr_b16 a[92:93], v47 offset:4096
  ds_read_b64_tr_b16 a[94:95], v47 offset:6144
  v_exp_f32 v149, v149
  v_mfma_f32_32x32x16_bf16 v[128:143], a[48:51], v[192:195], v[128:143]
  v_cvt_pk_bf16_f32 v161, v146, v147
  v_exp_f32 v150, v150
  v_exp_f32 v151, v151
  v_cvt_pk_bf16_f32 v162, v148, v149
  v_exp_f32 v152, v152
  v_mfma_f32_32x32x16_bf16 v[128:143], a[52:55], v[196:199], v[128:143]
  v_exp_f32 v153, v153
  s_add_u32 s48, s48, 8192
  v_cvt_pk_bf16_f32 v163, v150, v151
  v_exp_f32 v154, v154
  v_mfma_f32_32x32x16_bf16 v[128:143], a[56:59], v[200:203], v[128:143]
  v_exp_f32 v155, v155
  v_cvt_pk_bf16_f32 v164, v152, v153
  v_exp_f32 v156, v156
  v_exp_f32 v157, v157
  v_cvt_pk_bf16_f32 v165, v154, v155
  v_mfma_f32_32x32x16_bf16 v[128:143], a[60:63], v[204:207], v[128:143]
  v_exp_f32 v158, v158
  v_exp_f32 v159, v159
  v_cvt_pk_bf16_f32 v166, v156, v157
  s_nop 0
  v_cvt_pk_bf16_f32 v167, v158, v159
  s_waitcnt lgkmcnt(8)
  v_mfma_f32_32x32x16_bf16 v[64:79], a[64:67], v[160:163], v[64:79]
  ds_read_b128 a[32:35], v36 offset:0
  ds_read_b128 a[36:39], v37 offset:0
  v_add_f32 v10, v10, v144
  v_add_f32 v10, v10, v145
  buffer_load_dwordx4 v20, s[12:15], s48 offen offset:0 nt lds
  v_mfma_f32_32x32x16_bf16 v[80:95], a[68:71], v[160:163], v[80:95]
  ds_read_b128 a[40:43], v38 offset:0
  ds_read_b128 a[44:47], v39 offset:0
  v_add_f32 v10, v10, v146
  v_add_f32 v10, v10, v147
  v_add_f32 v10, v10, v148
  v_mfma_f32_32x32x16_bf16 v[96:111], a[72:75], v[160:163], v[96:111]
  v_add_f32 v10, v10, v149
  v_add_f32 v10, v10, v150
  v_add_f32 v10, v10, v151
  v_add_f32 v10, v10, v152
  v_add_f32 v10, v10, v153
  v_mfma_f32_32x32x16_bf16 v[112:127], a[76:79], v[160:163], v[112:127]
  v_max3_f32 v168, v128, v129, v130
  v_add_f32 v10, v10, v154
  v_max3_f32 v169, v131, v132, v133
  v_add_f32 v10, v10, v155
  v_add_f32 v10, v10, v156
  s_waitcnt lgkmcnt(4)
  v_mfma_f32_32x32x16_bf16 v[64:79], a[80:83], v[164:167], v[64:79]
  ds_read_b128 a[48:51], v40 offset:0
  ds_read_b128 a[52:55], v41 offset:0
  v_add_f32 v10, v10, v157
  v_add_f32 v10, v10, v158
  v_add_f32 v10, v10, v159
  v_mfma_f32_32x32x16_bf16 v[80:95], a[84:87], v[164:167], v[80:95]
  ds_read_b128 a[56:59], v42 offset:0
  ds_read_b128 a[60:63], v43 offset:0
  v_max3_f32 v170, v134, v135, v136
  v_max3_f32 v171, v137, v138, v139
  v_mfma_f32_32x32x16_bf16 v[96:111], a[88:91], v[164:167], v[96:111]
  v_max3_f32 v172, v140, v141, v142
  v_max3_f32 v168, v168, v169, v170
  buffer_load_dwordx4 v20, s[12:15], s48 offen offset:1024 nt lds
  v_max3_f32 v171, v171, v172, v143
  v_max_f32 v168, v168, v171
  v_mfma_f32_32x32x16_bf16 v[112:127], a[92:95], v[164:167], v[112:127]
  v_mov_b32 v169, v168
  s_nop 1
  v_permlane32_swap_b32 v168, v169
  v_max_f32 v168, v168, v169
  v_cmp_lt_f32 vcc, s50, v168
  s_cbranch_vccnz L_resc_16
L_back_17:
  s_waitcnt vmcnt(7) lgkmcnt(0)
  s_barrier
  v_mfma_f32_32x32x16_bf16 v[144:159], a[32:35], v[176:179], v[208:223]
  ds_read_b64_tr_b16 a[64:65], v44 offset:40960
  ds_read_b64_tr_b16 a[66:67], v44 offset:43008
  ds_read_b64_tr_b16 a[68:69], v45 offset:40960
  ds_read_b64_tr_b16 a[70:71], v45 offset:43008
  v_exp_f32 v128, v128
  s_add_u32 m0, s29, 90112
  v_exp_f32 v129, v129
  v_mfma_f32_32x32x16_bf16 v[144:159], a[36:39], v[180:183], v[144:159]
  ds_read_b64_tr_b16 a[72:73], v46 offset:40960
  ds_read_b64_tr_b16 a[74:75], v46 offset:43008
  ds_read_b64_tr_b16 a[76:77], v47 offset:40960
  ds_read_b64_tr_b16 a[78:79], v47 offset:43008
  v_exp_f32 v130, v130
  v_mfma_f32_32x32x16_bf16 v[144:159], a[40:43], v[184:187], v[144:159]
  ds_read_b64_tr_b16 a[80:81], v44 offset:45056
  ds_read_b64_tr_b16 a[82:83], v44 offset:47104
  ds_read_b64_tr_b16 a[84:85], v45 offset:45056
  ds_read_b64_tr_b16 a[86:87], v45 offset:47104
  v_exp_f32 v131, v131
  v_cvt_pk_bf16_f32 v160, v128, v129
  v_exp_f32 v132, v132
  v_mfma_f32_32x32x16_bf16 v[144:159], a[44:47], v[188:191], v[144:159]
  s_waitcnt lgkmcnt(8)
  ds_read_b64_tr_b16 a[88:89], v46 offset:45056
  ds_read_b64_tr_b16 a[90:91], v46 offset:47104
  ds_read_b64_tr_b16 a[92:93], v47 offset:45056
  ds_read_b64_tr_b16 a[94:95], v47 offset:47104
  v_exp_f32 v133, v133
  v_mfma_f32_32x32x16_bf16 v[144:159], a[48:51], v[192:195], v[144:159]
  v_cvt_pk_bf16_f32 v161, v130, v131
  v_exp_f32 v134, v134
  v_exp_f32 v135, v135
  v_cvt_pk_bf16_f32 v162, v132, v133
  v_exp_f32 v136, v136
  v_mfma_f32_32x32x16_bf16 v[144:159], a[52:55], v[196:199], v[144:159]
  v_exp_f32 v137, v137
  s_add_u32 s48, s48, 8192
  v_cvt_pk_bf16_f32 v163, v134, v135
  v_exp_f32 v138, v138
  v_mfma_f32_32x32x16_bf16 v[144:159], a[56:59], v[200:203], v[144:159]
  v_exp_f32 v139, v139
  v_cvt_pk_bf16_f32 v164, v136, v137
  v_exp_f32 v140, v140
  v_exp_f32 v141, v141
  v_cvt_pk_bf16_f32 v165, v138, v139
  v_mfma_f32_32x32x16_bf16 v[144:159], a[60:63], v[204:207], v[144:159]
  v_exp_f32 v142, v142
  v_exp_f32 v143, v143
  v_cvt_pk_bf16_f32 v166, v140, v141
  s_nop 0
  v_cvt_pk_bf16_f32 v167, v142, v143
  s_waitcnt lgkmcnt(8)
  v_mfma_f32_32x32x16_bf16 v[64:79], a[64:67], v[160:163], v[64:79]
  ds_read_b128 a[32:35], v36 offset:40960
  ds_read_b128 a[36:39], v37 offset:40960
  v_add_f32 v10, v10, v128
  v_add_f32 v10, v10, v129
  buffer_load_dwordx4 v20, s[12:15], s48 offen offset:0 nt lds
  v_mfma_f32_32x32x16_bf16 v[80:95], a[68:71], v[160:163], v[80:95]
  ds_read_b128 a[40:43], v38 offset:40960
  ds_read_b128 a[44:47], v39 offset:40960
  v_add_f32 v10, v10, v130
  v_add_f32 v10, v10, v131
  v_add_f32 v10, v10, v132
  v_mfma_f32_32x32x16_bf16 v[96:111], a[72:75], v[160:163], v[96:111]
  v_add_f32 v10, v10, v133
  v_add_f32 v10, v10, v134
  v_add_f32 v10, v10, v135
  v_add_f32 v10, v10, v136
  v_add_f32 v10, v10, v137
  v_mfma_f32_32x32x16_bf16 v[112:127], a[76:79], v[160:163], v[112:127]
  v_max3_f32 v168, v144, v145, v146
  v_add_f32 v10, v10, v138
  v_max3_f32 v169, v147, v148, v149
  v_add_f32 v10, v10, v139
  v_add_f32 v10, v10, v140
  s_waitcnt lgkmcnt(4)
  v_mfma_f32_32x32x16_bf16 v[64:79], a[80:83], v[164:167], v[64:79]
  ds_read_b128 a[48:51], v40 offset:40960
  ds_read_b128 a[52:55], v41 offset:40960
  v_add_f32 v10, v10, v141
  v_add_f32 v10, v10, v142
  v_add_f32 v10, v10, v143
  v_mfma_f32_32x32x16_bf16 v[80:95], a[84:87], v[164:167], v[80:95]
  ds_read_b128 a[56:59], v42 offset:40960
  ds_read_b128 a[60:63], v43 offset:40960
  v_max3_f32 v170, v150, v151, v152
  v_max3_f32 v171, v153, v154, v155
  v_mfma_f32_32x32x16_bf16 v[96:111], a[88:91], v[164:167], v[96:111]
  v_max3_f32 v172, v156, v157, v158
  v_max3_f32 v168, v168, v169, v170
  buffer_load_dwordx4 v20, s[12:15], s48 offen offset:1024 nt lds
  v_max3_f32 v171, v171, v172, v159
  v_max_f32 v168, v168, v171
  v_mfma_f32_32x32x16_bf16 v[112:127], a[92:95], v[164:167], v[112:127]
  v_mov_b32 v169, v168
  s_nop 1
  v_permlane32_swap_b32 v168, v169
  v_max_f32 v168, v168, v169
  v_cmp_lt_f32 vcc, s50, v168
  s_cbranch_vccnz L_resc_18
L_back_19:
  s_waitcnt vmcnt(4) lgkmcnt(0)
  s_barrier
  v_mfma_f32_32x32x16_bf16 v[128:143], a[32:35], v[176:179], v[208:223]
  ds_read_b64_tr_b16 a[64:65], v32 offset:0
  ds_read_b64_tr_b16 a[66:67], v32 offset:2048
  ds_read_b64_tr_b16 a[68:69], v33 offset:0
  ds_read_b64_tr_b16 a[70:71], v33 offset:2048
  v_exp_f32 v144, v144
  v_exp_f32 v145, v145
  v_mfma_f32_32x32x16_bf16 v[128:143], a[36:39], v[180:183], v[128:143]
  ds_read_b64_tr_b16 a[72:73], v34 offset:0
  ds_read_b64_tr_b16 a[74:75], v34 offset:2048
  ds_read_b64_tr_b16 a[76:77], v35 offset:0
  ds_read_b64_tr_b16 a[78:79], v35 offset:2048
  v_exp_f32 v146, v146
  v_exp_f32 v147, v147
  v_mfma_f32_32x32x16_bf16 v[128:143], a[40:43], v[184:187], v[128:143]
  ds_read_b64_tr_b16 a[80:81], v32 offset:4096
  ds_read_b64_tr_b16 a[82:83], v32 offset:6144
  ds_read_b64_tr_b16 a[84:85], v33 offset:4096
  ds_read_b64_tr_b16 a[86:87], v33 offset:6144
  v_cvt_pk_bf16_f32 v160, v144, v145
  v_exp_f32 v148, v148
  v_mfma_f32_32x32x16_bf16 v[128:143], a[44:47], v[188:191], v[128:143]
  s_waitcnt lgkmcnt(8)
  ds_read_b64_tr_b16 a[88:89], v34 offset:4096
  ds_read_b64_tr_b16 a[90:91], v34 offset:6144
  ds_read_b64_tr_b16 a[92:93], v35 offset:4096
  ds_read_b64_tr_b16 a[94:95], v35 offset:6144
  v_exp_f32 v149, v149
  v_mfma_f32_32x32x16_bf16 v[128:143], a[48:51], v[192:195], v[128:143]
  v_cvt_pk_bf16_f32 v161, v146, v147
  v_exp_f32 v150, v150
  v_exp_f32 v151, v151
  v_cvt_pk_bf16_f32 v162, v148, v149
  v_exp_f32 v152, v152
  v_mfma_f32_32x32x16_bf16 v[128:143], a[52:55], v[196:199], v[128:143]
  v_exp_f32 v153, v153
  v_cvt_pk_bf16_f32 v163, v150, v151
  v_exp_f32 v154, v154
  v_exp_f32 v155, v155
  v_mfma_f32_32x32x16_bf16 v[128:143], a[56:59], v[200:203], v[128:143]
  v_cvt_pk_bf16_f32 v164, v152, v153
  v_exp_f32 v156, v156
  v_exp_f32 v157, v157
  v_cvt_pk_bf16_f32 v165, v154, v155
  v_mfma_f32_32x32x16_bf16 v[128:143], a[60:63], v[204:207], v[128:143]
  v_exp_f32 v158, v158
  v_exp_f32 v159, v159
  v_cvt_pk_bf16_f32 v166, v156, v157
  s_nop 0
  v_cvt_pk_bf16_f32 v167, v158, v159
  s_waitcnt lgkmcnt(8)
  v_mfma_f32_32x32x16_bf16 v[64:79], a[64:67], v[160:163], v[64:79]
  ds_read_b128 a[32:35], v24 offset:0
  ds_read_b128 a[36:39], v25 offset:0
  v_add_f32 v10, v10, v144
  v_add_f32 v10, v10, v145
  v_add_f32 v10, v10, v146
  v_mfma_f32_32x32x16_bf16 v[80:95], a[68:71], v[160:163], v[80:95]
  ds_read_b128 a[40:43], v26 offset:0
  ds_read_b128 a[44:47], v27 offset:0
  v_add_f32 v10, v10, v147
  v_add_f32 v10, v10, v148
  v_mfma_f32_32x32x16_bf16 v[96:111], a[72:75], v[160:163], v[96:111]
  v_add_f32 v10, v10, v149
  v_add_f32 v10, v10, v150
  v_add_f32 v10, v10, v151
  v_add_f32 v10, v10, v152
  v_add_f32 v10, v10, v153
  v_mfma_f32_32x32x16_bf16 v[112:127], a[76:79], v[160:163], v[112:127]
  v_max3_f32 v168, v128, v129, v130
  v_add_f32 v10, v10, v154
  v_max3_f32 v169, v131, v132, v133
  v_add_f32 v10, v10, v155
  v_add_f32 v10, v10, v156
  s_waitcnt lgkmcnt(4)
  v_mfma_f32_32x32x16_bf16 v[64:79], a[80:83], v[164:167], v[64:79]
  ds_read_b128 a[48:51], v28 offset:0
  ds_read_b128 a[52:55], v29 offset:0
  v_add_f32 v10, v10, v157
  v_add_f32 v10, v10, v158
  v_add_f32 v10, v10, v159
  v_mfma_f32_32x32x16_bf16 v[80:95], a[84:87], v[164:167], v[80:95]
  ds_read_b128 a[56:59], v30 offset:0
  ds_read_b128 a[60:63], v31 offset:0
  v_max3_f32 v170, v134, v135, v136
  v_max3_f32 v171, v137, v138, v139
  v_mfma_f32_32x32x16_bf16 v[96:111], a[88:91], v[164:167], v[96:111]
  v_max3_f32 v172, v140, v141, v142
  v_max3_f32 v168, v168, v169, v170
  v_max3_f32 v171, v171, v172, v143
  v_max_f32 v168, v168, v171
  v_mov_b32 v169, v168
  v_mfma_f32_32x32x16_bf16 v[112:127], a[92:95], v[164:167], v[112:127]
  s_nop 1
  v_permlane32_swap_b32 v168, v169
  v_max_f32 v168, v168, v169
  v_cmp_lt_f32 vcc, s50, v168
  s_cbranch_vccnz L_resc_20
L_back_21:
  s_waitcnt vmcnt(2) lgkmcnt(0)
  s_barrier
  v_mfma_f32_32x32x16_bf16 v[144:159], a[32:35], v[176:179], v[208:223]
  ds_read_b64_tr_b16 a[64:65], v32 offset:40960
  ds_read_b64_tr_b16 a[66:67], v32 offset:43008
  ds_read_b64_tr_b16 a[68:69], v33 offset:40960
  ds_read_b64_tr_b16 a[70:71], v33 offset:43008
  v_exp_f32 v128, v128
  v_exp_f32 v129, v129
  v_mfma_f32_32x32x16_bf16 v[144:159], a[36:39], v[180:183], v[144:159]
  ds_read_b64_tr_b16 a[72:73], v34 offset:40960
  ds_read_b64_tr_b16 a[74:75], v34 offset:43008
  ds_read_b64_tr_b16 a[76:77], v35 offset:40960
  ds_read_b64_tr_b16 a[78:79], v35 offset:43008
  v_exp_f32 v130, v130
  v_exp_f32 v131, v131
  v_mfma_f32_32x32x16_bf16 v[144:159], a[40:43], v[184:187], v[144:159]
  ds_read_b64_tr_b16 a[80:81], v32 offset:45056
  ds_read_b64_tr_b16 a[82:83], v32 offset:47104
  ds_read_b64_tr_b16 a[84:85], v33 offset:45056
  ds_read_b64_tr_b16 a[86:87], v33 offset:47104
  v_cvt_pk_bf16_f32 v160, v128, v129
  v_exp_f32 v132, v132
  v_mfma_f32_32x32x16_bf16 v[144:159], a[44:47], v[188:191], v[144:159]
  s_waitcnt lgkmcnt(8)
  ds_read_b64_tr_b16 a[88:89], v34 offset:45056
  ds_read_b64_tr_b16 a[90:91], v34 offset:47104
  ds_read_b64_tr_b16 a[92:93], v35 offset:45056
  ds_read_b64_tr_b16 a[94:95], v35 offset:47104
  v_exp_f32 v133, v133
  v_mfma_f32_32x32x16_bf16 v[144:159], a[48:51], v[192:195], v[144:159]
  v_cvt_pk_bf16_f32 v161, v130, v131
  v_exp_f32 v134, v134
  v_exp_f32 v135, v135
  v_cvt_pk_bf16_f32 v162, v132, v133
  v_exp_f32 v136, v136
  v_mfma_f32_32x32x16_bf16 v[144:159], a[52:55], v[196:199], v[144:159]
  v_exp_f32 v137, v137
  v_cvt_pk_bf16_f32 v163, v134, v135
  v_exp_f32 v138, v138
  v_exp_f32 v139, v139
  v_mfma_f32_32x32x16_bf16 v[144:159], a[56:59], v[200:203], v[144:159]
  v_cvt_pk_bf16_f32 v164, v136, v137
  v_exp_f32 v140, v140
  v_exp_f32 v141, v141
  v_cvt_pk_bf16_f32 v165, v138, v139
  v_mfma_f32_32x32x16_bf16 v[144:159], a[60:63], v[204:207], v[144:159]
  v_exp_f32 v142, v142
  v_exp_f32 v143, v143
  v_cvt_pk_bf16_f32 v166, v140, v141
  s_nop 0
  v_cvt_pk_bf16_f32 v167, v142, v143
  s_waitcnt lgkmcnt(8)
  v_mfma_f32_32x32x16_bf16 v[64:79], a[64:67], v[160:163], v[64:79]
  v_add_f32 v10, v10, v128
  v_add_f32 v10, v10, v129
  v_add_f32 v10, v10, v130
  v_add_f32 v10, v10, v131
  v_mfma_f32_32x32x16_bf16 v[80:95], a[68:71], v[160:163], v[80:95]
  v_add_f32 v10, v10, v132
  v_add_f32 v10, v10, v133
  v_add_f32 v10, v10, v134
  v_mfma_f32_32x32x16_bf16 v[96:111], a[72:75], v[160:163], v[96:111]
  v_add_f32 v10, v10, v135
  v_add_f32 v10, v10, v136
  v_add_f32 v10, v10, v137
  v_add_f32 v10, v10, v138
  v_mfma_f32_32x32x16_bf16 v[112:127], a[76:79], v[160:163], v[112:127]
  v_max3_f32 v168, v144, v145, v146
  v_max3_f32 v169, v147, v148, v149
  v_add_f32 v10, v10, v139
  v_add_f32 v10, v10, v140
  s_waitcnt lgkmcnt(0)
  v_mfma_f32_32x32x16_bf16 v[64:79], a[80:83], v[164:167], v[64:79]
  v_add_f32 v10, v10, v141
  v_add_f32 v10, v10, v142
  v_add_f32 v10, v10, v143
  v_mfma_f32_32x32x16_bf16 v[80:95], a[84:87], v[164:167], v[80:95]
  v_max3_f32 v170, v150, v151, v152
  v_max3_f32 v171, v153, v154, v155
  v_max3_f32 v172, v156, v157, v158
  v_max3_f32 v168, v168, v169, v170
  v_mfma_f32_32x32x16_bf16 v[96:111], a[88:91], v[164:167], v[96:111]
  v_max3_f32 v171, v171, v172, v159
  v_max_f32 v168, v168, v171
  v_mov_b32 v169, v168
  s_nop 1
  v_mfma_f32_32x32x16_bf16 v[112:127], a[92:95], v[164:167], v[112:127]
  v_permlane32_swap_b32 v168, v169
  v_max_f32 v168, v168, v169
  v_cmp_lt_f32 vcc, s50, v168
  s_cbranch_vccnz L_resc_22
L_back_23:
  s_waitcnt vmcnt(0) lgkmcnt(0)
  s_barrier
  ds_read_b64_tr_b16 a[64:65], v44 offset:0
  ds_read_b64_tr_b16 a[66:67], v44 offset:2048
  ds_read_b64_tr_b16 a[68:69], v45 offset:0
  ds_read_b64_tr_b16 a[70:71], v45 offset:2048
  ds_read_b64_tr_b16 a[72:73], v46 offset:0
  ds_read_b64_tr_b16 a[74:75], v46 offset:2048
  ds_read_b64_tr_b16 a[76:77], v47 offset:0
  ds_read_b64_tr_b16 a[78:79], v47 offset:2048
  ds_read_b64_tr_b16 a[80:81], v44 offset:4096
  ds_read_b64_tr_b16 a[82:83], v44 offset:6144
  ds_read_b64_tr_b16 a[84:85], v45 offset:4096
  ds_read_b64_tr_b16 a[86:87], v45 offset:6144
  s_waitcnt lgkmcnt(8)
  ds_read_b64_tr_b16 a[88:89], v46 offset:4096
  ds_read_b64_tr_b16 a[90:91], v46 offset:6144
  ds_read_b64_tr_b16 a[92:93], v47 offset:4096
  ds_read_b64_tr_b16 a[94:95], v47 offset:6144
  v_exp_f32 v144, v144
  v_exp_f32 v145, v145
  v_exp_f32 v146, v146
  v_exp_f32 v147, v147
  v_cvt_pk_bf16_f32 v160, v144, v145
  v_exp_f32 v148, v148
  v_exp_f32 v149, v149
  v_cvt_pk_bf16_f32 v161, v146, v147
  v_exp_f32 v150, v150
  v_exp_f32 v151, v151
  v_cvt_pk_bf16_f32 v162, v148, v149
  v_exp_f32 v152, v152
  v_exp_f32 v153, v153
  v_cvt_pk_bf16_f32 v163, v150, v151
  v_exp_f32 v154, v154
  v_exp_f32 v155, v155
  v_cvt_pk_bf16_f32 v164, v152, v153
  v_exp_f32 v156, v156
  v_exp_f32 v157, v157
  v_cvt_pk_bf16_f32 v165, v154, v155
  v_exp_f32 v158, v158
  v_exp_f32 v159, v159
  v_cvt_pk_bf16_f32 v166, v156, v157
  s_nop 0
  v_cvt_pk_bf16_f32 v167, v158, v159
  s_waitcnt lgkmcnt(8)
  v_mfma_f32_32x32x16_bf16 v[64:79], a[64:67], v[160:163], v[64:79]
  v_add_f32 v10, v10, v144
  v_add_f32 v10, v10, v145
  v_mfma_f32_32x32x16_bf16 v[80:95], a[68:71], v[160:163], v[80:95]
  v_add_f32 v10, v10, v146
  v_add_f32 v10, v10, v147
  v_mfma_f32_32x32x16_bf16 v[96:111], a[72:75], v[160:163], v[96:111]
  v_add_f32 v10, v10, v148
  v_add_f32 v10, v10, v149
  v_mfma_f32_32x32x16_bf16 v[112:127], a[76:79], v[160:163], v[112:127]
  v_add_f32 v10, v10, v150
  v_add_f32 v10, v10, v151
  s_waitcnt lgkmcnt(0)
  v_mfma_f32_32x32x16_bf16 v[64:79], a[80:83], v[164:167], v[64:79]
  v_add_f32 v10, v10, v152
  v_add_f32 v10, v10, v153
  v_add_f32 v10, v10, v154
  v_add_f32 v10, v10, v155
  v_add_f32 v10, v10, v156
  v_add_f32 v10, v10, v157
  v_add_f32 v10, v10, v158
  v_add_f32 v10, v10, v159
  v_mfma_f32_32x32x16_bf16 v[80:95], a[84:87], v[164:167], v[80:95]
  v_mfma_f32_32x32x16_bf16 v[96:111], a[88:91], v[164:167], v[96:111]
  v_mfma_f32_32x32x16_bf16 v[112:127], a[92:95], v[164:167], v[112:127]
  v_mov_b32 v2, v10
  s_nop 1
  v_permlane32_swap_b32 v10, v2
  v_add_f32 v10, v10, v2
  v_rcp_f32 v12, v10
  v_lshlrev_b32 v2, 4, v1
  s_add_u32 s51, s52, 1048576
  s_nop 7
  v_mov_b32 v13, v12
  s_nop 1
  v_pk_mul_f32 v[64:65], v[64:65], v[12:13]
  v_pk_mul_f32 v[66:67], v[66:67], v[12:13]
  v_pk_mul_f32 v[68:69], v[68:69], v[12:13]
  v_pk_mul_f32 v[70:71], v[70:71], v[12:13]
  v_cvt_pk_bf16_f32 v128, v64, v65
  v_cvt_pk_bf16_f32 v129, v66, v67
  v_cvt_pk_bf16_f32 v130, v68, v69
  v_cvt_pk_bf16_f32 v131, v70, v71
  s_add_u32 s55, s51, 0
  buffer_store_dwordx4 v[128:131], v2, s[24:27], s55 offen sc1
  v_pk_mul_f32 v[72:73], v[72:73], v[12:13]
  v_pk_mul_f32 v[74:75], v[74:75], v[12:13]
  v_pk_mul_f32 v[76:77], v[76:77], v[12:13]
  v_pk_mul_f32 v[78:79], v[78:79], v[12:13]
  v_cvt_pk_bf16_f32 v132, v72, v73
  v_cvt_pk_bf16_f32 v133, v74, v75
  v_cvt_pk_bf16_f32 v134, v76, v77
  v_cvt_pk_bf16_f32 v135, v78, v79
  s_add_u32 s55, s51, 1024
  buffer_store_dwordx4 v[132:135], v2, s[24:27], s55 offen sc1
  v_pk_mul_f32 v[80:81], v[80:81], v[12:13]
  v_pk_mul_f32 v[82:83], v[82:83], v[12:13]
  v_pk_mul_f32 v[84:85], v[84:85], v[12:13]
  v_pk_mul_f32 v[86:87], v[86:87], v[12:13]
  v_cvt_pk_bf16_f32 v136, v80, v81
  v_cvt_pk_bf16_f32 v137, v82, v83
  v_cvt_pk_bf16_f32 v138, v84, v85
  v_cvt_pk_bf16_f32 v139, v86, v87
  s_add_u32 s55, s51, 2048
  buffer_store_dwordx4 v[136:139], v2, s[24:27], s55 offen sc1
  v_pk_mul_f32 v[88:89], v[88:89], v[12:13]
  v_pk_mul_f32 v[90:91], v[90:91], v[12:13]
  v_pk_mul_f32 v[92:93], v[92:93], v[12:13]
  v_pk_mul_f32 v[94:95], v[94:95], v[12:13]
  v_cvt_pk_bf16_f32 v140, v88, v89
  v_cvt_pk_bf16_f32 v141, v90, v91
  v_cvt_pk_bf16_f32 v142, v92, v93
  v_cvt_pk_bf16_f32 v143, v94, v95
  s_add_u32 s55, s51, 3072
  buffer_store_dwordx4 v[140:143], v2, s[24:27], s55 offen sc1
  v_pk_mul_f32 v[96:97], v[96:97], v[12:13]
  v_pk_mul_f32 v[98:99], v[98:99], v[12:13]
  v_pk_mul_f32 v[100:101], v[100:101], v[12:13]
  v_pk_mul_f32 v[102:103], v[102:103], v[12:13]
  v_cvt_pk_bf16_f32 v144, v96, v97
  v_cvt_pk_bf16_f32 v145, v98, v99
  v_cvt_pk_bf16_f32 v146, v100, v101
  v_cvt_pk_bf16_f32 v147, v102, v103
  s_add_u32 s55, s51, 4096
  buffer_store_dwordx4 v[144:147], v2, s[24:27], s55 offen sc1
  v_pk_mul_f32 v[104:105], v[104:105], v[12:13]
  v_pk_mul_f32 v[106:107], v[106:107], v[12:13]
  v_pk_mul_f32 v[108:109], v[108:109], v[12:13]
  v_pk_mul_f32 v[110:111], v[110:111], v[12:13]
  v_cvt_pk_bf16_f32 v148, v104, v105
  v_cvt_pk_bf16_f32 v149, v106, v107
  v_cvt_pk_bf16_f32 v150, v108, v109
  v_cvt_pk_bf16_f32 v151, v110, v111
  s_add_u32 s55, s51, 5120
  buffer_store_dwordx4 v[148:151], v2, s[24:27], s55 offen sc1
  v_pk_mul_f32 v[112:113], v[112:113], v[12:13]
  v_pk_mul_f32 v[114:115], v[114:115], v[12:13]
  v_pk_mul_f32 v[116:117], v[116:117], v[12:13]
  v_pk_mul_f32 v[118:119], v[118:119], v[12:13]
  v_cvt_pk_bf16_f32 v152, v112, v113
  v_cvt_pk_bf16_f32 v153, v114, v115
  v_cvt_pk_bf16_f32 v154, v116, v117
  v_cvt_pk_bf16_f32 v155, v118, v119
  s_add_u32 s55, s51, 6144
  buffer_store_dwordx4 v[152:155], v2, s[24:27], s55 offen sc1
  v_pk_mul_f32 v[120:121], v[120:121], v[12:13]
  v_pk_mul_f32 v[122:123], v[122:123], v[12:13]
  v_pk_mul_f32 v[124:125], v[124:125], v[12:13]
  v_pk_mul_f32 v[126:127], v[126:127], v[12:13]
  v_cvt_pk_bf16_f32 v156, v120, v121
  v_cvt_pk_bf16_f32 v157, v122, v123
  v_cvt_pk_bf16_f32 v158, v124, v125
  v_cvt_pk_bf16_f32 v159, v126, v127
  s_add_u32 s55, s51, 7168
  buffer_store_dwordx4 v[156:159], v2, s[24:27], s55 offen sc1
  s_and_b32 s55, s5, 1
  s_lshl_b32 s55, s55, 1
  s_add_u32 s55, s55, s53
  s_bfe_u32 s56, s5, 0x10001
  s_lshl_b32 s56, s56, 1
  s_add_u32 s56, s56, s54
  s_lshl_b32 s56, s56, 2
  s_add_u32 s55, s55, s56
  s_lshl_b32 s55, s55, 3
  s_and_b32 s56, s5, 12
  s_lshl_b32 s56, s56, 4
  s_add_u32 s56, s56, s4
  s_lshl_b32 s56, s56, 9
  s_add_u32 s55, s55, s56
  s_add_u32 s55, s55, 524288
  v_lshlrev_b32 v3, 13, v1
  v_add_u32 v3, s55, v3
  s_and_b32 s56, s5, 3
  s_mul_i32 s56, s56, 288
  s_mul_i32 s57, s6, 36864
  s_add_u32 s56, s56, s57
  s_add_u32 s58, s5, 0
  s_and_b32 s58, s58, 3
  s_lshr_b32 s57, s58, 1
  s_lshl_b32 s57, s57, 4
  s_and_b32 s59, s58, 1
  s_add_u32 s57, s57, s59
  s_lshl_b32 s59, s4, 1
  s_add_u32 s57, s57, s59
  s_mul_i32 s57, s57, 147456
  s_add_u32 s97, s57, s56
  s_add_u32 s58, s5, 1
  s_and_b32 s58, s58, 3
  s_lshr_b32 s57, s58, 1
  s_lshl_b32 s57, s57, 4
  s_and_b32 s59, s58, 1
  s_add_u32 s57, s57, s59
  s_lshl_b32 s59, s4, 1
  s_add_u32 s57, s57, s59
  s_mul_i32 s57, s57, 147456
  s_add_u32 s98, s57, s56
  s_add_u32 s58, s5, 2
  s_and_b32 s58, s58, 3
  s_lshr_b32 s57, s58, 1
  s_lshl_b32 s57, s57, 4
  s_and_b32 s59, s58, 1
  s_add_u32 s57, s57, s59
  s_lshl_b32 s59, s4, 1
  s_add_u32 s57, s57, s59
  s_mul_i32 s57, s57, 147456
  s_add_u32 s99, s57, s56
  s_add_u32 s58, s5, 3
  s_and_b32 s58, s58, 3
  s_lshr_b32 s57, s58, 1
  s_lshl_b32 s57, s57, 4
  s_and_b32 s59, s58, 1
  s_add_u32 s57, s57, s59
  s_lshl_b32 s59, s4, 1
  s_add_u32 s57, s57, s59
  s_mul_i32 s57, s57, 147456
  s_add_u32 s100, s57, s56
  s_waitcnt vmcnt(0)
  s_mov_b32 s57, 0x40000
L_non_24:
  v_or_b32 v6, v4, v5
  v_cmp_eq_u32 vcc, 0, v6
  s_cbranch_vccz L_nond_25
  s_sleep 2
  global_load_dwordx2 v[4:5], v14, s[34:35] sc1
  s_waitcnt vmcnt(0)
  s_sub_u32 s57, s57, 1
  s_cmp_lg_u32 s57, 0
  s_cbranch_scc1 L_non_24
L_nond_25:
  v_readfirstlane_b32 s88, v4
  v_readfirstlane_b32 s89, v5
  v_mov_b32 v6, v4
  v_mov_b32 v7, v5
  s_mov_b64 exec, 15
  buffer_store_dwordx2 v[6:7], v3, s[24:27], 0 offen sc1
  s_mov_b64 exec, -1
  s_barrier
  v_and_b32 v2, 3, v1
  s_lshl_b32 s56, s6, 2
  v_add_u32 v2, s56, v2
  v_lshlrev_b32 v2, 3, v2
  s_lshl_b32 s56, s2, 9
  s_add_u32 s56, s56, 524288
  v_add_u32 v2, s56, v2
  v_lshrrev_b32 v3, 5, v1
  v_bfe_u32 v10, v1, 4, 1
  v_and_b32 v11, 15, v1
  v_lshlrev_b32 v12, 10, v3
  v_lshl_add_u32 v12, v10, 9, v12
  v_lshl_add_u32 v26, v11, 4, v12
  v_bfe_u32 v11, v1, 2, 2
  v_and_b32 v12, 3, v1
  v_lshlrev_b32 v3, 4, v3
  v_lshl_add_u32 v3, v10, 2, v3
  v_add_u32 v3, v3, v11
  v_mul_u32_u24 v3, 288, v3
  v_lshl_add_u32 v27, v12, 3, v3
  v_add_u32 v28, 0, v27
  v_add_u32 v29, 36864, v27
  v_add_u32 v30, 73728, v27
  v_add_u32 v31, 110592, v27
  s_lshr_b32 s56, s5, 2
  s_lshl_b32 s56, s56, 1
  s_add_u32 s56, s56, s53
  s_lshl_b32 s56, s56, 19
  s_lshl_b32 s57, s54, 13
  s_add_u32 s56, s56, s57
  s_add_u32 s56, s56, 1048576
  s_add_u32 s58, s5, 0
  s_and_b32 s58, s58, 3
  s_lshr_b32 s57, s58, 1
  s_lshl_b32 s57, s57, 4
  s_and_b32 s59, s58, 1
  s_add_u32 s57, s57, s59
  s_lshl_b32 s59, s4, 1
  s_add_u32 s57, s57, s59
  s_lshl_b32 s57, s57, 14
  s_add_u32 s84, s57, s56
  s_add_u32 s58, s5, 1
  s_and_b32 s58, s58, 3
  s_lshr_b32 s57, s58, 1
  s_lshl_b32 s57, s57, 4
  s_and_b32 s59, s58, 1
  s_add_u32 s57, s57, s59
  s_lshl_b32 s59, s4, 1
  s_add_u32 s57, s57, s59
  s_lshl_b32 s57, s57, 14
  s_add_u32 s85, s57, s56
  s_add_u32 s58, s5, 2
  s_and_b32 s58, s58, 3
  s_lshr_b32 s57, s58, 1
  s_lshl_b32 s57, s57, 4
  s_and_b32 s59, s58, 1
  s_add_u32 s57, s57, s59
  s_lshl_b32 s59, s4, 1
  s_add_u32 s57, s57, s59
  s_lshl_b32 s57, s57, 14
  s_add_u32 s86, s57, s56
  s_add_u32 s58, s5, 3
  s_and_b32 s58, s58, 3
  s_lshr_b32 s57, s58, 1
  s_lshl_b32 s57, s57, 4
  s_and_b32 s59, s58, 1
  s_add_u32 s57, s57, s59
  s_lshl_b32 s59, s4, 1
  s_add_u32 s57, s57, s59
  s_lshl_b32 s57, s57, 14
  s_add_u32 s87, s57, s56
  s_mul_i32 s51, s6, 9216
  s_add_u32 m0, s51, 0
  s_nop 0
  buffer_load_dwordx4 v224, s[16:19], s97 offen lds
  s_add_u32 m0, s51, 1024
  s_nop 0
  buffer_load_dwordx4 v225, s[16:19], s97 offen lds
  s_add_u32 m0, s51, 2048
  s_nop 0
  buffer_load_dwordx4 v226, s[16:19], s97 offen lds
  s_add_u32 m0, s51, 3072
  s_nop 0
  buffer_load_dwordx4 v227, s[16:19], s97 offen lds
  s_add_u32 m0, s51, 4096
  s_nop 0
  buffer_load_dwordx4 v228, s[16:19], s97 offen lds
  s_add_u32 m0, s51, 5120
  s_nop 0
  buffer_load_dwordx4 v229, s[16:19], s97 offen lds
  s_add_u32 m0, s51, 6144
  s_nop 0
  buffer_load_dwordx4 v230, s[16:19], s97 offen lds
  s_add_u32 m0, s51, 7168
  s_nop 0
  buffer_load_dwordx4 v231, s[16:19], s97 offen lds
  s_add_u32 m0, s51, 8192
  s_nop 0
  buffer_load_dwordx4 v232, s[16:19], s97 offen lds
  s_mov_b32 s55, 0x20000
  buffer_load_dwordx2 v[240:241], v2, s[24:27], 0 offen sc1
L_spin_26:
  s_waitcnt vmcnt(0)
  v_cmp_ne_u64 vcc, s[88:89], v[240:241]
  s_cbranch_vccz L_spun_27
  s_sleep 1
  buffer_load_dwordx2 v[240:241], v2, s[24:27], 0 offen sc1
  s_sub_u32 s55, s55, 1
  s_cmp_lg_u32 s55, 0
  s_cbranch_scc1 L_spin_26
L_spun_27:
  s_add_u32 s55, s84, 0
  buffer_load_dwordx4 a[0:3], v26, s[24:27], s55 offen offset:0 sc1
  buffer_load_dwordx4 a[4:7], v26, s[24:27], s55 offen offset:256 sc1
  s_add_u32 s55, s84, 2048
  buffer_load_dwordx4 a[8:11], v26, s[24:27], s55 offen offset:0 sc1
  buffer_load_dwordx4 a[12:15], v26, s[24:27], s55 offen offset:256 sc1
  s_add_u32 s55, s84, 4096
  buffer_load_dwordx4 a[16:19], v26, s[24:27], s55 offen offset:0 sc1
  buffer_load_dwordx4 a[20:23], v26, s[24:27], s55 offen offset:256 sc1
  s_add_u32 s55, s84, 6144
  buffer_load_dwordx4 a[24:27], v26, s[24:27], s55 offen offset:0 sc1
  buffer_load_dwordx4 a[28:31], v26, s[24:27], s55 offen offset:256 sc1
  s_mul_i32 s51, s6, 9216
  s_add_u32 m0, s51, 36864
  s_nop 0
  buffer_load_dwordx4 v224, s[16:19], s98 offen lds
  s_add_u32 m0, s51, 37888
  s_nop 0
  buffer_load_dwordx4 v225, s[16:19], s98 offen lds
  s_add_u32 m0, s51, 38912
  s_nop 0
  buffer_load_dwordx4 v226, s[16:19], s98 offen lds
  s_add_u32 m0, s51, 39936
  s_nop 0
  buffer_load_dwordx4 v227, s[16:19], s98 offen lds
  s_add_u32 m0, s51, 40960
  s_nop 0
  buffer_load_dwordx4 v228, s[16:19], s98 offen lds
  s_add_u32 m0, s51, 41984
  s_nop 0
  buffer_load_dwordx4 v229, s[16:19], s98 offen lds
  s_add_u32 m0, s51, 43008
  s_nop 0
  buffer_load_dwordx4 v230, s[16:19], s98 offen lds
  s_add_u32 m0, s51, 44032
  s_nop 0
  buffer_load_dwordx4 v231, s[16:19], s98 offen lds
  s_add_u32 m0, s51, 45056
  s_nop 0
  buffer_load_dwordx4 v232, s[16:19], s98 offen lds
  s_add_u32 s55, s85, 0
  buffer_load_dwordx4 a[32:35], v26, s[24:27], s55 offen offset:0 sc1
  buffer_load_dwordx4 a[36:39], v26, s[24:27], s55 offen offset:256 sc1
  s_add_u32 s55, s85, 2048
  buffer_load_dwordx4 a[40:43], v26, s[24:27], s55 offen offset:0 sc1
  buffer_load_dwordx4 a[44:47], v26, s[24:27], s55 offen offset:256 sc1
  s_add_u32 s55, s85, 4096
  buffer_load_dwordx4 a[48:51], v26, s[24:27], s55 offen offset:0 sc1
  buffer_load_dwordx4 a[52:55], v26, s[24:27], s55 offen offset:256 sc1
  s_add_u32 s55, s85, 6144
  buffer_load_dwordx4 a[56:59], v26, s[24:27], s55 offen offset:0 sc1
  buffer_load_dwordx4 a[60:63], v26, s[24:27], s55 offen offset:256 sc1
  s_waitcnt vmcnt(17)
  s_barrier
  ds_read_b64_tr_b16 v[32:33], v28 offset:0
  ds_read_b64_tr_b16 v[34:35], v28 offset:2304
  ds_read_b64_tr_b16 v[36:37], v28 offset:32
  ds_read_b64_tr_b16 v[38:39], v28 offset:2336
  ds_read_b64_tr_b16 v[40:41], v28 offset:64
  ds_read_b64_tr_b16 v[42:43], v28 offset:2368
  ds_read_b64_tr_b16 v[44:45], v28 offset:96
  ds_read_b64_tr_b16 v[46:47], v28 offset:2400
  ds_read_b64_tr_b16 v[48:49], v28 offset:128
  ds_read_b64_tr_b16 v[50:51], v28 offset:2432
  ds_read_b64_tr_b16 v[52:53], v28 offset:160
  ds_read_b64_tr_b16 v[54:55], v28 offset:2464
  ds_read_b64_tr_b16 v[56:57], v28 offset:192
  ds_read_b64_tr_b16 v[58:59], v28 offset:2496
  s_waitcnt lgkmcnt(10)
  v_mfma_f32_16x16x32_bf16 v[64:67], v[32:35], a[0:3], 0
  v_mfma_f32_16x16x32_bf16 v[68:71], v[32:35], a[4:7], 0
  s_mul_i32 s51, s6, 9216
  s_add_u32 m0, s51, 73728
  ds_read_b64_tr_b16 v[60:61], v28 offset:224
  ds_read_b64_tr_b16 v[62:63], v28 offset:2528
  v_mfma_f32_16x16x32_bf16 v[72:75], v[36:39], a[0:3], 0
  v_mfma_f32_16x16x32_bf16 v[76:79], v[36:39], a[4:7], 0
  s_nop 0
  buffer_load_dwordx4 v224, s[16:19], s99 offen lds
  ds_read_b64_tr_b16 v[32:33], v28 offset:256
  ds_read_b64_tr_b16 v[34:35], v28 offset:2560
  s_waitcnt lgkmcnt(10)
  v_mfma_f32_16x16x32_bf16 v[80:83], v[40:43], a[0:3], 0
  v_mfma_f32_16x16x32_bf16 v[84:87], v[40:43], a[4:7], 0
  s_add_u32 m0, s51, 74752
  s_nop 0
  ds_read_b64_tr_b16 v[36:37], v28 offset:9216
  ds_read_b64_tr_b16 v[38:39], v28 offset:11520
  v_mfma_f32_16x16x32_bf16 v[88:91], v[44:47], a[0:3], 0
  v_mfma_f32_16x16x32_bf16 v[92:95], v[44:47], a[4:7], 0
  buffer_load_dwordx4 v225, s[16:19], s99 offen lds
  s_add_u32 m0, s51, 75776
  ds_read_b64_tr_b16 v[40:41], v28 offset:9248
  ds_read_b64_tr_b16 v[42:43], v28 offset:11552
  s_waitcnt lgkmcnt(10)
  v_mfma_f32_16x16x32_bf16 v[96:99], v[48:51], a[0:3], 0
  v_mfma_f32_16x16x32_bf16 v[100:103], v[48:51], a[4:7], 0
  s_nop 0
  buffer_load_dwordx4 v226, s[16:19], s99 offen lds
  ds_read_b64_tr_b16 v[44:45], v28 offset:9280
  ds_read_b64_tr_b16 v[46:47], v28 offset:11584
  v_mfma_f32_16x16x32_bf16 v[104:107], v[52:55], a[0:3], 0
  v_mfma_f32_16x16x32_bf16 v[108:111], v[52:55], a[4:7], 0
  s_add_u32 m0, s51, 76800
  s_nop 0
  ds_read_b64_tr_b16 v[48:49], v28 offset:9312
  ds_read_b64_tr_b16 v[50:51], v28 offset:11616
  s_waitcnt lgkmcnt(10)
  v_mfma_f32_16x16x32_bf16 v[112:115], v[56:59], a[0:3], 0
  v_mfma_f32_16x16x32_bf16 v[116:119], v[56:59], a[4:7], 0
  buffer_load_dwordx4 v227, s[16:19], s99 offen lds
  s_add_u32 m0, s51, 77824
  ds_read_b64_tr_b16 v[52:53], v28 offset:9344
  ds_read_b64_tr_b16 v[54:55], v28 offset:11648
  v_mfma_f32_16x16x32_bf16 v[120:123], v[60:63], a[0:3], 0
  v_mfma_f32_16x16x32_bf16 v[124:127], v[60:63], a[4:7], 0
  s_nop 0
  buffer_load_dwordx4 v228, s[16:19], s99 offen lds
  ds_read_b64_tr_b16 v[56:57], v28 offset:9376
  ds_read_b64_tr_b16 v[58:59], v28 offset:11680
  s_waitcnt lgkmcnt(10)
  v_mfma_f32_16x16x32_bf16 v[128:131], v[32:35], a[0:3], 0
  v_mfma_f32_16x16x32_bf16 v[132:135], v[32:35], a[4:7], 0
  s_add_u32 m0, s51, 78848
  s_nop 0
  ds_read_b64_tr_b16 v[60:61], v28 offset:9408
  ds_read_b64_tr_b16 v[62:63], v28 offset:11712
  v_mfma_f32_16x16x32_bf16 v[64:67], v[36:39], a[8:11], v[64:67]
  v_mfma_f32_16x16x32_bf16 v[68:71], v[36:39], a[12:15], v[68:71]
  buffer_load_dwordx4 v229, s[16:19], s99 offen lds
  s_add_u32 m0, s51, 79872
  ds_read_b64_tr_b16 v[32:33], v28 offset:9440
  ds_read_b64_tr_b16 v[34:35], v28 offset:11744
  s_waitcnt lgkmcnt(10)
  v_mfma_f32_16x16x32_bf16 v[72:75], v[40:43], a[8:11], v[72:75]
  v_mfma_f32_16x16x32_bf16 v[76:79], v[40:43], a[12:15], v[76:79]
  s_nop 0
  ds_read_b64_tr_b16 v[36:37], v28 offset:9472
  ds_read_b64_tr_b16 v[38:39], v28 offset:11776
  v_mfma_f32_16x16x32_bf16 v[80:83], v[44:47], a[8:11], v[80:83]
  v_mfma_f32_16x16x32_bf16 v[84:87], v[44:47], a[12:15], v[84:87]
  buffer_load_dwordx4 v230, s[16:19], s99 offen lds
  ds_read_b64_tr_b16 v[40:41], v28 offset:18432
  ds_read_b64_tr_b16 v[42:43], v28 offset:20736
  s_waitcnt lgkmcnt(10)
  v_mfma_f32_16x16x32_bf16 v[88:91], v[48:51], a[8:11], v[88:91]
  v_mfma_f32_16x16x32_bf16 v[92:95], v[48:51], a[12:15], v[92:95]
  s_add_u32 m0, s51, 80896
  ds_read_b64_tr_b16 v[44:45], v28 offset:18464
  ds_read_b64_tr_b16 v[46:47], v28 offset:20768
  v_mfma_f32_16x16x32_bf16 v[96:99], v[52:55], a[8:11], v[96:99]
  v_mfma_f32_16x16x32_bf16 v[100:103], v[52:55], a[12:15], v[100:103]
  s_nop 0
  ds_read_b64_tr_b16 v[48:49], v28 offset:18496
  ds_read_b64_tr_b16 v[50:51], v28 offset:20800
  s_waitcnt lgkmcnt(10)
  v_mfma_f32_16x16x32_bf16 v[104:107], v[56:59], a[8:11], v[104:107]
  v_mfma_f32_16x16x32_bf16 v[108:111], v[56:59], a[12:15], v[108:111]
  buffer_load_dwordx4 v231, s[16:19], s99 offen lds
  ds_read_b64_tr_b16 v[52:53], v28 offset:18528
  ds_read_b64_tr_b16 v[54:55], v28 offset:20832
  v_mfma_f32_16x16x32_bf16 v[112:115], v[60:63], a[8:11], v[112:115]
  v_mfma_f32_16x16x32_bf16 v[116:119], v[60:63], a[12:15], v[116:119]
  s_add_u32 m0, s51, 81920
  ds_read_b64_tr_b16 v[56:57], v28 offset:18560
  ds_read_b64_tr_b16 v[58:59], v28 offset:20864
  s_waitcnt lgkmcnt(10)
  v_mfma_f32_16x16x32_bf16 v[120:123], v[32:35], a[8:11], v[120:123]
  v_mfma_f32_16x16x32_bf16 v[124:127], v[32:35], a[12:15], v[124:127]
  s_nop 0
  ds_read_b64_tr_b16 v[60:61], v28 offset:18592
  ds_read_b64_tr_b16 v[62:63], v28 offset:20896
  v_mfma_f32_16x16x32_bf16 v[128:131], v[36:39], a[8:11], v[128:131]
  v_mfma_f32_16x16x32_bf16 v[132:135], v[36:39], a[12:15], v[132:135]
  buffer_load_dwordx4 v232, s[16:19], s99 offen lds
  ds_read_b64_tr_b16 v[32:33], v28 offset:18624
  ds_read_b64_tr_b16 v[34:35], v28 offset:20928
  s_waitcnt lgkmcnt(10)
  v_mfma_f32_16x16x32_bf16 v[64:67], v[40:43], a[16:19], v[64:67]
  v_mfma_f32_16x16x32_bf16 v[68:71], v[40:43], a[20:23], v[68:71]
  s_add_u32 s55, s86, 0
  ds_read_b64_tr_b16 v[36:37], v28 offset:18656
  ds_read_b64_tr_b16 v[38:39], v28 offset:20960
  v_mfma_f32_16x16x32_bf16 v[72:75], v[44:47], a[16:19], v[72:75]
  v_mfma_f32_16x16x32_bf16 v[76:79], v[44:47], a[20:23], v[76:79]
  buffer_load_dwordx4 a[64:67], v26, s[24:27], s55 offen offset:0 sc1
  ds_read_b64_tr_b16 v[40:41], v28 offset:18688
  ds_read_b64_tr_b16 v[42:43], v28 offset:20992
  s_waitcnt lgkmcnt(10)
  v_mfma_f32_16x16x32_bf16 v[80:83], v[48:51], a[16:19], v[80:83]
  v_mfma_f32_16x16x32_bf16 v[84:87], v[48:51], a[20:23], v[84:87]
  buffer_load_dwordx4 a[68:71], v26, s[24:27], s55 offen offset:256 sc1
  ds_read_b64_tr_b16 v[44:45], v28 offset:27648
  ds_read_b64_tr_b16 v[46:47], v28 offset:29952
  v_mfma_f32_16x16x32_bf16 v[88:91], v[52:55], a[16:19], v[88:91]
  v_mfma_f32_16x16x32_bf16 v[92:95], v[52:55], a[20:23], v[92:95]
  s_add_u32 s55, s86, 2048
  ds_read_b64_tr_b16 v[48:49], v28 offset:27680
  ds_read_b64_tr_b16 v[50:51], v28 offset:29984
  s_waitcnt lgkmcnt(10)
  v_mfma_f32_16x16x32_bf16 v[96:99], v[56:59], a[16:19], v[96:99]
  v_mfma_f32_16x16x32_bf16 v[100:103], v[56:59], a[20:23], v[100:103]
  buffer_load_dwordx4 a[72:75], v26, s[24:27], s55 offen offset:0 sc1
  ds_read_b64_tr_b16 v[52:53], v28 offset:27712
  ds_read_b64_tr_b16 v[54:55], v28 offset:30016
  v_mfma_f32_16x16x32_bf16 v[104:107], v[60:63], a[16:19], v[104:107]
  v_mfma_f32_16x16x32_bf16 v[108:111], v[60:63], a[20:23], v[108:111]
  buffer_load_dwordx4 a[76:79], v26, s[24:27], s55 offen offset:256 sc1
  ds_read_b64_tr_b16 v[56:57], v28 offset:27744
  ds_read_b64_tr_b16 v[58:59], v28 offset:30048
  s_waitcnt lgkmcnt(10)
  v_mfma_f32_16x16x32_bf16 v[112:115], v[32:35], a[16:19], v[112:115]
  v_mfma_f32_16x16x32_bf16 v[116:119], v[32:35], a[20:23], v[116:119]
  s_add_u32 s55, s86, 4096
  ds_read_b64_tr_b16 v[60:61], v28 offset:27776
  ds_read_b64_tr_b16 v[62:63], v28 offset:30080
  v_mfma_f32_16x16x32_bf16 v[120:123], v[36:39], a[16:19], v[120:123]
  v_mfma_f32_16x16x32_bf16 v[124:127], v[36:39], a[20:23], v[124:127]
  buffer_load_dwordx4 a[80:83], v26, s[24:27], s55 offen offset:0 sc1
  ds_read_b64_tr_b16 v[32:33], v28 offset:27808
  ds_read_b64_tr_b16 v[34:35], v28 offset:30112
  s_waitcnt lgkmcnt(10)
  v_mfma_f32_16x16x32_bf16 v[128:131], v[40:43], a[16:19], v[128:131]
  v_mfma_f32_16x16x32_bf16 v[132:135], v[40:43], a[20:23], v[132:135]
  buffer_load_dwordx4 a[84:87], v26, s[24:27], s55 offen offset:256 sc1
  ds_read_b64_tr_b16 v[36:37], v28 offset:27840
  ds_read_b64_tr_b16 v[38:39], v28 offset:30144
  v_mfma_f32_16x16x32_bf16 v[64:67], v[44:47], a[24:27], v[64:67]
  v_mfma_f32_16x16x32_bf16 v[68:71], v[44:47], a[28:31], v[68:71]
  s_add_u32 s55, s86, 6144
  ds_read_b64_tr_b16 v[40:41], v28 offset:27872
  ds_read_b64_tr_b16 v[42:43], v28 offset:30176
  s_waitcnt lgkmcnt(10)
  v_mfma_f32_16x16x32_bf16 v[72:75], v[48:51], a[24:27], v[72:75]
  v_mfma_f32_16x16x32_bf16 v[76:79], v[48:51], a[28:31], v[76:79]
  buffer_load_dwordx4 a[88:91], v26, s[24:27], s55 offen offset:0 sc1
  ds_read_b64_tr_b16 v[44:45], v28 offset:27904
  ds_read_b64_tr_b16 v[46:47], v28 offset:30208
  v_mfma_f32_16x16x32_bf16 v[80:83], v[52:55], a[24:27], v[80:83]
  v_mfma_f32_16x16x32_bf16 v[84:87], v[52:55], a[28:31], v[84:87]
  buffer_load_dwordx4 a[92:95], v26, s[24:27], s55 offen offset:256 sc1
  s_waitcnt lgkmcnt(8)
  v_mfma_f32_16x16x32_bf16 v[88:91], v[56:59], a[24:27], v[88:91]
  v_mfma_f32_16x16x32_bf16 v[92:95], v[56:59], a[28:31], v[92:95]
  v_mfma_f32_16x16x32_bf16 v[96:99], v[60:63], a[24:27], v[96:99]
  v_mfma_f32_16x16x32_bf16 v[100:103], v[60:63], a[28:31], v[100:103]
  s_waitcnt lgkmcnt(4)
  v_mfma_f32_16x16x32_bf16 v[104:107], v[32:35], a[24:27], v[104:107]
  v_mfma_f32_16x16x32_bf16 v[108:111], v[32:35], a[28:31], v[108:111]
  v_mfma_f32_16x16x32_bf16 v[112:115], v[36:39], a[24:27], v[112:115]
  v_mfma_f32_16x16x32_bf16 v[116:119], v[36:39], a[28:31], v[116:119]
  s_waitcnt lgkmcnt(0)
  v_mfma_f32_16x16x32_bf16 v[120:123], v[40:43], a[24:27], v[120:123]
  v_mfma_f32_16x16x32_bf16 v[124:127], v[40:43], a[28:31], v[124:127]
  v_mfma_f32_16x16x32_bf16 v[128:131], v[44:47], a[24:27], v[128:131]
  v_mfma_f32_16x16x32_bf16 v[132:135], v[44:47], a[28:31], v[132:135]
  s_waitcnt vmcnt(17)
  s_barrier
  ds_read_b64_tr_b16 v[48:49], v29 offset:0
  ds_read_b64_tr_b16 v[50:51], v29 offset:2304
  ds_read_b64_tr_b16 v[52:53], v29 offset:32
  ds_read_b64_tr_b16 v[54:55], v29 offset:2336
  ds_read_b64_tr_b16 v[56:57], v29 offset:64
  ds_read_b64_tr_b16 v[58:59], v29 offset:2368
  ds_read_b64_tr_b16 v[60:61], v29 offset:96
  ds_read_b64_tr_b16 v[62:63], v29 offset:2400
  ds_read_b64_tr_b16 v[32:33], v29 offset:128
  ds_read_b64_tr_b16 v[34:35], v29 offset:2432
  ds_read_b64_tr_b16 v[36:37], v29 offset:160
  ds_read_b64_tr_b16 v[38:39], v29 offset:2464
  ds_read_b64_tr_b16 v[40:41], v29 offset:192
  ds_read_b64_tr_b16 v[42:43], v29 offset:2496
  s_waitcnt lgkmcnt(10)
  v_mfma_f32_16x16x32_bf16 v[64:67], v[48:51], a[32:35], v[64:67]
  v_mfma_f32_16x16x32_bf16 v[68:71], v[48:51], a[36:39], v[68:71]
  s_mul_i32 s51, s6, 9216
  s_add_u32 m0, s51, 110592
  ds_read_b64_tr_b16 v[44:45], v29 offset:224
  ds_read_b64_tr_b16 v[46:47], v29 offset:2528
  v_mfma_f32_16x16x32_bf16 v[72:75], v[52:55], a[32:35], v[72:75]
  v_mfma_f32_16x16x32_bf16 v[76:79], v[52:55], a[36:39], v[76:79]
  s_nop 0
  buffer_load_dwordx4 v224, s[16:19], s100 offen lds
  ds_read_b64_tr_b16 v[48:49], v29 offset:256
  ds_read_b64_tr_b16 v[50:51], v29 offset:2560
  s_waitcnt lgkmcnt(10)
  v_mfma_f32_16x16x32_bf16 v[80:83], v[56:59], a[32:35], v[80:83]
  v_mfma_f32_16x16x32_bf16 v[84:87], v[56:59], a[36:39], v[84:87]
  s_add_u32 m0, s51, 111616
  s_nop 0
  ds_read_b64_tr_b16 v[52:53], v29 offset:9216
  ds_read_b64_tr_b16 v[54:55], v29 offset:11520
  v_mfma_f32_16x16x32_bf16 v[88:91], v[60:63], a[32:35], v[88:91]
  v_mfma_f32_16x16x32_bf16 v[92:95], v[60:63], a[36:39], v[92:95]
  buffer_load_dwordx4 v225, s[16:19], s100 offen lds
  s_add_u32 m0, s51, 112640
  ds_read_b64_tr_b16 v[56:57], v29 offset:9248
  ds_read_b64_tr_b16 v[58:59], v29 offset:11552
  s_waitcnt lgkmcnt(10)
  v_mfma_f32_16x16x32_bf16 v[96:99], v[32:35], a[32:35], v[96:99]
  v_mfma_f32_16x16x32_bf16 v[100:103], v[32:35], a[36:39], v[100:103]
  s_nop 0
  buffer_load_dwordx4 v226, s[16:19], s100 offen lds
  ds_read_b64_tr_b16 v[60:61], v29 offset:9280
  ds_read_b64_tr_b16 v[62:63], v29 offset:11584
  v_mfma_f32_16x16x32_bf16 v[104:107], v[36:39], a[32:35], v[104:107]
  v_mfma_f32_16x16x32_bf16 v[108:111], v[36:39], a[36:39], v[108:111]
  s_add_u32 m0, s51, 113664
  s_nop 0
  ds_read_b64_tr_b16 v[32:33], v29 offset:9312
  ds_read_b64_tr_b16 v[34:35], v29 offset:11616
  s_waitcnt lgkmcnt(10)
  v_mfma_f32_16x16x32_bf16 v[112:115], v[40:43], a[32:35], v[112:115]
  v_mfma_f32_16x16x32_bf16 v[116:119], v[40:43], a[36:39], v[116:119]
  buffer_load_dwordx4 v227, s[16:19], s100 offen lds
  s_add_u32 m0, s51, 114688
  ds_read_b64_tr_b16 v[36:37], v29 offset:9344
  ds_read_b64_tr_b16 v[38:39], v29 offset:11648
  v_mfma_f32_16x16x32_bf16 v[120:123], v[44:47], a[32:35], v[120:123]
  v_mfma_f32_16x16x32_bf16 v[124:127], v[44:47], a[36:39], v[124:127]
  s_nop 0
  buffer_load_dwordx4 v228, s[16:19], s100 offen lds
  ds_read_b64_tr_b16 v[40:41], v29 offset:9376
  ds_read_b64_tr_b16 v[42:43], v29 offset:11680
  s_waitcnt lgkmcnt(10)
  v_mfma_f32_16x16x32_bf16 v[128:131], v[48:51], a[32:35], v[128:131]
  v_mfma_f32_16x16x32_bf16 v[132:135], v[48:51], a[36:39], v[132:135]
  s_add_u32 m0, s51, 115712
  s_nop 0
  ds_read_b64_tr_b16 v[44:45], v29 offset:9408
  ds_read_b64_tr_b16 v[46:47], v29 offset:11712
  v_mfma_f32_16x16x32_bf16 v[64:67], v[52:55], a[40:43], v[64:67]
  v_mfma_f32_16x16x32_bf16 v[68:71], v[52:55], a[44:47], v[68:71]
  buffer_load_dwordx4 v229, s[16:19], s100 offen lds
  s_add_u32 m0, s51, 116736
  ds_read_b64_tr_b16 v[48:49], v29 offset:9440
  ds_read_b64_tr_b16 v[50:51], v29 offset:11744
  s_waitcnt lgkmcnt(10)
  v_mfma_f32_16x16x32_bf16 v[72:75], v[56:59], a[40:43], v[72:75]
  v_mfma_f32_16x16x32_bf16 v[76:79], v[56:59], a[44:47], v[76:79]
  s_nop 0
  ds_read_b64_tr_b16 v[52:53], v29 offset:9472
  ds_read_b64_tr_b16 v[54:55], v29 offset:11776
  v_mfma_f32_16x16x32_bf16 v[80:83], v[60:63], a[40:43], v[80:83]
  v_mfma_f32_16x16x32_bf16 v[84:87], v[60:63], a[44:47], v[84:87]
  buffer_load_dwordx4 v230, s[16:19], s100 offen lds
  ds_read_b64_tr_b16 v[56:57], v29 offset:18432
  ds_read_b64_tr_b16 v[58:59], v29 offset:20736
  s_waitcnt lgkmcnt(10)
  v_mfma_f32_16x16x32_bf16 v[88:91], v[32:35], a[40:43], v[88:91]
  v_mfma_f32_16x16x32_bf16 v[92:95], v[32:35], a[44:47], v[92:95]
  s_add_u32 m0, s51, 117760
  ds_read_b64_tr_b16 v[60:61], v29 offset:18464
  ds_read_b64_tr_b16 v[62:63], v29 offset:20768
  v_mfma_f32_16x16x32_bf16 v[96:99], v[36:39], a[40:43], v[96:99]
  v_mfma_f32_16x16x32_bf16 v[100:103], v[36:39], a[44:47], v[100:103]
  s_nop 0
  ds_read_b64_tr_b16 v[32:33], v29 offset:18496
  ds_read_b64_tr_b16 v[34:35], v29 offset:20800
  s_waitcnt lgkmcnt(10)
  v_mfma_f32_16x16x32_bf16 v[104:107], v[40:43], a[40:43], v[104:107]
  v_mfma_f32_16x16x32_bf16 v[108:111], v[40:43], a[44:47], v[108:111]
  buffer_load_dwordx4 v231, s[16:19], s100 offen lds
  ds_read_b64_tr_b16 v[36:37], v29 offset:18528
  ds_read_b64_tr_b16 v[38:39], v29 offset:20832
  v_mfma_f32_16x16x32_bf16 v[112:115], v[44:47], a[40:43], v[112:115]
  v_mfma_f32_16x16x32_bf16 v[116:119], v[44:47], a[44:47], v[116:119]
  s_add_u32 m0, s51, 118784
  ds_read_b64_tr_b16 v[40:41], v29 offset:18560
  ds_read_b64_tr_b16 v[42:43], v29 offset:20864
  s_waitcnt lgkmcnt(10)
  v_mfma_f32_16x16x32_bf16 v[120:123], v[48:51], a[40:43], v[120:123]
  v_mfma_f32_16x16x32_bf16 v[124:127], v[48:51], a[44:47], v[124:127]
  s_nop 0
  ds_read_b64_tr_b16 v[44:45], v29 offset:18592
  ds_read_b64_tr_b16 v[46:47], v29 offset:20896
  v_mfma_f32_16x16x32_bf16 v[128:131], v[52:55], a[40:43], v[128:131]
  v_mfma_f32_16x16x32_bf16 v[132:135], v[52:55], a[44:47], v[132:135]
  buffer_load_dwordx4 v232, s[16:19], s100 offen lds
  ds_read_b64_tr_b16 v[48:49], v29 offset:18624
  ds_read_b64_tr_b16 v[50:51], v29 offset:20928
  s_waitcnt lgkmcnt(10)
  v_mfma_f32_16x16x32_bf16 v[64:67], v[56:59], a[48:51], v[64:67]
  v_mfma_f32_16x16x32_bf16 v[68:71], v[56:59], a[52:55], v[68:71]
  s_add_u32 s55, s87, 0
  ds_read_b64_tr_b16 v[52:53], v29 offset:18656
  ds_read_b64_tr_b16 v[54:55], v29 offset:20960
  v_mfma_f32_16x16x32_bf16 v[72:75], v[60:63], a[48:51], v[72:75]
  v_mfma_f32_16x16x32_bf16 v[76:79], v[60:63], a[52:55], v[76:79]
  buffer_load_dwordx4 a[96:99], v26, s[24:27], s55 offen offset:0 sc1
  ds_read_b64_tr_b16 v[56:57], v29 offset:18688
  ds_read_b64_tr_b16 v[58:59], v29 offset:20992
  s_waitcnt lgkmcnt(10)
  v_mfma_f32_16x16x32_bf16 v[80:83], v[32:35], a[48:51], v[80:83]
  v_mfma_f32_16x16x32_bf16 v[84:87], v[32:35], a[52:55], v[84:87]
  buffer_load_dwordx4 a[100:103], v26, s[24:27], s55 offen offset:256 sc1
  ds_read_b64_tr_b16 v[60:61], v29 offset:27648
  ds_read_b64_tr_b16 v[62:63], v29 offset:29952
  v_mfma_f32_16x16x32_bf16 v[88:91], v[36:39], a[48:51], v[88:91]
  v_mfma_f32_16x16x32_bf16 v[92:95], v[36:39], a[52:55], v[92:95]
  s_add_u32 s55, s87, 2048
  ds_read_b64_tr_b16 v[32:33], v29 offset:27680
  ds_read_b64_tr_b16 v[34:35], v29 offset:29984
  s_waitcnt lgkmcnt(10)
  v_mfma_f32_16x16x32_bf16 v[96:99], v[40:43], a[48:51], v[96:99]
  v_mfma_f32_16x16x32_bf16 v[100:103], v[40:43], a[52:55], v[100:103]
  buffer_load_dwordx4 a[104:107], v26, s[24:27], s55 offen offset:0 sc1
  ds_read_b64_tr_b16 v[36:37], v29 offset:27712
  ds_read_b64_tr_b16 v[38:39], v29 offset:30016
  v_mfma_f32_16x16x32_bf16 v[104:107], v[44:47], a[48:51], v[104:107]
  v_mfma_f32_16x16x32_bf16 v[108:111], v[44:47], a[52:55], v[108:111]
  buffer_load_dwordx4 a[108:111], v26, s[24:27], s55 offen offset:256 sc1
  ds_read_b64_tr_b16 v[40:41], v29 offset:27744
  ds_read_b64_tr_b16 v[42:43], v29 offset:30048
  s_waitcnt lgkmcnt(10)
  v_mfma_f32_16x16x32_bf16 v[112:115], v[48:51], a[48:51], v[112:115]
  v_mfma_f32_16x16x32_bf16 v[116:119], v[48:51], a[52:55], v[116:119]
  s_add_u32 s55, s87, 4096
  ds_read_b64_tr_b16 v[44:45], v29 offset:27776
  ds_read_b64_tr_b16 v[46:47], v29 offset:30080
  v_mfma_f32_16x16x32_bf16 v[120:123], v[52:55], a[48:51], v[120:123]
  v_mfma_f32_16x16x32_bf16 v[124:127], v[52:55], a[52:55], v[124:127]
  buffer_load_dwordx4 a[112:115], v26, s[24:27], s55 offen offset:0 sc1
  ds_read_b64_tr_b16 v[48:49], v29 offset:27808
  ds_read_b64_tr_b16 v[50:51], v29 offset:30112
  s_waitcnt lgkmcnt(10)
  v_mfma_f32_16x16x32_bf16 v[128:131], v[56:59], a[48:51], v[128:131]
  v_mfma_f32_16x16x32_bf16 v[132:135], v[56:59], a[52:55], v[132:135]
  buffer_load_dwordx4 a[116:119], v26, s[24:27], s55 offen offset:256 sc1
  ds_read_b64_tr_b16 v[52:53], v29 offset:27840
  ds_read_b64_tr_b16 v[54:55], v29 offset:30144
  v_mfma_f32_16x16x32_bf16 v[64:67], v[60:63], a[56:59], v[64:67]
  v_mfma_f32_16x16x32_bf16 v[68:71], v[60:63], a[60:63], v[68:71]
  s_add_u32 s55, s87, 6144
  ds_read_b64_tr_b16 v[56:57], v29 offset:27872
  ds_read_b64_tr_b16 v[58:59], v29 offset:30176
  s_waitcnt lgkmcnt(10)
  v_mfma_f32_16x16x32_bf16 v[72:75], v[32:35], a[56:59], v[72:75]
  v_mfma_f32_16x16x32_bf16 v[76:79], v[32:35], a[60:63], v[76:79]
  buffer_load_dwordx4 a[120:123], v26, s[24:27], s55 offen offset:0 sc1
  ds_read_b64_tr_b16 v[60:61], v29 offset:27904
  ds_read_b64_tr_b16 v[62:63], v29 offset:30208
  v_mfma_f32_16x16x32_bf16 v[80:83], v[36:39], a[56:59], v[80:83]
  v_mfma_f32_16x16x32_bf16 v[84:87], v[36:39], a[60:63], v[84:87]
  buffer_load_dwordx4 a[124:127], v26, s[24:27], s55 offen offset:256 sc1
  s_waitcnt lgkmcnt(8)
  v_mfma_f32_16x16x32_bf16 v[88:91], v[40:43], a[56:59], v[88:91]
  v_mfma_f32_16x16x32_bf16 v[92:95], v[40:43], a[60:63], v[92:95]
  v_mfma_f32_16x16x32_bf16 v[96:99], v[44:47], a[56:59], v[96:99]
  v_mfma_f32_16x16x32_bf16 v[100:103], v[44:47], a[60:63], v[100:103]
  s_waitcnt lgkmcnt(4)
  v_mfma_f32_16x16x32_bf16 v[104:107], v[48:51], a[56:59], v[104:107]
  v_mfma_f32_16x16x32_bf16 v[108:111], v[48:51], a[60:63], v[108:111]
  v_mfma_f32_16x16x32_bf16 v[112:115], v[52:55], a[56:59], v[112:115]
  v_mfma_f32_16x16x32_bf16 v[116:119], v[52:55], a[60:63], v[116:119]
  s_waitcnt lgkmcnt(0)
  v_mfma_f32_16x16x32_bf16 v[120:123], v[56:59], a[56:59], v[120:123]
  v_mfma_f32_16x16x32_bf16 v[124:127], v[56:59], a[60:63], v[124:127]
  v_mfma_f32_16x16x32_bf16 v[128:131], v[60:63], a[56:59], v[128:131]
  v_mfma_f32_16x16x32_bf16 v[132:135], v[60:63], a[60:63], v[132:135]
  s_waitcnt vmcnt(17)
  s_barrier
  ds_read_b64_tr_b16 v[32:33], v30 offset:0
  ds_read_b64_tr_b16 v[34:35], v30 offset:2304
  ds_read_b64_tr_b16 v[36:37], v30 offset:32
  ds_read_b64_tr_b16 v[38:39], v30 offset:2336
  ds_read_b64_tr_b16 v[40:41], v30 offset:64
  ds_read_b64_tr_b16 v[42:43], v30 offset:2368
  ds_read_b64_tr_b16 v[44:45], v30 offset:96
  ds_read_b64_tr_b16 v[46:47], v30 offset:2400
  ds_read_b64_tr_b16 v[48:49], v30 offset:128
  ds_read_b64_tr_b16 v[50:51], v30 offset:2432
  ds_read_b64_tr_b16 v[52:53], v30 offset:160
  ds_read_b64_tr_b16 v[54:55], v30 offset:2464
  ds_read_b64_tr_b16 v[56:57], v30 offset:192
  ds_read_b64_tr_b16 v[58:59], v30 offset:2496
  s_waitcnt lgkmcnt(10)
  v_mfma_f32_16x16x32_bf16 v[64:67], v[32:35], a[64:67], v[64:67]
  v_mfma_f32_16x16x32_bf16 v[68:71], v[32:35], a[68:71], v[68:71]
  ds_read_b64_tr_b16 v[60:61], v30 offset:224
  ds_read_b64_tr_b16 v[62:63], v30 offset:2528
  v_mfma_f32_16x16x32_bf16 v[72:75], v[36:39], a[64:67], v[72:75]
  v_mfma_f32_16x16x32_bf16 v[76:79], v[36:39], a[68:71], v[76:79]
  ds_read_b64_tr_b16 v[32:33], v30 offset:256
  ds_read_b64_tr_b16 v[34:35], v30 offset:2560
  s_waitcnt lgkmcnt(10)
  v_mfma_f32_16x16x32_bf16 v[80:83], v[40:43], a[64:67], v[80:83]
  v_mfma_f32_16x16x32_bf16 v[84:87], v[40:43], a[68:71], v[84:87]
  ds_read_b64_tr_b16 v[36:37], v30 offset:9216
  ds_read_b64_tr_b16 v[38:39], v30 offset:11520
  v_mfma_f32_16x16x32_bf16 v[88:91], v[44:47], a[64:67], v[88:91]
  v_mfma_f32_16x16x32_bf16 v[92:95], v[44:47], a[68:71], v[92:95]
  ds_read_b64_tr_b16 v[40:41], v30 offset:9248
  ds_read_b64_tr_b16 v[42:43], v30 offset:11552
  s_waitcnt lgkmcnt(10)
  v_mfma_f32_16x16x32_bf16 v[96:99], v[48:51], a[64:67], v[96:99]
  v_mfma_f32_16x16x32_bf16 v[100:103], v[48:51], a[68:71], v[100:103]
  ds_read_b64_tr_b16 v[44:45], v30 offset:9280
  ds_read_b64_tr_b16 v[46:47], v30 offset:11584
  v_mfma_f32_16x16x32_bf16 v[104:107], v[52:55], a[64:67], v[104:107]
  v_mfma_f32_16x16x32_bf16 v[108:111], v[52:55], a[68:71], v[108:111]
  ds_read_b64_tr_b16 v[48:49], v30 offset:9312
  ds_read_b64_tr_b16 v[50:51], v30 offset:11616
  s_waitcnt lgkmcnt(10)
  v_mfma_f32_16x16x32_bf16 v[112:115], v[56:59], a[64:67], v[112:115]
  v_mfma_f32_16x16x32_bf16 v[116:119], v[56:59], a[68:71], v[116:119]
  ds_read_b64_tr_b16 v[52:53], v30 offset:9344
  ds_read_b64_tr_b16 v[54:55], v30 offset:11648
  v_mfma_f32_16x16x32_bf16 v[120:123], v[60:63], a[64:67], v[120:123]
  v_mfma_f32_16x16x32_bf16 v[124:127], v[60:63], a[68:71], v[124:127]
  ds_read_b64_tr_b16 v[56:57], v30 offset:9376
  ds_read_b64_tr_b16 v[58:59], v30 offset:11680
  s_waitcnt lgkmcnt(10)
  v_mfma_f32_16x16x32_bf16 v[128:131], v[32:35], a[64:67], v[128:131]
  v_mfma_f32_16x16x32_bf16 v[132:135], v[32:35], a[68:71], v[132:135]
  ds_read_b64_tr_b16 v[60:61], v30 offset:9408
  ds_read_b64_tr_b16 v[62:63], v30 offset:11712
  v_mfma_f32_16x16x32_bf16 v[64:67], v[36:39], a[72:75], v[64:67]
  v_mfma_f32_16x16x32_bf16 v[68:71], v[36:39], a[76:79], v[68:71]
  ds_read_b64_tr_b16 v[32:33], v30 offset:9440
  ds_read_b64_tr_b16 v[34:35], v30 offset:11744
  s_waitcnt lgkmcnt(10)
  v_mfma_f32_16x16x32_bf16 v[72:75], v[40:43], a[72:75], v[72:75]
  v_mfma_f32_16x16x32_bf16 v[76:79], v[40:43], a[76:79], v[76:79]
  ds_read_b64_tr_b16 v[36:37], v30 offset:9472
  ds_read_b64_tr_b16 v[38:39], v30 offset:11776
  v_mfma_f32_16x16x32_bf16 v[80:83], v[44:47], a[72:75], v[80:83]
  v_mfma_f32_16x16x32_bf16 v[84:87], v[44:47], a[76:79], v[84:87]
  ds_read_b64_tr_b16 v[40:41], v30 offset:18432
  ds_read_b64_tr_b16 v[42:43], v30 offset:20736
  s_waitcnt lgkmcnt(10)
  v_mfma_f32_16x16x32_bf16 v[88:91], v[48:51], a[72:75], v[88:91]
  v_mfma_f32_16x16x32_bf16 v[92:95], v[48:51], a[76:79], v[92:95]
  ds_read_b64_tr_b16 v[44:45], v30 offset:18464
  ds_read_b64_tr_b16 v[46:47], v30 offset:20768
  v_mfma_f32_16x16x32_bf16 v[96:99], v[52:55], a[72:75], v[96:99]
  v_mfma_f32_16x16x32_bf16 v[100:103], v[52:55], a[76:79], v[100:103]
  ds_read_b64_tr_b16 v[48:49], v30 offset:18496
  ds_read_b64_tr_b16 v[50:51], v30 offset:20800
  s_waitcnt lgkmcnt(10)
  v_mfma_f32_16x16x32_bf16 v[104:107], v[56:59], a[72:75], v[104:107]
  v_mfma_f32_16x16x32_bf16 v[108:111], v[56:59], a[76:79], v[108:111]
  ds_read_b64_tr_b16 v[52:53], v30 offset:18528
  ds_read_b64_tr_b16 v[54:55], v30 offset:20832
  v_mfma_f32_16x16x32_bf16 v[112:115], v[60:63], a[72:75], v[112:115]
  v_mfma_f32_16x16x32_bf16 v[116:119], v[60:63], a[76:79], v[116:119]
  ds_read_b64_tr_b16 v[56:57], v30 offset:18560
  ds_read_b64_tr_b16 v[58:59], v30 offset:20864
  s_waitcnt lgkmcnt(10)
  v_mfma_f32_16x16x32_bf16 v[120:123], v[32:35], a[72:75], v[120:123]
  v_mfma_f32_16x16x32_bf16 v[124:127], v[32:35], a[76:79], v[124:127]
  ds_read_b64_tr_b16 v[60:61], v30 offset:18592
  ds_read_b64_tr_b16 v[62:63], v30 offset:20896
  v_mfma_f32_16x16x32_bf16 v[128:131], v[36:39], a[72:75], v[128:131]
  v_mfma_f32_16x16x32_bf16 v[132:135], v[36:39], a[76:79], v[132:135]
  ds_read_b64_tr_b16 v[32:33], v30 offset:18624
  ds_read_b64_tr_b16 v[34:35], v30 offset:20928
  s_waitcnt lgkmcnt(10)
  v_mfma_f32_16x16x32_bf16 v[64:67], v[40:43], a[80:83], v[64:67]
  v_mfma_f32_16x16x32_bf16 v[68:71], v[40:43], a[84:87], v[68:71]
  ds_read_b64_tr_b16 v[36:37], v30 offset:18656
  ds_read_b64_tr_b16 v[38:39], v30 offset:20960
  v_mfma_f32_16x16x32_bf16 v[72:75], v[44:47], a[80:83], v[72:75]
  v_mfma_f32_16x16x32_bf16 v[76:79], v[44:47], a[84:87], v[76:79]
  ds_read_b64_tr_b16 v[40:41], v30 offset:18688
  ds_read_b64_tr_b16 v[42:43], v30 offset:20992
  s_waitcnt lgkmcnt(10)
  v_mfma_f32_16x16x32_bf16 v[80:83], v[48:51], a[80:83], v[80:83]
  v_mfma_f32_16x16x32_bf16 v[84:87], v[48:51], a[84:87], v[84:87]
  ds_read_b64_tr_b16 v[44:45], v30 offset:27648
  ds_read_b64_tr_b16 v[46:47], v30 offset:29952
  v_mfma_f32_16x16x32_bf16 v[88:91], v[52:55], a[80:83], v[88:91]
  v_mfma_f32_16x16x32_bf16 v[92:95], v[52:55], a[84:87], v[92:95]
  ds_read_b64_tr_b16 v[48:49], v30 offset:27680
  ds_read_b64_tr_b16 v[50:51], v30 offset:29984
  s_waitcnt lgkmcnt(10)
  v_mfma_f32_16x16x32_bf16 v[96:99], v[56:59], a[80:83], v[96:99]
  v_mfma_f32_16x16x32_bf16 v[100:103], v[56:59], a[84:87], v[100:103]
  ds_read_b64_tr_b16 v[52:53], v30 offset:27712
  ds_read_b64_tr_b16 v[54:55], v30 offset:30016
  v_mfma_f32_16x16x32_bf16 v[104:107], v[60:63], a[80:83], v[104:107]
  v_mfma_f32_16x16x32_bf16 v[108:111], v[60:63], a[84:87], v[108:111]
  ds_read_b64_tr_b16 v[56:57], v30 offset:27744
  ds_read_b64_tr_b16 v[58:59], v30 offset:30048
  s_waitcnt lgkmcnt(10)
  v_mfma_f32_16x16x32_bf16 v[112:115], v[32:35], a[80:83], v[112:115]
  v_mfma_f32_16x16x32_bf16 v[116:119], v[32:35], a[84:87], v[116:119]
  ds_read_b64_tr_b16 v[60:61], v30 offset:27776
  ds_read_b64_tr_b16 v[62:63], v30 offset:30080
  v_mfma_f32_16x16x32_bf16 v[120:123], v[36:39], a[80:83], v[120:123]
  v_mfma_f32_16x16x32_bf16 v[124:127], v[36:39], a[84:87], v[124:127]
  ds_read_b64_tr_b16 v[32:33], v30 offset:27808
  ds_read_b64_tr_b16 v[34:35], v30 offset:30112
  s_waitcnt lgkmcnt(10)
  v_mfma_f32_16x16x32_bf16 v[128:131], v[40:43], a[80:83], v[128:131]
  v_mfma_f32_16x16x32_bf16 v[132:135], v[40:43], a[84:87], v[132:135]
  ds_read_b64_tr_b16 v[36:37], v30 offset:27840
  ds_read_b64_tr_b16 v[38:39], v30 offset:30144
  v_mfma_f32_16x16x32_bf16 v[64:67], v[44:47], a[88:91], v[64:67]
  v_mfma_f32_16x16x32_bf16 v[68:71], v[44:47], a[92:95], v[68:71]
  ds_read_b64_tr_b16 v[40:41], v30 offset:27872
  ds_read_b64_tr_b16 v[42:43], v30 offset:30176
  s_waitcnt lgkmcnt(10)
  v_mfma_f32_16x16x32_bf16 v[72:75], v[48:51], a[88:91], v[72:75]
  v_mfma_f32_16x16x32_bf16 v[76:79], v[48:51], a[92:95], v[76:79]
  ds_read_b64_tr_b16 v[44:45], v30 offset:27904
  ds_read_b64_tr_b16 v[46:47], v30 offset:30208
  v_mfma_f32_16x16x32_bf16 v[80:83], v[52:55], a[88:91], v[80:83]
  v_mfma_f32_16x16x32_bf16 v[84:87], v[52:55], a[92:95], v[84:87]
  s_waitcnt lgkmcnt(8)
  v_mfma_f32_16x16x32_bf16 v[88:91], v[56:59], a[88:91], v[88:91]
  v_mfma_f32_16x16x32_bf16 v[92:95], v[56:59], a[92:95], v[92:95]
  v_mfma_f32_16x16x32_bf16 v[96:99], v[60:63], a[88:91], v[96:99]
  v_mfma_f32_16x16x32_bf16 v[100:103], v[60:63], a[92:95], v[100:103]
  s_waitcnt lgkmcnt(4)
  v_mfma_f32_16x16x32_bf16 v[104:107], v[32:35], a[88:91], v[104:107]
  v_mfma_f32_16x16x32_bf16 v[108:111], v[32:35], a[92:95], v[108:111]
  v_mfma_f32_16x16x32_bf16 v[112:115], v[36:39], a[88:91], v[112:115]
  v_mfma_f32_16x16x32_bf16 v[116:119], v[36:39], a[92:95], v[116:119]
  s_waitcnt lgkmcnt(0)
  v_mfma_f32_16x16x32_bf16 v[120:123], v[40:43], a[88:91], v[120:123]
  v_mfma_f32_16x16x32_bf16 v[124:127], v[40:43], a[92:95], v[124:127]
  v_mfma_f32_16x16x32_bf16 v[128:131], v[44:47], a[88:91], v[128:131]
  v_mfma_f32_16x16x32_bf16 v[132:135], v[44:47], a[92:95], v[132:135]
  s_waitcnt vmcnt(0)
  s_barrier
  s_lshl_b32 s56, s5, 3
  s_add_u32 s56, s56, s4
  s_mul_i32 s56, s56, 36864
  s_mul_i32 s57, s6, 9216
  s_add_u32 s56, s56, s57
  s_add_u32 s58, s56, 9437184
  v_lshlrev_b32 v2, 4, v1
  ds_read_b64_tr_b16 v[48:49], v31 offset:0
  ds_read_b64_tr_b16 v[50:51], v31 offset:2304
  ds_read_b64_tr_b16 v[52:53], v31 offset:9216
  ds_read_b64_tr_b16 v[54:55], v31 offset:11520
  ds_read_b64_tr_b16 v[56:57], v31 offset:18432
  ds_read_b64_tr_b16 v[58:59], v31 offset:20736
  ds_read_b64_tr_b16 v[60:61], v31 offset:27648
  ds_read_b64_tr_b16 v[62:63], v31 offset:29952
  ds_read_b64_tr_b16 v[32:33], v31 offset:32
  ds_read_b64_tr_b16 v[34:35], v31 offset:2336
  ds_read_b64_tr_b16 v[36:37], v31 offset:9248
  ds_read_b64_tr_b16 v[38:39], v31 offset:11552
  ds_read_b64_tr_b16 v[40:41], v31 offset:18464
  ds_read_b64_tr_b16 v[42:43], v31 offset:20768
  s_waitcnt lgkmcnt(10)
  v_mfma_f32_16x16x32_bf16 v[64:67], v[48:51], a[96:99], v[64:67]
  v_mfma_f32_16x16x32_bf16 v[68:71], v[48:51], a[100:103], v[68:71]
  ds_read_b64_tr_b16 v[44:45], v31 offset:27680
  ds_read_b64_tr_b16 v[46:47], v31 offset:29984
  v_mfma_f32_16x16x32_bf16 v[64:67], v[52:55], a[104:107], v[64:67]
  v_mfma_f32_16x16x32_bf16 v[68:71], v[52:55], a[108:111], v[68:71]
  ds_read_b64_tr_b16 v[48:49], v31 offset:64
  ds_read_b64_tr_b16 v[50:51], v31 offset:2368
  s_waitcnt lgkmcnt(10)
  v_mfma_f32_16x16x32_bf16 v[64:67], v[56:59], a[112:115], v[64:67]
  v_mfma_f32_16x16x32_bf16 v[68:71], v[56:59], a[116:119], v[68:71]
  ds_read_b64_tr_b16 v[52:53], v31 offset:9280
  ds_read_b64_tr_b16 v[54:55], v31 offset:11584
  v_mfma_f32_16x16x32_bf16 v[64:67], v[60:63], a[120:123], v[64:67]
  v_mfma_f32_16x16x32_bf16 v[68:71], v[60:63], a[124:127], v[68:71]
  ds_read_b64_tr_b16 v[56:57], v31 offset:18496
  ds_read_b64_tr_b16 v[58:59], v31 offset:20800
  s_waitcnt lgkmcnt(10)
  v_mfma_f32_16x16x32_bf16 v[72:75], v[32:35], a[96:99], v[72:75]
  v_mfma_f32_16x16x32_bf16 v[76:79], v[32:35], a[100:103], v[76:79]
  ds_read_b64_tr_b16 v[60:61], v31 offset:27712
  ds_read_b64_tr_b16 v[62:63], v31 offset:30016
  v_mfma_f32_16x16x32_bf16 v[72:75], v[36:39], a[104:107], v[72:75]
  v_mfma_f32_16x16x32_bf16 v[76:79], v[36:39], a[108:111], v[76:79]
  ds_read_b64_tr_b16 v[32:33], v31 offset:96
  ds_read_b64_tr_b16 v[34:35], v31 offset:2400
  s_waitcnt lgkmcnt(10)
  v_mfma_f32_16x16x32_bf16 v[72:75], v[40:43], a[112:115], v[72:75]
  v_mfma_f32_16x16x32_bf16 v[76:79], v[40:43], a[116:119], v[76:79]
  ds_read_b64_tr_b16 v[36:37], v31 offset:9312
  ds_read_b64_tr_b16 v[38:39], v31 offset:11616
  v_mfma_f32_16x16x32_bf16 v[72:75], v[44:47], a[120:123], v[72:75]
  v_mfma_f32_16x16x32_bf16 v[76:79], v[44:47], a[124:127], v[76:79]
  v_cvt_pk_bf16_f32 v160, v64, v65
  v_cvt_pk_bf16_f32 v161, v66, v67
  v_cvt_pk_bf16_f32 v162, v68, v69
  v_cvt_pk_bf16_f32 v163, v70, v71
  s_add_u32 s57, s58, 0
  buffer_store_dwordx4 v[160:163], v2, s[24:27], s57 offen sc1
  ds_read_b64_tr_b16 v[40:41], v31 offset:18528
  ds_read_b64_tr_b16 v[42:43], v31 offset:20832
  s_waitcnt lgkmcnt(10)
  v_mfma_f32_16x16x32_bf16 v[80:83], v[48:51], a[96:99], v[80:83]
  v_mfma_f32_16x16x32_bf16 v[84:87], v[48:51], a[100:103], v[84:87]
  ds_read_b64_tr_b16 v[44:45], v31 offset:27744
  ds_read_b64_tr_b16 v[46:47], v31 offset:30048
  v_mfma_f32_16x16x32_bf16 v[80:83], v[52:55], a[104:107], v[80:83]
  v_mfma_f32_16x16x32_bf16 v[84:87], v[52:55], a[108:111], v[84:87]
  ds_read_b64_tr_b16 v[48:49], v31 offset:128
  ds_read_b64_tr_b16 v[50:51], v31 offset:2432
  s_waitcnt lgkmcnt(10)
  v_mfma_f32_16x16x32_bf16 v[80:83], v[56:59], a[112:115], v[80:83]
  v_mfma_f32_16x16x32_bf16 v[84:87], v[56:59], a[116:119], v[84:87]
  ds_read_b64_tr_b16 v[52:53], v31 offset:9344
  ds_read_b64_tr_b16 v[54:55], v31 offset:11648
  v_mfma_f32_16x16x32_bf16 v[80:83], v[60:63], a[120:123], v[80:83]
  v_mfma_f32_16x16x32_bf16 v[84:87], v[60:63], a[124:127], v[84:87]
  v_cvt_pk_bf16_f32 v164, v72, v73
  v_cvt_pk_bf16_f32 v165, v74, v75
  v_cvt_pk_bf16_f32 v166, v76, v77
  v_cvt_pk_bf16_f32 v167, v78, v79
  s_add_u32 s57, s58, 1024
  buffer_store_dwordx4 v[164:167], v2, s[24:27], s57 offen sc1
  ds_read_b64_tr_b16 v[56:57], v31 offset:18560
  ds_read_b64_tr_b16 v[58:59], v31 offset:20864
  s_waitcnt lgkmcnt(10)
  v_mfma_f32_16x16x32_bf16 v[88:91], v[32:35], a[96:99], v[88:91]
  v_mfma_f32_16x16x32_bf16 v[92:95], v[32:35], a[100:103], v[92:95]
  ds_read_b64_tr_b16 v[60:61], v31 offset:27776
  ds_read_b64_tr_b16 v[62:63], v31 offset:30080
  v_mfma_f32_16x16x32_bf16 v[88:91], v[36:39], a[104:107], v[88:91]
  v_mfma_f32_16x16x32_bf16 v[92:95], v[36:39], a[108:111], v[92:95]
  ds_read_b64_tr_b16 v[32:33], v31 offset:160
  ds_read_b64_tr_b16 v[34:35], v31 offset:2464
  s_waitcnt lgkmcnt(10)
  v_mfma_f32_16x16x32_bf16 v[88:91], v[40:43], a[112:115], v[88:91]
  v_mfma_f32_16x16x32_bf16 v[92:95], v[40:43], a[116:119], v[92:95]
  ds_read_b64_tr_b16 v[36:37], v31 offset:9376
  ds_read_b64_tr_b16 v[38:39], v31 offset:11680
  v_mfma_f32_16x16x32_bf16 v[88:91], v[44:47], a[120:123], v[88:91]
  v_mfma_f32_16x16x32_bf16 v[92:95], v[44:47], a[124:127], v[92:95]
  v_cvt_pk_bf16_f32 v168, v80, v81
  v_cvt_pk_bf16_f32 v169, v82, v83
  v_cvt_pk_bf16_f32 v170, v84, v85
  v_cvt_pk_bf16_f32 v171, v86, v87
  s_add_u32 s57, s58, 2048
  buffer_store_dwordx4 v[168:171], v2, s[24:27], s57 offen sc1
  ds_read_b64_tr_b16 v[40:41], v31 offset:18592
  ds_read_b64_tr_b16 v[42:43], v31 offset:20896
  s_waitcnt lgkmcnt(10)
  v_mfma_f32_16x16x32_bf16 v[96:99], v[48:51], a[96:99], v[96:99]
  v_mfma_f32_16x16x32_bf16 v[100:103], v[48:51], a[100:103], v[100:103]
  ds_read_b64_tr_b16 v[44:45], v31 offset:27808
  ds_read_b64_tr_b16 v[46:47], v31 offset:30112
  v_mfma_f32_16x16x32_bf16 v[96:99], v[52:55], a[104:107], v[96:99]
  v_mfma_f32_16x16x32_bf16 v[100:103], v[52:55], a[108:111], v[100:103]
  ds_read_b64_tr_b16 v[48:49], v31 offset:192
  ds_read_b64_tr_b16 v[50:51], v31 offset:2496
  s_waitcnt lgkmcnt(10)
  v_mfma_f32_16x16x32_bf16 v[96:99], v[56:59], a[112:115], v[96:99]
  v_mfma_f32_16x16x32_bf16 v[100:103], v[56:59], a[116:119], v[100:103]
  ds_read_b64_tr_b16 v[52:53], v31 offset:9408
  ds_read_b64_tr_b16 v[54:55], v31 offset:11712
  v_mfma_f32_16x16x32_bf16 v[96:99], v[60:63], a[120:123], v[96:99]
  v_mfma_f32_16x16x32_bf16 v[100:103], v[60:63], a[124:127], v[100:103]
  v_cvt_pk_bf16_f32 v172, v88, v89
  v_cvt_pk_bf16_f32 v173, v90, v91
  v_cvt_pk_bf16_f32 v174, v92, v93
  v_cvt_pk_bf16_f32 v175, v94, v95
  s_add_u32 s57, s58, 3072
  buffer_store_dwordx4 v[172:175], v2, s[24:27], s57 offen sc1
  ds_read_b64_tr_b16 v[56:57], v31 offset:18624
  ds_read_b64_tr_b16 v[58:59], v31 offset:20928
  s_waitcnt lgkmcnt(10)
  v_mfma_f32_16x16x32_bf16 v[104:107], v[32:35], a[96:99], v[104:107]
  v_mfma_f32_16x16x32_bf16 v[108:111], v[32:35], a[100:103], v[108:111]
  ds_read_b64_tr_b16 v[60:61], v31 offset:27840
  ds_read_b64_tr_b16 v[62:63], v31 offset:30144
  v_mfma_f32_16x16x32_bf16 v[104:107], v[36:39], a[104:107], v[104:107]
  v_mfma_f32_16x16x32_bf16 v[108:111], v[36:39], a[108:111], v[108:111]
  ds_read_b64_tr_b16 v[32:33], v31 offset:224
  ds_read_b64_tr_b16 v[34:35], v31 offset:2528
  s_waitcnt lgkmcnt(10)
  v_mfma_f32_16x16x32_bf16 v[104:107], v[40:43], a[112:115], v[104:107]
  v_mfma_f32_16x16x32_bf16 v[108:111], v[40:43], a[116:119], v[108:111]
  ds_read_b64_tr_b16 v[36:37], v31 offset:9440
  ds_read_b64_tr_b16 v[38:39], v31 offset:11744
  v_mfma_f32_16x16x32_bf16 v[104:107], v[44:47], a[120:123], v[104:107]
  v_mfma_f32_16x16x32_bf16 v[108:111], v[44:47], a[124:127], v[108:111]
  v_cvt_pk_bf16_f32 v176, v96, v97
  v_cvt_pk_bf16_f32 v177, v98, v99
  v_cvt_pk_bf16_f32 v178, v100, v101
  v_cvt_pk_bf16_f32 v179, v102, v103
  s_add_u32 s57, s58, 4096
  buffer_store_dwordx4 v[176:179], v2, s[24:27], s57 offen sc1
  ds_read_b64_tr_b16 v[40:41], v31 offset:18656
  ds_read_b64_tr_b16 v[42:43], v31 offset:20960
  s_waitcnt lgkmcnt(10)
  v_mfma_f32_16x16x32_bf16 v[112:115], v[48:51], a[96:99], v[112:115]
  v_mfma_f32_16x16x32_bf16 v[116:119], v[48:51], a[100:103], v[116:119]
  ds_read_b64_tr_b16 v[44:45], v31 offset:27872
  ds_read_b64_tr_b16 v[46:47], v31 offset:30176
  v_mfma_f32_16x16x32_bf16 v[112:115], v[52:55], a[104:107], v[112:115]
  v_mfma_f32_16x16x32_bf16 v[116:119], v[52:55], a[108:111], v[116:119]
  ds_read_b64_tr_b16 v[48:49], v31 offset:256
  ds_read_b64_tr_b16 v[50:51], v31 offset:2560
  s_waitcnt lgkmcnt(10)
  v_mfma_f32_16x16x32_bf16 v[112:115], v[56:59], a[112:115], v[112:115]
  v_mfma_f32_16x16x32_bf16 v[116:119], v[56:59], a[116:119], v[116:119]
  ds_read_b64_tr_b16 v[52:53], v31 offset:9472
  ds_read_b64_tr_b16 v[54:55], v31 offset:11776
  v_mfma_f32_16x16x32_bf16 v[112:115], v[60:63], a[120:123], v[112:115]
  v_mfma_f32_16x16x32_bf16 v[116:119], v[60:63], a[124:127], v[116:119]
  v_cvt_pk_bf16_f32 v180, v104, v105
  v_cvt_pk_bf16_f32 v181, v106, v107
  v_cvt_pk_bf16_f32 v182, v108, v109
  v_cvt_pk_bf16_f32 v183, v110, v111
  s_add_u32 s57, s58, 5120
  buffer_store_dwordx4 v[180:183], v2, s[24:27], s57 offen sc1
  ds_read_b64_tr_b16 v[56:57], v31 offset:18688
  ds_read_b64_tr_b16 v[58:59], v31 offset:20992
  s_waitcnt lgkmcnt(10)
  v_mfma_f32_16x16x32_bf16 v[120:123], v[32:35], a[96:99], v[120:123]
  v_mfma_f32_16x16x32_bf16 v[124:127], v[32:35], a[100:103], v[124:127]
  ds_read_b64_tr_b16 v[60:61], v31 offset:27904
  ds_read_b64_tr_b16 v[62:63], v31 offset:30208
  v_mfma_f32_16x16x32_bf16 v[120:123], v[36:39], a[104:107], v[120:123]
  v_mfma_f32_16x16x32_bf16 v[124:127], v[36:39], a[108:111], v[124:127]
  s_waitcnt lgkmcnt(8)
  v_mfma_f32_16x16x32_bf16 v[120:123], v[40:43], a[112:115], v[120:123]
  v_mfma_f32_16x16x32_bf16 v[124:127], v[40:43], a[116:119], v[124:127]
  v_mfma_f32_16x16x32_bf16 v[120:123], v[44:47], a[120:123], v[120:123]
  v_mfma_f32_16x16x32_bf16 v[124:127], v[44:47], a[124:127], v[124:127]
  v_cvt_pk_bf16_f32 v184, v112, v113
  v_cvt_pk_bf16_f32 v185, v114, v115
  v_cvt_pk_bf16_f32 v186, v116, v117
  v_cvt_pk_bf16_f32 v187, v118, v119
  s_add_u32 s57, s58, 6144
  buffer_store_dwordx4 v[184:187], v2, s[24:27], s57 offen sc1
  s_waitcnt lgkmcnt(4)
  v_mfma_f32_16x16x32_bf16 v[128:131], v[48:51], a[96:99], v[128:131]
  v_mfma_f32_16x16x32_bf16 v[132:135], v[48:51], a[100:103], v[132:135]
  v_mfma_f32_16x16x32_bf16 v[128:131], v[52:55], a[104:107], v[128:131]
  v_mfma_f32_16x16x32_bf16 v[132:135], v[52:55], a[108:111], v[132:135]
  s_waitcnt lgkmcnt(0)
  v_mfma_f32_16x16x32_bf16 v[128:131], v[56:59], a[112:115], v[128:131]
  v_mfma_f32_16x16x32_bf16 v[132:135], v[56:59], a[116:119], v[132:135]
  v_mfma_f32_16x16x32_bf16 v[128:131], v[60:63], a[120:123], v[128:131]
  v_mfma_f32_16x16x32_bf16 v[132:135], v[60:63], a[124:127], v[132:135]
  v_cvt_pk_bf16_f32 v188, v120, v121
  v_cvt_pk_bf16_f32 v189, v122, v123
  v_cvt_pk_bf16_f32 v190, v124, v125
  v_cvt_pk_bf16_f32 v191, v126, v127
  s_add_u32 s57, s58, 7168
  buffer_store_dwordx4 v[188:191], v2, s[24:27], s57 offen sc1
  s_nop 7
  v_cvt_pk_bf16_f32 v192, v128, v129
  v_cvt_pk_bf16_f32 v193, v130, v131
  v_cvt_pk_bf16_f32 v194, v132, v133
  v_cvt_pk_bf16_f32 v195, v134, v135
  s_add_u32 s57, s58, 8192
  buffer_store_dwordx4 v[192:195], v2, s[24:27], s57 offen sc1
  s_lshl_b32 s56, s6, 1
  s_lshl_b32 s57, s5, 4
  s_add_u32 s56, s56, s57
  s_lshl_b32 s57, s90, 3
  s_add_u32 s56, s56, s57
  v_add_u32 v3, s56, v1
  s_lshl_b32 s57, s4, 3
  s_add_u32 s57, s57, 524416
  v_lshlrev_b32 v3, 9, v3
  v_add_u32 v3, s57, v3
  v_mov_b32 v6, s88
  v_mov_b32 v7, s89
  s_waitcnt vmcnt(0)
  s_mov_b64 exec, 3
  buffer_store_dwordx2 v[6:7], v3, s[24:27], 0 offen sc1
  s_mov_b64 exec, -1
  s_barrier
  s_mov_b32 s16, s42
  s_and_b32 s17, s43, 0xffff
  s_mov_b32 s18, 0x480000
  s_mov_b32 s19, 0x20000
  s_and_b32 s56, s5, 3
  s_mul_i32 s56, s56, 288
  s_mul_i32 s57, s6, 36864
  s_add_u32 s56, s56, s57
  s_add_u32 s58, s5, 0
  s_and_b32 s58, s58, 3
  s_lshl_b32 s57, s58, 3
  s_add_u32 s57, s57, s4
  s_mul_i32 s57, s57, 147456
  s_add_u32 s97, s57, s56
  s_add_u32 s58, s5, 1
  s_and_b32 s58, s58, 3
  s_lshl_b32 s57, s58, 3
  s_add_u32 s57, s57, s4
  s_mul_i32 s57, s57, 147456
  s_add_u32 s98, s57, s56
  s_add_u32 s58, s5, 2
  s_and_b32 s58, s58, 3
  s_lshl_b32 s57, s58, 3
  s_add_u32 s57, s57, s4
  s_mul_i32 s57, s57, 147456
  s_add_u32 s99, s57, s56
  s_add_u32 s58, s5, 3
  s_and_b32 s58, s58, 3
  s_lshl_b32 s57, s58, 3
  s_add_u32 s57, s57, s4
  s_mul_i32 s57, s57, 147456
  s_add_u32 s100, s57, s56
  s_mul_i32 s51, s6, 9216
  s_add_u32 m0, s51, 0
  s_nop 0
  buffer_load_dwordx4 v224, s[16:19], s97 offen lds
  s_add_u32 m0, s51, 1024
  s_nop 0
  buffer_load_dwordx4 v225, s[16:19], s97 offen lds
  s_add_u32 m0, s51, 2048
  s_nop 0
  buffer_load_dwordx4 v226, s[16:19], s97 offen lds
  s_add_u32 m0, s51, 3072
  s_nop 0
  buffer_load_dwordx4 v227, s[16:19], s97 offen lds
  s_add_u32 m0, s51, 4096
  s_nop 0
  buffer_load_dwordx4 v228, s[16:19], s97 offen lds
  s_add_u32 m0, s51, 5120
  s_nop 0
  buffer_load_dwordx4 v229, s[16:19], s97 offen lds
  s_add_u32 m0, s51, 6144
  s_nop 0
  buffer_load_dwordx4 v230, s[16:19], s97 offen lds
  s_add_u32 m0, s51, 7168
  s_nop 0
  buffer_load_dwordx4 v231, s[16:19], s97 offen lds
  s_add_u32 m0, s51, 8192
  s_nop 0
  buffer_load_dwordx4 v232, s[16:19], s97 offen lds
  s_mul_i32 s51, s6, 9216
  s_add_u32 m0, s51, 36864
  s_nop 0
  buffer_load_dwordx4 v224, s[16:19], s98 offen lds
  s_add_u32 m0, s51, 37888
  s_nop 0
  buffer_load_dwordx4 v225, s[16:19], s98 offen lds
  s_add_u32 m0, s51, 38912
  s_nop 0
  buffer_load_dwordx4 v226, s[16:19], s98 offen lds
  s_add_u32 m0, s51, 39936
  s_nop 0
  buffer_load_dwordx4 v227, s[16:19], s98 offen lds
  s_add_u32 m0, s51, 40960
  s_nop 0
  buffer_load_dwordx4 v228, s[16:19], s98 offen lds
  s_add_u32 m0, s51, 41984
  s_nop 0
  buffer_load_dwordx4 v229, s[16:19], s98 offen lds
  s_add_u32 m0, s51, 43008
  s_nop 0
  buffer_load_dwordx4 v230, s[16:19], s98 offen lds
  s_add_u32 m0, s51, 44032
  s_nop 0
  buffer_load_dwordx4 v231, s[16:19], s98 offen lds
  s_add_u32 m0, s51, 45056
  s_nop 0
  buffer_load_dwordx4 v232, s[16:19], s98 offen lds
  s_mul_i32 s51, s6, 9216
  s_add_u32 m0, s51, 73728
  s_nop 0
  buffer_load_dwordx4 v224, s[16:19], s99 offen lds
  s_add_u32 m0, s51, 74752
  s_nop 0
  buffer_load_dwordx4 v225, s[16:19], s99 offen lds
  s_add_u32 m0, s51, 75776
  s_nop 0
  buffer_load_dwordx4 v226, s[16:19], s99 offen lds
  s_add_u32 m0, s51, 76800
  s_nop 0
  buffer_load_dwordx4 v227, s[16:19], s99 offen lds
  s_add_u32 m0, s51, 77824
  s_nop 0
  buffer_load_dwordx4 v228, s[16:19], s99 offen lds
  s_add_u32 m0, s51, 78848
  s_nop 0
  buffer_load_dwordx4 v229, s[16:19], s99 offen lds
  s_add_u32 m0, s51, 79872
  s_nop 0
  buffer_load_dwordx4 v230, s[16:19], s99 offen lds
  s_add_u32 m0, s51, 80896
  s_nop 0
  buffer_load_dwordx4 v231, s[16:19], s99 offen lds
  s_add_u32 m0, s51, 81920
  s_nop 0
  buffer_load_dwordx4 v232, s[16:19], s99 offen lds
  s_mul_i32 s51, s6, 9216
  s_add_u32 m0, s51, 110592
  s_nop 0
  buffer_load_dwordx4 v224, s[16:19], s100 offen lds
  s_add_u32 m0, s51, 111616
  s_nop 0
  buffer_load_dwordx4 v225, s[16:19], s100 offen lds
  s_add_u32 m0, s51, 112640
  s_nop 0
  buffer_load_dwordx4 v226, s[16:19], s100 offen lds
  s_add_u32 m0, s51, 113664
  s_nop 0
  buffer_load_dwordx4 v227, s[16:19], s100 offen lds
  s_add_u32 m0, s51, 114688
  s_nop 0
  buffer_load_dwordx4 v228, s[16:19], s100 offen lds
  s_add_u32 m0, s51, 115712
  s_nop 0
  buffer_load_dwordx4 v229, s[16:19], s100 offen lds
  s_add_u32 m0, s51, 116736
  s_nop 0
  buffer_load_dwordx4 v230, s[16:19], s100 offen lds
  s_add_u32 m0, s51, 117760
  s_nop 0
  buffer_load_dwordx4 v231, s[16:19], s100 offen lds
  s_add_u32 m0, s51, 118784
  s_nop 0
  buffer_load_dwordx4 v232, s[16:19], s100 offen lds
  v_and_b32 v2, 7, v1
  v_lshlrev_b32 v2, 3, v2
  s_lshl_b32 s56, s2, 9
  s_add_u32 s56, s56, 524416
  v_add_u32 v2, s56, v2
  s_mul_i32 s56, s4, 288
  v_add_u32 v25, s56, v0
  v_lshlrev_b32 v16, 4, v25
  v_lshrrev_b32 v20, 6, v25
  v_and_b32 v21, 63, v25
  s_movk_i32 s57, 7282
  v_mul_lo_u32 v22, v20, s57
  v_lshrrev_b32 v22, 16, v22
  v_mul_u32_u24 v23, 9, v22
  v_sub_u32 v23, v20, v23
  v_lshlrev_b32 v22, 5, v22
  s_lshr_b32 s57, s5, 2
  s_lshl_b32 s57, s57, 7
  v_and_b32 v24, 15, v21
  v_add_u32 v22, v22, v24
  v_add_u32 v22, s57, v22
  v_mul_u32_u24 v22, 2304, v22
  v_lshrrev_b32 v21, 4, v21
  v_lshlrev_b32 v21, 2, v21
  v_lshl_add_u32 v21, v23, 4, v21
  s_and_b32 s57, s5, 3
  s_mul_i32 s57, s57, 144
  v_add_u32 v21, s57, v21
  v_lshl_add_u32 v13, v21, 1, v22
  v_add_u32 v25, s56, v0
  v_add_u32 v25, 256, v25
  v_lshlrev_b32 v17, 4, v25
  v_lshrrev_b32 v20, 6, v25
  v_and_b32 v21, 63, v25
  s_movk_i32 s57, 7282
  v_mul_lo_u32 v22, v20, s57
  v_lshrrev_b32 v22, 16, v22
  v_mul_u32_u24 v23, 9, v22
  v_sub_u32 v23, v20, v23
  v_lshlrev_b32 v22, 5, v22
  s_lshr_b32 s57, s5, 2
  s_lshl_b32 s57, s57, 7
  v_and_b32 v24, 15, v21
  v_add_u32 v22, v22, v24
  v_add_u32 v22, s57, v22
  v_mul_u32_u24 v22, 2304, v22
  v_lshrrev_b32 v21, 4, v21
  v_lshlrev_b32 v21, 2, v21
  v_lshl_add_u32 v21, v23, 4, v21
  s_and_b32 s57, s5, 3
  s_mul_i32 s57, s57, 144
  v_add_u32 v21, s57, v21
  v_lshl_add_u32 v14, v21, 1, v22
  s_lshl_b32 s56, s5, 3
  s_mul_i32 s56, s56, 36864
  s_add_u32 s56, s56, 9437184
  s_mov_b32 s55, 0x20000
  buffer_load_dwordx2 v[240:241], v2, s[24:27], 0 offen sc1
L_spin_29:
  s_waitcnt vmcnt(0)
  v_cmp_ne_u64 vcc, s[88:89], v[240:241]
  s_cbranch_vccz L_spun_30
  s_sleep 1
  buffer_load_dwordx2 v[240:241], v2, s[24:27], 0 offen sc1
  s_sub_u32 s55, s55, 1
  s_cmp_lg_u32 s55, 0
  s_cbranch_scc1 L_spin_29
L_spun_30:
  s_cmp_eq_u32 s6, 0
  s_cbranch_scc1 L_rx_31
  s_add_u32 s57, s56, 0
  buffer_load_dwordx4 v[32:35], v16, s[24:27], s57 offen sc1
  s_add_u32 s57, s56, 36864
  buffer_load_dwordx4 v[36:39], v16, s[24:27], s57 offen sc1
  s_add_u32 s57, s56, 73728
  buffer_load_dwordx4 v[40:43], v16, s[24:27], s57 offen sc1
  s_add_u32 s57, s56, 110592
  buffer_load_dwordx4 v[44:47], v16, s[24:27], s57 offen sc1
  s_add_u32 s57, s56, 147456
  buffer_load_dwordx4 v[48:51], v16, s[24:27], s57 offen sc1
  s_add_u32 s57, s56, 184320
  buffer_load_dwordx4 v[52:55], v16, s[24:27], s57 offen sc1
  s_add_u32 s57, s56, 221184
  buffer_load_dwordx4 v[56:59], v16, s[24:27], s57 offen sc1
  s_add_u32 s57, s56, 258048
  buffer_load_dwordx4 v[60:63], v16, s[24:27], s57 offen sc1
  s_waitcnt vmcnt(0)
  v_lshlrev_b32 v160, 16, v32
  v_lshlrev_b32 v169, 16, v36
  v_add_f32 v160, v160, v169
  v_lshlrev_b32 v168, 16, v40
  v_add_f32 v160, v160, v168
  v_lshlrev_b32 v169, 16, v44
  v_add_f32 v160, v160, v169
  v_lshlrev_b32 v168, 16, v48
  v_add_f32 v160, v160, v168
  v_lshlrev_b32 v169, 16, v52
  v_add_f32 v160, v160, v169
  v_lshlrev_b32 v168, 16, v56
  v_add_f32 v160, v160, v168
  v_lshlrev_b32 v169, 16, v60
  v_add_f32 v160, v160, v169
  v_and_b32 v161, 0xffff0000, v32
  v_and_b32 v169, 0xffff0000, v36
  v_add_f32 v161, v161, v169
  v_and_b32 v168, 0xffff0000, v40
  v_add_f32 v161, v161, v168
  v_and_b32 v169, 0xffff0000, v44
  v_add_f32 v161, v161, v169
  v_and_b32 v168, 0xffff0000, v48
  v_add_f32 v161, v161, v168
  v_and_b32 v169, 0xffff0000, v52
  v_add_f32 v161, v161, v169
  v_and_b32 v168, 0xffff0000, v56
  v_add_f32 v161, v161, v168
  v_and_b32 v169, 0xffff0000, v60
  v_add_f32 v161, v161, v169
  v_lshlrev_b32 v162, 16, v33
  v_lshlrev_b32 v169, 16, v37
  v_add_f32 v162, v162, v169
  v_lshlrev_b32 v168, 16, v41
  v_add_f32 v162, v162, v168
  v_lshlrev_b32 v169, 16, v45
  v_add_f32 v162, v162, v169
  v_lshlrev_b32 v168, 16, v49
  v_add_f32 v162, v162, v168
  v_lshlrev_b32 v169, 16, v53
  v_add_f32 v162, v162, v169
  v_lshlrev_b32 v168, 16, v57
  v_add_f32 v162, v162, v168
  v_lshlrev_b32 v169, 16, v61
  v_add_f32 v162, v162, v169
  v_and_b32 v163, 0xffff0000, v33
  v_and_b32 v169, 0xffff0000, v37
  v_add_f32 v163, v163, v169
  v_and_b32 v168, 0xffff0000, v41
  v_add_f32 v163, v163, v168
  v_and_b32 v169, 0xffff0000, v45
  v_add_f32 v163, v163, v169
  v_and_b32 v168, 0xffff0000, v49
  v_add_f32 v163, v163, v168
  v_and_b32 v169, 0xffff0000, v53
  v_add_f32 v163, v163, v169
  v_and_b32 v168, 0xffff0000, v57
  v_add_f32 v163, v163, v168
  v_and_b32 v169, 0xffff0000, v61
  v_add_f32 v163, v163, v169
  v_lshlrev_b32 v164, 16, v34
  v_lshlrev_b32 v169, 16, v38
  v_add_f32 v164, v164, v169
  v_lshlrev_b32 v168, 16, v42
  v_add_f32 v164, v164, v168
  v_lshlrev_b32 v169, 16, v46
  v_add_f32 v164, v164, v169
  v_lshlrev_b32 v168, 16, v50
  v_add_f32 v164, v164, v168
  v_lshlrev_b32 v169, 16, v54
  v_add_f32 v164, v164, v169
  v_lshlrev_b32 v168, 16, v58
  v_add_f32 v164, v164, v168
  v_lshlrev_b32 v169, 16, v62
  v_add_f32 v164, v164, v169
  v_and_b32 v165, 0xffff0000, v34
  v_and_b32 v169, 0xffff0000, v38
  v_add_f32 v165, v165, v169
  v_and_b32 v168, 0xffff0000, v42
  v_add_f32 v165, v165, v168
  v_and_b32 v169, 0xffff0000, v46
  v_add_f32 v165, v165, v169
  v_and_b32 v168, 0xffff0000, v50
  v_add_f32 v165, v165, v168
  v_and_b32 v169, 0xffff0000, v54
  v_add_f32 v165, v165, v169
  v_and_b32 v168, 0xffff0000, v58
  v_add_f32 v165, v165, v168
  v_and_b32 v169, 0xffff0000, v62
  v_add_f32 v165, v165, v169
  v_lshlrev_b32 v166, 16, v35
  v_lshlrev_b32 v169, 16, v39
  v_add_f32 v166, v166, v169
  v_lshlrev_b32 v168, 16, v43
  v_add_f32 v166, v166, v168
  v_lshlrev_b32 v169, 16, v47
  v_add_f32 v166, v166, v169
  v_lshlrev_b32 v168, 16, v51
  v_add_f32 v166, v166, v168
  v_lshlrev_b32 v169, 16, v55
  v_add_f32 v166, v166, v169
  v_lshlrev_b32 v168, 16, v59
  v_add_f32 v166, v166, v168
  v_lshlrev_b32 v169, 16, v63
  v_add_f32 v166, v166, v169
  v_and_b32 v167, 0xffff0000, v35
  v_and_b32 v169, 0xffff0000, v39
  v_add_f32 v167, v167, v169
  v_and_b32 v168, 0xffff0000, v43
  v_add_f32 v167, v167, v168
  v_and_b32 v169, 0xffff0000, v47
  v_add_f32 v167, v167, v169
  v_and_b32 v168, 0xffff0000, v51
  v_add_f32 v167, v167, v168
  v_and_b32 v169, 0xffff0000, v55
  v_add_f32 v167, v167, v169
  v_and_b32 v168, 0xffff0000, v59
  v_add_f32 v167, v167, v168
  v_and_b32 v169, 0xffff0000, v63
  v_add_f32 v167, v167, v169
  v_cvt_pk_bf16_f32 v172, v160, v161
  v_cvt_pk_bf16_f32 v173, v162, v163
  v_cvt_pk_bf16_f32 v174, v164, v165
  v_cvt_pk_bf16_f32 v175, v166, v167
  buffer_store_dwordx2 v[172:173], v13, s[20:23], 0 offen
  s_mov_b32 s57, 36864
  buffer_store_dwordx2 v[174:175], v13, s[20:23], s57 offen
  s_branch L_rx2_32
L_rx_31:
  s_add_u32 s57, s56, 0
  buffer_load_dwordx4 v[32:35], v16, s[24:27], s57 offen sc1
  s_add_u32 s57, s56, 36864
  buffer_load_dwordx4 v[36:39], v16, s[24:27], s57 offen sc1
  s_add_u32 s57, s56, 73728
  buffer_load_dwordx4 v[40:43], v16, s[24:27], s57 offen sc1
  s_add_u32 s57, s56, 110592
  buffer_load_dwordx4 v[44:47], v16, s[24:27], s57 offen sc1
  s_add_u32 s57, s56, 147456
  buffer_load_dwordx4 v[48:51], v16, s[24:27], s57 offen sc1
  s_add_u32 s57, s56, 184320
  buffer_load_dwordx4 v[52:55], v16, s[24:27], s57 offen sc1
  s_add_u32 s57, s56, 221184
  buffer_load_dwordx4 v[56:59], v16, s[24:27], s57 offen sc1
  s_add_u32 s57, s56, 258048
  buffer_load_dwordx4 v[60:63], v16, s[24:27], s57 offen sc1
  s_mov_b32 exec_hi, 0
  s_add_u32 s57, s56, 0
  buffer_load_dwordx4 v[96:99], v17, s[24:27], s57 offen sc1
  s_add_u32 s57, s56, 36864
  buffer_load_dwordx4 v[100:103], v17, s[24:27], s57 offen sc1
  s_add_u32 s57, s56, 73728
  buffer_load_dwordx4 v[104:107], v17, s[24:27], s57 offen sc1
  s_add_u32 s57, s56, 110592
  buffer_load_dwordx4 v[108:111], v17, s[24:27], s57 offen sc1
  s_add_u32 s57, s56, 147456
  buffer_load_dwordx4 v[112:115], v17, s[24:27], s57 offen sc1
  s_add_u32 s57, s56, 184320
  buffer_load_dwordx4 v[116:119], v17, s[24:27], s57 offen sc1
  s_add_u32 s57, s56, 221184
  buffer_load_dwordx4 v[120:123], v17, s[24:27], s57 offen sc1
  s_add_u32 s57, s56, 258048
  buffer_load_dwordx4 v[124:127], v17, s[24:27], s57 offen sc1
  s_mov_b64 exec, -1
  s_waitcnt vmcnt(8)
  v_lshlrev_b32 v160, 16, v32
  v_lshlrev_b32 v169, 16, v36
  v_add_f32 v160, v160, v169
  v_lshlrev_b32 v168, 16, v40
  v_add_f32 v160, v160, v168
  v_lshlrev_b32 v169, 16, v44
  v_add_f32 v160, v160, v169
  v_lshlrev_b32 v168, 16, v48
  v_add_f32 v160, v160, v168
  v_lshlrev_b32 v169, 16, v52
  v_add_f32 v160, v160, v169
  v_lshlrev_b32 v168, 16, v56
  v_add_f32 v160, v160, v168
  v_lshlrev_b32 v169, 16, v60
  v_add_f32 v160, v160, v169
  v_and_b32 v161, 0xffff0000, v32
  v_and_b32 v169, 0xffff0000, v36
  v_add_f32 v161, v161, v169
  v_and_b32 v168, 0xffff0000, v40
  v_add_f32 v161, v161, v168
  v_and_b32 v169, 0xffff0000, v44
  v_add_f32 v161, v161, v169
  v_and_b32 v168, 0xffff0000, v48
  v_add_f32 v161, v161, v168
  v_and_b32 v169, 0xffff0000, v52
  v_add_f32 v161, v161, v169
  v_and_b32 v168, 0xffff0000, v56
  v_add_f32 v161, v161, v168
  v_and_b32 v169, 0xffff0000, v60
  v_add_f32 v161, v161, v169
  v_lshlrev_b32 v162, 16, v33
  v_lshlrev_b32 v169, 16, v37
  v_add_f32 v162, v162, v169
  v_lshlrev_b32 v168, 16, v41
  v_add_f32 v162, v162, v168
  v_lshlrev_b32 v169, 16, v45
  v_add_f32 v162, v162, v169
  v_lshlrev_b32 v168, 16, v49
  v_add_f32 v162, v162, v168
  v_lshlrev_b32 v169, 16, v53
  v_add_f32 v162, v162, v169
  v_lshlrev_b32 v168, 16, v57
  v_add_f32 v162, v162, v168
  v_lshlrev_b32 v169, 16, v61
  v_add_f32 v162, v162, v169
  v_and_b32 v163, 0xffff0000, v33
  v_and_b32 v169, 0xffff0000, v37
  v_add_f32 v163, v163, v169
  v_and_b32 v168, 0xffff0000, v41
  v_add_f32 v163, v163, v168
  v_and_b32 v169, 0xffff0000, v45
  v_add_f32 v163, v163, v169
  v_and_b32 v168, 0xffff0000, v49
  v_add_f32 v163, v163, v168
  v_and_b32 v169, 0xffff0000, v53
  v_add_f32 v163, v163, v169
  v_and_b32 v168, 0xffff0000, v57
  v_add_f32 v163, v163, v168
  v_and_b32 v169, 0xffff0000, v61
  v_add_f32 v163, v163, v169
  v_lshlrev_b32 v164, 16, v34
  v_lshlrev_b32 v169, 16, v38
  v_add_f32 v164, v164, v169
  v_lshlrev_b32 v168, 16, v42
  v_add_f32 v164, v164, v168
  v_lshlrev_b32 v169, 16, v46
  v_add_f32 v164, v164, v169
  v_lshlrev_b32 v168, 16, v50
  v_add_f32 v164, v164, v168
  v_lshlrev_b32 v169, 16, v54
  v_add_f32 v164, v164, v169
  v_lshlrev_b32 v168, 16, v58
  v_add_f32 v164, v164, v168
  v_lshlrev_b32 v169, 16, v62
  v_add_f32 v164, v164, v169
  v_and_b32 v165, 0xffff0000, v34
  v_and_b32 v169, 0xffff0000, v38
  v_add_f32 v165, v165, v169
  v_and_b32 v168, 0xffff0000, v42
  v_add_f32 v165, v165, v168
  v_and_b32 v169, 0xffff0000, v46
  v_add_f32 v165, v165, v169
  v_and_b32 v168, 0xffff0000, v50
  v_add_f32 v165, v165, v168
  v_and_b32 v169, 0xffff0000, v54
  v_add_f32 v165, v165, v169
  v_and_b32 v168, 0xffff0000, v58
  v_add_f32 v165, v165, v168
  v_and_b32 v169, 0xffff0000, v62
  v_add_f32 v165, v165, v169
  v_lshlrev_b32 v166, 16, v35
  v_lshlrev_b32 v169, 16, v39
  v_add_f32 v166, v166, v169
  v_lshlrev_b32 v168, 16, v43
  v_add_f32 v166, v166, v168
  v_lshlrev_b32 v169, 16, v47
  v_add_f32 v166, v166, v169
  v_lshlrev_b32 v168, 16, v51
  v_add_f32 v166, v166, v168
  v_lshlrev_b32 v169, 16, v55
  v_add_f32 v166, v166, v169
  v_lshlrev_b32 v168, 16, v59
  v_add_f32 v166, v166, v168
  v_lshlrev_b32 v169, 16, v63
  v_add_f32 v166, v166, v169
  v_and_b32 v167, 0xffff0000, v35
  v_and_b32 v169, 0xffff0000, v39
  v_add_f32 v167, v167, v169
  v_and_b32 v168, 0xffff0000, v43
  v_add_f32 v167, v167, v168
  v_and_b32 v169, 0xffff0000, v47
  v_add_f32 v167, v167, v169
  v_and_b32 v168, 0xffff0000, v51
  v_add_f32 v167, v167, v168
  v_and_b32 v169, 0xffff0000, v55
  v_add_f32 v167, v167, v169
  v_and_b32 v168, 0xffff0000, v59
  v_add_f32 v167, v167, v168
  v_and_b32 v169, 0xffff0000, v63
  v_add_f32 v167, v167, v169
  v_cvt_pk_bf16_f32 v172, v160, v161
  v_cvt_pk_bf16_f32 v173, v162, v163
  v_cvt_pk_bf16_f32 v174, v164, v165
  v_cvt_pk_bf16_f32 v175, v166, v167
  buffer_store_dwordx2 v[172:173], v13, s[20:23], 0 offen
  s_mov_b32 s57, 36864
  buffer_store_dwordx2 v[174:175], v13, s[20:23], s57 offen
  s_mov_b32 exec_hi, 0
  s_waitcnt vmcnt(2)
  v_lshlrev_b32 v160, 16, v96
  v_lshlrev_b32 v169, 16, v100
  v_add_f32 v160, v160, v169
  v_lshlrev_b32 v168, 16, v104
  v_add_f32 v160, v160, v168
  v_lshlrev_b32 v169, 16, v108
  v_add_f32 v160, v160, v169
  v_lshlrev_b32 v168, 16, v112
  v_add_f32 v160, v160, v168
  v_lshlrev_b32 v169, 16, v116
  v_add_f32 v160, v160, v169
  v_lshlrev_b32 v168, 16, v120
  v_add_f32 v160, v160, v168
  v_lshlrev_b32 v169, 16, v124
  v_add_f32 v160, v160, v169
  v_and_b32 v161, 0xffff0000, v96
  v_and_b32 v169, 0xffff0000, v100
  v_add_f32 v161, v161, v169
  v_and_b32 v168, 0xffff0000, v104
  v_add_f32 v161, v161, v168
  v_and_b32 v169, 0xffff0000, v108
  v_add_f32 v161, v161, v169
  v_and_b32 v168, 0xffff0000, v112
  v_add_f32 v161, v161, v168
  v_and_b32 v169, 0xffff0000, v116
  v_add_f32 v161, v161, v169
  v_and_b32 v168, 0xffff0000, v120
  v_add_f32 v161, v161, v168
  v_and_b32 v169, 0xffff0000, v124
  v_add_f32 v161, v161, v169
  v_lshlrev_b32 v162, 16, v97
  v_lshlrev_b32 v169, 16, v101
  v_add_f32 v162, v162, v169
  v_lshlrev_b32 v168, 16, v105
  v_add_f32 v162, v162, v168
  v_lshlrev_b32 v169, 16, v109
  v_add_f32 v162, v162, v169
  v_lshlrev_b32 v168, 16, v113
  v_add_f32 v162, v162, v168
  v_lshlrev_b32 v169, 16, v117
  v_add_f32 v162, v162, v169
  v_lshlrev_b32 v168, 16, v121
  v_add_f32 v162, v162, v168
  v_lshlrev_b32 v169, 16, v125
  v_add_f32 v162, v162, v169
  v_and_b32 v163, 0xffff0000, v97
  v_and_b32 v169, 0xffff0000, v101
  v_add_f32 v163, v163, v169
  v_and_b32 v168, 0xffff0000, v105
  v_add_f32 v163, v163, v168
  v_and_b32 v169, 0xffff0000, v109
  v_add_f32 v163, v163, v169
  v_and_b32 v168, 0xffff0000, v113
  v_add_f32 v163, v163, v168
  v_and_b32 v169, 0xffff0000, v117
  v_add_f32 v163, v163, v169
  v_and_b32 v168, 0xffff0000, v121
  v_add_f32 v163, v163, v168
  v_and_b32 v169, 0xffff0000, v125
  v_add_f32 v163, v163, v169
  v_lshlrev_b32 v164, 16, v98
  v_lshlrev_b32 v169, 16, v102
  v_add_f32 v164, v164, v169
  v_lshlrev_b32 v168, 16, v106
  v_add_f32 v164, v164, v168
  v_lshlrev_b32 v169, 16, v110
  v_add_f32 v164, v164, v169
  v_lshlrev_b32 v168, 16, v114
  v_add_f32 v164, v164, v168
  v_lshlrev_b32 v169, 16, v118
  v_add_f32 v164, v164, v169
  v_lshlrev_b32 v168, 16, v122
  v_add_f32 v164, v164, v168
  v_lshlrev_b32 v169, 16, v126
  v_add_f32 v164, v164, v169
  v_and_b32 v165, 0xffff0000, v98
  v_and_b32 v169, 0xffff0000, v102
  v_add_f32 v165, v165, v169
  v_and_b32 v168, 0xffff0000, v106
  v_add_f32 v165, v165, v168
  v_and_b32 v169, 0xffff0000, v110
  v_add_f32 v165, v165, v169
  v_and_b32 v168, 0xffff0000, v114
  v_add_f32 v165, v165, v168
  v_and_b32 v169, 0xffff0000, v118
  v_add_f32 v165, v165, v169
  v_and_b32 v168, 0xffff0000, v122
  v_add_f32 v165, v165, v168
  v_and_b32 v169, 0xffff0000, v126
  v_add_f32 v165, v165, v169
  v_lshlrev_b32 v166, 16, v99
  v_lshlrev_b32 v169, 16, v103
  v_add_f32 v166, v166, v169
  v_lshlrev_b32 v168, 16, v107
  v_add_f32 v166, v166, v168
  v_lshlrev_b32 v169, 16, v111
  v_add_f32 v166, v166, v169
  v_lshlrev_b32 v168, 16, v115
  v_add_f32 v166, v166, v168
  v_lshlrev_b32 v169, 16, v119
  v_add_f32 v166, v166, v169
  v_lshlrev_b32 v168, 16, v123
  v_add_f32 v166, v166, v168
  v_lshlrev_b32 v169, 16, v127
  v_add_f32 v166, v166, v169
  v_and_b32 v167, 0xffff0000, v99
  v_and_b32 v169, 0xffff0000, v103
  v_add_f32 v167, v167, v169
  v_and_b32 v168, 0xffff0000, v107
  v_add_f32 v167, v167, v168
  v_and_b32 v169, 0xffff0000, v111
  v_add_f32 v167, v167, v169
  v_and_b32 v168, 0xffff0000, v115
  v_add_f32 v167, v167, v168
  v_and_b32 v169, 0xffff0000, v119
  v_add_f32 v167, v167, v169
  v_and_b32 v168, 0xffff0000, v123
  v_add_f32 v167, v167, v168
  v_and_b32 v169, 0xffff0000, v127
  v_add_f32 v167, v167, v169
  v_cvt_pk_bf16_f32 v172, v160, v161
  v_cvt_pk_bf16_f32 v173, v162, v163
  v_cvt_pk_bf16_f32 v174, v164, v165
  v_cvt_pk_bf16_f32 v175, v166, v167
  buffer_store_dwordx2 v[172:173], v14, s[20:23], 0 offen
  s_mov_b32 s57, 36864
  buffer_store_dwordx2 v[174:175], v14, s[20:23], s57 offen
  s_mov_b64 exec, -1
L_rx2_32:
  v_and_b32 v2, 3, v1
  v_lshlrev_b32 v2, 1, v2
  v_add_u32 v2, s53, v2
  v_lshlrev_b32 v2, 3, v2
  s_lshl_b32 s56, s2, 9
  s_add_u32 s56, s56, 524544
  v_add_u32 v2, s56, v2
  v_lshrrev_b32 v3, 5, v1
  v_bfe_u32 v10, v1, 4, 1
  v_and_b32 v11, 15, v1
  v_lshlrev_b32 v12, 10, v3
  v_lshl_add_u32 v12, v10, 9, v12
  v_lshl_add_u32 v26, v11, 4, v12
  v_bfe_u32 v11, v1, 2, 2
  v_and_b32 v12, 3, v1
  v_lshlrev_b32 v3, 4, v3
  v_lshl_add_u32 v3, v10, 2, v3
  v_add_u32 v3, v3, v11
  v_mul_u32_u24 v3, 288, v3
  v_lshl_add_u32 v27, v12, 3, v3
  v_add_u32 v28, 0, v27
  v_add_u32 v29, 36864, v27
  v_add_u32 v30, 73728, v27
  v_add_u32 v31, 110592, v27
  s_lshr_b32 s56, s5, 2
  s_lshl_b32 s56, s56, 1
  s_add_u32 s56, s56, s90
  s_add_u32 s56, s56, 8
  s_lshl_b32 s56, s56, 19
  s_lshl_b32 s57, s53, 13
  s_add_u32 s56, s56, s57
  s_lshl_b32 s57, s54, 8
  s_add_u32 s56, s56, s57
  s_add_u32 s56, s56, 1048576
  s_add_u32 s58, s5, 0
  s_and_b32 s58, s58, 3
  s_lshl_b32 s57, s58, 3
  s_add_u32 s57, s57, s4
  s_lshl_b32 s57, s57, 14
  s_add_u32 s84, s57, s56
  s_add_u32 s58, s5, 1
  s_and_b32 s58, s58, 3
  s_lshl_b32 s57, s58, 3
  s_add_u32 s57, s57, s4
  s_lshl_b32 s57, s57, 14
  s_add_u32 s85, s57, s56
  s_add_u32 s58, s5, 2
  s_and_b32 s58, s58, 3
  s_lshl_b32 s57, s58, 3
  s_add_u32 s57, s57, s4
  s_lshl_b32 s57, s57, 14
  s_add_u32 s86, s57, s56
  s_add_u32 s58, s5, 3
  s_and_b32 s58, s58, 3
  s_lshl_b32 s57, s58, 3
  s_add_u32 s57, s57, s4
  s_lshl_b32 s57, s57, 14
  s_add_u32 s87, s57, s56
  s_mov_b32 s55, 0x20000
  buffer_load_dwordx2 v[240:241], v2, s[24:27], 0 offen sc1
L_spin_33:
  s_waitcnt vmcnt(0)
  v_cmp_ne_u64 vcc, s[88:89], v[240:241]
  s_cbranch_vccz L_spun_34
  s_sleep 1
  buffer_load_dwordx2 v[240:241], v2, s[24:27], 0 offen sc1
  s_sub_u32 s55, s55, 1
  s_cmp_lg_u32 s55, 0
  s_cbranch_scc1 L_spin_33
L_spun_34:
  s_add_u32 s55, s84, 0
  buffer_load_dwordx4 a[0:3], v26, s[24:27], s55 offen offset:0 sc1
  s_add_u32 s55, s84, 2048
  buffer_load_dwordx4 a[4:7], v26, s[24:27], s55 offen offset:0 sc1
  s_add_u32 s55, s84, 4096
  buffer_load_dwordx4 a[8:11], v26, s[24:27], s55 offen offset:0 sc1
  s_add_u32 s55, s84, 6144
  buffer_load_dwordx4 a[12:15], v26, s[24:27], s55 offen offset:0 sc1
  s_add_u32 s55, s85, 0
  buffer_load_dwordx4 a[16:19], v26, s[24:27], s55 offen offset:0 sc1
  s_add_u32 s55, s85, 2048
  buffer_load_dwordx4 a[20:23], v26, s[24:27], s55 offen offset:0 sc1
  s_add_u32 s55, s85, 4096
  buffer_load_dwordx4 a[24:27], v26, s[24:27], s55 offen offset:0 sc1
  s_add_u32 s55, s85, 6144
  buffer_load_dwordx4 a[28:31], v26, s[24:27], s55 offen offset:0 sc1
  s_waitcnt vmcnt(4)
  s_barrier
  ds_read_b64_tr_b16 v[32:33], v28 offset:0
  ds_read_b64_tr_b16 v[34:35], v28 offset:2304
  ds_read_b64_tr_b16 v[36:37], v28 offset:32
  ds_read_b64_tr_b16 v[38:39], v28 offset:2336
  ds_read_b64_tr_b16 v[40:41], v28 offset:64
  ds_read_b64_tr_b16 v[42:43], v28 offset:2368
  ds_read_b64_tr_b16 v[44:45], v28 offset:96
  ds_read_b64_tr_b16 v[46:47], v28 offset:2400
  ds_read_b64_tr_b16 v[48:49], v28 offset:128
  ds_read_b64_tr_b16 v[50:51], v28 offset:2432
  ds_read_b64_tr_b16 v[52:53], v28 offset:160
  ds_read_b64_tr_b16 v[54:55], v28 offset:2464
  ds_read_b64_tr_b16 v[56:57], v28 offset:192
  ds_read_b64_tr_b16 v[58:59], v28 offset:2496
  s_waitcnt lgkmcnt(10)
  v_mfma_f32_16x16x32_bf16 v[64:67], v[32:35], a[0:3], 0
  s_add_u32 s55, s86, 0
  ds_read_b64_tr_b16 v[60:61], v28 offset:224
  ds_read_b64_tr_b16 v[62:63], v28 offset:2528
  v_mfma_f32_16x16x32_bf16 v[68:71], v[36:39], a[0:3], 0
  buffer_load_dwordx4 a[32:35], v26, s[24:27], s55 offen offset:0 sc1
  ds_read_b64_tr_b16 v[32:33], v28 offset:256
  ds_read_b64_tr_b16 v[34:35], v28 offset:2560
  s_waitcnt lgkmcnt(10)
  v_mfma_f32_16x16x32_bf16 v[72:75], v[40:43], a[0:3], 0
  s_add_u32 s55, s86, 2048
  ds_read_b64_tr_b16 v[36:37], v28 offset:9216
  ds_read_b64_tr_b16 v[38:39], v28 offset:11520
  v_mfma_f32_16x16x32_bf16 v[76:79], v[44:47], a[0:3], 0
  buffer_load_dwordx4 a[36:39], v26, s[24:27], s55 offen offset:0 sc1
  ds_read_b64_tr_b16 v[40:41], v28 offset:9248
  ds_read_b64_tr_b16 v[42:43], v28 offset:11552
  s_waitcnt lgkmcnt(10)
  v_mfma_f32_16x16x32_bf16 v[80:83], v[48:51], a[0:3], 0
  s_add_u32 s55, s86, 4096
  ds_read_b64_tr_b16 v[44:45], v28 offset:9280
  ds_read_b64_tr_b16 v[46:47], v28 offset:11584
  v_mfma_f32_16x16x32_bf16 v[84:87], v[52:55], a[0:3], 0
  buffer_load_dwordx4 a[40:43], v26, s[24:27], s55 offen offset:0 sc1
  ds_read_b64_tr_b16 v[48:49], v28 offset:9312
  ds_read_b64_tr_b16 v[50:51], v28 offset:11616
  s_waitcnt lgkmcnt(10)
  v_mfma_f32_16x16x32_bf16 v[88:91], v[56:59], a[0:3], 0
  s_add_u32 s55, s86, 6144
  ds_read_b64_tr_b16 v[52:53], v28 offset:9344
  ds_read_b64_tr_b16 v[54:55], v28 offset:11648
  v_mfma_f32_16x16x32_bf16 v[92:95], v[60:63], a[0:3], 0
  buffer_load_dwordx4 a[44:47], v26, s[24:27], s55 offen offset:0 sc1
  ds_read_b64_tr_b16 v[56:57], v28 offset:9376
  ds_read_b64_tr_b16 v[58:59], v28 offset:11680
  s_waitcnt lgkmcnt(10)
  v_mfma_f32_16x16x32_bf16 v[96:99], v[32:35], a[0:3], 0
  ds_read_b64_tr_b16 v[60:61], v28 offset:9408
  ds_read_b64_tr_b16 v[62:63], v28 offset:11712
  v_mfma_f32_16x16x32_bf16 v[64:67], v[36:39], a[4:7], v[64:67]
  ds_read_b64_tr_b16 v[32:33], v28 offset:9440
  ds_read_b64_tr_b16 v[34:35], v28 offset:11744
  s_waitcnt lgkmcnt(10)
  v_mfma_f32_16x16x32_bf16 v[68:71], v[40:43], a[4:7], v[68:71]
  ds_read_b64_tr_b16 v[36:37], v28 offset:9472
  ds_read_b64_tr_b16 v[38:39], v28 offset:11776
  v_mfma_f32_16x16x32_bf16 v[72:75], v[44:47], a[4:7], v[72:75]
  ds_read_b64_tr_b16 v[40:41], v28 offset:18432
  ds_read_b64_tr_b16 v[42:43], v28 offset:20736
  s_waitcnt lgkmcnt(10)
  v_mfma_f32_16x16x32_bf16 v[76:79], v[48:51], a[4:7], v[76:79]
  ds_read_b64_tr_b16 v[44:45], v28 offset:18464
  ds_read_b64_tr_b16 v[46:47], v28 offset:20768
  v_mfma_f32_16x16x32_bf16 v[80:83], v[52:55], a[4:7], v[80:83]
  ds_read_b64_tr_b16 v[48:49], v28 offset:18496
  ds_read_b64_tr_b16 v[50:51], v28 offset:20800
  s_waitcnt lgkmcnt(10)
  v_mfma_f32_16x16x32_bf16 v[84:87], v[56:59], a[4:7], v[84:87]
  ds_read_b64_tr_b16 v[52:53], v28 offset:18528
  ds_read_b64_tr_b16 v[54:55], v28 offset:20832
  v_mfma_f32_16x16x32_bf16 v[88:91], v[60:63], a[4:7], v[88:91]
  ds_read_b64_tr_b16 v[56:57], v28 offset:18560
  ds_read_b64_tr_b16 v[58:59], v28 offset:20864
  s_waitcnt lgkmcnt(10)
  v_mfma_f32_16x16x32_bf16 v[92:95], v[32:35], a[4:7], v[92:95]
  ds_read_b64_tr_b16 v[60:61], v28 offset:18592
  ds_read_b64_tr_b16 v[62:63], v28 offset:20896
  v_mfma_f32_16x16x32_bf16 v[96:99], v[36:39], a[4:7], v[96:99]
  ds_read_b64_tr_b16 v[32:33], v28 offset:18624
  ds_read_b64_tr_b16 v[34:35], v28 offset:20928
  s_waitcnt lgkmcnt(10)
  v_mfma_f32_16x16x32_bf16 v[64:67], v[40:43], a[8:11], v[64:67]
  ds_read_b64_tr_b16 v[36:37], v28 offset:18656
  ds_read_b64_tr_b16 v[38:39], v28 offset:20960
  v_mfma_f32_16x16x32_bf16 v[68:71], v[44:47], a[8:11], v[68:71]
  ds_read_b64_tr_b16 v[40:41], v28 offset:18688
  ds_read_b64_tr_b16 v[42:43], v28 offset:20992
  s_waitcnt lgkmcnt(10)
  v_mfma_f32_16x16x32_bf16 v[72:75], v[48:51], a[8:11], v[72:75]
  ds_read_b64_tr_b16 v[44:45], v28 offset:27648
  ds_read_b64_tr_b16 v[46:47], v28 offset:29952
  v_mfma_f32_16x16x32_bf16 v[76:79], v[52:55], a[8:11], v[76:79]
  ds_read_b64_tr_b16 v[48:49], v28 offset:27680
  ds_read_b64_tr_b16 v[50:51], v28 offset:29984
  s_waitcnt lgkmcnt(10)
  v_mfma_f32_16x16x32_bf16 v[80:83], v[56:59], a[8:11], v[80:83]
  ds_read_b64_tr_b16 v[52:53], v28 offset:27712
  ds_read_b64_tr_b16 v[54:55], v28 offset:30016
  v_mfma_f32_16x16x32_bf16 v[84:87], v[60:63], a[8:11], v[84:87]
  ds_read_b64_tr_b16 v[56:57], v28 offset:27744
  ds_read_b64_tr_b16 v[58:59], v28 offset:30048
  s_waitcnt lgkmcnt(10)
  v_mfma_f32_16x16x32_bf16 v[88:91], v[32:35], a[8:11], v[88:91]
  ds_read_b64_tr_b16 v[60:61], v28 offset:27776
  ds_read_b64_tr_b16 v[62:63], v28 offset:30080
  v_mfma_f32_16x16x32_bf16 v[92:95], v[36:39], a[8:11], v[92:95]
  ds_read_b64_tr_b16 v[32:33], v28 offset:27808
  ds_read_b64_tr_b16 v[34:35], v28 offset:30112
  s_waitcnt lgkmcnt(10)
  v_mfma_f32_16x16x32_bf16 v[96:99], v[40:43], a[8:11], v[96:99]
  ds_read_b64_tr_b16 v[36:37], v28 offset:27840
  ds_read_b64_tr_b16 v[38:39], v28 offset:30144
  v_mfma_f32_16x16x32_bf16 v[64:67], v[44:47], a[12:15], v[64:67]
  ds_read_b64_tr_b16 v[40:41], v28 offset:27872
  ds_read_b64_tr_b16 v[42:43], v28 offset:30176
  s_waitcnt lgkmcnt(10)
  v_mfma_f32_16x16x32_bf16 v[68:71], v[48:51], a[12:15], v[68:71]
  ds_read_b64_tr_b16 v[44:45], v28 offset:27904
  ds_read_b64_tr_b16 v[46:47], v28 offset:30208
  v_mfma_f32_16x16x32_bf16 v[72:75], v[52:55], a[12:15], v[72:75]
  s_waitcnt lgkmcnt(8)
  v_mfma_f32_16x16x32_bf16 v[76:79], v[56:59], a[12:15], v[76:79]
  v_mfma_f32_16x16x32_bf16 v[80:83], v[60:63], a[12:15], v[80:83]
  s_waitcnt lgkmcnt(4)
  v_mfma_f32_16x16x32_bf16 v[84:87], v[32:35], a[12:15], v[84:87]
  v_mfma_f32_16x16x32_bf16 v[88:91], v[36:39], a[12:15], v[88:91]
  s_waitcnt lgkmcnt(0)
  v_mfma_f32_16x16x32_bf16 v[92:95], v[40:43], a[12:15], v[92:95]
  v_mfma_f32_16x16x32_bf16 v[96:99], v[44:47], a[12:15], v[96:99]
  s_waitcnt vmcnt(4)
  ds_read_b64_tr_b16 v[48:49], v29 offset:0
  ds_read_b64_tr_b16 v[50:51], v29 offset:2304
  ds_read_b64_tr_b16 v[52:53], v29 offset:32
  ds_read_b64_tr_b16 v[54:55], v29 offset:2336
  ds_read_b64_tr_b16 v[56:57], v29 offset:64
  ds_read_b64_tr_b16 v[58:59], v29 offset:2368
  ds_read_b64_tr_b16 v[60:61], v29 offset:96
  ds_read_b64_tr_b16 v[62:63], v29 offset:2400
  ds_read_b64_tr_b16 v[32:33], v29 offset:128
  ds_read_b64_tr_b16 v[34:35], v29 offset:2432
  ds_read_b64_tr_b16 v[36:37], v29 offset:160
  ds_read_b64_tr_b16 v[38:39], v29 offset:2464
  ds_read_b64_tr_b16 v[40:41], v29 offset:192
  ds_read_b64_tr_b16 v[42:43], v29 offset:2496
  s_waitcnt lgkmcnt(10)
  v_mfma_f32_16x16x32_bf16 v[64:67], v[48:51], a[16:19], v[64:67]
  s_add_u32 s55, s87, 0
  ds_read_b64_tr_b16 v[44:45], v29 offset:224
  ds_read_b64_tr_b16 v[46:47], v29 offset:2528
  v_mfma_f32_16x16x32_bf16 v[68:71], v[52:55], a[16:19], v[68:71]
  buffer_load_dwordx4 a[48:51], v26, s[24:27], s55 offen offset:0 sc1
  ds_read_b64_tr_b16 v[48:49], v29 offset:256
  ds_read_b64_tr_b16 v[50:51], v29 offset:2560
  s_waitcnt lgkmcnt(10)
  v_mfma_f32_16x16x32_bf16 v[72:75], v[56:59], a[16:19], v[72:75]
  s_add_u32 s55, s87, 2048
  ds_read_b64_tr_b16 v[52:53], v29 offset:9216
  ds_read_b64_tr_b16 v[54:55], v29 offset:11520
  v_mfma_f32_16x16x32_bf16 v[76:79], v[60:63], a[16:19], v[76:79]
  buffer_load_dwordx4 a[52:55], v26, s[24:27], s55 offen offset:0 sc1
  ds_read_b64_tr_b16 v[56:57], v29 offset:9248
  ds_read_b64_tr_b16 v[58:59], v29 offset:11552
  s_waitcnt lgkmcnt(10)
  v_mfma_f32_16x16x32_bf16 v[80:83], v[32:35], a[16:19], v[80:83]
  s_add_u32 s55, s87, 4096
  ds_read_b64_tr_b16 v[60:61], v29 offset:9280
  ds_read_b64_tr_b16 v[62:63], v29 offset:11584
  v_mfma_f32_16x16x32_bf16 v[84:87], v[36:39], a[16:19], v[84:87]
  buffer_load_dwordx4 a[56:59], v26, s[24:27], s55 offen offset:0 sc1
  ds_read_b64_tr_b16 v[32:33], v29 offset:9312
  ds_read_b64_tr_b16 v[34:35], v29 offset:11616
  s_waitcnt lgkmcnt(10)
  v_mfma_f32_16x16x32_bf16 v[88:91], v[40:43], a[16:19], v[88:91]
  s_add_u32 s55, s87, 6144
  ds_read_b64_tr_b16 v[36:37], v29 offset:9344
  ds_read_b64_tr_b16 v[38:39], v29 offset:11648
  v_mfma_f32_16x16x32_bf16 v[92:95], v[44:47], a[16:19], v[92:95]
  buffer_load_dwordx4 a[60:63], v26, s[24:27], s55 offen offset:0 sc1
  ds_read_b64_tr_b16 v[40:41], v29 offset:9376
  ds_read_b64_tr_b16 v[42:43], v29 offset:11680
  s_waitcnt lgkmcnt(10)
  v_mfma_f32_16x16x32_bf16 v[96:99], v[48:51], a[16:19], v[96:99]
  ds_read_b64_tr_b16 v[44:45], v29 offset:9408
  ds_read_b64_tr_b16 v[46:47], v29 offset:11712
  v_mfma_f32_16x16x32_bf16 v[64:67], v[52:55], a[20:23], v[64:67]
  ds_read_b64_tr_b16 v[48:49], v29 offset:9440
  ds_read_b64_tr_b16 v[50:51], v29 offset:11744
  s_waitcnt lgkmcnt(10)
  v_mfma_f32_16x16x32_bf16 v[68:71], v[56:59], a[20:23], v[68:71]
  ds_read_b64_tr_b16 v[52:53], v29 offset:9472
  ds_read_b64_tr_b16 v[54:55], v29 offset:11776
  v_mfma_f32_16x16x32_bf16 v[72:75], v[60:63], a[20:23], v[72:75]
  ds_read_b64_tr_b16 v[56:57], v29 offset:18432
  ds_read_b64_tr_b16 v[58:59], v29 offset:20736
  s_waitcnt lgkmcnt(10)
  v_mfma_f32_16x16x32_bf16 v[76:79], v[32:35], a[20:23], v[76:79]
  ds_read_b64_tr_b16 v[60:61], v29 offset:18464
  ds_read_b64_tr_b16 v[62:63], v29 offset:20768
  v_mfma_f32_16x16x32_bf16 v[80:83], v[36:39], a[20:23], v[80:83]
  ds_read_b64_tr_b16 v[32:33], v29 offset:18496
  ds_read_b64_tr_b16 v[34:35], v29 offset:20800
  s_waitcnt lgkmcnt(10)
  v_mfma_f32_16x16x32_bf16 v[84:87], v[40:43], a[20:23], v[84:87]
  ds_read_b64_tr_b16 v[36:37], v29 offset:18528
  ds_read_b64_tr_b16 v[38:39], v29 offset:20832
  v_mfma_f32_16x16x32_bf16 v[88:91], v[44:47], a[20:23], v[88:91]
  ds_read_b64_tr_b16 v[40:41], v29 offset:18560
  ds_read_b64_tr_b16 v[42:43], v29 offset:20864
  s_waitcnt lgkmcnt(10)
  v_mfma_f32_16x16x32_bf16 v[92:95], v[48:51], a[20:23], v[92:95]
  ds_read_b64_tr_b16 v[44:45], v29 offset:18592
  ds_read_b64_tr_b16 v[46:47], v29 offset:20896
  v_mfma_f32_16x16x32_bf16 v[96:99], v[52:55], a[20:23], v[96:99]
  ds_read_b64_tr_b16 v[48:49], v29 offset:18624
  ds_read_b64_tr_b16 v[50:51], v29 offset:20928
  s_waitcnt lgkmcnt(10)
  v_mfma_f32_16x16x32_bf16 v[64:67], v[56:59], a[24:27], v[64:67]
  ds_read_b64_tr_b16 v[52:53], v29 offset:18656
  ds_read_b64_tr_b16 v[54:55], v29 offset:20960
  v_mfma_f32_16x16x32_bf16 v[68:71], v[60:63], a[24:27], v[68:71]
  ds_read_b64_tr_b16 v[56:57], v29 offset:18688
  ds_read_b64_tr_b16 v[58:59], v29 offset:20992
  s_waitcnt lgkmcnt(10)
  v_mfma_f32_16x16x32_bf16 v[72:75], v[32:35], a[24:27], v[72:75]
  ds_read_b64_tr_b16 v[60:61], v29 offset:27648
  ds_read_b64_tr_b16 v[62:63], v29 offset:29952
  v_mfma_f32_16x16x32_bf16 v[76:79], v[36:39], a[24:27], v[76:79]
  ds_read_b64_tr_b16 v[32:33], v29 offset:27680
  ds_read_b64_tr_b16 v[34:35], v29 offset:29984
  s_waitcnt lgkmcnt(10)
  v_mfma_f32_16x16x32_bf16 v[80:83], v[40:43], a[24:27], v[80:83]
  ds_read_b64_tr_b16 v[36:37], v29 offset:27712
  ds_read_b64_tr_b16 v[38:39], v29 offset:30016
  v_mfma_f32_16x16x32_bf16 v[84:87], v[44:47], a[24:27], v[84:87]
  ds_read_b64_tr_b16 v[40:41], v29 offset:27744
  ds_read_b64_tr_b16 v[42:43], v29 offset:30048
  s_waitcnt lgkmcnt(10)
  v_mfma_f32_16x16x32_bf16 v[88:91], v[48:51], a[24:27], v[88:91]
  ds_read_b64_tr_b16 v[44:45], v29 offset:27776
  ds_read_b64_tr_b16 v[46:47], v29 offset:30080
  v_mfma_f32_16x16x32_bf16 v[92:95], v[52:55], a[24:27], v[92:95]
  ds_read_b64_tr_b16 v[48:49], v29 offset:27808
  ds_read_b64_tr_b16 v[50:51], v29 offset:30112
  s_waitcnt lgkmcnt(10)
  v_mfma_f32_16x16x32_bf16 v[96:99], v[56:59], a[24:27], v[96:99]
  ds_read_b64_tr_b16 v[52:53], v29 offset:27840
  ds_read_b64_tr_b16 v[54:55], v29 offset:30144
  v_mfma_f32_16x16x32_bf16 v[64:67], v[60:63], a[28:31], v[64:67]
  ds_read_b64_tr_b16 v[56:57], v29 offset:27872
  ds_read_b64_tr_b16 v[58:59], v29 offset:30176
  s_waitcnt lgkmcnt(10)
  v_mfma_f32_16x16x32_bf16 v[68:71], v[32:35], a[28:31], v[68:71]
  ds_read_b64_tr_b16 v[60:61], v29 offset:27904
  ds_read_b64_tr_b16 v[62:63], v29 offset:30208
  v_mfma_f32_16x16x32_bf16 v[72:75], v[36:39], a[28:31], v[72:75]
  s_waitcnt lgkmcnt(8)
  v_mfma_f32_16x16x32_bf16 v[76:79], v[40:43], a[28:31], v[76:79]
  v_mfma_f32_16x16x32_bf16 v[80:83], v[44:47], a[28:31], v[80:83]
  s_waitcnt lgkmcnt(4)
  v_mfma_f32_16x16x32_bf16 v[84:87], v[48:51], a[28:31], v[84:87]
  v_mfma_f32_16x16x32_bf16 v[88:91], v[52:55], a[28:31], v[88:91]
  s_waitcnt lgkmcnt(0)
  v_mfma_f32_16x16x32_bf16 v[92:95], v[56:59], a[28:31], v[92:95]
  v_mfma_f32_16x16x32_bf16 v[96:99], v[60:63], a[28:31], v[96:99]
  s_waitcnt vmcnt(4)
  ds_read_b64_tr_b16 v[32:33], v30 offset:0
  ds_read_b64_tr_b16 v[34:35], v30 offset:2304
  ds_read_b64_tr_b16 v[36:37], v30 offset:32
  ds_read_b64_tr_b16 v[38:39], v30 offset:2336
  ds_read_b64_tr_b16 v[40:41], v30 offset:64
  ds_read_b64_tr_b16 v[42:43], v30 offset:2368
  ds_read_b64_tr_b16 v[44:45], v30 offset:96
  ds_read_b64_tr_b16 v[46:47], v30 offset:2400
  ds_read_b64_tr_b16 v[48:49], v30 offset:128
  ds_read_b64_tr_b16 v[50:51], v30 offset:2432
  ds_read_b64_tr_b16 v[52:53], v30 offset:160
  ds_read_b64_tr_b16 v[54:55], v30 offset:2464
  ds_read_b64_tr_b16 v[56:57], v30 offset:192
  ds_read_b64_tr_b16 v[58:59], v30 offset:2496
  s_waitcnt lgkmcnt(10)
  v_mfma_f32_16x16x32_bf16 v[64:67], v[32:35], a[32:35], v[64:67]
  ds_read_b64_tr_b16 v[60:61], v30 offset:224
  ds_read_b64_tr_b16 v[62:63], v30 offset:2528
  v_mfma_f32_16x16x32_bf16 v[68:71], v[36:39], a[32:35], v[68:71]
  ds_read_b64_tr_b16 v[32:33], v30 offset:256
  ds_read_b64_tr_b16 v[34:35], v30 offset:2560
  s_waitcnt lgkmcnt(10)
  v_mfma_f32_16x16x32_bf16 v[72:75], v[40:43], a[32:35], v[72:75]
  ds_read_b64_tr_b16 v[36:37], v30 offset:9216
  ds_read_b64_tr_b16 v[38:39], v30 offset:11520
  v_mfma_f32_16x16x32_bf16 v[76:79], v[44:47], a[32:35], v[76:79]
  ds_read_b64_tr_b16 v[40:41], v30 offset:9248
  ds_read_b64_tr_b16 v[42:43], v30 offset:11552
  s_waitcnt lgkmcnt(10)
  v_mfma_f32_16x16x32_bf16 v[80:83], v[48:51], a[32:35], v[80:83]
  ds_read_b64_tr_b16 v[44:45], v30 offset:9280
  ds_read_b64_tr_b16 v[46:47], v30 offset:11584
  v_mfma_f32_16x16x32_bf16 v[84:87], v[52:55], a[32:35], v[84:87]
  ds_read_b64_tr_b16 v[48:49], v30 offset:9312
  ds_read_b64_tr_b16 v[50:51], v30 offset:11616
  s_waitcnt lgkmcnt(10)
  v_mfma_f32_16x16x32_bf16 v[88:91], v[56:59], a[32:35], v[88:91]
  ds_read_b64_tr_b16 v[52:53], v30 offset:9344
  ds_read_b64_tr_b16 v[54:55], v30 offset:11648
  v_mfma_f32_16x16x32_bf16 v[92:95], v[60:63], a[32:35], v[92:95]
  ds_read_b64_tr_b16 v[56:57], v30 offset:9376
  ds_read_b64_tr_b16 v[58:59], v30 offset:11680
  s_waitcnt lgkmcnt(10)
  v_mfma_f32_16x16x32_bf16 v[96:99], v[32:35], a[32:35], v[96:99]
  ds_read_b64_tr_b16 v[60:61], v30 offset:9408
  ds_read_b64_tr_b16 v[62:63], v30 offset:11712
  v_mfma_f32_16x16x32_bf16 v[64:67], v[36:39], a[36:39], v[64:67]
  ds_read_b64_tr_b16 v[32:33], v30 offset:9440
  ds_read_b64_tr_b16 v[34:35], v30 offset:11744
  s_waitcnt lgkmcnt(10)
  v_mfma_f32_16x16x32_bf16 v[68:71], v[40:43], a[36:39], v[68:71]
  ds_read_b64_tr_b16 v[36:37], v30 offset:9472
  ds_read_b64_tr_b16 v[38:39], v30 offset:11776
  v_mfma_f32_16x16x32_bf16 v[72:75], v[44:47], a[36:39], v[72:75]
  ds_read_b64_tr_b16 v[40:41], v30 offset:18432
  ds_read_b64_tr_b16 v[42:43], v30 offset:20736
  s_waitcnt lgkmcnt(10)
  v_mfma_f32_16x16x32_bf16 v[76:79], v[48:51], a[36:39], v[76:79]
  ds_read_b64_tr_b16 v[44:45], v30 offset:18464
  ds_read_b64_tr_b16 v[46:47], v30 offset:20768
  v_mfma_f32_16x16x32_bf16 v[80:83], v[52:55], a[36:39], v[80:83]
  ds_read_b64_tr_b16 v[48:49], v30 offset:18496
  ds_read_b64_tr_b16 v[50:51], v30 offset:20800
  s_waitcnt lgkmcnt(10)
  v_mfma_f32_16x16x32_bf16 v[84:87], v[56:59], a[36:39], v[84:87]
  ds_read_b64_tr_b16 v[52:53], v30 offset:18528
  ds_read_b64_tr_b16 v[54:55], v30 offset:20832
  v_mfma_f32_16x16x32_bf16 v[88:91], v[60:63], a[36:39], v[88:91]
  ds_read_b64_tr_b16 v[56:57], v30 offset:18560
  ds_read_b64_tr_b16 v[58:59], v30 offset:20864
  s_waitcnt lgkmcnt(10)
  v_mfma_f32_16x16x32_bf16 v[92:95], v[32:35], a[36:39], v[92:95]
  ds_read_b64_tr_b16 v[60:61], v30 offset:18592
  ds_read_b64_tr_b16 v[62:63], v30 offset:20896
  v_mfma_f32_16x16x32_bf16 v[96:99], v[36:39], a[36:39], v[96:99]
  ds_read_b64_tr_b16 v[32:33], v30 offset:18624
  ds_read_b64_tr_b16 v[34:35], v30 offset:20928
  s_waitcnt lgkmcnt(10)
  v_mfma_f32_16x16x32_bf16 v[64:67], v[40:43], a[40:43], v[64:67]
  ds_read_b64_tr_b16 v[36:37], v30 offset:18656
  ds_read_b64_tr_b16 v[38:39], v30 offset:20960
  v_mfma_f32_16x16x32_bf16 v[68:71], v[44:47], a[40:43], v[68:71]
  ds_read_b64_tr_b16 v[40:41], v30 offset:18688
  ds_read_b64_tr_b16 v[42:43], v30 offset:20992
  s_waitcnt lgkmcnt(10)
  v_mfma_f32_16x16x32_bf16 v[72:75], v[48:51], a[40:43], v[72:75]
  ds_read_b64_tr_b16 v[44:45], v30 offset:27648
  ds_read_b64_tr_b16 v[46:47], v30 offset:29952
  v_mfma_f32_16x16x32_bf16 v[76:79], v[52:55], a[40:43], v[76:79]
  ds_read_b64_tr_b16 v[48:49], v30 offset:27680
  ds_read_b64_tr_b16 v[50:51], v30 offset:29984
  s_waitcnt lgkmcnt(10)
  v_mfma_f32_16x16x32_bf16 v[80:83], v[56:59], a[40:43], v[80:83]
  ds_read_b64_tr_b16 v[52:53], v30 offset:27712
  ds_read_b64_tr_b16 v[54:55], v30 offset:30016
  v_mfma_f32_16x16x32_bf16 v[84:87], v[60:63], a[40:43], v[84:87]
  ds_read_b64_tr_b16 v[56:57], v30 offset:27744
  ds_read_b64_tr_b16 v[58:59], v30 offset:30048
  s_waitcnt lgkmcnt(10)
  v_mfma_f32_16x16x32_bf16 v[88:91], v[32:35], a[40:43], v[88:91]
  ds_read_b64_tr_b16 v[60:61], v30 offset:27776
  ds_read_b64_tr_b16 v[62:63], v30 offset:30080
  v_mfma_f32_16x16x32_bf16 v[92:95], v[36:39], a[40:43], v[92:95]
  ds_read_b64_tr_b16 v[32:33], v30 offset:27808
  ds_read_b64_tr_b16 v[34:35], v30 offset:30112
  s_waitcnt lgkmcnt(10)
  v_mfma_f32_16x16x32_bf16 v[96:99], v[40:43], a[40:43], v[96:99]
  ds_read_b64_tr_b16 v[36:37], v30 offset:27840
  ds_read_b64_tr_b16 v[38:39], v30 offset:30144
  v_mfma_f32_16x16x32_bf16 v[64:67], v[44:47], a[44:47], v[64:67]
  ds_read_b64_tr_b16 v[40:41], v30 offset:27872
  ds_read_b64_tr_b16 v[42:43], v30 offset:30176
  s_waitcnt lgkmcnt(10)
  v_mfma_f32_16x16x32_bf16 v[68:71], v[48:51], a[44:47], v[68:71]
  ds_read_b64_tr_b16 v[44:45], v30 offset:27904
  ds_read_b64_tr_b16 v[46:47], v30 offset:30208
  v_mfma_f32_16x16x32_bf16 v[72:75], v[52:55], a[44:47], v[72:75]
  s_waitcnt lgkmcnt(8)
  v_mfma_f32_16x16x32_bf16 v[76:79], v[56:59], a[44:47], v[76:79]
  v_mfma_f32_16x16x32_bf16 v[80:83], v[60:63], a[44:47], v[80:83]
  s_waitcnt lgkmcnt(4)
  v_mfma_f32_16x16x32_bf16 v[84:87], v[32:35], a[44:47], v[84:87]
  v_mfma_f32_16x16x32_bf16 v[88:91], v[36:39], a[44:47], v[88:91]
  s_waitcnt lgkmcnt(0)
  v_mfma_f32_16x16x32_bf16 v[92:95], v[40:43], a[44:47], v[92:95]
  v_mfma_f32_16x16x32_bf16 v[96:99], v[44:47], a[44:47], v[96:99]
  s_waitcnt vmcnt(0)
  s_lshl_b32 s56, s90, 4
  s_add_u32 s56, s56, s5
  s_lshl_b32 s56, s56, 3
  s_add_u32 s56, s56, s4
  s_mul_i32 s56, s56, 18432
  s_mul_i32 s57, s6, 4608
  s_add_u32 s56, s56, s57
  s_add_u32 s58, s56, 14680064
  v_lshlrev_b32 v2, 3, v1
  ds_read_b64_tr_b16 v[48:49], v31 offset:0
  ds_read_b64_tr_b16 v[50:51], v31 offset:2304
  ds_read_b64_tr_b16 v[52:53], v31 offset:9216
  ds_read_b64_tr_b16 v[54:55], v31 offset:11520
  ds_read_b64_tr_b16 v[56:57], v31 offset:18432
  ds_read_b64_tr_b16 v[58:59], v31 offset:20736
  ds_read_b64_tr_b16 v[60:61], v31 offset:27648
  ds_read_b64_tr_b16 v[62:63], v31 offset:29952
  ds_read_b64_tr_b16 v[32:33], v31 offset:32
  ds_read_b64_tr_b16 v[34:35], v31 offset:2336
  ds_read_b64_tr_b16 v[36:37], v31 offset:9248
  ds_read_b64_tr_b16 v[38:39], v31 offset:11552
  ds_read_b64_tr_b16 v[40:41], v31 offset:18464
  ds_read_b64_tr_b16 v[42:43], v31 offset:20768
  s_waitcnt lgkmcnt(10)
  v_mfma_f32_16x16x32_bf16 v[64:67], v[48:51], a[48:51], v[64:67]
  ds_read_b64_tr_b16 v[44:45], v31 offset:27680
  ds_read_b64_tr_b16 v[46:47], v31 offset:29984
  v_mfma_f32_16x16x32_bf16 v[64:67], v[52:55], a[52:55], v[64:67]
  ds_read_b64_tr_b16 v[48:49], v31 offset:64
  ds_read_b64_tr_b16 v[50:51], v31 offset:2368
  s_waitcnt lgkmcnt(10)
  v_mfma_f32_16x16x32_bf16 v[64:67], v[56:59], a[56:59], v[64:67]
  ds_read_b64_tr_b16 v[52:53], v31 offset:9280
  ds_read_b64_tr_b16 v[54:55], v31 offset:11584
  v_mfma_f32_16x16x32_bf16 v[64:67], v[60:63], a[60:63], v[64:67]
  ds_read_b64_tr_b16 v[56:57], v31 offset:18496
  ds_read_b64_tr_b16 v[58:59], v31 offset:20800
  s_waitcnt lgkmcnt(10)
  v_mfma_f32_16x16x32_bf16 v[68:71], v[32:35], a[48:51], v[68:71]
  ds_read_b64_tr_b16 v[60:61], v31 offset:27712
  ds_read_b64_tr_b16 v[62:63], v31 offset:30016
  v_mfma_f32_16x16x32_bf16 v[68:71], v[36:39], a[52:55], v[68:71]
  ds_read_b64_tr_b16 v[32:33], v31 offset:96
  ds_read_b64_tr_b16 v[34:35], v31 offset:2400
  s_waitcnt lgkmcnt(10)
  v_mfma_f32_16x16x32_bf16 v[68:71], v[40:43], a[56:59], v[68:71]
  ds_read_b64_tr_b16 v[36:37], v31 offset:9312
  ds_read_b64_tr_b16 v[38:39], v31 offset:11616
  v_mfma_f32_16x16x32_bf16 v[68:71], v[44:47], a[60:63], v[68:71]
  v_cvt_pk_bf16_f32 v160, v64, v65
  v_cvt_pk_bf16_f32 v161, v66, v67
  s_add_u32 s57, s58, 0
  buffer_store_dwordx2 v[160:161], v2, s[24:27], s57 offen sc1
  ds_read_b64_tr_b16 v[40:41], v31 offset:18528
  ds_read_b64_tr_b16 v[42:43], v31 offset:20832
  s_waitcnt lgkmcnt(10)
  v_mfma_f32_16x16x32_bf16 v[72:75], v[48:51], a[48:51], v[72:75]
  ds_read_b64_tr_b16 v[44:45], v31 offset:27744
  ds_read_b64_tr_b16 v[46:47], v31 offset:30048
  v_mfma_f32_16x16x32_bf16 v[72:75], v[52:55], a[52:55], v[72:75]
  ds_read_b64_tr_b16 v[48:49], v31 offset:128
  ds_read_b64_tr_b16 v[50:51], v31 offset:2432
  s_waitcnt lgkmcnt(10)
  v_mfma_f32_16x16x32_bf16 v[72:75], v[56:59], a[56:59], v[72:75]
  ds_read_b64_tr_b16 v[52:53], v31 offset:9344
  ds_read_b64_tr_b16 v[54:55], v31 offset:11648
  v_mfma_f32_16x16x32_bf16 v[72:75], v[60:63], a[60:63], v[72:75]
  v_cvt_pk_bf16_f32 v162, v68, v69
  v_cvt_pk_bf16_f32 v163, v70, v71
  s_add_u32 s57, s58, 512
  buffer_store_dwordx2 v[162:163], v2, s[24:27], s57 offen sc1
  ds_read_b64_tr_b16 v[56:57], v31 offset:18560
  ds_read_b64_tr_b16 v[58:59], v31 offset:20864
  s_waitcnt lgkmcnt(10)
  v_mfma_f32_16x16x32_bf16 v[76:79], v[32:35], a[48:51], v[76:79]
  ds_read_b64_tr_b16 v[60:61], v31 offset:27776
  ds_read_b64_tr_b16 v[62:63], v31 offset:30080
  v_mfma_f32_16x16x32_bf16 v[76:79], v[36:39], a[52:55], v[76:79]
  ds_read_b64_tr_b16 v[32:33], v31 offset:160
  ds_read_b64_tr_b16 v[34:35], v31 offset:2464
  s_waitcnt lgkmcnt(10)
  v_mfma_f32_16x16x32_bf16 v[76:79], v[40:43], a[56:59], v[76:79]
  ds_read_b64_tr_b16 v[36:37], v31 offset:9376
  ds_read_b64_tr_b16 v[38:39], v31 offset:11680
  v_mfma_f32_16x16x32_bf16 v[76:79], v[44:47], a[60:63], v[76:79]
  v_cvt_pk_bf16_f32 v164, v72, v73
  v_cvt_pk_bf16_f32 v165, v74, v75
  s_add_u32 s57, s58, 1024
  buffer_store_dwordx2 v[164:165], v2, s[24:27], s57 offen sc1
  ds_read_b64_tr_b16 v[40:41], v31 offset:18592
  ds_read_b64_tr_b16 v[42:43], v31 offset:20896
  s_waitcnt lgkmcnt(10)
  v_mfma_f32_16x16x32_bf16 v[80:83], v[48:51], a[48:51], v[80:83]
  ds_read_b64_tr_b16 v[44:45], v31 offset:27808
  ds_read_b64_tr_b16 v[46:47], v31 offset:30112
  v_mfma_f32_16x16x32_bf16 v[80:83], v[52:55], a[52:55], v[80:83]
  ds_read_b64_tr_b16 v[48:49], v31 offset:192
  ds_read_b64_tr_b16 v[50:51], v31 offset:2496
  s_waitcnt lgkmcnt(10)
  v_mfma_f32_16x16x32_bf16 v[80:83], v[56:59], a[56:59], v[80:83]
  ds_read_b64_tr_b16 v[52:53], v31 offset:9408
  ds_read_b64_tr_b16 v[54:55], v31 offset:11712
  v_mfma_f32_16x16x32_bf16 v[80:83], v[60:63], a[60:63], v[80:83]
  v_cvt_pk_bf16_f32 v166, v76, v77
  v_cvt_pk_bf16_f32 v167, v78, v79
  s_add_u32 s57, s58, 1536
  buffer_store_dwordx2 v[166:167], v2, s[24:27], s57 offen sc1
  ds_read_b64_tr_b16 v[56:57], v31 offset:18624
  ds_read_b64_tr_b16 v[58:59], v31 offset:20928
  s_waitcnt lgkmcnt(10)
  v_mfma_f32_16x16x32_bf16 v[84:87], v[32:35], a[48:51], v[84:87]
  ds_read_b64_tr_b16 v[60:61], v31 offset:27840
  ds_read_b64_tr_b16 v[62:63], v31 offset:30144
  v_mfma_f32_16x16x32_bf16 v[84:87], v[36:39], a[52:55], v[84:87]
  ds_read_b64_tr_b16 v[32:33], v31 offset:224
  ds_read_b64_tr_b16 v[34:35], v31 offset:2528
  s_waitcnt lgkmcnt(10)
  v_mfma_f32_16x16x32_bf16 v[84:87], v[40:43], a[56:59], v[84:87]
  ds_read_b64_tr_b16 v[36:37], v31 offset:9440
  ds_read_b64_tr_b16 v[38:39], v31 offset:11744
  v_mfma_f32_16x16x32_bf16 v[84:87], v[44:47], a[60:63], v[84:87]
  v_cvt_pk_bf16_f32 v168, v80, v81
  v_cvt_pk_bf16_f32 v169, v82, v83
  s_add_u32 s57, s58, 2048
  buffer_store_dwordx2 v[168:169], v2, s[24:27], s57 offen sc1
  ds_read_b64_tr_b16 v[40:41], v31 offset:18656
  ds_read_b64_tr_b16 v[42:43], v31 offset:20960
  s_waitcnt lgkmcnt(10)
  v_mfma_f32_16x16x32_bf16 v[88:91], v[48:51], a[48:51], v[88:91]
  ds_read_b64_tr_b16 v[44:45], v31 offset:27872
  ds_read_b64_tr_b16 v[46:47], v31 offset:30176
  v_mfma_f32_16x16x32_bf16 v[88:91], v[52:55], a[52:55], v[88:91]
  ds_read_b64_tr_b16 v[48:49], v31 offset:256
  ds_read_b64_tr_b16 v[50:51], v31 offset:2560
  s_waitcnt lgkmcnt(10)
  v_mfma_f32_16x16x32_bf16 v[88:91], v[56:59], a[56:59], v[88:91]
  ds_read_b64_tr_b16 v[52:53], v31 offset:9472
  ds_read_b64_tr_b16 v[54:55], v31 offset:11776
  v_mfma_f32_16x16x32_bf16 v[88:91], v[60:63], a[60:63], v[88:91]
  v_cvt_pk_bf16_f32 v170, v84, v85
  v_cvt_pk_bf16_f32 v171, v86, v87
  s_add_u32 s57, s58, 2560
  buffer_store_dwordx2 v[170:171], v2, s[24:27], s57 offen sc1
  ds_read_b64_tr_b16 v[56:57], v31 offset:18688
  ds_read_b64_tr_b16 v[58:59], v31 offset:20992
  s_waitcnt lgkmcnt(10)
  v_mfma_f32_16x16x32_bf16 v[92:95], v[32:35], a[48:51], v[92:95]
  ds_read_b64_tr_b16 v[60:61], v31 offset:27904
  ds_read_b64_tr_b16 v[62:63], v31 offset:30208
  v_mfma_f32_16x16x32_bf16 v[92:95], v[36:39], a[52:55], v[92:95]
  s_waitcnt lgkmcnt(8)
  v_mfma_f32_16x16x32_bf16 v[92:95], v[40:43], a[56:59], v[92:95]
  v_mfma_f32_16x16x32_bf16 v[92:95], v[44:47], a[60:63], v[92:95]
  v_cvt_pk_bf16_f32 v172, v88, v89
  v_cvt_pk_bf16_f32 v173, v90, v91
  s_add_u32 s57, s58, 3072
  buffer_store_dwordx2 v[172:173], v2, s[24:27], s57 offen sc1
  s_waitcnt lgkmcnt(4)
  v_mfma_f32_16x16x32_bf16 v[96:99], v[48:51], a[48:51], v[96:99]
  v_mfma_f32_16x16x32_bf16 v[96:99], v[52:55], a[52:55], v[96:99]
  s_waitcnt lgkmcnt(0)
  v_mfma_f32_16x16x32_bf16 v[96:99], v[56:59], a[56:59], v[96:99]
  v_mfma_f32_16x16x32_bf16 v[96:99], v[60:63], a[60:63], v[96:99]
  v_cvt_pk_bf16_f32 v174, v92, v93
  v_cvt_pk_bf16_f32 v175, v94, v95
  s_add_u32 s57, s58, 3584
  buffer_store_dwordx2 v[174:175], v2, s[24:27], s57 offen sc1
  s_nop 7
  v_cvt_pk_bf16_f32 v176, v96, v97
  v_cvt_pk_bf16_f32 v177, v98, v99
  s_add_u32 s57, s58, 4096
  buffer_store_dwordx2 v[176:177], v2, s[24:27], s57 offen sc1
  s_lshl_b32 s56, s6, 1
  s_lshl_b32 s57, s5, 4
  s_add_u32 s56, s56, s57
  s_lshl_b32 s57, s90, 3
  s_add_u32 s56, s56, s57
  v_add_u32 v3, s56, v1
  s_lshl_b32 s57, s4, 3
  s_add_u32 s57, s57, 524672
  v_lshlrev_b32 v3, 9, v3
  v_add_u32 v3, s57, v3
  v_mov_b32 v6, s88
  v_mov_b32 v7, s89
  s_waitcnt vmcnt(0)
  s_mov_b64 exec, 3
  buffer_store_dwordx2 v[6:7], v3, s[24:27], 0 offen sc1
  s_mov_b64 exec, -1
  v_and_b32 v2, 7, v1
  v_lshlrev_b32 v2, 3, v2
  s_lshl_b32 s56, s2, 9
  s_add_u32 s56, s56, 524672
  v_add_u32 v2, s56, v2
  s_mul_i32 s56, s4, 288
  v_add_u32 v25, s56, v0
  v_lshlrev_b32 v16, 3, v25
  v_lshrrev_b32 v20, 6, v25
  v_and_b32 v21, 63, v25
  s_movk_i32 s57, 7282
  v_mul_lo_u32 v22, v20, s57
  v_lshrrev_b32 v22, 16, v22
  v_mul_u32_u24 v23, 9, v22
  v_sub_u32 v23, v20, v23
  v_lshlrev_b32 v22, 4, v22
  s_lshr_b32 s57, s5, 2
  s_lshl_b32 s57, s57, 1
  s_add_u32 s57, s57, s90
  s_lshl_b32 s57, s57, 6
  v_and_b32 v24, 15, v21
  v_add_u32 v22, v22, v24
  v_add_u32 v22, s57, v22
  v_mul_u32_u24 v22, 2304, v22
  v_lshrrev_b32 v21, 4, v21
  v_lshlrev_b32 v21, 2, v21
  v_lshl_add_u32 v21, v23, 4, v21
  s_and_b32 s57, s5, 3
  s_mul_i32 s57, s57, 144
  s_add_u32 s57, s57, 576
  v_add_u32 v21, s57, v21
  v_lshl_add_u32 v13, v21, 1, v22
  v_add_u32 v25, s56, v0
  v_add_u32 v25, 256, v25
  v_lshlrev_b32 v17, 3, v25
  v_lshrrev_b32 v20, 6, v25
  v_and_b32 v21, 63, v25
  s_movk_i32 s57, 7282
  v_mul_lo_u32 v22, v20, s57
  v_lshrrev_b32 v22, 16, v22
  v_mul_u32_u24 v23, 9, v22
  v_sub_u32 v23, v20, v23
  v_lshlrev_b32 v22, 4, v22
  s_lshr_b32 s57, s5, 2
  s_lshl_b32 s57, s57, 1
  s_add_u32 s57, s57, s90
  s_lshl_b32 s57, s57, 6
  v_and_b32 v24, 15, v21
  v_add_u32 v22, v22, v24
  v_add_u32 v22, s57, v22
  v_mul_u32_u24 v22, 2304, v22
  v_lshrrev_b32 v21, 4, v21
  v_lshlrev_b32 v21, 2, v21
  v_lshl_add_u32 v21, v23, 4, v21
  s_and_b32 s57, s5, 3
  s_mul_i32 s57, s57, 144
  s_add_u32 s57, s57, 576
  v_add_u32 v21, s57, v21
  v_lshl_add_u32 v14, v21, 1, v22
  s_lshl_b32 s56, s90, 4
  s_add_u32 s56, s56, s5
  s_lshl_b32 s56, s56, 3
  s_mul_i32 s56, s56, 18432
  s_add_u32 s56, s56, 14680064
  s_mov_b32 s55, 0x20000
  buffer_load_dwordx2 v[240:241], v2, s[24:27], 0 offen sc1
L_spin_36:
  s_waitcnt vmcnt(0)
  v_cmp_ne_u64 vcc, s[88:89], v[240:241]
  s_cbranch_vccz L_spun_37
  s_sleep 1
  buffer_load_dwordx2 v[240:241], v2, s[24:27], 0 offen sc1
  s_sub_u32 s55, s55, 1
  s_cmp_lg_u32 s55, 0
  s_cbranch_scc1 L_spin_36
L_spun_37:
  s_cmp_eq_u32 s6, 0
  s_cbranch_scc1 L_rx_38
  s_add_u32 s57, s56, 0
  buffer_load_dwordx2 v[32:33], v16, s[24:27], s57 offen sc1
  s_add_u32 s57, s56, 18432
  buffer_load_dwordx2 v[36:37], v16, s[24:27], s57 offen sc1
  s_add_u32 s57, s56, 36864
  buffer_load_dwordx2 v[40:41], v16, s[24:27], s57 offen sc1
  s_add_u32 s57, s56, 55296
  buffer_load_dwordx2 v[44:45], v16, s[24:27], s57 offen sc1
  s_add_u32 s57, s56, 73728
  buffer_load_dwordx2 v[48:49], v16, s[24:27], s57 offen sc1
  s_add_u32 s57, s56, 92160
  buffer_load_dwordx2 v[52:53], v16, s[24:27], s57 offen sc1
  s_add_u32 s57, s56, 110592
  buffer_load_dwordx2 v[56:57], v16, s[24:27], s57 offen sc1
  s_add_u32 s57, s56, 129024
  buffer_load_dwordx2 v[60:61], v16, s[24:27], s57 offen sc1
  s_waitcnt vmcnt(0)
  v_lshlrev_b32 v160, 16, v32
  v_lshlrev_b32 v169, 16, v36
  v_add_f32 v160, v160, v169
  v_lshlrev_b32 v168, 16, v40
  v_add_f32 v160, v160, v168
  v_lshlrev_b32 v169, 16, v44
  v_add_f32 v160, v160, v169
  v_lshlrev_b32 v168, 16, v48
  v_add_f32 v160, v160, v168
  v_lshlrev_b32 v169, 16, v52
  v_add_f32 v160, v160, v169
  v_lshlrev_b32 v168, 16, v56
  v_add_f32 v160, v160, v168
  v_lshlrev_b32 v169, 16, v60
  v_add_f32 v160, v160, v169
  v_and_b32 v161, 0xffff0000, v32
  v_and_b32 v169, 0xffff0000, v36
  v_add_f32 v161, v161, v169
  v_and_b32 v168, 0xffff0000, v40
  v_add_f32 v161, v161, v168
  v_and_b32 v169, 0xffff0000, v44
  v_add_f32 v161, v161, v169
  v_and_b32 v168, 0xffff0000, v48
  v_add_f32 v161, v161, v168
  v_and_b32 v169, 0xffff0000, v52
  v_add_f32 v161, v161, v169
  v_and_b32 v168, 0xffff0000, v56
  v_add_f32 v161, v161, v168
  v_and_b32 v169, 0xffff0000, v60
  v_add_f32 v161, v161, v169
  v_lshlrev_b32 v162, 16, v33
  v_lshlrev_b32 v169, 16, v37
  v_add_f32 v162, v162, v169
  v_lshlrev_b32 v168, 16, v41
  v_add_f32 v162, v162, v168
  v_lshlrev_b32 v169, 16, v45
  v_add_f32 v162, v162, v169
  v_lshlrev_b32 v168, 16, v49
  v_add_f32 v162, v162, v168
  v_lshlrev_b32 v169, 16, v53
  v_add_f32 v162, v162, v169
  v_lshlrev_b32 v168, 16, v57
  v_add_f32 v162, v162, v168
  v_lshlrev_b32 v169, 16, v61
  v_add_f32 v162, v162, v169
  v_and_b32 v163, 0xffff0000, v33
  v_and_b32 v169, 0xffff0000, v37
  v_add_f32 v163, v163, v169
  v_and_b32 v168, 0xffff0000, v41
  v_add_f32 v163, v163, v168
  v_and_b32 v169, 0xffff0000, v45
  v_add_f32 v163, v163, v169
  v_and_b32 v168, 0xffff0000, v49
  v_add_f32 v163, v163, v168
  v_and_b32 v169, 0xffff0000, v53
  v_add_f32 v163, v163, v169
  v_and_b32 v168, 0xffff0000, v57
  v_add_f32 v163, v163, v168
  v_and_b32 v169, 0xffff0000, v61
  v_add_f32 v163, v163, v169
  v_cvt_pk_bf16_f32 v172, v160, v161
  v_cvt_pk_bf16_f32 v173, v162, v163
  buffer_store_dwordx2 v[172:173], v13, s[20:23], 0 offen
  s_branch L_rx2_39
L_rx_38:
  s_add_u32 s57, s56, 0
  buffer_load_dwordx2 v[32:33], v16, s[24:27], s57 offen sc1
  s_add_u32 s57, s56, 18432
  buffer_load_dwordx2 v[36:37], v16, s[24:27], s57 offen sc1
  s_add_u32 s57, s56, 36864
  buffer_load_dwordx2 v[40:41], v16, s[24:27], s57 offen sc1
  s_add_u32 s57, s56, 55296
  buffer_load_dwordx2 v[44:45], v16, s[24:27], s57 offen sc1
  s_add_u32 s57, s56, 73728
  buffer_load_dwordx2 v[48:49], v16, s[24:27], s57 offen sc1
  s_add_u32 s57, s56, 92160
  buffer_load_dwordx2 v[52:53], v16, s[24:27], s57 offen sc1
  s_add_u32 s57, s56, 110592
  buffer_load_dwordx2 v[56:57], v16, s[24:27], s57 offen sc1
  s_add_u32 s57, s56, 129024
  buffer_load_dwordx2 v[60:61], v16, s[24:27], s57 offen sc1
  s_mov_b32 exec_hi, 0
  s_add_u32 s57, s56, 0
  buffer_load_dwordx2 v[96:97], v17, s[24:27], s57 offen sc1
  s_add_u32 s57, s56, 18432
  buffer_load_dwordx2 v[100:101], v17, s[24:27], s57 offen sc1
  s_add_u32 s57, s56, 36864
  buffer_load_dwordx2 v[104:105], v17, s[24:27], s57 offen sc1
  s_add_u32 s57, s56, 55296
  buffer_load_dwordx2 v[108:109], v17, s[24:27], s57 offen sc1
  s_add_u32 s57, s56, 73728
  buffer_load_dwordx2 v[112:113], v17, s[24:27], s57 offen sc1
  s_add_u32 s57, s56, 92160
  buffer_load_dwordx2 v[116:117], v17, s[24:27], s57 offen sc1
  s_add_u32 s57, s56, 110592
  buffer_load_dwordx2 v[120:121], v17, s[24:27], s57 offen sc1
  s_add_u32 s57, s56, 129024
  buffer_load_dwordx2 v[124:125], v17, s[24:27], s57 offen sc1
  s_mov_b64 exec, -1
  s_waitcnt vmcnt(8)
  v_lshlrev_b32 v160, 16, v32
  v_lshlrev_b32 v169, 16, v36
  v_add_f32 v160, v160, v169
  v_lshlrev_b32 v168, 16, v40
  v_add_f32 v160, v160, v168
  v_lshlrev_b32 v169, 16, v44
  v_add_f32 v160, v160, v169
  v_lshlrev_b32 v168, 16, v48
  v_add_f32 v160, v160, v168
  v_lshlrev_b32 v169, 16, v52
  v_add_f32 v160, v160, v169
  v_lshlrev_b32 v168, 16, v56
  v_add_f32 v160, v160, v168
  v_lshlrev_b32 v169, 16, v60
  v_add_f32 v160, v160, v169
  v_and_b32 v161, 0xffff0000, v32
  v_and_b32 v169, 0xffff0000, v36
  v_add_f32 v161, v161, v169
  v_and_b32 v168, 0xffff0000, v40
  v_add_f32 v161, v161, v168
  v_and_b32 v169, 0xffff0000, v44
  v_add_f32 v161, v161, v169
  v_and_b32 v168, 0xffff0000, v48
  v_add_f32 v161, v161, v168
  v_and_b32 v169, 0xffff0000, v52
  v_add_f32 v161, v161, v169
  v_and_b32 v168, 0xffff0000, v56
  v_add_f32 v161, v161, v168
  v_and_b32 v169, 0xffff0000, v60
  v_add_f32 v161, v161, v169
  v_lshlrev_b32 v162, 16, v33
  v_lshlrev_b32 v169, 16, v37
  v_add_f32 v162, v162, v169
  v_lshlrev_b32 v168, 16, v41
  v_add_f32 v162, v162, v168
  v_lshlrev_b32 v169, 16, v45
  v_add_f32 v162, v162, v169
  v_lshlrev_b32 v168, 16, v49
  v_add_f32 v162, v162, v168
  v_lshlrev_b32 v169, 16, v53
  v_add_f32 v162, v162, v169
  v_lshlrev_b32 v168, 16, v57
  v_add_f32 v162, v162, v168
  v_lshlrev_b32 v169, 16, v61
  v_add_f32 v162, v162, v169
  v_and_b32 v163, 0xffff0000, v33
  v_and_b32 v169, 0xffff0000, v37
  v_add_f32 v163, v163, v169
  v_and_b32 v168, 0xffff0000, v41
  v_add_f32 v163, v163, v168
  v_and_b32 v169, 0xffff0000, v45
  v_add_f32 v163, v163, v169
  v_and_b32 v168, 0xffff0000, v49
  v_add_f32 v163, v163, v168
  v_and_b32 v169, 0xffff0000, v53
  v_add_f32 v163, v163, v169
  v_and_b32 v168, 0xffff0000, v57
  v_add_f32 v163, v163, v168
  v_and_b32 v169, 0xffff0000, v61
  v_add_f32 v163, v163, v169
  v_cvt_pk_bf16_f32 v172, v160, v161
  v_cvt_pk_bf16_f32 v173, v162, v163
  buffer_store_dwordx2 v[172:173], v13, s[20:23], 0 offen
  s_mov_b32 exec_hi, 0
  s_waitcnt vmcnt(1)
  v_lshlrev_b32 v160, 16, v96
  v_lshlrev_b32 v169, 16, v100
  v_add_f32 v160, v160, v169
  v_lshlrev_b32 v168, 16, v104
  v_add_f32 v160, v160, v168
  v_lshlrev_b32 v169, 16, v108
  v_add_f32 v160, v160, v169
  v_lshlrev_b32 v168, 16, v112
  v_add_f32 v160, v160, v168
  v_lshlrev_b32 v169, 16, v116
  v_add_f32 v160, v160, v169
  v_lshlrev_b32 v168, 16, v120
  v_add_f32 v160, v160, v168
  v_lshlrev_b32 v169, 16, v124
  v_add_f32 v160, v160, v169
  v_and_b32 v161, 0xffff0000, v96
  v_and_b32 v169, 0xffff0000, v100
  v_add_f32 v161, v161, v169
  v_and_b32 v168, 0xffff0000, v104
  v_add_f32 v161, v161, v168
  v_and_b32 v169, 0xffff0000, v108
  v_add_f32 v161, v161, v169
  v_and_b32 v168, 0xffff0000, v112
  v_add_f32 v161, v161, v168
  v_and_b32 v169, 0xffff0000, v116
  v_add_f32 v161, v161, v169
  v_and_b32 v168, 0xffff0000, v120
  v_add_f32 v161, v161, v168
  v_and_b32 v169, 0xffff0000, v124
  v_add_f32 v161, v161, v169
  v_lshlrev_b32 v162, 16, v97
  v_lshlrev_b32 v169, 16, v101
  v_add_f32 v162, v162, v169
  v_lshlrev_b32 v168, 16, v105
  v_add_f32 v162, v162, v168
  v_lshlrev_b32 v169, 16, v109
  v_add_f32 v162, v162, v169
  v_lshlrev_b32 v168, 16, v113
  v_add_f32 v162, v162, v168
  v_lshlrev_b32 v169, 16, v117
  v_add_f32 v162, v162, v169
  v_lshlrev_b32 v168, 16, v121
  v_add_f32 v162, v162, v168
  v_lshlrev_b32 v169, 16, v125
  v_add_f32 v162, v162, v169
  v_and_b32 v163, 0xffff0000, v97
  v_and_b32 v169, 0xffff0000, v101
  v_add_f32 v163, v163, v169
  v_and_b32 v168, 0xffff0000, v105
  v_add_f32 v163, v163, v168
  v_and_b32 v169, 0xffff0000, v109
  v_add_f32 v163, v163, v169
  v_and_b32 v168, 0xffff0000, v113
  v_add_f32 v163, v163, v168
  v_and_b32 v169, 0xffff0000, v117
  v_add_f32 v163, v163, v169
  v_and_b32 v168, 0xffff0000, v121
  v_add_f32 v163, v163, v168
  v_and_b32 v169, 0xffff0000, v125
  v_add_f32 v163, v163, v169
  v_cvt_pk_bf16_f32 v172, v160, v161
  v_cvt_pk_bf16_f32 v173, v162, v163
  buffer_store_dwordx2 v[172:173], v14, s[20:23], 0 offen
  s_mov_b64 exec, -1
L_rx2_39:
  s_endpgm
L_resc_2:
  v_max_f32 v168, 0, v168
  v_sub_f32 v12, 0, v168
  v_exp_f32 v12, v12
  v_sub_f32 v208, v208, v168
  v_sub_f32 v144, v144, v168
  v_sub_f32 v145, v145, v168
  v_sub_f32 v146, v146, v168
  v_sub_f32 v147, v147, v168
  v_sub_f32 v148, v148, v168
  v_sub_f32 v149, v149, v168
  v_sub_f32 v150, v150, v168
  v_sub_f32 v151, v151, v168
  v_sub_f32 v152, v152, v168
  v_sub_f32 v153, v153, v168
  v_sub_f32 v154, v154, v168
  v_sub_f32 v155, v155, v168
  v_sub_f32 v156, v156, v168
  v_sub_f32 v157, v157, v168
  v_sub_f32 v158, v158, v168
  v_sub_f32 v159, v159, v168
  v_mov_b32 v209, v208
  v_mov_b32 v210, v208
  v_mov_b32 v211, v208
  v_mov_b32 v212, v208
  v_mov_b32 v213, v208
  v_mov_b32 v214, v208
  v_mov_b32 v215, v208
  v_mov_b32 v216, v208
  v_mov_b32 v217, v208
  v_mov_b32 v218, v208
  v_mov_b32 v219, v208
  v_mov_b32 v220, v208
  v_mov_b32 v221, v208
  v_mov_b32 v222, v208
  v_mov_b32 v223, v208
  v_mul_f32 v10, v10, v12
  v_mul_f32 v64, v64, v12
  v_mul_f32 v65, v65, v12
  v_mul_f32 v66, v66, v12
  v_mul_f32 v67, v67, v12
  v_mul_f32 v68, v68, v12
  v_mul_f32 v69, v69, v12
  v_mul_f32 v70, v70, v12
  v_mul_f32 v71, v71, v12
  v_mul_f32 v72, v72, v12
  v_mul_f32 v73, v73, v12
  v_mul_f32 v74, v74, v12
  v_mul_f32 v75, v75, v12
  v_mul_f32 v76, v76, v12
  v_mul_f32 v77, v77, v12
  v_mul_f32 v78, v78, v12
  v_mul_f32 v79, v79, v12
  v_mul_f32 v80, v80, v12
  v_mul_f32 v81, v81, v12
  v_mul_f32 v82, v82, v12
  v_mul_f32 v83, v83, v12
  v_mul_f32 v84, v84, v12
  v_mul_f32 v85, v85, v12
  v_mul_f32 v86, v86, v12
  v_mul_f32 v87, v87, v12
  v_mul_f32 v88, v88, v12
  v_mul_f32 v89, v89, v12
  v_mul_f32 v90, v90, v12
  v_mul_f32 v91, v91, v12
  v_mul_f32 v92, v92, v12
  v_mul_f32 v93, v93, v12
  v_mul_f32 v94, v94, v12
  v_mul_f32 v95, v95, v12
  v_mul_f32 v96, v96, v12
  v_mul_f32 v97, v97, v12
  v_mul_f32 v98, v98, v12
  v_mul_f32 v99, v99, v12
  v_mul_f32 v100, v100, v12
  v_mul_f32 v101, v101, v12
  v_mul_f32 v102, v102, v12
  v_mul_f32 v103, v103, v12
  v_mul_f32 v104, v104, v12
  v_mul_f32 v105, v105, v12
  v_mul_f32 v106, v106, v12
  v_mul_f32 v107, v107, v12
  v_mul_f32 v108, v108, v12
  v_mul_f32 v109, v109, v12
  v_mul_f32 v110, v110, v12
  v_mul_f32 v111, v111, v12
  v_mul_f32 v112, v112, v12
  v_mul_f32 v113, v113, v12
  v_mul_f32 v114, v114, v12
  v_mul_f32 v115, v115, v12
  v_mul_f32 v116, v116, v12
  v_mul_f32 v117, v117, v12
  v_mul_f32 v118, v118, v12
  v_mul_f32 v119, v119, v12
  v_mul_f32 v120, v120, v12
  v_mul_f32 v121, v121, v12
  v_mul_f32 v122, v122, v12
  v_mul_f32 v123, v123, v12
  v_mul_f32 v124, v124, v12
  v_mul_f32 v125, v125, v12
  v_mul_f32 v126, v126, v12
  v_mul_f32 v127, v127, v12
  s_nop 1
  s_branch L_back_3
L_resc_4:
  v_max_f32 v168, 0, v168
  v_sub_f32 v12, 0, v168
  v_exp_f32 v12, v12
  v_sub_f32 v208, v208, v168
  v_sub_f32 v128, v128, v168
  v_sub_f32 v129, v129, v168
  v_sub_f32 v130, v130, v168
  v_sub_f32 v131, v131, v168
  v_sub_f32 v132, v132, v168
  v_sub_f32 v133, v133, v168
  v_sub_f32 v134, v134, v168
  v_sub_f32 v135, v135, v168
  v_sub_f32 v136, v136, v168
  v_sub_f32 v137, v137, v168
  v_sub_f32 v138, v138, v168
  v_sub_f32 v139, v139, v168
  v_sub_f32 v140, v140, v168
  v_sub_f32 v141, v141, v168
  v_sub_f32 v142, v142, v168
  v_sub_f32 v143, v143, v168
  v_mov_b32 v209, v208
  v_mov_b32 v210, v208
  v_mov_b32 v211, v208
  v_mov_b32 v212, v208
  v_mov_b32 v213, v208
  v_mov_b32 v214, v208
  v_mov_b32 v215, v208
  v_mov_b32 v216, v208
  v_mov_b32 v217, v208
  v_mov_b32 v218, v208
  v_mov_b32 v219, v208
  v_mov_b32 v220, v208
  v_mov_b32 v221, v208
  v_mov_b32 v222, v208
  v_mov_b32 v223, v208
  v_mul_f32 v10, v10, v12
  v_mul_f32 v64, v64, v12
  v_mul_f32 v65, v65, v12
  v_mul_f32 v66, v66, v12
  v_mul_f32 v67, v67, v12
  v_mul_f32 v68, v68, v12
  v_mul_f32 v69, v69, v12
  v_mul_f32 v70, v70, v12
  v_mul_f32 v71, v71, v12
  v_mul_f32 v72, v72, v12
  v_mul_f32 v73, v73, v12
  v_mul_f32 v74, v74, v12
  v_mul_f32 v75, v75, v12
  v_mul_f32 v76, v76, v12
  v_mul_f32 v77, v77, v12
  v_mul_f32 v78, v78, v12
  v_mul_f32 v79, v79, v12
  v_mul_f32 v80, v80, v12
  v_mul_f32 v81, v81, v12
  v_mul_f32 v82, v82, v12
  v_mul_f32 v83, v83, v12
  v_mul_f32 v84, v84, v12
  v_mul_f32 v85, v85, v12
  v_mul_f32 v86, v86, v12
  v_mul_f32 v87, v87, v12
  v_mul_f32 v88, v88, v12
  v_mul_f32 v89, v89, v12
  v_mul_f32 v90, v90, v12
  v_mul_f32 v91, v91, v12
  v_mul_f32 v92, v92, v12
  v_mul_f32 v93, v93, v12
  v_mul_f32 v94, v94, v12
  v_mul_f32 v95, v95, v12
  v_mul_f32 v96, v96, v12
  v_mul_f32 v97, v97, v12
  v_mul_f32 v98, v98, v12
  v_mul_f32 v99, v99, v12
  v_mul_f32 v100, v100, v12
  v_mul_f32 v101, v101, v12
  v_mul_f32 v102, v102, v12
  v_mul_f32 v103, v103, v12
  v_mul_f32 v104, v104, v12
  v_mul_f32 v105, v105, v12
  v_mul_f32 v106, v106, v12
  v_mul_f32 v107, v107, v12
  v_mul_f32 v108, v108, v12
  v_mul_f32 v109, v109, v12
  v_mul_f32 v110, v110, v12
  v_mul_f32 v111, v111, v12
  v_mul_f32 v112, v112, v12
  v_mul_f32 v113, v113, v12
  v_mul_f32 v114, v114, v12
  v_mul_f32 v115, v115, v12
  v_mul_f32 v116, v116, v12
  v_mul_f32 v117, v117, v12
  v_mul_f32 v118, v118, v12
  v_mul_f32 v119, v119, v12
  v_mul_f32 v120, v120, v12
  v_mul_f32 v121, v121, v12
  v_mul_f32 v122, v122, v12
  v_mul_f32 v123, v123, v12
  v_mul_f32 v124, v124, v12
  v_mul_f32 v125, v125, v12
  v_mul_f32 v126, v126, v12
  v_mul_f32 v127, v127, v12
  s_nop 1
  s_branch L_back_5
L_resc_6:
  v_max_f32 v168, 0, v168
  v_sub_f32 v12, 0, v168
  v_exp_f32 v12, v12
  v_sub_f32 v208, v208, v168
  v_sub_f32 v144, v144, v168
  v_sub_f32 v145, v145, v168
  v_sub_f32 v146, v146, v168
  v_sub_f32 v147, v147, v168
  v_sub_f32 v148, v148, v168
  v_sub_f32 v149, v149, v168
  v_sub_f32 v150, v150, v168
  v_sub_f32 v151, v151, v168
  v_sub_f32 v152, v152, v168
  v_sub_f32 v153, v153, v168
  v_sub_f32 v154, v154, v168
  v_sub_f32 v155, v155, v168
  v_sub_f32 v156, v156, v168
  v_sub_f32 v157, v157, v168
  v_sub_f32 v158, v158, v168
  v_sub_f32 v159, v159, v168
  v_mov_b32 v209, v208
  v_mov_b32 v210, v208
  v_mov_b32 v211, v208
  v_mov_b32 v212, v208
  v_mov_b32 v213, v208
  v_mov_b32 v214, v208
  v_mov_b32 v215, v208
  v_mov_b32 v216, v208
  v_mov_b32 v217, v208
  v_mov_b32 v218, v208
  v_mov_b32 v219, v208
  v_mov_b32 v220, v208
  v_mov_b32 v221, v208
  v_mov_b32 v222, v208
  v_mov_b32 v223, v208
  v_mul_f32 v10, v10, v12
  v_mul_f32 v64, v64, v12
  v_mul_f32 v65, v65, v12
  v_mul_f32 v66, v66, v12
  v_mul_f32 v67, v67, v12
  v_mul_f32 v68, v68, v12
  v_mul_f32 v69, v69, v12
  v_mul_f32 v70, v70, v12
  v_mul_f32 v71, v71, v12
  v_mul_f32 v72, v72, v12
  v_mul_f32 v73, v73, v12
  v_mul_f32 v74, v74, v12
  v_mul_f32 v75, v75, v12
  v_mul_f32 v76, v76, v12
  v_mul_f32 v77, v77, v12
  v_mul_f32 v78, v78, v12
  v_mul_f32 v79, v79, v12
  v_mul_f32 v80, v80, v12
  v_mul_f32 v81, v81, v12
  v_mul_f32 v82, v82, v12
  v_mul_f32 v83, v83, v12
  v_mul_f32 v84, v84, v12
  v_mul_f32 v85, v85, v12
  v_mul_f32 v86, v86, v12
  v_mul_f32 v87, v87, v12
  v_mul_f32 v88, v88, v12
  v_mul_f32 v89, v89, v12
  v_mul_f32 v90, v90, v12
  v_mul_f32 v91, v91, v12
  v_mul_f32 v92, v92, v12
  v_mul_f32 v93, v93, v12
  v_mul_f32 v94, v94, v12
  v_mul_f32 v95, v95, v12
  v_mul_f32 v96, v96, v12
  v_mul_f32 v97, v97, v12
  v_mul_f32 v98, v98, v12
  v_mul_f32 v99, v99, v12
  v_mul_f32 v100, v100, v12
  v_mul_f32 v101, v101, v12
  v_mul_f32 v102, v102, v12
  v_mul_f32 v103, v103, v12
  v_mul_f32 v104, v104, v12
  v_mul_f32 v105, v105, v12
  v_mul_f32 v106, v106, v12
  v_mul_f32 v107, v107, v12
  v_mul_f32 v108, v108, v12
  v_mul_f32 v109, v109, v12
  v_mul_f32 v110, v110, v12
  v_mul_f32 v111, v111, v12
  v_mul_f32 v112, v112, v12
  v_mul_f32 v113, v113, v12
  v_mul_f32 v114, v114, v12
  v_mul_f32 v115, v115, v12
  v_mul_f32 v116, v116, v12
  v_mul_f32 v117, v117, v12
  v_mul_f32 v118, v118, v12
  v_mul_f32 v119, v119, v12
  v_mul_f32 v120, v120, v12
  v_mul_f32 v121, v121, v12
  v_mul_f32 v122, v122, v12
  v_mul_f32 v123, v123, v12
  v_mul_f32 v124, v124, v12
  v_mul_f32 v125, v125, v12
  v_mul_f32 v126, v126, v12
  v_mul_f32 v127, v127, v12
  s_nop 1
  s_branch L_back_7
L_resc_8:
  v_max_f32 v168, 0, v168
  v_sub_f32 v12, 0, v168
  v_exp_f32 v12, v12
  v_sub_f32 v208, v208, v168
  v_sub_f32 v128, v128, v168
  v_sub_f32 v129, v129, v168
  v_sub_f32 v130, v130, v168
  v_sub_f32 v131, v131, v168
  v_sub_f32 v132, v132, v168
  v_sub_f32 v133, v133, v168
  v_sub_f32 v134, v134, v168
  v_sub_f32 v135, v135, v168
  v_sub_f32 v136, v136, v168
  v_sub_f32 v137, v137, v168
  v_sub_f32 v138, v138, v168
  v_sub_f32 v139, v139, v168
  v_sub_f32 v140, v140, v168
  v_sub_f32 v141, v141, v168
  v_sub_f32 v142, v142, v168
  v_sub_f32 v143, v143, v168
  v_mov_b32 v209, v208
  v_mov_b32 v210, v208
  v_mov_b32 v211, v208
  v_mov_b32 v212, v208
  v_mov_b32 v213, v208
  v_mov_b32 v214, v208
  v_mov_b32 v215, v208
  v_mov_b32 v216, v208
  v_mov_b32 v217, v208
  v_mov_b32 v218, v208
  v_mov_b32 v219, v208
  v_mov_b32 v220, v208
  v_mov_b32 v221, v208
  v_mov_b32 v222, v208
  v_mov_b32 v223, v208
  v_mul_f32 v10, v10, v12
  v_mul_f32 v64, v64, v12
  v_mul_f32 v65, v65, v12
  v_mul_f32 v66, v66, v12
  v_mul_f32 v67, v67, v12
  v_mul_f32 v68, v68, v12
  v_mul_f32 v69, v69, v12
  v_mul_f32 v70, v70, v12
  v_mul_f32 v71, v71, v12
  v_mul_f32 v72, v72, v12
  v_mul_f32 v73, v73, v12
  v_mul_f32 v74, v74, v12
  v_mul_f32 v75, v75, v12
  v_mul_f32 v76, v76, v12
  v_mul_f32 v77, v77, v12
  v_mul_f32 v78, v78, v12
  v_mul_f32 v79, v79, v12
  v_mul_f32 v80, v80, v12
  v_mul_f32 v81, v81, v12
  v_mul_f32 v82, v82, v12
  v_mul_f32 v83, v83, v12
  v_mul_f32 v84, v84, v12
  v_mul_f32 v85, v85, v12
  v_mul_f32 v86, v86, v12
  v_mul_f32 v87, v87, v12
  v_mul_f32 v88, v88, v12
  v_mul_f32 v89, v89, v12
  v_mul_f32 v90, v90, v12
  v_mul_f32 v91, v91, v12
  v_mul_f32 v92, v92, v12
  v_mul_f32 v93, v93, v12
  v_mul_f32 v94, v94, v12
  v_mul_f32 v95, v95, v12
  v_mul_f32 v96, v96, v12
  v_mul_f32 v97, v97, v12
  v_mul_f32 v98, v98, v12
  v_mul_f32 v99, v99, v12
  v_mul_f32 v100, v100, v12
  v_mul_f32 v101, v101, v12
  v_mul_f32 v102, v102, v12
  v_mul_f32 v103, v103, v12
  v_mul_f32 v104, v104, v12
  v_mul_f32 v105, v105, v12
  v_mul_f32 v106, v106, v12
  v_mul_f32 v107, v107, v12
  v_mul_f32 v108, v108, v12
  v_mul_f32 v109, v109, v12
  v_mul_f32 v110, v110, v12
  v_mul_f32 v111, v111, v12
  v_mul_f32 v112, v112, v12
  v_mul_f32 v113, v113, v12
  v_mul_f32 v114, v114, v12
  v_mul_f32 v115, v115, v12
  v_mul_f32 v116, v116, v12
  v_mul_f32 v117, v117, v12
  v_mul_f32 v118, v118, v12
  v_mul_f32 v119, v119, v12
  v_mul_f32 v120, v120, v12
  v_mul_f32 v121, v121, v12
  v_mul_f32 v122, v122, v12
  v_mul_f32 v123, v123, v12
  v_mul_f32 v124, v124, v12
  v_mul_f32 v125, v125, v12
  v_mul_f32 v126, v126, v12
  v_mul_f32 v127, v127, v12
  s_nop 1
  s_branch L_back_9
L_resc_10:
  v_max_f32 v168, 0, v168
  v_sub_f32 v12, 0, v168
  v_exp_f32 v12, v12
  v_sub_f32 v208, v208, v168
  v_sub_f32 v144, v144, v168
  v_sub_f32 v145, v145, v168
  v_sub_f32 v146, v146, v168
  v_sub_f32 v147, v147, v168
  v_sub_f32 v148, v148, v168
  v_sub_f32 v149, v149, v168
  v_sub_f32 v150, v150, v168
  v_sub_f32 v151, v151, v168
  v_sub_f32 v152, v152, v168
  v_sub_f32 v153, v153, v168
  v_sub_f32 v154, v154, v168
  v_sub_f32 v155, v155, v168
  v_sub_f32 v156, v156, v168
  v_sub_f32 v157, v157, v168
  v_sub_f32 v158, v158, v168
  v_sub_f32 v159, v159, v168
  v_mov_b32 v209, v208
  v_mov_b32 v210, v208
  v_mov_b32 v211, v208
  v_mov_b32 v212, v208
  v_mov_b32 v213, v208
  v_mov_b32 v214, v208
  v_mov_b32 v215, v208
  v_mov_b32 v216, v208
  v_mov_b32 v217, v208
  v_mov_b32 v218, v208
  v_mov_b32 v219, v208
  v_mov_b32 v220, v208
  v_mov_b32 v221, v208
  v_mov_b32 v222, v208
  v_mov_b32 v223, v208
  v_mul_f32 v10, v10, v12
  v_mul_f32 v64, v64, v12
  v_mul_f32 v65, v65, v12
  v_mul_f32 v66, v66, v12
  v_mul_f32 v67, v67, v12
  v_mul_f32 v68, v68, v12
  v_mul_f32 v69, v69, v12
  v_mul_f32 v70, v70, v12
  v_mul_f32 v71, v71, v12
  v_mul_f32 v72, v72, v12
  v_mul_f32 v73, v73, v12
  v_mul_f32 v74, v74, v12
  v_mul_f32 v75, v75, v12
  v_mul_f32 v76, v76, v12
  v_mul_f32 v77, v77, v12
  v_mul_f32 v78, v78, v12
  v_mul_f32 v79, v79, v12
  v_mul_f32 v80, v80, v12
  v_mul_f32 v81, v81, v12
  v_mul_f32 v82, v82, v12
  v_mul_f32 v83, v83, v12
  v_mul_f32 v84, v84, v12
  v_mul_f32 v85, v85, v12
  v_mul_f32 v86, v86, v12
  v_mul_f32 v87, v87, v12
  v_mul_f32 v88, v88, v12
  v_mul_f32 v89, v89, v12
  v_mul_f32 v90, v90, v12
  v_mul_f32 v91, v91, v12
  v_mul_f32 v92, v92, v12
  v_mul_f32 v93, v93, v12
  v_mul_f32 v94, v94, v12
  v_mul_f32 v95, v95, v12
  v_mul_f32 v96, v96, v12
  v_mul_f32 v97, v97, v12
  v_mul_f32 v98, v98, v12
  v_mul_f32 v99, v99, v12
  v_mul_f32 v100, v100, v12
  v_mul_f32 v101, v101, v12
  v_mul_f32 v102, v102, v12
  v_mul_f32 v103, v103, v12
  v_mul_f32 v104, v104, v12
  v_mul_f32 v105, v105, v12
  v_mul_f32 v106, v106, v12
  v_mul_f32 v107, v107, v12
  v_mul_f32 v108, v108, v12
  v_mul_f32 v109, v109, v12
  v_mul_f32 v110, v110, v12
  v_mul_f32 v111, v111, v12
  v_mul_f32 v112, v112, v12
  v_mul_f32 v113, v113, v12
  v_mul_f32 v114, v114, v12
  v_mul_f32 v115, v115, v12
  v_mul_f32 v116, v116, v12
  v_mul_f32 v117, v117, v12
  v_mul_f32 v118, v118, v12
  v_mul_f32 v119, v119, v12
  v_mul_f32 v120, v120, v12
  v_mul_f32 v121, v121, v12
  v_mul_f32 v122, v122, v12
  v_mul_f32 v123, v123, v12
  v_mul_f32 v124, v124, v12
  v_mul_f32 v125, v125, v12
  v_mul_f32 v126, v126, v12
  v_mul_f32 v127, v127, v12
  s_nop 1
  s_branch L_back_11
L_resc_12:
  v_max_f32 v168, 0, v168
  v_sub_f32 v12, 0, v168
  v_exp_f32 v12, v12
  v_sub_f32 v208, v208, v168
  v_sub_f32 v128, v128, v168
  v_sub_f32 v129, v129, v168
  v_sub_f32 v130, v130, v168
  v_sub_f32 v131, v131, v168
  v_sub_f32 v132, v132, v168
  v_sub_f32 v133, v133, v168
  v_sub_f32 v134, v134, v168
  v_sub_f32 v135, v135, v168
  v_sub_f32 v136, v136, v168
  v_sub_f32 v137, v137, v168
  v_sub_f32 v138, v138, v168
  v_sub_f32 v139, v139, v168
  v_sub_f32 v140, v140, v168
  v_sub_f32 v141, v141, v168
  v_sub_f32 v142, v142, v168
  v_sub_f32 v143, v143, v168
  v_mov_b32 v209, v208
  v_mov_b32 v210, v208
  v_mov_b32 v211, v208
  v_mov_b32 v212, v208
  v_mov_b32 v213, v208
  v_mov_b32 v214, v208
  v_mov_b32 v215, v208
  v_mov_b32 v216, v208
  v_mov_b32 v217, v208
  v_mov_b32 v218, v208
  v_mov_b32 v219, v208
  v_mov_b32 v220, v208
  v_mov_b32 v221, v208
  v_mov_b32 v222, v208
  v_mov_b32 v223, v208
  v_mul_f32 v10, v10, v12
  v_mul_f32 v64, v64, v12
  v_mul_f32 v65, v65, v12
  v_mul_f32 v66, v66, v12
  v_mul_f32 v67, v67, v12
  v_mul_f32 v68, v68, v12
  v_mul_f32 v69, v69, v12
  v_mul_f32 v70, v70, v12
  v_mul_f32 v71, v71, v12
  v_mul_f32 v72, v72, v12
  v_mul_f32 v73, v73, v12
  v_mul_f32 v74, v74, v12
  v_mul_f32 v75, v75, v12
  v_mul_f32 v76, v76, v12
  v_mul_f32 v77, v77, v12
  v_mul_f32 v78, v78, v12
  v_mul_f32 v79, v79, v12
  v_mul_f32 v80, v80, v12
  v_mul_f32 v81, v81, v12
  v_mul_f32 v82, v82, v12
  v_mul_f32 v83, v83, v12
  v_mul_f32 v84, v84, v12
  v_mul_f32 v85, v85, v12
  v_mul_f32 v86, v86, v12
  v_mul_f32 v87, v87, v12
  v_mul_f32 v88, v88, v12
  v_mul_f32 v89, v89, v12
  v_mul_f32 v90, v90, v12
  v_mul_f32 v91, v91, v12
  v_mul_f32 v92, v92, v12
  v_mul_f32 v93, v93, v12
  v_mul_f32 v94, v94, v12
  v_mul_f32 v95, v95, v12
  v_mul_f32 v96, v96, v12
  v_mul_f32 v97, v97, v12
  v_mul_f32 v98, v98, v12
  v_mul_f32 v99, v99, v12
  v_mul_f32 v100, v100, v12
  v_mul_f32 v101, v101, v12
  v_mul_f32 v102, v102, v12
  v_mul_f32 v103, v103, v12
  v_mul_f32 v104, v104, v12
  v_mul_f32 v105, v105, v12
  v_mul_f32 v106, v106, v12
  v_mul_f32 v107, v107, v12
  v_mul_f32 v108, v108, v12
  v_mul_f32 v109, v109, v12
  v_mul_f32 v110, v110, v12
  v_mul_f32 v111, v111, v12
  v_mul_f32 v112, v112, v12
  v_mul_f32 v113, v113, v12
  v_mul_f32 v114, v114, v12
  v_mul_f32 v115, v115, v12
  v_mul_f32 v116, v116, v12
  v_mul_f32 v117, v117, v12
  v_mul_f32 v118, v118, v12
  v_mul_f32 v119, v119, v12
  v_mul_f32 v120, v120, v12
  v_mul_f32 v121, v121, v12
  v_mul_f32 v122, v122, v12
  v_mul_f32 v123, v123, v12
  v_mul_f32 v124, v124, v12
  v_mul_f32 v125, v125, v12
  v_mul_f32 v126, v126, v12
  v_mul_f32 v127, v127, v12
  s_nop 1
  s_branch L_back_13
L_resc_14:
  v_max_f32 v168, 0, v168
  v_sub_f32 v12, 0, v168
  v_exp_f32 v12, v12
  v_sub_f32 v208, v208, v168
  v_sub_f32 v144, v144, v168
  v_sub_f32 v145, v145, v168
  v_sub_f32 v146, v146, v168
  v_sub_f32 v147, v147, v168
  v_sub_f32 v148, v148, v168
  v_sub_f32 v149, v149, v168
  v_sub_f32 v150, v150, v168
  v_sub_f32 v151, v151, v168
  v_sub_f32 v152, v152, v168
  v_sub_f32 v153, v153, v168
  v_sub_f32 v154, v154, v168
  v_sub_f32 v155, v155, v168
  v_sub_f32 v156, v156, v168
  v_sub_f32 v157, v157, v168
  v_sub_f32 v158, v158, v168
  v_sub_f32 v159, v159, v168
  v_mov_b32 v209, v208
  v_mov_b32 v210, v208
  v_mov_b32 v211, v208
  v_mov_b32 v212, v208
  v_mov_b32 v213, v208
  v_mov_b32 v214, v208
  v_mov_b32 v215, v208
  v_mov_b32 v216, v208
  v_mov_b32 v217, v208
  v_mov_b32 v218, v208
  v_mov_b32 v219, v208
  v_mov_b32 v220, v208
  v_mov_b32 v221, v208
  v_mov_b32 v222, v208
  v_mov_b32 v223, v208
  v_mul_f32 v10, v10, v12
  v_mul_f32 v64, v64, v12
  v_mul_f32 v65, v65, v12
  v_mul_f32 v66, v66, v12
  v_mul_f32 v67, v67, v12
  v_mul_f32 v68, v68, v12
  v_mul_f32 v69, v69, v12
  v_mul_f32 v70, v70, v12
  v_mul_f32 v71, v71, v12
  v_mul_f32 v72, v72, v12
  v_mul_f32 v73, v73, v12
  v_mul_f32 v74, v74, v12
  v_mul_f32 v75, v75, v12
  v_mul_f32 v76, v76, v12
  v_mul_f32 v77, v77, v12
  v_mul_f32 v78, v78, v12
  v_mul_f32 v79, v79, v12
  v_mul_f32 v80, v80, v12
  v_mul_f32 v81, v81, v12
  v_mul_f32 v82, v82, v12
  v_mul_f32 v83, v83, v12
  v_mul_f32 v84, v84, v12
  v_mul_f32 v85, v85, v12
  v_mul_f32 v86, v86, v12
  v_mul_f32 v87, v87, v12
  v_mul_f32 v88, v88, v12
  v_mul_f32 v89, v89, v12
  v_mul_f32 v90, v90, v12
  v_mul_f32 v91, v91, v12
  v_mul_f32 v92, v92, v12
  v_mul_f32 v93, v93, v12
  v_mul_f32 v94, v94, v12
  v_mul_f32 v95, v95, v12
  v_mul_f32 v96, v96, v12
  v_mul_f32 v97, v97, v12
  v_mul_f32 v98, v98, v12
  v_mul_f32 v99, v99, v12
  v_mul_f32 v100, v100, v12
  v_mul_f32 v101, v101, v12
  v_mul_f32 v102, v102, v12
  v_mul_f32 v103, v103, v12
  v_mul_f32 v104, v104, v12
  v_mul_f32 v105, v105, v12
  v_mul_f32 v106, v106, v12
  v_mul_f32 v107, v107, v12
  v_mul_f32 v108, v108, v12
  v_mul_f32 v109, v109, v12
  v_mul_f32 v110, v110, v12
  v_mul_f32 v111, v111, v12
  v_mul_f32 v112, v112, v12
  v_mul_f32 v113, v113, v12
  v_mul_f32 v114, v114, v12
  v_mul_f32 v115, v115, v12
  v_mul_f32 v116, v116, v12
  v_mul_f32 v117, v117, v12
  v_mul_f32 v118, v118, v12
  v_mul_f32 v119, v119, v12
  v_mul_f32 v120, v120, v12
  v_mul_f32 v121, v121, v12
  v_mul_f32 v122, v122, v12
  v_mul_f32 v123, v123, v12
  v_mul_f32 v124, v124, v12
  v_mul_f32 v125, v125, v12
  v_mul_f32 v126, v126, v12
  v_mul_f32 v127, v127, v12
  s_nop 1
  s_branch L_back_15
L_resc_16:
  v_max_f32 v168, 0, v168
  v_sub_f32 v12, 0, v168
  v_exp_f32 v12, v12
  v_sub_f32 v208, v208, v168
  v_sub_f32 v128, v128, v168
  v_sub_f32 v129, v129, v168
  v_sub_f32 v130, v130, v168
  v_sub_f32 v131, v131, v168
  v_sub_f32 v132, v132, v168
  v_sub_f32 v133, v133, v168
  v_sub_f32 v134, v134, v168
  v_sub_f32 v135, v135, v168
  v_sub_f32 v136, v136, v168
  v_sub_f32 v137, v137, v168
  v_sub_f32 v138, v138, v168
  v_sub_f32 v139, v139, v168
  v_sub_f32 v140, v140, v168
  v_sub_f32 v141, v141, v168
  v_sub_f32 v142, v142, v168
  v_sub_f32 v143, v143, v168
  v_mov_b32 v209, v208
  v_mov_b32 v210, v208
  v_mov_b32 v211, v208
  v_mov_b32 v212, v208
  v_mov_b32 v213, v208
  v_mov_b32 v214, v208
  v_mov_b32 v215, v208
  v_mov_b32 v216, v208
  v_mov_b32 v217, v208
  v_mov_b32 v218, v208
  v_mov_b32 v219, v208
  v_mov_b32 v220, v208
  v_mov_b32 v221, v208
  v_mov_b32 v222, v208
  v_mov_b32 v223, v208
  v_mul_f32 v10, v10, v12
  v_mul_f32 v64, v64, v12
  v_mul_f32 v65, v65, v12
  v_mul_f32 v66, v66, v12
  v_mul_f32 v67, v67, v12
  v_mul_f32 v68, v68, v12
  v_mul_f32 v69, v69, v12
  v_mul_f32 v70, v70, v12
  v_mul_f32 v71, v71, v12
  v_mul_f32 v72, v72, v12
  v_mul_f32 v73, v73, v12
  v_mul_f32 v74, v74, v12
  v_mul_f32 v75, v75, v12
  v_mul_f32 v76, v76, v12
  v_mul_f32 v77, v77, v12
  v_mul_f32 v78, v78, v12
  v_mul_f32 v79, v79, v12
  v_mul_f32 v80, v80, v12
  v_mul_f32 v81, v81, v12
  v_mul_f32 v82, v82, v12
  v_mul_f32 v83, v83, v12
  v_mul_f32 v84, v84, v12
  v_mul_f32 v85, v85, v12
  v_mul_f32 v86, v86, v12
  v_mul_f32 v87, v87, v12
  v_mul_f32 v88, v88, v12
  v_mul_f32 v89, v89, v12
  v_mul_f32 v90, v90, v12
  v_mul_f32 v91, v91, v12
  v_mul_f32 v92, v92, v12
  v_mul_f32 v93, v93, v12
  v_mul_f32 v94, v94, v12
  v_mul_f32 v95, v95, v12
  v_mul_f32 v96, v96, v12
  v_mul_f32 v97, v97, v12
  v_mul_f32 v98, v98, v12
  v_mul_f32 v99, v99, v12
  v_mul_f32 v100, v100, v12
  v_mul_f32 v101, v101, v12
  v_mul_f32 v102, v102, v12
  v_mul_f32 v103, v103, v12
  v_mul_f32 v104, v104, v12
  v_mul_f32 v105, v105, v12
  v_mul_f32 v106, v106, v12
  v_mul_f32 v107, v107, v12
  v_mul_f32 v108, v108, v12
  v_mul_f32 v109, v109, v12
  v_mul_f32 v110, v110, v12
  v_mul_f32 v111, v111, v12
  v_mul_f32 v112, v112, v12
  v_mul_f32 v113, v113, v12
  v_mul_f32 v114, v114, v12
  v_mul_f32 v115, v115, v12
  v_mul_f32 v116, v116, v12
  v_mul_f32 v117, v117, v12
  v_mul_f32 v118, v118, v12
  v_mul_f32 v119, v119, v12
  v_mul_f32 v120, v120, v12
  v_mul_f32 v121, v121, v12
  v_mul_f32 v122, v122, v12
  v_mul_f32 v123, v123, v12
  v_mul_f32 v124, v124, v12
  v_mul_f32 v125, v125, v12
  v_mul_f32 v126, v126, v12
  v_mul_f32 v127, v127, v12
  s_nop 1
  s_branch L_back_17
L_resc_18:
  v_max_f32 v168, 0, v168
  v_sub_f32 v12, 0, v168
  v_exp_f32 v12, v12
  v_sub_f32 v208, v208, v168
  v_sub_f32 v144, v144, v168
  v_sub_f32 v145, v145, v168
  v_sub_f32 v146, v146, v168
  v_sub_f32 v147, v147, v168
  v_sub_f32 v148, v148, v168
  v_sub_f32 v149, v149, v168
  v_sub_f32 v150, v150, v168
  v_sub_f32 v151, v151, v168
  v_sub_f32 v152, v152, v168
  v_sub_f32 v153, v153, v168
  v_sub_f32 v154, v154, v168
  v_sub_f32 v155, v155, v168
  v_sub_f32 v156, v156, v168
  v_sub_f32 v157, v157, v168
  v_sub_f32 v158, v158, v168
  v_sub_f32 v159, v159, v168
  v_mov_b32 v209, v208
  v_mov_b32 v210, v208
  v_mov_b32 v211, v208
  v_mov_b32 v212, v208
  v_mov_b32 v213, v208
  v_mov_b32 v214, v208
  v_mov_b32 v215, v208
  v_mov_b32 v216, v208
  v_mov_b32 v217, v208
  v_mov_b32 v218, v208
  v_mov_b32 v219, v208
  v_mov_b32 v220, v208
  v_mov_b32 v221, v208
  v_mov_b32 v222, v208
  v_mov_b32 v223, v208
  v_mul_f32 v10, v10, v12
  v_mul_f32 v64, v64, v12
  v_mul_f32 v65, v65, v12
  v_mul_f32 v66, v66, v12
  v_mul_f32 v67, v67, v12
  v_mul_f32 v68, v68, v12
  v_mul_f32 v69, v69, v12
  v_mul_f32 v70, v70, v12
  v_mul_f32 v71, v71, v12
  v_mul_f32 v72, v72, v12
  v_mul_f32 v73, v73, v12
  v_mul_f32 v74, v74, v12
  v_mul_f32 v75, v75, v12
  v_mul_f32 v76, v76, v12
  v_mul_f32 v77, v77, v12
  v_mul_f32 v78, v78, v12
  v_mul_f32 v79, v79, v12
  v_mul_f32 v80, v80, v12
  v_mul_f32 v81, v81, v12
  v_mul_f32 v82, v82, v12
  v_mul_f32 v83, v83, v12
  v_mul_f32 v84, v84, v12
  v_mul_f32 v85, v85, v12
  v_mul_f32 v86, v86, v12
  v_mul_f32 v87, v87, v12
  v_mul_f32 v88, v88, v12
  v_mul_f32 v89, v89, v12
  v_mul_f32 v90, v90, v12
  v_mul_f32 v91, v91, v12
  v_mul_f32 v92, v92, v12
  v_mul_f32 v93, v93, v12
  v_mul_f32 v94, v94, v12
  v_mul_f32 v95, v95, v12
  v_mul_f32 v96, v96, v12
  v_mul_f32 v97, v97, v12
  v_mul_f32 v98, v98, v12
  v_mul_f32 v99, v99, v12
  v_mul_f32 v100, v100, v12
  v_mul_f32 v101, v101, v12
  v_mul_f32 v102, v102, v12
  v_mul_f32 v103, v103, v12
  v_mul_f32 v104, v104, v12
  v_mul_f32 v105, v105, v12
  v_mul_f32 v106, v106, v12
  v_mul_f32 v107, v107, v12
  v_mul_f32 v108, v108, v12
  v_mul_f32 v109, v109, v12
  v_mul_f32 v110, v110, v12
  v_mul_f32 v111, v111, v12
  v_mul_f32 v112, v112, v12
  v_mul_f32 v113, v113, v12
  v_mul_f32 v114, v114, v12
  v_mul_f32 v115, v115, v12
  v_mul_f32 v116, v116, v12
  v_mul_f32 v117, v117, v12
  v_mul_f32 v118, v118, v12
  v_mul_f32 v119, v119, v12
  v_mul_f32 v120, v120, v12
  v_mul_f32 v121, v121, v12
  v_mul_f32 v122, v122, v12
  v_mul_f32 v123, v123, v12
  v_mul_f32 v124, v124, v12
  v_mul_f32 v125, v125, v12
  v_mul_f32 v126, v126, v12
  v_mul_f32 v127, v127, v12
  s_nop 1
  s_branch L_back_19
L_resc_20:
  v_max_f32 v168, 0, v168
  v_sub_f32 v12, 0, v168
  v_exp_f32 v12, v12
  v_sub_f32 v208, v208, v168
  v_sub_f32 v128, v128, v168
  v_sub_f32 v129, v129, v168
  v_sub_f32 v130, v130, v168
  v_sub_f32 v131, v131, v168
  v_sub_f32 v132, v132, v168
  v_sub_f32 v133, v133, v168
  v_sub_f32 v134, v134, v168
  v_sub_f32 v135, v135, v168
  v_sub_f32 v136, v136, v168
  v_sub_f32 v137, v137, v168
  v_sub_f32 v138, v138, v168
  v_sub_f32 v139, v139, v168
  v_sub_f32 v140, v140, v168
  v_sub_f32 v141, v141, v168
  v_sub_f32 v142, v142, v168
  v_sub_f32 v143, v143, v168
  v_mov_b32 v209, v208
  v_mov_b32 v210, v208
  v_mov_b32 v211, v208
  v_mov_b32 v212, v208
  v_mov_b32 v213, v208
  v_mov_b32 v214, v208
  v_mov_b32 v215, v208
  v_mov_b32 v216, v208
  v_mov_b32 v217, v208
  v_mov_b32 v218, v208
  v_mov_b32 v219, v208
  v_mov_b32 v220, v208
  v_mov_b32 v221, v208
  v_mov_b32 v222, v208
  v_mov_b32 v223, v208
  v_mul_f32 v10, v10, v12
  v_mul_f32 v64, v64, v12
  v_mul_f32 v65, v65, v12
  v_mul_f32 v66, v66, v12
  v_mul_f32 v67, v67, v12
  v_mul_f32 v68, v68, v12
  v_mul_f32 v69, v69, v12
  v_mul_f32 v70, v70, v12
  v_mul_f32 v71, v71, v12
  v_mul_f32 v72, v72, v12
  v_mul_f32 v73, v73, v12
  v_mul_f32 v74, v74, v12
  v_mul_f32 v75, v75, v12
  v_mul_f32 v76, v76, v12
  v_mul_f32 v77, v77, v12
  v_mul_f32 v78, v78, v12
  v_mul_f32 v79, v79, v12
  v_mul_f32 v80, v80, v12
  v_mul_f32 v81, v81, v12
  v_mul_f32 v82, v82, v12
  v_mul_f32 v83, v83, v12
  v_mul_f32 v84, v84, v12
  v_mul_f32 v85, v85, v12
  v_mul_f32 v86, v86, v12
  v_mul_f32 v87, v87, v12
  v_mul_f32 v88, v88, v12
  v_mul_f32 v89, v89, v12
  v_mul_f32 v90, v90, v12
  v_mul_f32 v91, v91, v12
  v_mul_f32 v92, v92, v12
  v_mul_f32 v93, v93, v12
  v_mul_f32 v94, v94, v12
  v_mul_f32 v95, v95, v12
  v_mul_f32 v96, v96, v12
  v_mul_f32 v97, v97, v12
  v_mul_f32 v98, v98, v12
  v_mul_f32 v99, v99, v12
  v_mul_f32 v100, v100, v12
  v_mul_f32 v101, v101, v12
  v_mul_f32 v102, v102, v12
  v_mul_f32 v103, v103, v12
  v_mul_f32 v104, v104, v12
  v_mul_f32 v105, v105, v12
  v_mul_f32 v106, v106, v12
  v_mul_f32 v107, v107, v12
  v_mul_f32 v108, v108, v12
  v_mul_f32 v109, v109, v12
  v_mul_f32 v110, v110, v12
  v_mul_f32 v111, v111, v12
  v_mul_f32 v112, v112, v12
  v_mul_f32 v113, v113, v12
  v_mul_f32 v114, v114, v12
  v_mul_f32 v115, v115, v12
  v_mul_f32 v116, v116, v12
  v_mul_f32 v117, v117, v12
  v_mul_f32 v118, v118, v12
  v_mul_f32 v119, v119, v12
  v_mul_f32 v120, v120, v12
  v_mul_f32 v121, v121, v12
  v_mul_f32 v122, v122, v12
  v_mul_f32 v123, v123, v12
  v_mul_f32 v124, v124, v12
  v_mul_f32 v125, v125, v12
  v_mul_f32 v126, v126, v12
  v_mul_f32 v127, v127, v12
  s_nop 1
  s_branch L_back_21
L_resc_22:
  v_max_f32 v168, 0, v168
  v_sub_f32 v12, 0, v168
  v_exp_f32 v12, v12
  v_sub_f32 v208, v208, v168
  v_sub_f32 v144, v144, v168
  v_sub_f32 v145, v145, v168
  v_sub_f32 v146, v146, v168
  v_sub_f32 v147, v147, v168
  v_sub_f32 v148, v148, v168
  v_sub_f32 v149, v149, v168
  v_sub_f32 v150, v150, v168
  v_sub_f32 v151, v151, v168
  v_sub_f32 v152, v152, v168
  v_sub_f32 v153, v153, v168
  v_sub_f32 v154, v154, v168
  v_sub_f32 v155, v155, v168
  v_sub_f32 v156, v156, v168
  v_sub_f32 v157, v157, v168
  v_sub_f32 v158, v158, v168
  v_sub_f32 v159, v159, v168
  v_mov_b32 v209, v208
  v_mov_b32 v210, v208
  v_mov_b32 v211, v208
  v_mov_b32 v212, v208
  v_mov_b32 v213, v208
  v_mov_b32 v214, v208
  v_mov_b32 v215, v208
  v_mov_b32 v216, v208
  v_mov_b32 v217, v208
  v_mov_b32 v218, v208
  v_mov_b32 v219, v208
  v_mov_b32 v220, v208
  v_mov_b32 v221, v208
  v_mov_b32 v222, v208
  v_mov_b32 v223, v208
  v_mul_f32 v10, v10, v12
  v_mul_f32 v64, v64, v12
  v_mul_f32 v65, v65, v12
  v_mul_f32 v66, v66, v12
  v_mul_f32 v67, v67, v12
  v_mul_f32 v68, v68, v12
  v_mul_f32 v69, v69, v12
  v_mul_f32 v70, v70, v12
  v_mul_f32 v71, v71, v12
  v_mul_f32 v72, v72, v12
  v_mul_f32 v73, v73, v12
  v_mul_f32 v74, v74, v12
  v_mul_f32 v75, v75, v12
  v_mul_f32 v76, v76, v12
  v_mul_f32 v77, v77, v12
  v_mul_f32 v78, v78, v12
  v_mul_f32 v79, v79, v12
  v_mul_f32 v80, v80, v12
  v_mul_f32 v81, v81, v12
  v_mul_f32 v82, v82, v12
  v_mul_f32 v83, v83, v12
  v_mul_f32 v84, v84, v12
  v_mul_f32 v85, v85, v12
  v_mul_f32 v86, v86, v12
  v_mul_f32 v87, v87, v12
  v_mul_f32 v88, v88, v12
  v_mul_f32 v89, v89, v12
  v_mul_f32 v90, v90, v12
  v_mul_f32 v91, v91, v12
  v_mul_f32 v92, v92, v12
  v_mul_f32 v93, v93, v12
  v_mul_f32 v94, v94, v12
  v_mul_f32 v95, v95, v12
  v_mul_f32 v96, v96, v12
  v_mul_f32 v97, v97, v12
  v_mul_f32 v98, v98, v12
  v_mul_f32 v99, v99, v12
  v_mul_f32 v100, v100, v12
  v_mul_f32 v101, v101, v12
  v_mul_f32 v102, v102, v12
  v_mul_f32 v103, v103, v12
  v_mul_f32 v104, v104, v12
  v_mul_f32 v105, v105, v12
  v_mul_f32 v106, v106, v12
  v_mul_f32 v107, v107, v12
  v_mul_f32 v108, v108, v12
  v_mul_f32 v109, v109, v12
  v_mul_f32 v110, v110, v12
  v_mul_f32 v111, v111, v12
  v_mul_f32 v112, v112, v12
  v_mul_f32 v113, v113, v12
  v_mul_f32 v114, v114, v12
  v_mul_f32 v115, v115, v12
  v_mul_f32 v116, v116, v12
  v_mul_f32 v117, v117, v12
  v_mul_f32 v118, v118, v12
  v_mul_f32 v119, v119, v12
  v_mul_f32 v120, v120, v12
  v_mul_f32 v121, v121, v12
  v_mul_f32 v122, v122, v12
  v_mul_f32 v123, v123, v12
  v_mul_f32 v124, v124, v12
  v_mul_f32 v125, v125, v12
  v_mul_f32 v126, v126, v12
  v_mul_f32 v127, v127, v12
  s_nop 1
  s_branch L_back_23
L_roleB:
  s_load_dwordx8 s[36:43], s[0:1], 40
  s_load_dwordx2 s[44:45], s[0:1], 96
  s_load_dwordx2 s[34:35], s[0:1], 88
  v_and_b32 v1, 63, v0
  v_lshrrev_b32 v2, 6, v0
  s_nop 0
  v_readfirstlane_b32 s6, v2
  s_and_b32 s4, s2, 7
  s_lshr_b32 s5, s2, 4
  v_lshrrev_b32 v2, 4, v1
  v_and_b32 v3, 15, v1
  v_lshlrev_b32 v6, 2, v2
  v_xor_b32 v6, v6, v3
  v_lshlrev_b32 v7, 13, v2
  v_lshl_add_u32 v21, v6, 4, v7
  v_lshlrev_b32 v5, 8, v2
  v_lshl_add_u32 v20, v6, 4, v5
  v_lshrrev_b32 v6, 3, v1
  v_and_b32 v7, 7, v1
  v_lshrrev_b32 v8, 1, v6
  v_xor_b32 v7, v7, v8
  v_mul_u32_u24 v6, 1152, v6
  v_lshl_add_u32 v22, v7, 4, v6
  v_xor_b32 v7, 4, v7
  v_lshl_add_u32 v23, v7, 4, v6
  s_lshr_b32 s53, s6, 1
  s_and_b32 s54, s6, 1
  s_and_b32 s3, s5, 3
  s_lshl_b32 s3, s3, 3
  s_add_u32 s3, s3, s4
  s_lshr_b32 s7, s5, 2
  s_lshl_b32 s56, s7, 1
  s_add_u32 s56, s56, s53
  s_lshl_b32 s30, s6, 17
  s_lshl_b32 s55, s3, 8
  s_add_u32 s30, s30, s55
  s_lshl_b32 s31, s6, 12
  s_lshl_b32 s55, s7, 7
  s_lshl_b32 s57, s6, 5
  s_add_u32 s55, s55, s57
  s_mul_i32 s32, s55, 1152
  s_lshl_b32 s55, s6, 12
  s_add_u32 s33, s55, 16384
  s_add_u32 s55, s7, s5
  s_and_b32 s55, s55, 3
  s_lshl_b32 s94, s55, 1
  s_waitcnt lgkmcnt(0)
  s_mov_b32 s16, s42
  s_and_b32 s17, s43, 0xffff
  s_mov_b32 s18, 0x480000
  s_mov_b32 s19, 0x20000
  s_mov_b32 s20, s36
  s_and_b32 s21, s37, 0xffff
  s_mov_b32 s22, 0x90000
  s_mov_b32 s23, 0x20000
  s_lshl_b32 s95, s94, 19
  s_add_u32 s95, s95, s30
  s_lshl_b32 s96, s94, 7
  s_add_u32 s96, s96, s32
  s_add_u32 s94, s94, 1
  s_cmp_eq_u32 s94, 9
  s_cselect_b32 s94, 0, s94
  s_add_u32 m0, s31, 0
  s_add_u32 s51, s95, 0
  buffer_load_dwordx4 v21, s[16:19], s51 offen offset:0 lds
  s_add_u32 s51, s95, 31744
  buffer_load_dwordx4 v21, s[16:19], s51 offen offset:1024 lds
  s_add_u32 s51, s95, 63488
  buffer_load_dwordx4 v21, s[16:19], s51 offen offset:2048 lds
  s_add_u32 s51, s95, 95232
  buffer_load_dwordx4 v21, s[16:19], s51 offen offset:3072 lds
  s_add_u32 m0, s33, 0
  s_add_u32 s51, s96, 0
  buffer_load_dwordx4 v22, s[20:23], s51 offen offset:0 lds
  s_add_u32 s51, s96, 8192
  buffer_load_dwordx4 v23, s[20:23], s51 offen offset:1024 lds
  s_add_u32 s51, s96, 16384
  buffer_load_dwordx4 v22, s[20:23], s51 offen offset:2048 lds
  s_add_u32 s51, s96, 24576
  buffer_load_dwordx4 v23, s[20:23], s51 offen offset:3072 lds
  s_lshl_b32 s95, s94, 19
  s_add_u32 s95, s95, s30
  s_lshl_b32 s96, s94, 7
  s_add_u32 s96, s96, s32
  s_add_u32 s94, s94, 1
  s_cmp_eq_u32 s94, 9
  s_cselect_b32 s94, 0, s94
  s_add_u32 m0, s31, 40960
  s_add_u32 s51, s95, 0
  buffer_load_dwordx4 v21, s[16:19], s51 offen offset:0 lds
  s_add_u32 s51, s95, 31744
  buffer_load_dwordx4 v21, s[16:19], s51 offen offset:1024 lds
  s_add_u32 s51, s95, 63488
  buffer_load_dwordx4 v21, s[16:19], s51 offen offset:2048 lds
  s_add_u32 s51, s95, 95232
  buffer_load_dwordx4 v21, s[16:19], s51 offen offset:3072 lds
  s_add_u32 m0, s33, 40960
  s_add_u32 s51, s96, 0
  buffer_load_dwordx4 v22, s[20:23], s51 offen offset:0 lds
  s_add_u32 s51, s96, 8192
  buffer_load_dwordx4 v23, s[20:23], s51 offen offset:1024 lds
  s_add_u32 s51, s96, 16384
  buffer_load_dwordx4 v22, s[20:23], s51 offen offset:2048 lds
  s_add_u32 s51, s96, 24576
  buffer_load_dwordx4 v23, s[20:23], s51 offen offset:3072 lds
  v_and_b32 v2, 7, v1
  v_lshrrev_b32 v3, 1, v2
  v_and_b32 v4, 1, v2
  v_lshlrev_b32 v3, 13, v3
  v_lshl_add_u32 v3, v4, 7, v3
  s_lshl_b32 s55, s7, 4
  s_lshl_b32 s57, s6, 2
  s_add_u32 s55, s55, s57
  s_add_u32 s55, s55, 512
  s_lshl_b32 s55, s55, 13
  s_lshl_b32 s57, s3, 8
  s_add_u32 s55, s55, s57
  v_mul_u32_u24 v4, 1152, v2
  s_and_b32 s57, s5, 3
  s_lshl_b32 s57, s57, 5
  s_lshl_b32 s58, s7, 7
  s_add_u32 s57, s57, s58
  s_lshl_b32 s58, s6, 3
  s_add_u32 s57, s57, s58
  s_mul_i32 s57, s57, 1152
  s_add_u32 s57, s57, 1024
  s_mov_b32 exec_lo, 0xff
  s_mov_b32 exec_hi, 0
  buffer_load_dword v246, v3, s[16:19], s55 offen
  buffer_load_dword v247, v4, s[20:23], s57 offen
  s_mov_b64 exec, -1
  s_mov_b32 s8, s38
  s_and_b32 s9, s39, 0xffff
  s_mov_b32 s10, 0x4000000
  s_mov_b32 s11, 0x20000
  s_mov_b32 s12, s40
  s_and_b32 s13, s41, 0xffff
  s_mov_b32 s14, 0x4000000
  s_mov_b32 s15, 0x20000
  s_mov_b32 s24, s44
  s_and_b32 s25, s45, 0xffff
  s_mov_b32 s26, 0x10000000
  s_mov_b32 s27, 0x20000
  s_load_dwordx2 s[36:37], s[0:1], 72
  s_load_dwordx2 s[42:43], s[0:1], 72
  s_load_dwordx2 s[38:39], s[0:1], 80
  s_load_dwordx2 s[40:41], s[0:1], 72
  s_mov_b32 s90, 1
  s_lshl_b32 s51, s56, 5
  s_add_u32 s51, s51, s3
  s_lshl_b32 s51, s51, 18
  s_lshl_b32 s55, s54, 12
  s_add_u32 s28, s51, s55
  s_lshl_b32 s57, s53, 14
  s_add_u32 s29, s57, s55
  s_add_u32 s57, s56, 8
  s_lshl_b32 s57, s57, 5
  s_add_u32 s57, s57, s3
  s_lshl_b32 s57, s57, 14
  s_lshl_b32 s58, s54, 13
  s_add_u32 s52, s57, s58
  s_cmp_eq_u32 s53, 0
  s_mov_b32 s57, 155648
  s_cselect_b32 s97, 122880, s57
  s_mov_b32 s57, 32768
  s_cselect_b32 s98, 131072, s57
  s_mov_b32 s57, 73728
  s_cselect_b32 s99, 139264, s57
  s_mov_b32 s57, 114688
  s_cselect_b32 s100, 147456, s57
  s_add_u32 s97, s97, s55
  s_add_u32 s98, s98, s55
  s_add_u32 s99, s99, s55
  s_add_u32 s100, s100, s55
  s_sub_u32 s47, s28, 8192
  s_sub_u32 s48, s28, 8192
  s_mov_b32 s50, 0x41000000
  v_lshrrev_b32 v2, 4, v1
  v_and_b32 v3, 15, v1
  v_xor_b32 v4, v3, v2
  v_lshlrev_b32 v5, 8, v2
  v_xor_b32 v6, 0, v4
  v_lshl_add_u32 v16, v6, 4, v5
  v_xor_b32 v6, 4, v4
  v_lshl_add_u32 v17, v6, 4, v5
  v_xor_b32 v6, 8, v4
  v_lshl_add_u32 v18, v6, 4, v5
  v_xor_b32 v6, 12, v4
  v_lshl_add_u32 v19, v6, 4, v5
  v_and_b32 v2, 31, v1
  v_lshrrev_b32 v3, 5, v1
  v_and_b32 v4, 15, v2
  v_xor_b32 v4, v4, v3
  v_lshlrev_b32 v4, 4, v4
  v_lshl_add_u32 v4, v2, 8, v4
  s_lshl_b32 s55, s53, 14
  v_add_u32 v4, s55, v4
  v_xor_b32 v24, 0, v4
  v_add_u32 v36, 81920, v24
  v_xor_b32 v25, 32, v4
  v_add_u32 v37, 81920, v25
  v_xor_b32 v26, 64, v4
  v_add_u32 v38, 81920, v26
  v_xor_b32 v27, 96, v4
  v_add_u32 v39, 81920, v27
  v_xor_b32 v28, 128, v4
  v_add_u32 v40, 81920, v28
  v_xor_b32 v29, 160, v4
  v_add_u32 v41, 81920, v29
  v_xor_b32 v30, 192, v4
  v_add_u32 v42, 81920, v30
  v_xor_b32 v31, 224, v4
  v_add_u32 v43, 81920, v31
  v_lshrrev_b32 v5, 1, v2
  v_and_b32 v5, 7, v5
  v_xor_b32 v5, v5, v3
  v_lshlrev_b32 v5, 4, v5
  v_lshl_add_u32 v5, v2, 7, v5
  s_lshl_b32 s55, s6, 12
  s_add_u32 s55, s55, 16384
  v_add_u32 v5, s55, v5
  v_xor_b32 v52, 0, v5
  v_add_u32 v60, 81920, v52
  v_xor_b32 v53, 32, v5
  v_add_u32 v61, 81920, v53
  v_xor_b32 v54, 64, v5
  v_add_u32 v62, 81920, v54
  v_xor_b32 v55, 96, v5
  v_add_u32 v63, 81920, v55
  v_lshrrev_b32 v2, 5, v1
  v_bfe_u32 v3, v1, 4, 1
  v_bfe_u32 v4, v1, 2, 2
  v_and_b32 v5, 3, v1
  v_lshl_add_u32 v6, v2, 2, v4
  v_lshlrev_b32 v6, 8, v6
  v_lshl_add_u32 v6, v4, 6, v6
  v_lshl_add_u32 v6, v3, 5, v6
  v_lshl_add_u32 v6, v5, 3, v6
  s_lshl_b32 s55, s53, 14
  s_add_u32 s55, s55, 8192
  v_add_u32 v6, s55, v6
  v_xor_b32 v32, 0, v6
  v_add_u32 v44, 81920, v32
  v_xor_b32 v33, 64, v6
  v_add_u32 v45, 81920, v33
  v_xor_b32 v34, 128, v6
  v_add_u32 v46, 81920, v34
  v_xor_b32 v35, 192, v6
  v_add_u32 v47, 81920, v35
  v_and_b32 v7, 1, v5
  v_lshlrev_b32 v7, 1, v7
  v_lshrrev_b32 v8, 1, v5
  v_or_b32 v7, v7, v8
  v_lshl_add_u32 v6, v2, 3, v4
  v_lshlrev_b32 v6, 8, v6
  v_lshl_add_u32 v6, v4, 6, v6
  v_lshl_add_u32 v6, v3, 5, v6
  v_lshl_add_u32 v6, v7, 3, v6
  v_xor_b32 v48, 0, v6
  v_add_u32 v56, 81920, v48
  v_xor_b32 v49, 64, v6
  v_add_u32 v57, 81920, v49
  v_xor_b32 v50, 128, v6
  v_add_u32 v58, 81920, v50
  v_xor_b32 v51, 192, v6
  v_add_u32 v59, 81920, v51
  v_mov_b32 v10, 0
  v_mov_b32 v208, 0
  v_mov_b32 v209, 0
  v_mov_b32 v210, 0
  v_mov_b32 v211, 0
  v_mov_b32 v212, 0
  v_mov_b32 v213, 0
  v_mov_b32 v214, 0
  v_mov_b32 v215, 0
  v_mov_b32 v216, 0
  v_mov_b32 v217, 0
  v_mov_b32 v218, 0
  v_mov_b32 v219, 0
  v_mov_b32 v220, 0
  v_mov_b32 v221, 0
  v_mov_b32 v222, 0
  v_mov_b32 v223, 0
  s_mov_b32 s55, 3641
  v_add_u32 v2, 0, v1
  v_mul_lo_u32 v3, v2, s55
  v_lshrrev_b32 v3, 16, v3
  v_mul_u32_u24 v4, 18, v3
  v_sub_u32 v4, v2, v4
  v_mul_u32_u24 v3, 1152, v3
  v_lshl_add_u32 v224, v4, 4, v3
  v_add_u32 v2, 64, v1
  v_mul_lo_u32 v3, v2, s55
  v_lshrrev_b32 v3, 16, v3
  v_mul_u32_u24 v4, 18, v3
  v_sub_u32 v4, v2, v4
  v_mul_u32_u24 v3, 1152, v3
  v_lshl_add_u32 v225, v4, 4, v3
  v_add_u32 v2, 128, v1
  v_mul_lo_u32 v3, v2, s55
  v_lshrrev_b32 v3, 16, v3
  v_mul_u32_u24 v4, 18, v3
  v_sub_u32 v4, v2, v4
  v_mul_u32_u24 v3, 1152, v3
  v_lshl_add_u32 v226, v4, 4, v3
  v_add_u32 v2, 192, v1
  v_mul_lo_u32 v3, v2, s55
  v_lshrrev_b32 v3, 16, v3
  v_mul_u32_u24 v4, 18, v3
  v_sub_u32 v4, v2, v4
  v_mul_u32_u24 v3, 1152, v3
  v_lshl_add_u32 v227, v4, 4, v3
  v_add_u32 v2, 256, v1
  v_mul_lo_u32 v3, v2, s55
  v_lshrrev_b32 v3, 16, v3
  v_mul_u32_u24 v4, 18, v3
  v_sub_u32 v4, v2, v4
  v_mul_u32_u24 v3, 1152, v3
  v_lshl_add_u32 v228, v4, 4, v3
  v_add_u32 v2, 320, v1
  v_mul_lo_u32 v3, v2, s55
  v_lshrrev_b32 v3, 16, v3
  v_mul_u32_u24 v4, 18, v3
  v_sub_u32 v4, v2, v4
  v_mul_u32_u24 v3, 1152, v3
  v_lshl_add_u32 v229, v4, 4, v3
  v_add_u32 v2, 384, v1
  v_mul_lo_u32 v3, v2, s55
  v_lshrrev_b32 v3, 16, v3
  v_mul_u32_u24 v4, 18, v3
  v_sub_u32 v4, v2, v4
  v_mul_u32_u24 v3, 1152, v3
  v_lshl_add_u32 v230, v4, 4, v3
  v_add_u32 v2, 448, v1
  v_mul_lo_u32 v3, v2, s55
  v_lshrrev_b32 v3, 16, v3
  v_mul_u32_u24 v4, 18, v3
  v_sub_u32 v4, v2, v4
  v_mul_u32_u24 v3, 1152, v3
  v_lshl_add_u32 v231, v4, 4, v3
  v_add_u32 v2, 512, v1
  v_mul_lo_u32 v3, v2, s55
  v_lshrrev_b32 v3, 16, v3
  v_mul_u32_u24 v4, 18, v3
  v_sub_u32 v4, v2, v4
  v_mul_u32_u24 v3, 1152, v3
  v_lshl_add_u32 v232, v4, 4, v3
  s_waitcnt lgkmcnt(0)
  s_mov_b32 s84, s40
  s_and_b32 s85, s41, 0xffff
  s_mov_b32 s86, 0x480000
  s_mov_b32 s87, 0x20000
  s_and_b32 s58, s5, 3
  s_lshl_b32 s57, s58, 3
  s_add_u32 s57, s57, s4
  s_mul_i32 s57, s57, 147456
  s_lshr_b32 s58, s5, 2
  s_mul_i32 s58, s58, 288
  s_mul_i32 s56, s6, 72
  s_add_u32 s58, s58, s56
  s_lshl_b32 s58, s58, 7
  s_add_u32 s91, s57, s58
  v_lshlrev_b32 v245, 7, v1
  s_waitcnt vmcnt(10) lgkmcnt(0)
  s_barrier
  ds_read_b128 a[96:99], v52 offset:0
  ds_read_b64_tr_b16 a[32:33], v48 offset:0
  ds_read_b64_tr_b16 a[34:35], v48 offset:1024
  ds_read_b64_tr_b16 a[36:37], v49 offset:0
  ds_read_b64_tr_b16 a[38:39], v49 offset:1024
  ds_read_b64_tr_b16 a[40:41], v50 offset:0
  ds_read_b64_tr_b16 a[42:43], v50 offset:1024
  ds_read_b64_tr_b16 a[44:45], v51 offset:0
  ds_read_b64_tr_b16 a[46:47], v51 offset:1024
  ds_read_b128 a[100:103], v53 offset:0
  ds_read_b64_tr_b16 a[48:49], v48 offset:4096
  ds_read_b64_tr_b16 a[50:51], v48 offset:5120
  ds_read_b64_tr_b16 a[52:53], v49 offset:4096
  ds_read_b64_tr_b16 a[54:55], v49 offset:5120
  s_waitcnt lgkmcnt(13)
  ds_read_b64_tr_b16 a[56:57], v50 offset:4096
  ds_read_b64_tr_b16 a[58:59], v50 offset:5120
  s_waitcnt lgkmcnt(13)
  v_mfma_f32_32x32x16_bf16 v[64:79], a[32:35], a[96:99], 0
  s_lshl_b32 s95, s94, 19
  s_add_u32 s95, s95, s30
  s_lshl_b32 s96, s94, 7
  ds_read_b64_tr_b16 a[60:61], v51 offset:4096
  ds_read_b64_tr_b16 a[62:63], v51 offset:5120
  s_waitcnt lgkmcnt(13)
  v_mfma_f32_32x32x16_bf16 v[80:95], a[36:39], a[96:99], 0
  s_add_u32 s96, s96, s32
  s_add_u32 s94, s94, 1
  s_waitcnt lgkmcnt(12)
  ds_read_b128 a[104:107], v54 offset:0
  ds_read_b64_tr_b16 a[64:65], v48 offset:8192
  ds_read_b64_tr_b16 a[66:67], v48 offset:9216
  s_waitcnt lgkmcnt(14)
  v_mfma_f32_32x32x16_bf16 v[96:111], a[40:43], a[96:99], 0
  s_cmp_eq_u32 s94, 9
  s_cselect_b32 s94, 0, s94
  s_waitcnt lgkmcnt(13)
  ds_read_b64_tr_b16 a[68:69], v49 offset:8192
  ds_read_b64_tr_b16 a[70:71], v49 offset:9216
  s_waitcnt lgkmcnt(14)
  v_mfma_f32_32x32x16_bf16 v[112:127], a[44:47], a[96:99], 0
  s_add_u32 m0, s31, 81920
  s_add_u32 s51, s95, 0
  s_waitcnt lgkmcnt(13)
  ds_read_b64_tr_b16 a[72:73], v50 offset:8192
  ds_read_b64_tr_b16 a[74:75], v50 offset:9216
  s_waitcnt lgkmcnt(13)
  v_mfma_f32_32x32x16_bf16 v[64:79], a[48:51], a[100:103], v[64:79]
  buffer_load_dwordx4 v21, s[16:19], s51 offen offset:0 lds
  s_add_u32 s51, s95, 31744
  ds_read_b64_tr_b16 a[76:77], v51 offset:8192
  ds_read_b64_tr_b16 a[78:79], v51 offset:9216
  s_waitcnt lgkmcnt(13)
  v_mfma_f32_32x32x16_bf16 v[80:95], a[52:55], a[100:103], v[80:95]
  buffer_load_dwordx4 v21, s[16:19], s51 offen offset:1024 lds
  s_add_u32 s51, s95, 63488
  s_waitcnt lgkmcnt(12)
  ds_read_b128 a[108:111], v55 offset:0
  ds_read_b64_tr_b16 a[80:81], v48 offset:12288
  ds_read_b64_tr_b16 a[82:83], v48 offset:13312
  s_waitcnt lgkmcnt(14)
  v_mfma_f32_32x32x16_bf16 v[96:111], a[56:59], a[100:103], v[96:111]
  buffer_load_dwordx4 v21, s[16:19], s51 offen offset:2048 lds
  s_add_u32 s51, s95, 95232
  s_waitcnt lgkmcnt(13)
  ds_read_b64_tr_b16 a[84:85], v49 offset:12288
  ds_read_b64_tr_b16 a[86:87], v49 offset:13312
  s_waitcnt lgkmcnt(14)
  v_mfma_f32_32x32x16_bf16 v[112:127], a[60:63], a[100:103], v[112:127]
  buffer_load_dwordx4 v21, s[16:19], s51 offen offset:3072 lds
  s_add_u32 m0, s33, 81920
  s_waitcnt lgkmcnt(13)
  ds_read_b64_tr_b16 a[88:89], v50 offset:12288
  ds_read_b64_tr_b16 a[90:91], v50 offset:13312
  s_waitcnt lgkmcnt(13)
  v_mfma_f32_32x32x16_bf16 v[64:79], a[64:67], a[104:107], v[64:79]
  s_add_u32 s51, s96, 0
  buffer_load_dwordx4 v22, s[20:23], s51 offen offset:0 lds
  ds_read_b64_tr_b16 a[92:93], v51 offset:12288
  ds_read_b64_tr_b16 a[94:95], v51 offset:13312
  s_waitcnt lgkmcnt(13)
  v_mfma_f32_32x32x16_bf16 v[80:95], a[68:71], a[104:107], v[80:95]
  s_add_u32 s51, s96, 8192
  buffer_load_dwordx4 v23, s[20:23], s51 offen offset:1024 lds
  s_waitcnt lgkmcnt(11)
  v_mfma_f32_32x32x16_bf16 v[96:111], a[72:75], a[104:107], v[96:111]
  s_add_u32 s51, s96, 16384
  buffer_load_dwordx4 v22, s[20:23], s51 offen offset:2048 lds
  s_waitcnt lgkmcnt(9)
  v_mfma_f32_32x32x16_bf16 v[112:127], a[76:79], a[104:107], v[112:127]
  s_add_u32 s51, s96, 24576
  buffer_load_dwordx4 v23, s[20:23], s51 offen offset:3072 lds
  s_waitcnt vmcnt(10) lgkmcnt(0)
  s_barrier
  ds_read_b128 a[96:99], v52 offset:40960
  ds_read_b64_tr_b16 a[32:33], v48 offset:40960
  ds_read_b64_tr_b16 a[34:35], v48 offset:41984
  ds_read_b64_tr_b16 a[36:37], v49 offset:40960
  ds_read_b64_tr_b16 a[38:39], v49 offset:41984
  ds_read_b64_tr_b16 a[40:41], v50 offset:40960
  ds_read_b64_tr_b16 a[42:43], v50 offset:41984
  ds_read_b64_tr_b16 a[44:45], v51 offset:40960
  ds_read_b64_tr_b16 a[46:47], v51 offset:41984
  v_mfma_f32_32x32x16_bf16 v[64:79], a[80:83], a[108:111], v[64:79]
  s_lshl_b32 s95, s94, 19
  s_add_u32 s95, s95, s30
  v_mfma_f32_32x32x16_bf16 v[80:95], a[84:87], a[108:111], v[80:95]
  s_lshl_b32 s96, s94, 7
  s_add_u32 s96, s96, s32
  ds_read_b128 a[100:103], v53 offset:40960
  ds_read_b64_tr_b16 a[48:49], v48 offset:45056
  ds_read_b64_tr_b16 a[50:51], v48 offset:46080
  v_mfma_f32_32x32x16_bf16 v[96:111], a[88:91], a[108:111], v[96:111]
  s_add_u32 s94, s94, 1
  s_cmp_eq_u32 s94, 9
  ds_read_b64_tr_b16 a[52:53], v49 offset:45056
  ds_read_b64_tr_b16 a[54:55], v49 offset:46080
  v_mfma_f32_32x32x16_bf16 v[112:127], a[92:95], a[108:111], v[112:127]
  s_cselect_b32 s94, 0, s94
  s_add_u32 m0, s31, 0
  s_waitcnt lgkmcnt(13)
  ds_read_b64_tr_b16 a[56:57], v50 offset:45056
  ds_read_b64_tr_b16 a[58:59], v50 offset:46080
  s_waitcnt lgkmcnt(13)
  v_mfma_f32_32x32x16_bf16 v[64:79], a[32:35], a[96:99], v[64:79]
  s_add_u32 s51, s95, 0
  buffer_load_dwordx4 v21, s[16:19], s51 offen offset:0 lds
  ds_read_b64_tr_b16 a[60:61], v51 offset:45056
  ds_read_b64_tr_b16 a[62:63], v51 offset:46080
  s_waitcnt lgkmcnt(13)
  v_mfma_f32_32x32x16_bf16 v[80:95], a[36:39], a[96:99], v[80:95]
  s_add_u32 s51, s95, 31744
  buffer_load_dwordx4 v21, s[16:19], s51 offen offset:1024 lds
  s_waitcnt lgkmcnt(12)
  ds_read_b128 a[104:107], v54 offset:40960
  ds_read_b64_tr_b16 a[64:65], v48 offset:49152
  ds_read_b64_tr_b16 a[66:67], v48 offset:50176
  s_waitcnt lgkmcnt(14)
  v_mfma_f32_32x32x16_bf16 v[96:111], a[40:43], a[96:99], v[96:111]
  s_add_u32 s51, s95, 63488
  buffer_load_dwordx4 v21, s[16:19], s51 offen offset:2048 lds
  s_waitcnt lgkmcnt(13)
  ds_read_b64_tr_b16 a[68:69], v49 offset:49152
  ds_read_b64_tr_b16 a[70:71], v49 offset:50176
  s_waitcnt lgkmcnt(14)
  v_mfma_f32_32x32x16_bf16 v[112:127], a[44:47], a[96:99], v[112:127]
  s_add_u32 s51, s95, 95232
  buffer_load_dwordx4 v21, s[16:19], s51 offen offset:3072 lds
  s_waitcnt lgkmcnt(13)
  ds_read_b64_tr_b16 a[72:73], v50 offset:49152
  ds_read_b64_tr_b16 a[74:75], v50 offset:50176
  s_waitcnt lgkmcnt(13)
  v_mfma_f32_32x32x16_bf16 v[64:79], a[48:51], a[100:103], v[64:79]
  s_add_u32 m0, s33, 0
  s_add_u32 s51, s96, 0
  ds_read_b64_tr_b16 a[76:77], v51 offset:49152
  ds_read_b64_tr_b16 a[78:79], v51 offset:50176
  s_waitcnt lgkmcnt(13)
  v_mfma_f32_32x32x16_bf16 v[80:95], a[52:55], a[100:103], v[80:95]
  buffer_load_dwordx4 v22, s[20:23], s51 offen offset:0 lds
  s_waitcnt lgkmcnt(12)
  ds_read_b128 a[108:111], v55 offset:40960
  ds_read_b64_tr_b16 a[80:81], v48 offset:53248
  ds_read_b64_tr_b16 a[82:83], v48 offset:54272
  s_waitcnt lgkmcnt(14)
  v_mfma_f32_32x32x16_bf16 v[96:111], a[56:59], a[100:103], v[96:111]
  s_add_u32 s51, s96, 8192
  s_waitcnt lgkmcnt(13)
  ds_read_b64_tr_b16 a[84:85], v49 offset:53248
  ds_read_b64_tr_b16 a[86:87], v49 offset:54272
  s_waitcnt lgkmcnt(14)
  v_mfma_f32_32x32x16_bf16 v[112:127], a[60:63], a[100:103], v[112:127]
  buffer_load_dwordx4 v23, s[20:23], s51 offen offset:1024 lds
  s_waitcnt lgkmcnt(13)
  ds_read_b64_tr_b16 a[88:89], v50 offset:53248
  ds_read_b64_tr_b16 a[90:91], v50 offset:54272
  s_waitcnt lgkmcnt(13)
  v_mfma_f32_32x32x16_bf16 v[64:79], a[64:67], a[104:107], v[64:79]
  s_add_u32 s51, s96, 16384
  ds_read_b64_tr_b16 a[92:93], v51 offset:53248
  ds_read_b64_tr_b16 a[94:95], v51 offset:54272
  s_waitcnt lgkmcnt(13)
  v_mfma_f32_32x32x16_bf16 v[80:95], a[68:71], a[104:107], v[80:95]
  buffer_load_dwordx4 v22, s[20:23], s51 offen offset:2048 lds
  s_waitcnt lgkmcnt(11)
  v_mfma_f32_32x32x16_bf16 v[96:111], a[72:75], a[104:107], v[96:111]
  s_add_u32 s51, s96, 24576
  s_waitcnt lgkmcnt(9)
  v_mfma_f32_32x32x16_bf16 v[112:127], a[76:79], a[104:107], v[112:127]
  buffer_load_dwordx4 v23, s[20:23], s51 offen offset:3072 lds
  s_waitcnt vmcnt(8) lgkmcnt(0)
  s_barrier
  ds_read_b128 a[96:99], v60 offset:0
  ds_read_b64_tr_b16 a[32:33], v56 offset:0
  ds_read_b64_tr_b16 a[34:35], v56 offset:1024
  ds_read_b64_tr_b16 a[36:37], v57 offset:0
  ds_read_b64_tr_b16 a[38:39], v57 offset:1024
  ds_read_b64_tr_b16 a[40:41], v58 offset:0
  ds_read_b64_tr_b16 a[42:43], v58 offset:1024
  ds_read_b64_tr_b16 a[44:45], v59 offset:0
  ds_read_b64_tr_b16 a[46:47], v59 offset:1024
  v_mfma_f32_32x32x16_bf16 v[64:79], a[80:83], a[108:111], v[64:79]
  s_lshl_b32 s95, s94, 19
  s_add_u32 s95, s95, s30
  v_mfma_f32_32x32x16_bf16 v[80:95], a[84:87], a[108:111], v[80:95]
  s_lshl_b32 s96, s94, 7
  s_add_u32 s96, s96, s32
  ds_read_b128 a[100:103], v61 offset:0
  ds_read_b64_tr_b16 a[48:49], v56 offset:4096
  ds_read_b64_tr_b16 a[50:51], v56 offset:5120
  v_mfma_f32_32x32x16_bf16 v[96:111], a[88:91], a[108:111], v[96:111]
  s_add_u32 s94, s94, 1
  s_cmp_eq_u32 s94, 9
  ds_read_b64_tr_b16 a[52:53], v57 offset:4096
  ds_read_b64_tr_b16 a[54:55], v57 offset:5120
  v_mfma_f32_32x32x16_bf16 v[112:127], a[92:95], a[108:111], v[112:127]
  s_cselect_b32 s94, 0, s94
  s_add_u32 m0, s31, 40960
  s_waitcnt lgkmcnt(13)
  ds_read_b64_tr_b16 a[56:57], v58 offset:4096
  ds_read_b64_tr_b16 a[58:59], v58 offset:5120
  s_waitcnt lgkmcnt(13)
  v_mfma_f32_32x32x16_bf16 v[64:79], a[32:35], a[96:99], v[64:79]
  s_add_u32 s51, s95, 0
  buffer_load_dwordx4 v21, s[16:19], s51 offen offset:0 lds
  ds_read_b64_tr_b16 a[60:61], v59 offset:4096
  ds_read_b64_tr_b16 a[62:63], v59 offset:5120
  s_waitcnt lgkmcnt(13)
  v_mfma_f32_32x32x16_bf16 v[80:95], a[36:39], a[96:99], v[80:95]
  s_add_u32 s51, s95, 31744
  buffer_load_dwordx4 v21, s[16:19], s51 offen offset:1024 lds
  s_waitcnt lgkmcnt(12)
  ds_read_b128 a[104:107], v62 offset:0
  ds_read_b64_tr_b16 a[64:65], v56 offset:8192
  ds_read_b64_tr_b16 a[66:67], v56 offset:9216
  s_waitcnt lgkmcnt(14)
  v_mfma_f32_32x32x16_bf16 v[96:111], a[40:43], a[96:99], v[96:111]
  s_add_u32 s51, s95, 63488
  buffer_load_dwordx4 v21, s[16:19], s51 offen offset:2048 lds
  s_waitcnt lgkmcnt(13)
  ds_read_b64_tr_b16 a[68:69], v57 offset:8192
  ds_read_b64_tr_b16 a[70:71], v57 offset:9216
  s_waitcnt lgkmcnt(14)
  v_mfma_f32_32x32x16_bf16 v[112:127], a[44:47], a[96:99], v[112:127]
  s_add_u32 s51, s95, 95232
  buffer_load_dwordx4 v21, s[16:19], s51 offen offset:3072 lds
  s_waitcnt lgkmcnt(13)
  ds_read_b64_tr_b16 a[72:73], v58 offset:8192
  ds_read_b64_tr_b16 a[74:75], v58 offset:9216
  s_waitcnt lgkmcnt(13)
  v_mfma_f32_32x32x16_bf16 v[64:79], a[48:51], a[100:103], v[64:79]
  s_add_u32 m0, s33, 40960
  s_add_u32 s51, s96, 0
  ds_read_b64_tr_b16 a[76:77], v59 offset:8192
  ds_read_b64_tr_b16 a[78:79], v59 offset:9216
  s_waitcnt lgkmcnt(13)
  v_mfma_f32_32x32x16_bf16 v[80:95], a[52:55], a[100:103], v[80:95]
  buffer_load_dwordx4 v22, s[20:23], s51 offen offset:0 lds
  s_add_u32 s51, s96, 8192
  s_waitcnt lgkmcnt(12)
  ds_read_b128 a[108:111], v63 offset:0
  ds_read_b64_tr_b16 a[80:81], v56 offset:12288
  ds_read_b64_tr_b16 a[82:83], v56 offset:13312
  s_waitcnt lgkmcnt(14)
  v_mfma_f32_32x32x16_bf16 v[96:111], a[56:59], a[100:103], v[96:111]
  buffer_load_dwordx4 v23, s[20:23], s51 offen offset:1024 lds
  s_add_u32 s51, s96, 16384
  s_waitcnt lgkmcnt(13)
  ds_read_b64_tr_b16 a[84:85], v57 offset:12288
  ds_read_b64_tr_b16 a[86:87], v57 offset:13312
  s_waitcnt lgkmcnt(14)
  v_mfma_f32_32x32x16_bf16 v[112:127], a[60:63], a[100:103], v[112:127]
  buffer_load_dwordx4 v22, s[20:23], s51 offen offset:2048 lds
  s_add_u32 s51, s96, 24576
  s_waitcnt lgkmcnt(13)
  ds_read_b64_tr_b16 a[88:89], v58 offset:12288
  ds_read_b64_tr_b16 a[90:91], v58 offset:13312
  s_waitcnt lgkmcnt(13)
  v_mfma_f32_32x32x16_bf16 v[64:79], a[64:67], a[104:107], v[64:79]
  buffer_load_dwordx4 v23, s[20:23], s51 offen offset:3072 lds
  s_mov_b32 m0, s97
  ds_read_b64_tr_b16 a[92:93], v59 offset:12288
  ds_read_b64_tr_b16 a[94:95], v59 offset:13312
  s_waitcnt lgkmcnt(13)
  v_mfma_f32_32x32x16_bf16 v[80:95], a[68:71], a[104:107], v[80:95]
  s_add_u32 s47, s47, 8192
  buffer_load_dwordx4 v16, s[8:11], s47 offen offset:0 nt lds
  s_waitcnt lgkmcnt(11)
  v_mfma_f32_32x32x16_bf16 v[96:111], a[72:75], a[104:107], v[96:111]
  buffer_load_dwordx4 v17, s[8:11], s47 offen offset:1024 nt lds
  buffer_load_dwordx4 v18, s[8:11], s47 offen offset:2048 nt lds
  s_waitcnt lgkmcnt(9)
  v_mfma_f32_32x32x16_bf16 v[112:127], a[76:79], a[104:107], v[112:127]
  buffer_load_dwordx4 v19, s[8:11], s47 offen offset:3072 nt lds
  s_waitcnt vmcnt(12) lgkmcnt(0)
  s_barrier
  ds_read_b128 a[96:99], v52 offset:0
  ds_read_b64_tr_b16 a[32:33], v48 offset:0
  ds_read_b64_tr_b16 a[34:35], v48 offset:1024
  ds_read_b64_tr_b16 a[36:37], v49 offset:0
  ds_read_b64_tr_b16 a[38:39], v49 offset:1024
  ds_read_b64_tr_b16 a[40:41], v50 offset:0
  ds_read_b64_tr_b16 a[42:43], v50 offset:1024
  ds_read_b64_tr_b16 a[44:45], v51 offset:0
  ds_read_b64_tr_b16 a[46:47], v51 offset:1024
  v_mfma_f32_32x32x16_bf16 v[64:79], a[80:83], a[108:111], v[64:79]
  s_lshl_b32 s95, s94, 19
  s_add_u32 s95, s95, s30
  v_mfma_f32_32x32x16_bf16 v[80:95], a[84:87], a[108:111], v[80:95]
  s_lshl_b32 s96, s94, 7
  s_add_u32 s96, s96, s32
  ds_read_b128 a[100:103], v53 offset:0
  ds_read_b64_tr_b16 a[48:49], v48 offset:4096
  ds_read_b64_tr_b16 a[50:51], v48 offset:5120
  v_mfma_f32_32x32x16_bf16 v[96:111], a[88:91], a[108:111], v[96:111]
  s_add_u32 s94, s94, 1
  s_cmp_eq_u32 s94, 9
  ds_read_b64_tr_b16 a[52:53], v49 offset:4096
  ds_read_b64_tr_b16 a[54:55], v49 offset:5120
  v_mfma_f32_32x32x16_bf16 v[112:127], a[92:95], a[108:111], v[112:127]
  s_cselect_b32 s94, 0, s94
  s_add_u32 m0, s31, 81920
  s_waitcnt lgkmcnt(13)
  ds_read_b64_tr_b16 a[56:57], v50 offset:4096
  ds_read_b64_tr_b16 a[58:59], v50 offset:5120
  s_waitcnt lgkmcnt(13)
  v_mfma_f32_32x32x16_bf16 v[64:79], a[32:35], a[96:99], v[64:79]
  s_add_u32 s51, s95, 0
  buffer_load_dwordx4 v21, s[16:19], s51 offen offset:0 lds
  ds_read_b64_tr_b16 a[60:61], v51 offset:4096
  ds_read_b64_tr_b16 a[62:63], v51 offset:5120
  s_waitcnt lgkmcnt(13)
  v_mfma_f32_32x32x16_bf16 v[80:95], a[36:39], a[96:99], v[80:95]
  s_add_u32 s51, s95, 31744
  buffer_load_dwordx4 v21, s[16:19], s51 offen offset:1024 lds
  s_waitcnt lgkmcnt(12)
  ds_read_b128 a[104:107], v54 offset:0
  ds_read_b64_tr_b16 a[64:65], v48 offset:8192
  ds_read_b64_tr_b16 a[66:67], v48 offset:9216
  s_waitcnt lgkmcnt(14)
  v_mfma_f32_32x32x16_bf16 v[96:111], a[40:43], a[96:99], v[96:111]
  s_add_u32 s51, s95, 63488
  buffer_load_dwordx4 v21, s[16:19], s51 offen offset:2048 lds
  s_waitcnt lgkmcnt(13)
  ds_read_b64_tr_b16 a[68:69], v49 offset:8192
  ds_read_b64_tr_b16 a[70:71], v49 offset:9216
  s_waitcnt lgkmcnt(14)
  v_mfma_f32_32x32x16_bf16 v[112:127], a[44:47], a[96:99], v[112:127]
  s_add_u32 s51, s95, 95232
  buffer_load_dwordx4 v21, s[16:19], s51 offen offset:3072 lds
  s_waitcnt lgkmcnt(13)
  ds_read_b64_tr_b16 a[72:73], v50 offset:8192
  ds_read_b64_tr_b16 a[74:75], v50 offset:9216
  s_waitcnt lgkmcnt(13)
  v_mfma_f32_32x32x16_bf16 v[64:79], a[48:51], a[100:103], v[64:79]
  s_add_u32 m0, s33, 81920
  s_add_u32 s51, s96, 0
  ds_read_b64_tr_b16 a[76:77], v51 offset:8192
  ds_read_b64_tr_b16 a[78:79], v51 offset:9216
  s_waitcnt lgkmcnt(13)
  v_mfma_f32_32x32x16_bf16 v[80:95], a[52:55], a[100:103], v[80:95]
  buffer_load_dwordx4 v22, s[20:23], s51 offen offset:0 lds
  s_add_u32 s51, s96, 8192
  s_waitcnt lgkmcnt(12)
  ds_read_b128 a[108:111], v55 offset:0
  ds_read_b64_tr_b16 a[80:81], v48 offset:12288
  ds_read_b64_tr_b16 a[82:83], v48 offset:13312
  s_waitcnt lgkmcnt(14)
  v_mfma_f32_32x32x16_bf16 v[96:111], a[56:59], a[100:103], v[96:111]
  buffer_load_dwordx4 v23, s[20:23], s51 offen offset:1024 lds
  s_add_u32 s51, s96, 16384
  s_waitcnt lgkmcnt(13)
  ds_read_b64_tr_b16 a[84:85], v49 offset:12288
  ds_read_b64_tr_b16 a[86:87], v49 offset:13312
  s_waitcnt lgkmcnt(14)
  v_mfma_f32_32x32x16_bf16 v[112:127], a[60:63], a[100:103], v[112:127]
  buffer_load_dwordx4 v22, s[20:23], s51 offen offset:2048 lds
  s_add_u32 s51, s96, 24576
  s_waitcnt lgkmcnt(13)
  ds_read_b64_tr_b16 a[88:89], v50 offset:12288
  ds_read_b64_tr_b16 a[90:91], v50 offset:13312
  s_waitcnt lgkmcnt(13)
  v_mfma_f32_32x32x16_bf16 v[64:79], a[64:67], a[104:107], v[64:79]
  buffer_load_dwordx4 v23, s[20:23], s51 offen offset:3072 lds
  s_mov_b32 m0, s98
  ds_read_b64_tr_b16 a[92:93], v51 offset:12288
  ds_read_b64_tr_b16 a[94:95], v51 offset:13312
  s_waitcnt lgkmcnt(13)
  v_mfma_f32_32x32x16_bf16 v[80:95], a[68:71], a[104:107], v[80:95]
  s_add_u32 s47, s47, 8192
  buffer_load_dwordx4 v16, s[8:11], s47 offen offset:0 nt lds
  s_waitcnt lgkmcnt(11)
  v_mfma_f32_32x32x16_bf16 v[96:111], a[72:75], a[104:107], v[96:111]
  buffer_load_dwordx4 v17, s[8:11], s47 offen offset:1024 nt lds
  buffer_load_dwordx4 v18, s[8:11], s47 offen offset:2048 nt lds
  s_waitcnt lgkmcnt(9)
  v_mfma_f32_32x32x16_bf16 v[112:127], a[76:79], a[104:107], v[112:127]
  buffer_load_dwordx4 v19, s[8:11], s47 offen offset:3072 nt lds
  s_mov_b32 exec_lo, 0x3ffff
  s_mov_b32 exec_hi, 0x0
  buffer_load_dword v246, v245, s[84:87], s91 offen
  s_mov_b64 exec, -1
  s_add_u32 s91, s91, 2304
  s_waitcnt vmcnt(17) lgkmcnt(0)
  s_barrier
  ds_read_b128 a[96:99], v52 offset:40960
  ds_read_b64_tr_b16 a[32:33], v48 offset:40960
  ds_read_b64_tr_b16 a[34:35], v48 offset:41984
  ds_read_b64_tr_b16 a[36:37], v49 offset:40960
  ds_read_b64_tr_b16 a[38:39], v49 offset:41984
  ds_read_b64_tr_b16 a[40:41], v50 offset:40960
  ds_read_b64_tr_b16 a[42:43], v50 offset:41984
  ds_read_b64_tr_b16 a[44:45], v51 offset:40960
  ds_read_b64_tr_b16 a[46:47], v51 offset:41984
  v_mfma_f32_32x32x16_bf16 v[64:79], a[80:83], a[108:111], v[64:79]
  s_lshl_b32 s95, s94, 19
  s_add_u32 s95, s95, s30
  v_mfma_f32_32x32x16_bf16 v[80:95], a[84:87], a[108:111], v[80:95]
  s_lshl_b32 s96, s94, 7
  s_add_u32 s96, s96, s32
  ds_read_b128 a[100:103], v53 offset:40960
  ds_read_b64_tr_b16 a[48:49], v48 offset:45056
  ds_read_b64_tr_b16 a[50:51], v48 offset:46080
  v_mfma_f32_32x32x16_bf16 v[96:111], a[88:91], a[108:111], v[96:111]
  s_add_u32 s94, s94, 1
  s_cmp_eq_u32 s94, 9
  ds_read_b64_tr_b16 a[52:53], v49 offset:45056
  ds_read_b64_tr_b16 a[54:55], v49 offset:46080
  v_mfma_f32_32x32x16_bf16 v[112:127], a[92:95], a[108:111], v[112:127]
  s_cselect_b32 s94, 0, s94
  s_add_u32 m0, s31, 0
  s_waitcnt lgkmcnt(13)
  ds_read_b64_tr_b16 a[56:57], v50 offset:45056
  ds_read_b64_tr_b16 a[58:59], v50 offset:46080
  s_waitcnt lgkmcnt(13)
  v_mfma_f32_32x32x16_bf16 v[64:79], a[32:35], a[96:99], v[64:79]
  s_add_u32 s51, s95, 0
  buffer_load_dwordx4 v21, s[16:19], s51 offen offset:0 lds
  ds_read_b64_tr_b16 a[60:61], v51 offset:45056
  ds_read_b64_tr_b16 a[62:63], v51 offset:46080
  s_waitcnt lgkmcnt(13)
  v_mfma_f32_32x32x16_bf16 v[80:95], a[36:39], a[96:99], v[80:95]
  s_add_u32 s51, s95, 31744
  buffer_load_dwordx4 v21, s[16:19], s51 offen offset:1024 lds
  s_waitcnt lgkmcnt(12)
  ds_read_b128 a[104:107], v54 offset:40960
  ds_read_b64_tr_b16 a[64:65], v48 offset:49152
  ds_read_b64_tr_b16 a[66:67], v48 offset:50176
  s_waitcnt lgkmcnt(14)
  v_mfma_f32_32x32x16_bf16 v[96:111], a[40:43], a[96:99], v[96:111]
  s_add_u32 s51, s95, 63488
  buffer_load_dwordx4 v21, s[16:19], s51 offen offset:2048 lds
  s_waitcnt lgkmcnt(13)
  ds_read_b64_tr_b16 a[68:69], v49 offset:49152
  ds_read_b64_tr_b16 a[70:71], v49 offset:50176
  s_waitcnt lgkmcnt(14)
  v_mfma_f32_32x32x16_bf16 v[112:127], a[44:47], a[96:99], v[112:127]
  s_add_u32 s51, s95, 95232
  buffer_load_dwordx4 v21, s[16:19], s51 offen offset:3072 lds
  s_waitcnt lgkmcnt(13)
  ds_read_b64_tr_b16 a[72:73], v50 offset:49152
  ds_read_b64_tr_b16 a[74:75], v50 offset:50176
  s_waitcnt lgkmcnt(13)
  v_mfma_f32_32x32x16_bf16 v[64:79], a[48:51], a[100:103], v[64:79]
  s_add_u32 m0, s33, 0
  s_add_u32 s51, s96, 0
  ds_read_b64_tr_b16 a[76:77], v51 offset:49152
  ds_read_b64_tr_b16 a[78:79], v51 offset:50176
  s_waitcnt lgkmcnt(13)
  v_mfma_f32_32x32x16_bf16 v[80:95], a[52:55], a[100:103], v[80:95]
  buffer_load_dwordx4 v22, s[20:23], s51 offen offset:0 lds
  s_add_u32 s51, s96, 8192
  s_waitcnt lgkmcnt(12)
  ds_read_b128 a[108:111], v55 offset:40960
  ds_read_b64_tr_b16 a[80:81], v48 offset:53248
  ds_read_b64_tr_b16 a[82:83], v48 offset:54272
  s_waitcnt lgkmcnt(14)
  v_mfma_f32_32x32x16_bf16 v[96:111], a[56:59], a[100:103], v[96:111]
  buffer_load_dwordx4 v23, s[20:23], s51 offen offset:1024 lds
  s_add_u32 s51, s96, 16384
  s_waitcnt lgkmcnt(13)
  ds_read_b64_tr_b16 a[84:85], v49 offset:53248
  ds_read_b64_tr_b16 a[86:87], v49 offset:54272
  s_waitcnt lgkmcnt(14)
  v_mfma_f32_32x32x16_bf16 v[112:127], a[60:63], a[100:103], v[112:127]
  buffer_load_dwordx4 v22, s[20:23], s51 offen offset:2048 lds
  s_add_u32 s51, s96, 24576
  s_waitcnt lgkmcnt(13)
  ds_read_b64_tr_b16 a[88:89], v50 offset:53248
  ds_read_b64_tr_b16 a[90:91], v50 offset:54272
  s_waitcnt lgkmcnt(13)
  v_mfma_f32_32x32x16_bf16 v[64:79], a[64:67], a[104:107], v[64:79]
  buffer_load_dwordx4 v23, s[20:23], s51 offen offset:3072 lds
  s_mov_b32 m0, s99
  ds_read_b64_tr_b16 a[92:93], v51 offset:53248
  ds_read_b64_tr_b16 a[94:95], v51 offset:54272
  s_waitcnt lgkmcnt(13)
  v_mfma_f32_32x32x16_bf16 v[80:95], a[68:71], a[104:107], v[80:95]
  s_add_u32 s47, s47, 8192
  buffer_load_dwordx4 v16, s[8:11], s47 offen offset:0 nt lds
  s_waitcnt lgkmcnt(11)
  v_mfma_f32_32x32x16_bf16 v[96:111], a[72:75], a[104:107], v[96:111]
  buffer_load_dwordx4 v17, s[8:11], s47 offen offset:1024 nt lds
  buffer_load_dwordx4 v18, s[8:11], s47 offen offset:2048 nt lds
  s_waitcnt lgkmcnt(9)
  v_mfma_f32_32x32x16_bf16 v[112:127], a[76:79], a[104:107], v[112:127]
  buffer_load_dwordx4 v19, s[8:11], s47 offen offset:3072 nt lds
  s_mov_b32 exec_lo, 0x3ffff
  s_mov_b32 exec_hi, 0x0
  buffer_load_dword v246, v245, s[84:87], s91 offen
  s_mov_b64 exec, -1
  s_add_u32 s91, s91, 2304
  s_waitcnt vmcnt(18) lgkmcnt(0)
  s_barrier
  ds_read_b128 a[96:99], v60 offset:0
  ds_read_b64_tr_b16 a[32:33], v56 offset:0
  ds_read_b64_tr_b16 a[34:35], v56 offset:1024
  ds_read_b64_tr_b16 a[36:37], v57 offset:0
  ds_read_b64_tr_b16 a[38:39], v57 offset:1024
  ds_read_b64_tr_b16 a[40:41], v58 offset:0
  ds_read_b64_tr_b16 a[42:43], v58 offset:1024
  ds_read_b64_tr_b16 a[44:45], v59 offset:0
  ds_read_b64_tr_b16 a[46:47], v59 offset:1024
  v_mfma_f32_32x32x16_bf16 v[64:79], a[80:83], a[108:111], v[64:79]
  s_lshl_b32 s95, s94, 19
  s_add_u32 s95, s95, s30
  v_mfma_f32_32x32x16_bf16 v[80:95], a[84:87], a[108:111], v[80:95]
  s_lshl_b32 s96, s94, 7
  s_add_u32 s96, s96, s32
  ds_read_b128 a[100:103], v61 offset:0
  ds_read_b64_tr_b16 a[48:49], v56 offset:4096
  ds_read_b64_tr_b16 a[50:51], v56 offset:5120
  v_mfma_f32_32x32x16_bf16 v[96:111], a[88:91], a[108:111], v[96:111]
  s_add_u32 s94, s94, 1
  s_cmp_eq_u32 s94, 9
  ds_read_b64_tr_b16 a[52:53], v57 offset:4096
  ds_read_b64_tr_b16 a[54:55], v57 offset:5120
  v_mfma_f32_32x32x16_bf16 v[112:127], a[92:95], a[108:111], v[112:127]
  s_cselect_b32 s94, 0, s94
  s_add_u32 m0, s31, 40960
  s_waitcnt lgkmcnt(13)
  ds_read_b64_tr_b16 a[56:57], v58 offset:4096
  ds_read_b64_tr_b16 a[58:59], v58 offset:5120
  s_waitcnt lgkmcnt(13)
  v_mfma_f32_32x32x16_bf16 v[64:79], a[32:35], a[96:99], v[64:79]
  s_add_u32 s51, s95, 0
  buffer_load_dwordx4 v21, s[16:19], s51 offen offset:0 lds
  ds_read_b64_tr_b16 a[60:61], v59 offset:4096
  ds_read_b64_tr_b16 a[62:63], v59 offset:5120
  s_waitcnt lgkmcnt(13)
  v_mfma_f32_32x32x16_bf16 v[80:95], a[36:39], a[96:99], v[80:95]
  s_add_u32 s51, s95, 31744
  buffer_load_dwordx4 v21, s[16:19], s51 offen offset:1024 lds
  s_waitcnt lgkmcnt(12)
  ds_read_b128 a[104:107], v62 offset:0
  ds_read_b64_tr_b16 a[64:65], v56 offset:8192
  ds_read_b64_tr_b16 a[66:67], v56 offset:9216
  s_waitcnt lgkmcnt(14)
  v_mfma_f32_32x32x16_bf16 v[96:111], a[40:43], a[96:99], v[96:111]
  s_add_u32 s51, s95, 63488
  buffer_load_dwordx4 v21, s[16:19], s51 offen offset:2048 lds
  s_waitcnt lgkmcnt(13)
  ds_read_b64_tr_b16 a[68:69], v57 offset:8192
  ds_read_b64_tr_b16 a[70:71], v57 offset:9216
  s_waitcnt lgkmcnt(14)
  v_mfma_f32_32x32x16_bf16 v[112:127], a[44:47], a[96:99], v[112:127]
  s_add_u32 s51, s95, 95232
  buffer_load_dwordx4 v21, s[16:19], s51 offen offset:3072 lds
  s_waitcnt lgkmcnt(13)
  ds_read_b64_tr_b16 a[72:73], v58 offset:8192
  ds_read_b64_tr_b16 a[74:75], v58 offset:9216
  s_waitcnt lgkmcnt(13)
  v_mfma_f32_32x32x16_bf16 v[64:79], a[48:51], a[100:103], v[64:79]
  s_add_u32 m0, s33, 40960
  s_add_u32 s51, s96, 0
  ds_read_b64_tr_b16 a[76:77], v59 offset:8192
  ds_read_b64_tr_b16 a[78:79], v59 offset:9216
  s_waitcnt lgkmcnt(13)
  v_mfma_f32_32x32x16_bf16 v[80:95], a[52:55], a[100:103], v[80:95]
  buffer_load_dwordx4 v22, s[20:23], s51 offen offset:0 lds
  s_add_u32 s51, s96, 8192
  s_waitcnt lgkmcnt(12)
  ds_read_b128 a[108:111], v63 offset:0
  ds_read_b64_tr_b16 a[80:81], v56 offset:12288
  ds_read_b64_tr_b16 a[82:83], v56 offset:13312
  s_waitcnt lgkmcnt(14)
  v_mfma_f32_32x32x16_bf16 v[96:111], a[56:59], a[100:103], v[96:111]
  buffer_load_dwordx4 v23, s[20:23], s51 offen offset:1024 lds
  s_add_u32 s51, s96, 16384
  s_waitcnt lgkmcnt(13)
  ds_read_b64_tr_b16 a[84:85], v57 offset:12288
  ds_read_b64_tr_b16 a[86:87], v57 offset:13312
  s_waitcnt lgkmcnt(14)
  v_mfma_f32_32x32x16_bf16 v[112:127], a[60:63], a[100:103], v[112:127]
  buffer_load_dwordx4 v22, s[20:23], s51 offen offset:2048 lds
  s_add_u32 s51, s96, 24576
  s_waitcnt lgkmcnt(13)
  ds_read_b64_tr_b16 a[88:89], v58 offset:12288
  ds_read_b64_tr_b16 a[90:91], v58 offset:13312
  s_waitcnt lgkmcnt(13)
  v_mfma_f32_32x32x16_bf16 v[64:79], a[64:67], a[104:107], v[64:79]
  buffer_load_dwordx4 v23, s[20:23], s51 offen offset:3072 lds
  s_mov_b32 m0, s100
  ds_read_b64_tr_b16 a[92:93], v59 offset:12288
  ds_read_b64_tr_b16 a[94:95], v59 offset:13312
  s_waitcnt lgkmcnt(13)
  v_mfma_f32_32x32x16_bf16 v[80:95], a[68:71], a[104:107], v[80:95]
  s_add_u32 s48, s48, 8192
  buffer_load_dwordx4 v20, s[12:15], s48 offen offset:0 nt lds
  s_waitcnt lgkmcnt(11)
  v_mfma_f32_32x32x16_bf16 v[96:111], a[72:75], a[104:107], v[96:111]
  buffer_load_dwordx4 v20, s[12:15], s48 offen offset:1024 nt lds
  buffer_load_dwordx4 v20, s[12:15], s48 offen offset:2048 nt lds
  s_waitcnt lgkmcnt(9)
  v_mfma_f32_32x32x16_bf16 v[112:127], a[76:79], a[104:107], v[112:127]
  buffer_load_dwordx4 v20, s[12:15], s48 offen offset:3072 nt lds
  s_mov_b32 exec_lo, 0x3ffff
  s_mov_b32 exec_hi, 0x0
  buffer_load_dword v246, v245, s[84:87], s91 offen
  s_mov_b64 exec, -1
  s_add_u32 s91, s91, 2304
  s_waitcnt vmcnt(18) lgkmcnt(0)
  s_barrier
  ds_read_b128 a[96:99], v52 offset:0
  ds_read_b64_tr_b16 a[32:33], v48 offset:0
  ds_read_b64_tr_b16 a[34:35], v48 offset:1024
  ds_read_b64_tr_b16 a[36:37], v49 offset:0
  ds_read_b64_tr_b16 a[38:39], v49 offset:1024
  ds_read_b64_tr_b16 a[40:41], v50 offset:0
  ds_read_b64_tr_b16 a[42:43], v50 offset:1024
  ds_read_b64_tr_b16 a[44:45], v51 offset:0
  ds_read_b64_tr_b16 a[46:47], v51 offset:1024
  v_mfma_f32_32x32x16_bf16 v[64:79], a[80:83], a[108:111], v[64:79]
  s_lshl_b32 s95, s94, 19
  s_add_u32 s95, s95, s30
  v_mfma_f32_32x32x16_bf16 v[80:95], a[84:87], a[108:111], v[80:95]
  s_lshl_b32 s96, s94, 7
  s_add_u32 s96, s96, s32
  ds_read_b128 a[100:103], v53 offset:0
  ds_read_b64_tr_b16 a[48:49], v48 offset:4096
  ds_read_b64_tr_b16 a[50:51], v48 offset:5120
  v_mfma_f32_32x32x16_bf16 v[96:111], a[88:91], a[108:111], v[96:111]
  s_add_u32 s94, s94, 1
  s_cmp_eq_u32 s94, 9
  ds_read_b64_tr_b16 a[52:53], v49 offset:4096
  ds_read_b64_tr_b16 a[54:55], v49 offset:5120
  v_mfma_f32_32x32x16_bf16 v[112:127], a[92:95], a[108:111], v[112:127]
  s_cselect_b32 s94, 0, s94
  s_add_u32 m0, s31, 81920
  s_waitcnt lgkmcnt(13)
  ds_read_b64_tr_b16 a[56:57], v50 offset:4096
  ds_read_b64_tr_b16 a[58:59], v50 offset:5120
  s_waitcnt lgkmcnt(13)
  v_mfma_f32_32x32x16_bf16 v[64:79], a[32:35], a[96:99], v[64:79]
  s_add_u32 s51, s95, 0
  buffer_load_dwordx4 v21, s[16:19], s51 offen offset:0 lds
  ds_read_b64_tr_b16 a[60:61], v51 offset:4096
  ds_read_b64_tr_b16 a[62:63], v51 offset:5120
  s_waitcnt lgkmcnt(13)
  v_mfma_f32_32x32x16_bf16 v[80:95], a[36:39], a[96:99], v[80:95]
  s_add_u32 s51, s95, 31744
  buffer_load_dwordx4 v21, s[16:19], s51 offen offset:1024 lds
  s_waitcnt lgkmcnt(12)
  ds_read_b128 a[104:107], v54 offset:0
  ds_read_b64_tr_b16 a[64:65], v48 offset:8192
  ds_read_b64_tr_b16 a[66:67], v48 offset:9216
  s_waitcnt lgkmcnt(14)
  v_mfma_f32_32x32x16_bf16 v[96:111], a[40:43], a[96:99], v[96:111]
  s_add_u32 s51, s95, 63488
  buffer_load_dwordx4 v21, s[16:19], s51 offen offset:2048 lds
  s_waitcnt lgkmcnt(13)
  ds_read_b64_tr_b16 a[68:69], v49 offset:8192
  ds_read_b64_tr_b16 a[70:71], v49 offset:9216
  s_waitcnt lgkmcnt(14)
  v_mfma_f32_32x32x16_bf16 v[112:127], a[44:47], a[96:99], v[112:127]
  s_add_u32 s51, s95, 95232
  buffer_load_dwordx4 v21, s[16:19], s51 offen offset:3072 lds
  s_waitcnt lgkmcnt(13)
  ds_read_b64_tr_b16 a[72:73], v50 offset:8192
  ds_read_b64_tr_b16 a[74:75], v50 offset:9216
  s_waitcnt lgkmcnt(13)
  v_mfma_f32_32x32x16_bf16 v[64:79], a[48:51], a[100:103], v[64:79]
  s_add_u32 m0, s33, 81920
  s_add_u32 s51, s96, 0
  ds_read_b64_tr_b16 a[76:77], v51 offset:8192
  ds_read_b64_tr_b16 a[78:79], v51 offset:9216
  s_waitcnt lgkmcnt(13)
  v_mfma_f32_32x32x16_bf16 v[80:95], a[52:55], a[100:103], v[80:95]
  buffer_load_dwordx4 v22, s[20:23], s51 offen offset:0 lds
  s_waitcnt lgkmcnt(12)
  ds_read_b128 a[108:111], v55 offset:0
  ds_read_b64_tr_b16 a[80:81], v48 offset:12288
  ds_read_b64_tr_b16 a[82:83], v48 offset:13312
  s_waitcnt lgkmcnt(14)
  v_mfma_f32_32x32x16_bf16 v[96:111], a[56:59], a[100:103], v[96:111]
  s_add_u32 s51, s96, 8192
  s_waitcnt lgkmcnt(13)
  ds_read_b64_tr_b16 a[84:85], v49 offset:12288
  ds_read_b64_tr_b16 a[86:87], v49 offset:13312
  s_waitcnt lgkmcnt(14)
  v_mfma_f32_32x32x16_bf16 v[112:127], a[60:63], a[100:103], v[112:127]
  buffer_load_dwordx4 v23, s[20:23], s51 offen offset:1024 lds
  s_waitcnt lgkmcnt(13)
  ds_read_b64_tr_b16 a[88:89], v50 offset:12288
  ds_read_b64_tr_b16 a[90:91], v50 offset:13312
  s_waitcnt lgkmcnt(13)
  v_mfma_f32_32x32x16_bf16 v[64:79], a[64:67], a[104:107], v[64:79]
  s_add_u32 s51, s96, 16384
  ds_read_b64_tr_b16 a[92:93], v51 offset:12288
  ds_read_b64_tr_b16 a[94:95], v51 offset:13312
  s_waitcnt lgkmcnt(13)
  v_mfma_f32_32x32x16_bf16 v[80:95], a[68:71], a[104:107], v[80:95]
  buffer_load_dwordx4 v22, s[20:23], s51 offen offset:2048 lds
  s_waitcnt lgkmcnt(11)
  v_mfma_f32_32x32x16_bf16 v[96:111], a[72:75], a[104:107], v[96:111]
  s_add_u32 s51, s96, 24576
  s_waitcnt lgkmcnt(9)
  v_mfma_f32_32x32x16_bf16 v[112:127], a[76:79], a[104:107], v[112:127]
  buffer_load_dwordx4 v23, s[20:23], s51 offen offset:3072 lds
  s_mov_b32 exec_lo, 0x3ffff
  s_mov_b32 exec_hi, 0x0
  buffer_load_dword v246, v245, s[84:87], s91 offen
  s_mov_b64 exec, -1
  s_add_u32 s91, s91, 2304
  s_waitcnt vmcnt(14) lgkmcnt(0)
  s_barrier
  ds_read_b128 a[96:99], v52 offset:40960
  ds_read_b64_tr_b16 a[32:33], v48 offset:40960
  ds_read_b64_tr_b16 a[34:35], v48 offset:41984
  ds_read_b64_tr_b16 a[36:37], v49 offset:40960
  ds_read_b64_tr_b16 a[38:39], v49 offset:41984
  ds_read_b64_tr_b16 a[40:41], v50 offset:40960
  ds_read_b64_tr_b16 a[42:43], v50 offset:41984
  ds_read_b64_tr_b16 a[44:45], v51 offset:40960
  ds_read_b64_tr_b16 a[46:47], v51 offset:41984
  v_mfma_f32_32x32x16_bf16 v[64:79], a[80:83], a[108:111], v[64:79]
  s_add_u32 m0, s29, 0
  v_mfma_f32_32x32x16_bf16 v[80:95], a[84:87], a[108:111], v[80:95]
  s_add_u32 s47, s47, 8192
  ds_read_b128 a[100:103], v53 offset:40960
  ds_read_b64_tr_b16 a[48:49], v48 offset:45056
  ds_read_b64_tr_b16 a[50:51], v48 offset:46080
  v_mfma_f32_32x32x16_bf16 v[96:111], a[88:91], a[108:111], v[96:111]
  buffer_load_dwordx4 v16, s[8:11], s47 offen offset:0 nt lds
  ds_read_b64_tr_b16 a[52:53], v49 offset:45056
  ds_read_b64_tr_b16 a[54:55], v49 offset:46080
  v_mfma_f32_32x32x16_bf16 v[112:127], a[92:95], a[108:111], v[112:127]
  buffer_load_dwordx4 v17, s[8:11], s47 offen offset:1024 nt lds
  s_waitcnt lgkmcnt(13)
  ds_read_b64_tr_b16 a[56:57], v50 offset:45056
  ds_read_b64_tr_b16 a[58:59], v50 offset:46080
  s_waitcnt lgkmcnt(13)
  v_mfma_f32_32x32x16_bf16 v[64:79], a[32:35], a[96:99], v[64:79]
  buffer_load_dwordx4 v18, s[8:11], s47 offen offset:2048 nt lds
  ds_read_b64_tr_b16 a[60:61], v51 offset:45056
  ds_read_b64_tr_b16 a[62:63], v51 offset:46080
  s_waitcnt lgkmcnt(13)
  v_mfma_f32_32x32x16_bf16 v[80:95], a[36:39], a[96:99], v[80:95]
  buffer_load_dwordx4 v19, s[8:11], s47 offen offset:3072 nt lds
  s_waitcnt lgkmcnt(12)
  ds_read_b128 a[104:107], v54 offset:40960
  ds_read_b64_tr_b16 a[64:65], v48 offset:49152
  ds_read_b64_tr_b16 a[66:67], v48 offset:50176
  s_waitcnt lgkmcnt(14)
  v_mfma_f32_32x32x16_bf16 v[96:111], a[40:43], a[96:99], v[96:111]
  s_add_u32 m0, s29, 8192
  s_waitcnt lgkmcnt(13)
  ds_read_b64_tr_b16 a[68:69], v49 offset:49152
  ds_read_b64_tr_b16 a[70:71], v49 offset:50176
  s_waitcnt lgkmcnt(14)
  v_mfma_f32_32x32x16_bf16 v[112:127], a[44:47], a[96:99], v[112:127]
  s_add_u32 s48, s48, 8192
  s_waitcnt lgkmcnt(13)
  ds_read_b64_tr_b16 a[72:73], v50 offset:49152
  ds_read_b64_tr_b16 a[74:75], v50 offset:50176
  s_waitcnt lgkmcnt(13)
  v_mfma_f32_32x32x16_bf16 v[64:79], a[48:51], a[100:103], v[64:79]
  buffer_load_dwordx4 v20, s[12:15], s48 offen offset:0 nt lds
  ds_read_b64_tr_b16 a[76:77], v51 offset:49152
  ds_read_b64_tr_b16 a[78:79], v51 offset:50176
  s_waitcnt lgkmcnt(13)
  v_mfma_f32_32x32x16_bf16 v[80:95], a[52:55], a[100:103], v[80:95]
  buffer_load_dwordx4 v20, s[12:15], s48 offen offset:1024 nt lds
  s_waitcnt lgkmcnt(12)
  ds_read_b128 a[108:111], v55 offset:40960
  ds_read_b64_tr_b16 a[80:81], v48 offset:53248
  ds_read_b64_tr_b16 a[82:83], v48 offset:54272
  s_waitcnt lgkmcnt(14)
  v_mfma_f32_32x32x16_bf16 v[96:111], a[56:59], a[100:103], v[96:111]
  buffer_load_dwordx4 v20, s[12:15], s48 offen offset:2048 nt lds
  s_waitcnt lgkmcnt(13)
  ds_read_b64_tr_b16 a[84:85], v49 offset:53248
  ds_read_b64_tr_b16 a[86:87], v49 offset:54272
  s_waitcnt lgkmcnt(14)
  v_mfma_f32_32x32x16_bf16 v[112:127], a[60:63], a[100:103], v[112:127]
  buffer_load_dwordx4 v20, s[12:15], s48 offen offset:3072 nt lds
  s_waitcnt lgkmcnt(13)
  ds_read_b64_tr_b16 a[88:89], v50 offset:53248
  ds_read_b64_tr_b16 a[90:91], v50 offset:54272
  s_waitcnt lgkmcnt(13)
  v_mfma_f32_32x32x16_bf16 v[64:79], a[64:67], a[104:107], v[64:79]
  ds_read_b64_tr_b16 a[92:93], v51 offset:53248
  ds_read_b64_tr_b16 a[94:95], v51 offset:54272
  s_waitcnt lgkmcnt(13)
  v_mfma_f32_32x32x16_bf16 v[80:95], a[68:71], a[104:107], v[80:95]
  s_waitcnt lgkmcnt(11)
  v_mfma_f32_32x32x16_bf16 v[96:111], a[72:75], a[104:107], v[96:111]
  s_waitcnt lgkmcnt(9)
  v_mfma_f32_32x32x16_bf16 v[112:127], a[76:79], a[104:107], v[112:127]
  s_waitcnt vmcnt(9) lgkmcnt(0)
  s_barrier
  ds_read_b128 a[96:99], v60 offset:0
  ds_read_b64_tr_b16 a[32:33], v56 offset:0
  ds_read_b64_tr_b16 a[34:35], v56 offset:1024
  ds_read_b64_tr_b16 a[36:37], v57 offset:0
  ds_read_b64_tr_b16 a[38:39], v57 offset:1024
  ds_read_b64_tr_b16 a[40:41], v58 offset:0
  ds_read_b64_tr_b16 a[42:43], v58 offset:1024
  ds_read_b64_tr_b16 a[44:45], v59 offset:0
  ds_read_b64_tr_b16 a[46:47], v59 offset:1024
  v_mfma_f32_32x32x16_bf16 v[64:79], a[80:83], a[108:111], v[64:79]
  s_add_u32 m0, s29, 40960
  v_mfma_f32_32x32x16_bf16 v[80:95], a[84:87], a[108:111], v[80:95]
  s_add_u32 s47, s47, 8192
  ds_read_b128 a[100:103], v61 offset:0
  ds_read_b64_tr_b16 a[48:49], v56 offset:4096
  ds_read_b64_tr_b16 a[50:51], v56 offset:5120
  v_mfma_f32_32x32x16_bf16 v[96:111], a[88:91], a[108:111], v[96:111]
  buffer_load_dwordx4 v16, s[8:11], s47 offen offset:0 nt lds
  ds_read_b64_tr_b16 a[52:53], v57 offset:4096
  ds_read_b64_tr_b16 a[54:55], v57 offset:5120
  v_mfma_f32_32x32x16_bf16 v[112:127], a[92:95], a[108:111], v[112:127]
  buffer_load_dwordx4 v17, s[8:11], s47 offen offset:1024 nt lds
  s_waitcnt lgkmcnt(13)
  ds_read_b64_tr_b16 a[56:57], v58 offset:4096
  ds_read_b64_tr_b16 a[58:59], v58 offset:5120
  s_waitcnt lgkmcnt(13)
  v_mfma_f32_32x32x16_bf16 v[64:79], a[32:35], a[96:99], v[64:79]
  buffer_load_dwordx4 v18, s[8:11], s47 offen offset:2048 nt lds
  ds_read_b64_tr_b16 a[60:61], v59 offset:4096
  ds_read_b64_tr_b16 a[62:63], v59 offset:5120
  s_waitcnt lgkmcnt(13)
  v_mfma_f32_32x32x16_bf16 v[80:95], a[36:39], a[96:99], v[80:95]
  buffer_load_dwordx4 v19, s[8:11], s47 offen offset:3072 nt lds
  s_waitcnt lgkmcnt(12)
  ds_read_b128 a[104:107], v62 offset:0
  ds_read_b64_tr_b16 a[64:65], v56 offset:8192
  ds_read_b64_tr_b16 a[66:67], v56 offset:9216
  s_waitcnt lgkmcnt(14)
  v_mfma_f32_32x32x16_bf16 v[96:111], a[40:43], a[96:99], v[96:111]
  s_add_u32 m0, s29, 49152
  s_waitcnt lgkmcnt(13)
  ds_read_b64_tr_b16 a[68:69], v57 offset:8192
  ds_read_b64_tr_b16 a[70:71], v57 offset:9216
  s_waitcnt lgkmcnt(14)
  v_mfma_f32_32x32x16_bf16 v[112:127], a[44:47], a[96:99], v[112:127]
  s_add_u32 s48, s48, 8192
  s_waitcnt lgkmcnt(13)
  ds_read_b64_tr_b16 a[72:73], v58 offset:8192
  ds_read_b64_tr_b16 a[74:75], v58 offset:9216
  s_waitcnt lgkmcnt(13)
  v_mfma_f32_32x32x16_bf16 v[64:79], a[48:51], a[100:103], v[64:79]
  buffer_load_dwordx4 v20, s[12:15], s48 offen offset:0 nt lds
  ds_read_b64_tr_b16 a[76:77], v59 offset:8192
  ds_read_b64_tr_b16 a[78:79], v59 offset:9216
  s_waitcnt lgkmcnt(13)
  v_mfma_f32_32x32x16_bf16 v[80:95], a[52:55], a[100:103], v[80:95]
  buffer_load_dwordx4 v20, s[12:15], s48 offen offset:1024 nt lds
  s_waitcnt lgkmcnt(12)
  ds_read_b128 a[108:111], v63 offset:0
  ds_read_b64_tr_b16 a[80:81], v56 offset:12288
  ds_read_b64_tr_b16 a[82:83], v56 offset:13312
  s_waitcnt lgkmcnt(14)
  v_mfma_f32_32x32x16_bf16 v[96:111], a[56:59], a[100:103], v[96:111]
  buffer_load_dwordx4 v20, s[12:15], s48 offen offset:2048 nt lds
  s_waitcnt lgkmcnt(13)
  ds_read_b64_tr_b16 a[84:85], v57 offset:12288
  ds_read_b64_tr_b16 a[86:87], v57 offset:13312
  s_waitcnt lgkmcnt(14)
  v_mfma_f32_32x32x16_bf16 v[112:127], a[60:63], a[100:103], v[112:127]
  buffer_load_dwordx4 v20, s[12:15], s48 offen offset:3072 nt lds
  s_waitcnt lgkmcnt(13)
  ds_read_b64_tr_b16 a[88:89], v58 offset:12288
  ds_read_b64_tr_b16 a[90:91], v58 offset:13312
  s_waitcnt lgkmcnt(13)
  v_mfma_f32_32x32x16_bf16 v[64:79], a[64:67], a[104:107], v[64:79]
  ds_read_b64_tr_b16 a[92:93], v59 offset:12288
  ds_read_b64_tr_b16 a[94:95], v59 offset:13312
  s_waitcnt lgkmcnt(13)
  v_mfma_f32_32x32x16_bf16 v[80:95], a[68:71], a[104:107], v[80:95]
  s_waitcnt lgkmcnt(11)
  v_mfma_f32_32x32x16_bf16 v[96:111], a[72:75], a[104:107], v[96:111]
  s_waitcnt lgkmcnt(9)
  v_mfma_f32_32x32x16_bf16 v[112:127], a[76:79], a[104:107], v[112:127]
  s_sub_u32 s55, s97, s29
  v_add_u32 v233, s55, v24
  v_add_u32 v234, s55, v25
  v_add_u32 v235, s55, v26
  v_add_u32 v236, s55, v27
  v_add_u32 v237, s55, v28
  v_add_u32 v238, s55, v29
  v_add_u32 v239, s55, v30
  v_add_u32 v240, s55, v31
  s_waitcnt vmcnt(63) lgkmcnt(0)
  s_barrier
  ds_read_b128 a[32:35], v233
  ds_read_b128 a[36:39], v234
  ds_read_b128 a[40:43], v235
  ds_read_b128 a[44:47], v236
  ds_read_b128 a[48:51], v237
  ds_read_b128 a[52:55], v238
  ds_read_b128 a[56:59], v239
  ds_read_b128 a[60:63], v240
  v_mfma_f32_32x32x16_bf16 v[64:79], a[80:83], a[108:111], v[64:79]
  s_add_u32 m0, s29, 81920
  s_add_u32 s47, s47, 8192
  buffer_load_dwordx4 v16, s[8:11], s47 offen offset:0 nt lds
  v_mfma_f32_32x32x16_bf16 v[80:95], a[84:87], a[108:111], v[80:95]
  buffer_load_dwordx4 v17, s[8:11], s47 offen offset:1024 nt lds
  buffer_load_dwordx4 v18, s[8:11], s47 offen offset:2048 nt lds
  buffer_load_dwordx4 v19, s[8:11], s47 offen offset:3072 nt lds
  v_mfma_f32_32x32x16_bf16 v[96:111], a[88:91], a[108:111], v[96:111]
  s_add_u32 m0, s29, 90112
  s_add_u32 s48, s48, 8192
  buffer_load_dwordx4 v20, s[12:15], s48 offen offset:0 nt lds
  v_mfma_f32_32x32x16_bf16 v[112:127], a[92:95], a[108:111], v[112:127]
  buffer_load_dwordx4 v20, s[12:15], s48 offen offset:1024 nt lds
  buffer_load_dwordx4 v20, s[12:15], s48 offen offset:2048 nt lds
  buffer_load_dwordx4 v20, s[12:15], s48 offen offset:3072 nt lds
  s_mov_b32 s16, s36
  s_and_b32 s17, s37, 0xffff
  s_mov_b32 s18, 0x480000
  s_mov_b32 s19, 0x20000
  s_mov_b32 s20, s38
  s_and_b32 s21, s39, 0xffff
  s_mov_b32 s22, 0x120000
  s_mov_b32 s23, 0x20000
  v_mov_b32 v2, 0x3e0293ee
  v_mov_b32 v3, 0x3e0293ee
  s_sub_u32 s55, s98, s29
  v_add_u32 v233, s55, v24
  v_add_u32 v234, s55, v25
  v_add_u32 v235, s55, v26
  v_add_u32 v236, s55, v27
  v_add_u32 v237, s55, v28
  v_add_u32 v238, s55, v29
  v_add_u32 v239, s55, v30
  v_add_u32 v240, s55, v31
  s_nop 1
  v_pk_mul_f32 v[64:65], v[64:65], v[2:3]
  v_pk_mul_f32 v[66:67], v[66:67], v[2:3]
  v_pk_mul_f32 v[68:69], v[68:69], v[2:3]
  v_pk_mul_f32 v[70:71], v[70:71], v[2:3]
  v_cvt_pk_bf16_f32 v176, v64, v65
  v_cvt_pk_bf16_f32 v177, v66, v67
  v_cvt_pk_bf16_f32 v178, v68, v69
  v_cvt_pk_bf16_f32 v179, v70, v71
  v_pk_mul_f32 v[72:73], v[72:73], v[2:3]
  v_pk_mul_f32 v[74:75], v[74:75], v[2:3]
  v_pk_mul_f32 v[76:77], v[76:77], v[2:3]
  v_pk_mul_f32 v[78:79], v[78:79], v[2:3]
  v_cvt_pk_bf16_f32 v180, v72, v73
  v_cvt_pk_bf16_f32 v181, v74, v75
  v_cvt_pk_bf16_f32 v182, v76, v77
  v_cvt_pk_bf16_f32 v183, v78, v79
  v_pk_mul_f32 v[80:81], v[80:81], v[2:3]
  v_pk_mul_f32 v[82:83], v[82:83], v[2:3]
  v_pk_mul_f32 v[84:85], v[84:85], v[2:3]
  v_pk_mul_f32 v[86:87], v[86:87], v[2:3]
  v_cvt_pk_bf16_f32 v184, v80, v81
  v_cvt_pk_bf16_f32 v185, v82, v83
  v_cvt_pk_bf16_f32 v186, v84, v85
  v_cvt_pk_bf16_f32 v187, v86, v87
  v_pk_mul_f32 v[88:89], v[88:89], v[2:3]
  v_pk_mul_f32 v[90:91], v[90:91], v[2:3]
  v_pk_mul_f32 v[92:93], v[92:93], v[2:3]
  v_pk_mul_f32 v[94:95], v[94:95], v[2:3]
  v_cvt_pk_bf16_f32 v188, v88, v89
  v_cvt_pk_bf16_f32 v189, v90, v91
  v_cvt_pk_bf16_f32 v190, v92, v93
  v_cvt_pk_bf16_f32 v191, v94, v95
  v_pk_mul_f32 v[96:97], v[96:97], v[2:3]
  v_pk_mul_f32 v[98:99], v[98:99], v[2:3]
  v_pk_mul_f32 v[100:101], v[100:101], v[2:3]
  v_pk_mul_f32 v[102:103], v[102:103], v[2:3]
  v_cvt_pk_bf16_f32 v192, v96, v97
  v_cvt_pk_bf16_f32 v193, v98, v99
  v_cvt_pk_bf16_f32 v194, v100, v101
  v_cvt_pk_bf16_f32 v195, v102, v103
  v_pk_mul_f32 v[104:105], v[104:105], v[2:3]
  v_pk_mul_f32 v[106:107], v[106:107], v[2:3]
  v_pk_mul_f32 v[108:109], v[108:109], v[2:3]
  v_pk_mul_f32 v[110:111], v[110:111], v[2:3]
  v_cvt_pk_bf16_f32 v196, v104, v105
  v_cvt_pk_bf16_f32 v197, v106, v107
  v_cvt_pk_bf16_f32 v198, v108, v109
  v_cvt_pk_bf16_f32 v199, v110, v111
  v_pk_mul_f32 v[112:113], v[112:113], v[2:3]
  v_pk_mul_f32 v[114:115], v[114:115], v[2:3]
  v_pk_mul_f32 v[116:117], v[116:117], v[2:3]
  v_pk_mul_f32 v[118:119], v[118:119], v[2:3]
  v_cvt_pk_bf16_f32 v200, v112, v113
  v_cvt_pk_bf16_f32 v201, v114, v115
  v_cvt_pk_bf16_f32 v202, v116, v117
  v_cvt_pk_bf16_f32 v203, v118, v119
  v_pk_mul_f32 v[120:121], v[120:121], v[2:3]
  v_pk_mul_f32 v[122:123], v[122:123], v[2:3]
  v_pk_mul_f32 v[124:125], v[124:125], v[2:3]
  v_pk_mul_f32 v[126:127], v[126:127], v[2:3]
  v_cvt_pk_bf16_f32 v204, v120, v121
  v_cvt_pk_bf16_f32 v205, v122, v123
  v_cvt_pk_bf16_f32 v206, v124, v125
  v_cvt_pk_bf16_f32 v207, v126, v127
  s_waitcnt vmcnt(60) lgkmcnt(0)
  s_barrier
  v_mfma_f32_32x32x16_bf16 v[128:143], a[32:35], v[176:179], v[208:223]
  v_mfma_f32_32x32x16_bf16 v[128:143], a[36:39], v[180:183], v[128:143]
  v_mfma_f32_32x32x16_bf16 v[128:143], a[40:43], v[184:187], v[128:143]
  v_mfma_f32_32x32x16_bf16 v[128:143], a[44:47], v[188:191], v[128:143]
  v_mfma_f32_32x32x16_bf16 v[128:143], a[48:51], v[192:195], v[128:143]
  v_mfma_f32_32x32x16_bf16 v[128:143], a[52:55], v[196:199], v[128:143]
  v_mfma_f32_32x32x16_bf16 v[128:143], a[56:59], v[200:203], v[128:143]
  v_mfma_f32_32x32x16_bf16 v[128:143], a[60:63], v[204:207], v[128:143]
  ds_read_b128 a[32:35], v233 offset:0
  ds_read_b128 a[36:39], v234 offset:0
  ds_read_b128 a[40:43], v235 offset:0
  ds_read_b128 a[44:47], v236 offset:0
  ds_read_b128 a[48:51], v237 offset:0
  ds_read_b128 a[52:55], v238 offset:0
  ds_read_b128 a[56:59], v239 offset:0
  ds_read_b128 a[60:63], v240 offset:0
  s_sub_u32 s55, s99, s29
  v_add_u32 v233, s55, v24
  v_add_u32 v234, s55, v25
  v_add_u32 v235, s55, v26
  v_add_u32 v236, s55, v27
  v_add_u32 v237, s55, v28
  v_add_u32 v238, s55, v29
  v_add_u32 v239, s55, v30
  v_add_u32 v240, s55, v31
  s_sub_u32 s55, s100, s29
  s_sub_u32 s55, s55, 8192
  v_add_u32 v241, s55, v32
  v_add_u32 v242, s55, v33
  v_add_u32 v243, s55, v34
  v_add_u32 v244, s55, v35
  v_max3_f32 v168, v128, v129, v130
  v_max3_f32 v169, v131, v132, v133
  v_max3_f32 v170, v134, v135, v136
  v_max3_f32 v171, v137, v138, v139
  v_max3_f32 v172, v140, v141, v142
  v_max3_f32 v168, v168, v169, v170
  v_max3_f32 v171, v171, v172, v143
  v_max_f32 v168, v168, v171
  v_mov_b32 v169, v168
  s_nop 1
  v_permlane32_swap_b32 v168, v169
  v_max_f32 v168, v168, v169
  v_sub_f32 v208, v208, v168
  v_sub_f32 v128, v128, v168
  v_sub_f32 v129, v129, v168
  v_sub_f32 v130, v130, v168
  v_sub_f32 v131, v131, v168
  v_sub_f32 v132, v132, v168
  v_sub_f32 v133, v133, v168
  v_sub_f32 v134, v134, v168
  v_sub_f32 v135, v135, v168
  v_sub_f32 v136, v136, v168
  v_sub_f32 v137, v137, v168
  v_sub_f32 v138, v138, v168
  v_sub_f32 v139, v139, v168
  v_sub_f32 v140, v140, v168
  v_sub_f32 v141, v141, v168
  v_sub_f32 v142, v142, v168
  v_sub_f32 v143, v143, v168
  v_mov_b32 v209, v208
  v_mov_b32 v210, v208
  v_mov_b32 v211, v208
  v_mov_b32 v212, v208
  v_mov_b32 v213, v208
  v_mov_b32 v214, v208
  v_mov_b32 v215, v208
  v_mov_b32 v216, v208
  v_mov_b32 v217, v208
  v_mov_b32 v218, v208
  v_mov_b32 v219, v208
  v_mov_b32 v220, v208
  v_mov_b32 v221, v208
  v_mov_b32 v222, v208
  v_mov_b32 v223, v208
  s_nop 1
  s_waitcnt vmcnt(34) lgkmcnt(0)
  s_barrier
  v_mfma_f32_32x32x16_bf16 v[144:159], a[32:35], v[176:179], v[208:223]
  ds_read_b64_tr_b16 a[64:65], v241 offset:0
  ds_read_b64_tr_b16 a[66:67], v241 offset:2048
  ds_read_b64_tr_b16 a[68:69], v242 offset:0
  ds_read_b64_tr_b16 a[70:71], v242 offset:2048
  v_exp_f32 v128, v128
  v_exp_f32 v129, v129
  v_mfma_f32_32x32x16_bf16 v[144:159], a[36:39], v[180:183], v[144:159]
  ds_read_b64_tr_b16 a[72:73], v243 offset:0
  ds_read_b64_tr_b16 a[74:75], v243 offset:2048
  ds_read_b64_tr_b16 a[76:77], v244 offset:0
  ds_read_b64_tr_b16 a[78:79], v244 offset:2048
  v_exp_f32 v130, v130
  v_exp_f32 v131, v131
  v_mfma_f32_32x32x16_bf16 v[144:159], a[40:43], v[184:187], v[144:159]
  ds_read_b64_tr_b16 a[80:81], v241 offset:4096
  ds_read_b64_tr_b16 a[82:83], v241 offset:6144
  ds_read_b64_tr_b16 a[84:85], v242 offset:4096
  ds_read_b64_tr_b16 a[86:87], v242 offset:6144
  v_cvt_pk_bf16_f32 v160, v128, v129
  v_exp_f32 v132, v132
  v_mfma_f32_32x32x16_bf16 v[144:159], a[44:47], v[188:191], v[144:159]
  s_waitcnt lgkmcnt(8)
  ds_read_b64_tr_b16 a[88:89], v243 offset:4096
  ds_read_b64_tr_b16 a[90:91], v243 offset:6144
  ds_read_b64_tr_b16 a[92:93], v244 offset:4096
  ds_read_b64_tr_b16 a[94:95], v244 offset:6144
  v_exp_f32 v133, v133
  v_mfma_f32_32x32x16_bf16 v[144:159], a[48:51], v[192:195], v[144:159]
  v_cvt_pk_bf16_f32 v161, v130, v131
  v_exp_f32 v134, v134
  v_exp_f32 v135, v135
  v_cvt_pk_bf16_f32 v162, v132, v133
  v_exp_f32 v136, v136
  v_mfma_f32_32x32x16_bf16 v[144:159], a[52:55], v[196:199], v[144:159]
  v_exp_f32 v137, v137
  v_cvt_pk_bf16_f32 v163, v134, v135
  v_exp_f32 v138, v138
  v_exp_f32 v139, v139
  v_mfma_f32_32x32x16_bf16 v[144:159], a[56:59], v[200:203], v[144:159]
  v_cvt_pk_bf16_f32 v164, v136, v137
  v_exp_f32 v140, v140
  v_exp_f32 v141, v141
  v_cvt_pk_bf16_f32 v165, v138, v139
  v_mfma_f32_32x32x16_bf16 v[144:159], a[60:63], v[204:207], v[144:159]
  v_exp_f32 v142, v142
  v_exp_f32 v143, v143
  v_cvt_pk_bf16_f32 v166, v140, v141
  s_nop 0
  v_cvt_pk_bf16_f32 v167, v142, v143
  s_waitcnt lgkmcnt(8)
  v_mfma_f32_32x32x16_bf16 v[64:79], a[64:67], v[160:163], 0
  ds_read_b128 a[32:35], v233 offset:0
  ds_read_b128 a[36:39], v234 offset:0
  v_add_f32 v10, v10, v128
  v_add_f32 v10, v10, v129
  v_add_f32 v10, v10, v130
  v_mfma_f32_32x32x16_bf16 v[80:95], a[68:71], v[160:163], 0
  ds_read_b128 a[40:43], v235 offset:0
  ds_read_b128 a[44:47], v236 offset:0
  v_add_f32 v10, v10, v131
  v_add_f32 v10, v10, v132
  v_mfma_f32_32x32x16_bf16 v[96:111], a[72:75], v[160:163], 0
  v_add_f32 v10, v10, v133
  v_add_f32 v10, v10, v134
  v_add_f32 v10, v10, v135
  v_add_f32 v10, v10, v136
  v_add_f32 v10, v10, v137
  v_mfma_f32_32x32x16_bf16 v[112:127], a[76:79], v[160:163], 0
  v_max3_f32 v168, v144, v145, v146
  v_add_f32 v10, v10, v138
  v_max3_f32 v169, v147, v148, v149
  v_add_f32 v10, v10, v139
  v_add_f32 v10, v10, v140
  s_waitcnt lgkmcnt(4)
  v_mfma_f32_32x32x16_bf16 v[64:79], a[80:83], v[164:167], v[64:79]
  ds_read_b128 a[48:51], v237 offset:0
  ds_read_b128 a[52:55], v238 offset:0
  v_add_f32 v10, v10, v141
  v_add_f32 v10, v10, v142
  v_add_f32 v10, v10, v143
  v_mfma_f32_32x32x16_bf16 v[80:95], a[84:87], v[164:167], v[80:95]
  ds_read_b128 a[56:59], v239 offset:0
  ds_read_b128 a[60:63], v240 offset:0
  v_max3_f32 v170, v150, v151, v152
  v_max3_f32 v171, v153, v154, v155
  v_mfma_f32_32x32x16_bf16 v[96:111], a[88:91], v[164:167], v[96:111]
  v_max3_f32 v172, v156, v157, v158
  v_max3_f32 v168, v168, v169, v170
  v_max3_f32 v171, v171, v172, v159
  v_max_f32 v168, v168, v171
  v_mov_b32 v169, v168
  v_mfma_f32_32x32x16_bf16 v[112:127], a[92:95], v[164:167], v[112:127]
  s_nop 1
  v_permlane32_swap_b32 v168, v169
  v_max_f32 v168, v168, v169
  v_cmp_lt_f32 vcc, s50, v168
  s_cbranch_vccnz L_resc_40
L_back_41:
  s_mov_b32 s46, 6
L_loopB:
  s_waitcnt vmcnt(16) lgkmcnt(0)
  s_barrier
  v_mfma_f32_32x32x16_bf16 v[128:143], a[32:35], v[176:179], v[208:223]
  ds_read_b64_tr_b16 a[64:65], v32 offset:0
  ds_read_b64_tr_b16 a[66:67], v32 offset:2048
  ds_read_b64_tr_b16 a[68:69], v33 offset:0
  ds_read_b64_tr_b16 a[70:71], v33 offset:2048
  v_exp_f32 v144, v144
  s_add_u32 m0, s29, 122880
  v_exp_f32 v145, v145
  v_mfma_f32_32x32x16_bf16 v[128:143], a[36:39], v[180:183], v[128:143]
  ds_read_b64_tr_b16 a[72:73], v34 offset:0
  ds_read_b64_tr_b16 a[74:75], v34 offset:2048
  ds_read_b64_tr_b16 a[76:77], v35 offset:0
  ds_read_b64_tr_b16 a[78:79], v35 offset:2048
  v_exp_f32 v146, v146
  v_exp_f32 v147, v147
  v_mfma_f32_32x32x16_bf16 v[128:143], a[40:43], v[184:187], v[128:143]
  ds_read_b64_tr_b16 a[80:81], v32 offset:4096
  ds_read_b64_tr_b16 a[82:83], v32 offset:6144
  ds_read_b64_tr_b16 a[84:85], v33 offset:4096
  ds_read_b64_tr_b16 a[86:87], v33 offset:6144
  v_cvt_pk_bf16_f32 v160, v144, v145
  s_add_u32 s47, s47, 8192
  v_exp_f32 v148, v148
  v_mfma_f32_32x32x16_bf16 v[128:143], a[44:47], v[188:191], v[128:143]
  s_waitcnt lgkmcnt(8)
  ds_read_b64_tr_b16 a[88:89], v34 offset:4096
  ds_read_b64_tr_b16 a[90:91], v34 offset:6144
  ds_read_b64_tr_b16 a[92:93], v35 offset:4096
  ds_read_b64_tr_b16 a[94:95], v35 offset:6144
  v_exp_f32 v149, v149
  v_mfma_f32_32x32x16_bf16 v[128:143], a[48:51], v[192:195], v[128:143]
  v_cvt_pk_bf16_f32 v161, v146, v147
  v_exp_f32 v150, v150
  buffer_load_dwordx4 v16, s[8:11], s47 offen offset:0 nt lds
  v_exp_f32 v151, v151
  v_cvt_pk_bf16_f32 v162, v148, v149
  v_exp_f32 v152, v152
  v_mfma_f32_32x32x16_bf16 v[128:143], a[52:55], v[196:199], v[128:143]
  v_exp_f32 v153, v153
  buffer_load_dwordx4 v17, s[8:11], s47 offen offset:1024 nt lds
  v_cvt_pk_bf16_f32 v163, v150, v151
  v_exp_f32 v154, v154
  v_exp_f32 v155, v155
  v_mfma_f32_32x32x16_bf16 v[128:143], a[56:59], v[200:203], v[128:143]
  v_cvt_pk_bf16_f32 v164, v152, v153
  buffer_load_dwordx4 v18, s[8:11], s47 offen offset:2048 nt lds
  v_exp_f32 v156, v156
  v_exp_f32 v157, v157
  v_cvt_pk_bf16_f32 v165, v154, v155
  v_mfma_f32_32x32x16_bf16 v[128:143], a[60:63], v[204:207], v[128:143]
  v_exp_f32 v158, v158
  buffer_load_dwordx4 v19, s[8:11], s47 offen offset:3072 nt lds
  v_exp_f32 v159, v159
  v_cvt_pk_bf16_f32 v166, v156, v157
  s_nop 0
  v_cvt_pk_bf16_f32 v167, v158, v159
  s_waitcnt lgkmcnt(8)
  v_mfma_f32_32x32x16_bf16 v[64:79], a[64:67], v[160:163], v[64:79]
  ds_read_b128 a[32:35], v24 offset:0
  ds_read_b128 a[36:39], v25 offset:0
  v_add_f32 v10, v10, v144
  v_add_f32 v10, v10, v145
  s_add_u32 m0, s29, 131072
  v_add_f32 v10, v10, v146
  v_mfma_f32_32x32x16_bf16 v[80:95], a[68:71], v[160:163], v[80:95]
  ds_read_b128 a[40:43], v26 offset:0
  ds_read_b128 a[44:47], v27 offset:0
  v_add_f32 v10, v10, v147
  v_add_f32 v10, v10, v148
  v_add_f32 v10, v10, v149
  v_mfma_f32_32x32x16_bf16 v[96:111], a[72:75], v[160:163], v[96:111]
  v_add_f32 v10, v10, v150
  s_add_u32 s48, s48, 8192
  v_add_f32 v10, v10, v151
  v_add_f32 v10, v10, v152
  buffer_load_dwordx4 v20, s[12:15], s48 offen offset:0 nt lds
  v_mfma_f32_32x32x16_bf16 v[112:127], a[76:79], v[160:163], v[112:127]
  v_add_f32 v10, v10, v153
  v_max3_f32 v168, v128, v129, v130
  v_add_f32 v10, v10, v154
  v_max3_f32 v169, v131, v132, v133
  v_add_f32 v10, v10, v155
  v_add_f32 v10, v10, v156
  s_waitcnt lgkmcnt(4)
  v_mfma_f32_32x32x16_bf16 v[64:79], a[80:83], v[164:167], v[64:79]
  ds_read_b128 a[48:51], v28 offset:0
  ds_read_b128 a[52:55], v29 offset:0
  v_add_f32 v10, v10, v157
  v_add_f32 v10, v10, v158
  v_add_f32 v10, v10, v159
  v_mfma_f32_32x32x16_bf16 v[80:95], a[84:87], v[164:167], v[80:95]
  ds_read_b128 a[56:59], v30 offset:0
  ds_read_b128 a[60:63], v31 offset:0
  v_max3_f32 v170, v134, v135, v136
  v_max3_f32 v171, v137, v138, v139
  v_max3_f32 v172, v140, v141, v142
  v_mfma_f32_32x32x16_bf16 v[96:111], a[88:91], v[164:167], v[96:111]
  v_max3_f32 v168, v168, v169, v170
  buffer_load_dwordx4 v20, s[12:15], s48 offen offset:1024 nt lds
  v_max3_f32 v171, v171, v172, v143
  v_max_f32 v168, v168, v171
  buffer_load_dwordx4 v20, s[12:15], s48 offen offset:2048 nt lds
  v_mov_b32 v169, v168
  v_mfma_f32_32x32x16_bf16 v[112:127], a[92:95], v[164:167], v[112:127]
  buffer_load_dwordx4 v20, s[12:15], s48 offen offset:3072 nt lds
  s_nop 1
  v_permlane32_swap_b32 v168, v169
  v_max_f32 v168, v168, v169
  v_cmp_lt_f32 vcc, s50, v168
  s_cbranch_vccnz L_resc_42
L_back_43:
  s_waitcnt vmcnt(16) lgkmcnt(0)
  s_barrier
  v_mfma_f32_32x32x16_bf16 v[144:159], a[32:35], v[176:179], v[208:223]
  ds_read_b64_tr_b16 a[64:65], v32 offset:40960
  ds_read_b64_tr_b16 a[66:67], v32 offset:43008
  ds_read_b64_tr_b16 a[68:69], v33 offset:40960
  ds_read_b64_tr_b16 a[70:71], v33 offset:43008
  v_exp_f32 v128, v128
  s_add_u32 m0, s29, 0
  v_exp_f32 v129, v129
  v_mfma_f32_32x32x16_bf16 v[144:159], a[36:39], v[180:183], v[144:159]
  ds_read_b64_tr_b16 a[72:73], v34 offset:40960
  ds_read_b64_tr_b16 a[74:75], v34 offset:43008
  ds_read_b64_tr_b16 a[76:77], v35 offset:40960
  ds_read_b64_tr_b16 a[78:79], v35 offset:43008
  v_exp_f32 v130, v130
  v_exp_f32 v131, v131
  v_mfma_f32_32x32x16_bf16 v[144:159], a[40:43], v[184:187], v[144:159]
  ds_read_b64_tr_b16 a[80:81], v32 offset:45056
  ds_read_b64_tr_b16 a[82:83], v32 offset:47104
  ds_read_b64_tr_b16 a[84:85], v33 offset:45056
  ds_read_b64_tr_b16 a[86:87], v33 offset:47104
  v_cvt_pk_bf16_f32 v160, v128, v129
  s_add_u32 s47, s47, 8192
  v_exp_f32 v132, v132
  v_mfma_f32_32x32x16_bf16 v[144:159], a[44:47], v[188:191], v[144:159]
  s_waitcnt lgkmcnt(8)
  ds_read_b64_tr_b16 a[88:89], v34 offset:45056
  ds_read_b64_tr_b16 a[90:91], v34 offset:47104
  ds_read_b64_tr_b16 a[92:93], v35 offset:45056
  ds_read_b64_tr_b16 a[94:95], v35 offset:47104
  v_exp_f32 v133, v133
  v_mfma_f32_32x32x16_bf16 v[144:159], a[48:51], v[192:195], v[144:159]
  v_cvt_pk_bf16_f32 v161, v130, v131
  v_exp_f32 v134, v134
  buffer_load_dwordx4 v16, s[8:11], s47 offen offset:0 nt lds
  v_exp_f32 v135, v135
  v_cvt_pk_bf16_f32 v162, v132, v133
  v_exp_f32 v136, v136
  v_mfma_f32_32x32x16_bf16 v[144:159], a[52:55], v[196:199], v[144:159]
  v_exp_f32 v137, v137
  buffer_load_dwordx4 v17, s[8:11], s47 offen offset:1024 nt lds
  v_cvt_pk_bf16_f32 v163, v134, v135
  v_exp_f32 v138, v138
  v_exp_f32 v139, v139
  v_mfma_f32_32x32x16_bf16 v[144:159], a[56:59], v[200:203], v[144:159]
  v_cvt_pk_bf16_f32 v164, v136, v137
  buffer_load_dwordx4 v18, s[8:11], s47 offen offset:2048 nt lds
  v_exp_f32 v140, v140
  v_exp_f32 v141, v141
  v_cvt_pk_bf16_f32 v165, v138, v139
  v_mfma_f32_32x32x16_bf16 v[144:159], a[60:63], v[204:207], v[144:159]
  v_exp_f32 v142, v142
  buffer_load_dwordx4 v19, s[8:11], s47 offen offset:3072 nt lds
  v_exp_f32 v143, v143
  v_cvt_pk_bf16_f32 v166, v140, v141
  s_nop 0
  v_cvt_pk_bf16_f32 v167, v142, v143
  s_waitcnt lgkmcnt(8)
  v_mfma_f32_32x32x16_bf16 v[64:79], a[64:67], v[160:163], v[64:79]
  ds_read_b128 a[32:35], v24 offset:40960
  ds_read_b128 a[36:39], v25 offset:40960
  v_add_f32 v10, v10, v128
  v_add_f32 v10, v10, v129
  s_add_u32 m0, s29, 8192
  v_add_f32 v10, v10, v130
  v_mfma_f32_32x32x16_bf16 v[80:95], a[68:71], v[160:163], v[80:95]
  ds_read_b128 a[40:43], v26 offset:40960
  ds_read_b128 a[44:47], v27 offset:40960
  v_add_f32 v10, v10, v131
  v_add_f32 v10, v10, v132
  v_add_f32 v10, v10, v133
  v_mfma_f32_32x32x16_bf16 v[96:111], a[72:75], v[160:163], v[96:111]
  v_add_f32 v10, v10, v134
  s_add_u32 s48, s48, 8192
  v_add_f32 v10, v10, v135
  v_add_f32 v10, v10, v136
  buffer_load_dwordx4 v20, s[12:15], s48 offen offset:0 nt lds
  v_mfma_f32_32x32x16_bf16 v[112:127], a[76:79], v[160:163], v[112:127]
  v_add_f32 v10, v10, v137
  v_max3_f32 v168, v144, v145, v146
  v_add_f32 v10, v10, v138
  v_max3_f32 v169, v147, v148, v149
  v_add_f32 v10, v10, v139
  v_add_f32 v10, v10, v140
  s_waitcnt lgkmcnt(4)
  v_mfma_f32_32x32x16_bf16 v[64:79], a[80:83], v[164:167], v[64:79]
  ds_read_b128 a[48:51], v28 offset:40960
  ds_read_b128 a[52:55], v29 offset:40960
  v_add_f32 v10, v10, v141
  v_add_f32 v10, v10, v142
  v_add_f32 v10, v10, v143
  v_mfma_f32_32x32x16_bf16 v[80:95], a[84:87], v[164:167], v[80:95]
  ds_read_b128 a[56:59], v30 offset:40960
  ds_read_b128 a[60:63], v31 offset:40960
  v_max3_f32 v170, v150, v151, v152
  v_max3_f32 v171, v153, v154, v155
  v_max3_f32 v172, v156, v157, v158
  v_mfma_f32_32x32x16_bf16 v[96:111], a[88:91], v[164:167], v[96:111]
  v_max3_f32 v168, v168, v169, v170
  buffer_load_dwordx4 v20, s[12:15], s48 offen offset:1024 nt lds
  v_max3_f32 v171, v171, v172, v159
  v_max_f32 v168, v168, v171
  buffer_load_dwordx4 v20, s[12:15], s48 offen offset:2048 nt lds
  v_mov_b32 v169, v168
  v_mfma_f32_32x32x16_bf16 v[112:127], a[92:95], v[164:167], v[112:127]
  buffer_load_dwordx4 v20, s[12:15], s48 offen offset:3072 nt lds
  s_nop 1
  v_permlane32_swap_b32 v168, v169
  v_max_f32 v168, v168, v169
  v_cmp_lt_f32 vcc, s50, v168
  s_cbranch_vccnz L_resc_44
L_back_45:
  s_waitcnt vmcnt(16) lgkmcnt(0)
  s_barrier
  v_mfma_f32_32x32x16_bf16 v[128:143], a[32:35], v[176:179], v[208:223]
  ds_read_b64_tr_b16 a[64:65], v44 offset:0
  ds_read_b64_tr_b16 a[66:67], v44 offset:2048
  ds_read_b64_tr_b16 a[68:69], v45 offset:0
  ds_read_b64_tr_b16 a[70:71], v45 offset:2048
  v_exp_f32 v144, v144
  s_add_u32 m0, s29, 40960
  v_exp_f32 v145, v145
  v_mfma_f32_32x32x16_bf16 v[128:143], a[36:39], v[180:183], v[128:143]
  ds_read_b64_tr_b16 a[72:73], v46 offset:0
  ds_read_b64_tr_b16 a[74:75], v46 offset:2048
  ds_read_b64_tr_b16 a[76:77], v47 offset:0
  ds_read_b64_tr_b16 a[78:79], v47 offset:2048
  v_exp_f32 v146, v146
  v_exp_f32 v147, v147
  v_mfma_f32_32x32x16_bf16 v[128:143], a[40:43], v[184:187], v[128:143]
  ds_read_b64_tr_b16 a[80:81], v44 offset:4096
  ds_read_b64_tr_b16 a[82:83], v44 offset:6144
  ds_read_b64_tr_b16 a[84:85], v45 offset:4096
  ds_read_b64_tr_b16 a[86:87], v45 offset:6144
  v_cvt_pk_bf16_f32 v160, v144, v145
  s_add_u32 s47, s47, 8192
  v_exp_f32 v148, v148
  v_mfma_f32_32x32x16_bf16 v[128:143], a[44:47], v[188:191], v[128:143]
  s_waitcnt lgkmcnt(8)
  ds_read_b64_tr_b16 a[88:89], v46 offset:4096
  ds_read_b64_tr_b16 a[90:91], v46 offset:6144
  ds_read_b64_tr_b16 a[92:93], v47 offset:4096
  ds_read_b64_tr_b16 a[94:95], v47 offset:6144
  v_exp_f32 v149, v149
  v_mfma_f32_32x32x16_bf16 v[128:143], a[48:51], v[192:195], v[128:143]
  v_cvt_pk_bf16_f32 v161, v146, v147
  v_exp_f32 v150, v150
  buffer_load_dwordx4 v16, s[8:11], s47 offen offset:0 nt lds
  v_exp_f32 v151, v151
  v_cvt_pk_bf16_f32 v162, v148, v149
  v_exp_f32 v152, v152
  v_mfma_f32_32x32x16_bf16 v[128:143], a[52:55], v[196:199], v[128:143]
  v_exp_f32 v153, v153
  buffer_load_dwordx4 v17, s[8:11], s47 offen offset:1024 nt lds
  v_cvt_pk_bf16_f32 v163, v150, v151
  v_exp_f32 v154, v154
  v_exp_f32 v155, v155
  v_mfma_f32_32x32x16_bf16 v[128:143], a[56:59], v[200:203], v[128:143]
  v_cvt_pk_bf16_f32 v164, v152, v153
  buffer_load_dwordx4 v18, s[8:11], s47 offen offset:2048 nt lds
  v_exp_f32 v156, v156
  v_exp_f32 v157, v157
  v_cvt_pk_bf16_f32 v165, v154, v155
  v_mfma_f32_32x32x16_bf16 v[128:143], a[60:63], v[204:207], v[128:143]
  v_exp_f32 v158, v158
  buffer_load_dwordx4 v19, s[8:11], s47 offen offset:3072 nt lds
  v_exp_f32 v159, v159
  v_cvt_pk_bf16_f32 v166, v156, v157
  s_nop 0
  v_cvt_pk_bf16_f32 v167, v158, v159
  s_waitcnt lgkmcnt(8)
  v_mfma_f32_32x32x16_bf16 v[64:79], a[64:67], v[160:163], v[64:79]
  ds_read_b128 a[32:35], v36 offset:0
  ds_read_b128 a[36:39], v37 offset:0
  v_add_f32 v10, v10, v144
  v_add_f32 v10, v10, v145
  s_add_u32 m0, s29, 49152
  v_add_f32 v10, v10, v146
  v_mfma_f32_32x32x16_bf16 v[80:95], a[68:71], v[160:163], v[80:95]
  ds_read_b128 a[40:43], v38 offset:0
  ds_read_b128 a[44:47], v39 offset:0
  v_add_f32 v10, v10, v147
  v_add_f32 v10, v10, v148
  v_add_f32 v10, v10, v149
  v_mfma_f32_32x32x16_bf16 v[96:111], a[72:75], v[160:163], v[96:111]
  v_add_f32 v10, v10, v150
  s_add_u32 s48, s48, 8192
  v_add_f32 v10, v10, v151
  v_add_f32 v10, v10, v152
  buffer_load_dwordx4 v20, s[12:15], s48 offen offset:0 nt lds
  v_mfma_f32_32x32x16_bf16 v[112:127], a[76:79], v[160:163], v[112:127]
  v_add_f32 v10, v10, v153
  v_max3_f32 v168, v128, v129, v130
  v_add_f32 v10, v10, v154
  v_max3_f32 v169, v131, v132, v133
  v_add_f32 v10, v10, v155
  v_add_f32 v10, v10, v156
  s_waitcnt lgkmcnt(4)
  v_mfma_f32_32x32x16_bf16 v[64:79], a[80:83], v[164:167], v[64:79]
  ds_read_b128 a[48:51], v40 offset:0
  ds_read_b128 a[52:55], v41 offset:0
  v_add_f32 v10, v10, v157
  v_add_f32 v10, v10, v158
  v_add_f32 v10, v10, v159
  v_mfma_f32_32x32x16_bf16 v[80:95], a[84:87], v[164:167], v[80:95]
  ds_read_b128 a[56:59], v42 offset:0
  ds_read_b128 a[60:63], v43 offset:0
  v_max3_f32 v170, v134, v135, v136
  v_max3_f32 v171, v137, v138, v139
  v_max3_f32 v172, v140, v141, v142
  v_mfma_f32_32x32x16_bf16 v[96:111], a[88:91], v[164:167], v[96:111]
  v_max3_f32 v168, v168, v169, v170
  buffer_load_dwordx4 v20, s[12:15], s48 offen offset:1024 nt lds
  v_max3_f32 v171, v171, v172, v143
  v_max_f32 v168, v168, v171
  buffer_load_dwordx4 v20, s[12:15], s48 offen offset:2048 nt lds
  v_mov_b32 v169, v168
  v_mfma_f32_32x32x16_bf16 v[112:127], a[92:95], v[164:167], v[112:127]
  buffer_load_dwordx4 v20, s[12:15], s48 offen offset:3072 nt lds
  s_nop 1
  v_permlane32_swap_b32 v168, v169
  v_max_f32 v168, v168, v169
  v_cmp_lt_f32 vcc, s50, v168
  s_cbranch_vccnz L_resc_46
L_back_47:
  s_waitcnt vmcnt(16) lgkmcnt(0)
  s_barrier
  v_mfma_f32_32x32x16_bf16 v[144:159], a[32:35], v[176:179], v[208:223]
  ds_read_b64_tr_b16 a[64:65], v44 offset:40960
  ds_read_b64_tr_b16 a[66:67], v44 offset:43008
  ds_read_b64_tr_b16 a[68:69], v45 offset:40960
  ds_read_b64_tr_b16 a[70:71], v45 offset:43008
  v_exp_f32 v128, v128
  s_add_u32 m0, s29, 81920
  v_exp_f32 v129, v129
  v_mfma_f32_32x32x16_bf16 v[144:159], a[36:39], v[180:183], v[144:159]
  ds_read_b64_tr_b16 a[72:73], v46 offset:40960
  ds_read_b64_tr_b16 a[74:75], v46 offset:43008
  ds_read_b64_tr_b16 a[76:77], v47 offset:40960
  ds_read_b64_tr_b16 a[78:79], v47 offset:43008
  v_exp_f32 v130, v130
  v_exp_f32 v131, v131
  v_mfma_f32_32x32x16_bf16 v[144:159], a[40:43], v[184:187], v[144:159]
  ds_read_b64_tr_b16 a[80:81], v44 offset:45056
  ds_read_b64_tr_b16 a[82:83], v44 offset:47104
  ds_read_b64_tr_b16 a[84:85], v45 offset:45056
  ds_read_b64_tr_b16 a[86:87], v45 offset:47104
  v_cvt_pk_bf16_f32 v160, v128, v129
  s_add_u32 s47, s47, 8192
  v_exp_f32 v132, v132
  v_mfma_f32_32x32x16_bf16 v[144:159], a[44:47], v[188:191], v[144:159]
  s_waitcnt lgkmcnt(8)
  ds_read_b64_tr_b16 a[88:89], v46 offset:45056
  ds_read_b64_tr_b16 a[90:91], v46 offset:47104
  ds_read_b64_tr_b16 a[92:93], v47 offset:45056
  ds_read_b64_tr_b16 a[94:95], v47 offset:47104
  v_exp_f32 v133, v133
  v_mfma_f32_32x32x16_bf16 v[144:159], a[48:51], v[192:195], v[144:159]
  v_cvt_pk_bf16_f32 v161, v130, v131
  v_exp_f32 v134, v134
  buffer_load_dwordx4 v16, s[8:11], s47 offen offset:0 nt lds
  v_exp_f32 v135, v135
  v_cvt_pk_bf16_f32 v162, v132, v133
  v_exp_f32 v136, v136
  v_mfma_f32_32x32x16_bf16 v[144:159], a[52:55], v[196:199], v[144:159]
  v_exp_f32 v137, v137
  buffer_load_dwordx4 v17, s[8:11], s47 offen offset:1024 nt lds
  v_cvt_pk_bf16_f32 v163, v134, v135
  v_exp_f32 v138, v138
  v_exp_f32 v139, v139
  v_mfma_f32_32x32x16_bf16 v[144:159], a[56:59], v[200:203], v[144:159]
  v_cvt_pk_bf16_f32 v164, v136, v137
  buffer_load_dwordx4 v18, s[8:11], s47 offen offset:2048 nt lds
  v_exp_f32 v140, v140
  v_exp_f32 v141, v141
  v_cvt_pk_bf16_f32 v165, v138, v139
  v_mfma_f32_32x32x16_bf16 v[144:159], a[60:63], v[204:207], v[144:159]
  v_exp_f32 v142, v142
  buffer_load_dwordx4 v19, s[8:11], s47 offen offset:3072 nt lds
  v_exp_f32 v143, v143
  v_cvt_pk_bf16_f32 v166, v140, v141
  s_nop 0
  v_cvt_pk_bf16_f32 v167, v142, v143
  s_waitcnt lgkmcnt(8)
  v_mfma_f32_32x32x16_bf16 v[64:79], a[64:67], v[160:163], v[64:79]
  ds_read_b128 a[32:35], v36 offset:40960
  ds_read_b128 a[36:39], v37 offset:40960
  v_add_f32 v10, v10, v128
  v_add_f32 v10, v10, v129
  s_add_u32 m0, s29, 90112
  v_add_f32 v10, v10, v130
  v_mfma_f32_32x32x16_bf16 v[80:95], a[68:71], v[160:163], v[80:95]
  ds_read_b128 a[40:43], v38 offset:40960
  ds_read_b128 a[44:47], v39 offset:40960
  v_add_f32 v10, v10, v131
  v_add_f32 v10, v10, v132
  v_add_f32 v10, v10, v133
  v_mfma_f32_32x32x16_bf16 v[96:111], a[72:75], v[160:163], v[96:111]
  v_add_f32 v10, v10, v134
  s_add_u32 s48, s48, 8192
  v_add_f32 v10, v10, v135
  v_add_f32 v10, v10, v136
  buffer_load_dwordx4 v20, s[12:15], s48 offen offset:0 nt lds
  v_mfma_f32_32x32x16_bf16 v[112:127], a[76:79], v[160:163], v[112:127]
  v_add_f32 v10, v10, v137
  v_max3_f32 v168, v144, v145, v146
  v_add_f32 v10, v10, v138
  v_max3_f32 v169, v147, v148, v149
  v_add_f32 v10, v10, v139
  v_add_f32 v10, v10, v140
  s_waitcnt lgkmcnt(4)
  v_mfma_f32_32x32x16_bf16 v[64:79], a[80:83], v[164:167], v[64:79]
  ds_read_b128 a[48:51], v40 offset:40960
  ds_read_b128 a[52:55], v41 offset:40960
  v_add_f32 v10, v10, v141
  v_add_f32 v10, v10, v142
  v_add_f32 v10, v10, v143
  v_mfma_f32_32x32x16_bf16 v[80:95], a[84:87], v[164:167], v[80:95]
  ds_read_b128 a[56:59], v42 offset:40960
  ds_read_b128 a[60:63], v43 offset:40960
  v_max3_f32 v170, v150, v151, v152
  v_max3_f32 v171, v153, v154, v155
  v_max3_f32 v172, v156, v157, v158
  v_mfma_f32_32x32x16_bf16 v[96:111], a[88:91], v[164:167], v[96:111]
  v_max3_f32 v168, v168, v169, v170
  buffer_load_dwordx4 v20, s[12:15], s48 offen offset:1024 nt lds
  v_max3_f32 v171, v171, v172, v159
  v_max_f32 v168, v168, v171
  buffer_load_dwordx4 v20, s[12:15], s48 offen offset:2048 nt lds
  v_mov_b32 v169, v168
  v_mfma_f32_32x32x16_bf16 v[112:127], a[92:95], v[164:167], v[112:127]
  buffer_load_dwordx4 v20, s[12:15], s48 offen offset:3072 nt lds
  s_nop 1
  v_permlane32_swap_b32 v168, v169
  v_max_f32 v168, v168, v169
  v_cmp_lt_f32 vcc, s50, v168
  s_cbranch_vccnz L_resc_48
L_back_49:
  s_sub_u32 s46, s46, 1
  s_cmp_lg_u32 s46, 0
  s_cbranch_scc1 L_loopB
  s_waitcnt vmcnt(16) lgkmcnt(0)
  s_barrier
  v_mfma_f32_32x32x16_bf16 v[128:143], a[32:35], v[176:179], v[208:223]
  ds_read_b64_tr_b16 a[64:65], v32 offset:0
  ds_read_b64_tr_b16 a[66:67], v32 offset:2048
  ds_read_b64_tr_b16 a[68:69], v33 offset:0
  ds_read_b64_tr_b16 a[70:71], v33 offset:2048
  v_exp_f32 v144, v144
  s_add_u32 m0, s29, 122880
  v_exp_f32 v145, v145
  v_mfma_f32_32x32x16_bf16 v[128:143], a[36:39], v[180:183], v[128:143]
  ds_read_b64_tr_b16 a[72:73], v34 offset:0
  ds_read_b64_tr_b16 a[74:75], v34 offset:2048
  ds_read_b64_tr_b16 a[76:77], v35 offset:0
  ds_read_b64_tr_b16 a[78:79], v35 offset:2048
  v_exp_f32 v146, v146
  v_exp_f32 v147, v147
  v_mfma_f32_32x32x16_bf16 v[128:143], a[40:43], v[184:187], v[128:143]
  ds_read_b64_tr_b16 a[80:81], v32 offset:4096
  ds_read_b64_tr_b16 a[82:83], v32 offset:6144
  ds_read_b64_tr_b16 a[84:85], v33 offset:4096
  ds_read_b64_tr_b16 a[86:87], v33 offset:6144
  s_add_u32 s47, s47, 8192
  v_cvt_pk_bf16_f32 v160, v144, v145
  v_exp_f32 v148, v148
  v_mfma_f32_32x32x16_bf16 v[128:143], a[44:47], v[188:191], v[128:143]
  s_waitcnt lgkmcnt(8)
  ds_read_b64_tr_b16 a[88:89], v34 offset:4096
  ds_read_b64_tr_b16 a[90:91], v34 offset:6144
  ds_read_b64_tr_b16 a[92:93], v35 offset:4096
  ds_read_b64_tr_b16 a[94:95], v35 offset:6144
  v_exp_f32 v149, v149
  v_cvt_pk_bf16_f32 v161, v146, v147
  v_mfma_f32_32x32x16_bf16 v[128:143], a[48:51], v[192:195], v[128:143]
  buffer_load_dwordx4 v16, s[8:11], s47 offen offset:0 nt lds
  v_exp_f32 v150, v150
  v_exp_f32 v151, v151
  v_cvt_pk_bf16_f32 v162, v148, v149
  buffer_load_dwordx4 v17, s[8:11], s47 offen offset:1024 nt lds
  v_exp_f32 v152, v152
  v_mfma_f32_32x32x16_bf16 v[128:143], a[52:55], v[196:199], v[128:143]
  v_exp_f32 v153, v153
  v_cvt_pk_bf16_f32 v163, v150, v151
  v_exp_f32 v154, v154
  buffer_load_dwordx4 v18, s[8:11], s47 offen offset:2048 nt lds
  v_exp_f32 v155, v155
  v_mfma_f32_32x32x16_bf16 v[128:143], a[56:59], v[200:203], v[128:143]
  v_cvt_pk_bf16_f32 v164, v152, v153
  v_exp_f32 v156, v156
  buffer_load_dwordx4 v19, s[8:11], s47 offen offset:3072 nt lds
  v_exp_f32 v157, v157
  v_cvt_pk_bf16_f32 v165, v154, v155
  v_mfma_f32_32x32x16_bf16 v[128:143], a[60:63], v[204:207], v[128:143]
  v_exp_f32 v158, v158
  s_add_u32 m0, s29, 131072
  v_exp_f32 v159, v159
  v_cvt_pk_bf16_f32 v166, v156, v157
  s_nop 0
  v_cvt_pk_bf16_f32 v167, v158, v159
  s_waitcnt lgkmcnt(8)
  v_mfma_f32_32x32x16_bf16 v[64:79], a[64:67], v[160:163], v[64:79]
  ds_read_b128 a[32:35], v24 offset:0
  ds_read_b128 a[36:39], v25 offset:0
  v_add_f32 v10, v10, v144
  v_add_f32 v10, v10, v145
  s_add_u32 s48, s48, 8192
  v_add_f32 v10, v10, v146
  v_mfma_f32_32x32x16_bf16 v[80:95], a[68:71], v[160:163], v[80:95]
  ds_read_b128 a[40:43], v26 offset:0
  ds_read_b128 a[44:47], v27 offset:0
  v_add_f32 v10, v10, v147
  v_add_f32 v10, v10, v148
  buffer_load_dwordx4 v20, s[12:15], s48 offen offset:0 nt lds
  v_mfma_f32_32x32x16_bf16 v[96:111], a[72:75], v[160:163], v[96:111]
  v_add_f32 v10, v10, v149
  v_add_f32 v10, v10, v150
  v_add_f32 v10, v10, v151
  v_add_f32 v10, v10, v152
  buffer_load_dwordx4 v20, s[12:15], s48 offen offset:1024 nt lds
  v_add_f32 v10, v10, v153
  v_mfma_f32_32x32x16_bf16 v[112:127], a[76:79], v[160:163], v[112:127]
  v_max3_f32 v168, v128, v129, v130
  v_add_f32 v10, v10, v154
  v_max3_f32 v169, v131, v132, v133
  v_add_f32 v10, v10, v155
  buffer_load_dwordx4 v20, s[12:15], s48 offen offset:2048 nt lds
  s_waitcnt lgkmcnt(4)
  v_mfma_f32_32x32x16_bf16 v[64:79], a[80:83], v[164:167], v[64:79]
  ds_read_b128 a[48:51], v28 offset:0
  ds_read_b128 a[52:55], v29 offset:0
  v_add_f32 v10, v10, v156
  v_add_f32 v10, v10, v157
  v_add_f32 v10, v10, v158
  v_add_f32 v10, v10, v159
  v_mfma_f32_32x32x16_bf16 v[80:95], a[84:87], v[164:167], v[80:95]
  ds_read_b128 a[56:59], v30 offset:0
  ds_read_b128 a[60:63], v31 offset:0
  v_max3_f32 v170, v134, v135, v136
  v_max3_f32 v171, v137, v138, v139
  v_max3_f32 v172, v140, v141, v142
  v_mfma_f32_32x32x16_bf16 v[96:111], a[88:91], v[164:167], v[96:111]
  v_max3_f32 v168, v168, v169, v170
  buffer_load_dwordx4 v20, s[12:15], s48 offen offset:3072 nt lds
  v_max3_f32 v171, v171, v172, v143
  v_max_f32 v168, v168, v171
  v_mov_b32 v14, 0
  v_mov_b32 v169, v168
  v_mfma_f32_32x32x16_bf16 v[112:127], a[92:95], v[164:167], v[112:127]
  global_load_dwordx2 v[4:5], v14, s[34:35] sc1
  s_nop 1
  v_permlane32_swap_b32 v168, v169
  v_max_f32 v168, v168, v169
  v_cmp_lt_f32 vcc, s50, v168
  s_cbranch_vccnz L_resc_50
L_back_51:
  s_waitcnt vmcnt(17) lgkmcnt(0)
  s_barrier
  v_mfma_f32_32x32x16_bf16 v[144:159], a[32:35], v[176:179], v[208:223]
  ds_read_b64_tr_b16 a[64:65], v32 offset:40960
  ds_read_b64_tr_b16 a[66:67], v32 offset:43008
  ds_read_b64_tr_b16 a[68:69], v33 offset:40960
  ds_read_b64_tr_b16 a[70:71], v33 offset:43008
  v_exp_f32 v128, v128
  s_add_u32 m0, s29, 0
  v_exp_f32 v129, v129
  v_mfma_f32_32x32x16_bf16 v[144:159], a[36:39], v[180:183], v[144:159]
  ds_read_b64_tr_b16 a[72:73], v34 offset:40960
  ds_read_b64_tr_b16 a[74:75], v34 offset:43008
  ds_read_b64_tr_b16 a[76:77], v35 offset:40960
  ds_read_b64_tr_b16 a[78:79], v35 offset:43008
  v_exp_f32 v130, v130
  v_exp_f32 v131, v131
  v_mfma_f32_32x32x16_bf16 v[144:159], a[40:43], v[184:187], v[144:159]
  ds_read_b64_tr_b16 a[80:81], v32 offset:45056
  ds_read_b64_tr_b16 a[82:83], v32 offset:47104
  ds_read_b64_tr_b16 a[84:85], v33 offset:45056
  ds_read_b64_tr_b16 a[86:87], v33 offset:47104
  v_cvt_pk_bf16_f32 v160, v128, v129
  s_add_u32 s47, s47, 8192
  v_exp_f32 v132, v132
  v_mfma_f32_32x32x16_bf16 v[144:159], a[44:47], v[188:191], v[144:159]
  s_waitcnt lgkmcnt(8)
  ds_read_b64_tr_b16 a[88:89], v34 offset:45056
  ds_read_b64_tr_b16 a[90:91], v34 offset:47104
  ds_read_b64_tr_b16 a[92:93], v35 offset:45056
  ds_read_b64_tr_b16 a[94:95], v35 offset:47104
  v_exp_f32 v133, v133
  v_mfma_f32_32x32x16_bf16 v[144:159], a[48:51], v[192:195], v[144:159]
  v_cvt_pk_bf16_f32 v161, v130, v131
  v_exp_f32 v134, v134
  buffer_load_dwordx4 v16, s[8:11], s47 offen offset:0 nt lds
  v_exp_f32 v135, v135
  v_cvt_pk_bf16_f32 v162, v132, v133
  v_exp_f32 v136, v136
  v_mfma_f32_32x32x16_bf16 v[144:159], a[52:55], v[196:199], v[144:159]
  v_exp_f32 v137, v137
  buffer_load_dwordx4 v17, s[8:11], s47 offen offset:1024 nt lds
  v_cvt_pk_bf16_f32 v163, v134, v135
  v_exp_f32 v138, v138
  v_exp_f32 v139, v139
  v_mfma_f32_32x32x16_bf16 v[144:159], a[56:59], v[200:203], v[144:159]
  v_cvt_pk_bf16_f32 v164, v136, v137
  buffer_load_dwordx4 v18, s[8:11], s47 offen offset:2048 nt lds
  v_exp_f32 v140, v140
  v_exp_f32 v141, v141
  v_cvt_pk_bf16_f32 v165, v138, v139
  v_mfma_f32_32x32x16_bf16 v[144:159], a[60:63], v[204:207], v[144:159]
  v_exp_f32 v142, v142
  buffer_load_dwordx4 v19, s[8:11], s47 offen offset:3072 nt lds
  v_exp_f32 v143, v143
  v_cvt_pk_bf16_f32 v166, v140, v141
  s_nop 0
  v_cvt_pk_bf16_f32 v167, v142, v143
  s_waitcnt lgkmcnt(8)
  v_mfma_f32_32x32x16_bf16 v[64:79], a[64:67], v[160:163], v[64:79]
  ds_read_b128 a[32:35], v24 offset:40960
  ds_read_b128 a[36:39], v25 offset:40960
  v_add_f32 v10, v10, v128
  v_add_f32 v10, v10, v129
  s_add_u32 m0, s29, 8192
  v_add_f32 v10, v10, v130
  v_mfma_f32_32x32x16_bf16 v[80:95], a[68:71], v[160:163], v[80:95]
  ds_read_b128 a[40:43], v26 offset:40960
  ds_read_b128 a[44:47], v27 offset:40960
  v_add_f32 v10, v10, v131
  v_add_f32 v10, v10, v132
  v_add_f32 v10, v10, v133
  v_mfma_f32_32x32x16_bf16 v[96:111], a[72:75], v[160:163], v[96:111]
  v_add_f32 v10, v10, v134
  s_add_u32 s48, s48, 8192
  v_add_f32 v10, v10, v135
  v_add_f32 v10, v10, v136
  buffer_load_dwordx4 v20, s[12:15], s48 offen offset:0 nt lds
  v_mfma_f32_32x32x16_bf16 v[112:127], a[76:79], v[160:163], v[112:127]
  v_add_f32 v10, v10, v137
  v_max3_f32 v168, v144, v145, v146
  v_add_f32 v10, v10, v138
  v_max3_f32 v169, v147, v148, v149
  v_add_f32 v10, v10, v139
  v_add_f32 v10, v10, v140
  s_waitcnt lgkmcnt(4)
  v_mfma_f32_32x32x16_bf16 v[64:79], a[80:83], v[164:167], v[64:79]
  ds_read_b128 a[48:51], v28 offset:40960
  ds_read_b128 a[52:55], v29 offset:40960
  v_add_f32 v10, v10, v141
  v_add_f32 v10, v10, v142
  v_add_f32 v10, v10, v143
  v_mfma_f32_32x32x16_bf16 v[80:95], a[84:87], v[164:167], v[80:95]
  ds_read_b128 a[56:59], v30 offset:40960
  ds_read_b128 a[60:63], v31 offset:40960
  v_max3_f32 v170, v150, v151, v152
  v_max3_f32 v171, v153, v154, v155
  v_max3_f32 v172, v156, v157, v158
  v_mfma_f32_32x32x16_bf16 v[96:111], a[88:91], v[164:167], v[96:111]
  v_max3_f32 v168, v168, v169, v170
  buffer_load_dwordx4 v20, s[12:15], s48 offen offset:1024 nt lds
  v_max3_f32 v171, v171, v172, v159
  v_max_f32 v168, v168, v171
  buffer_load_dwordx4 v20, s[12:15], s48 offen offset:2048 nt lds
  v_mov_b32 v169, v168
  v_mfma_f32_32x32x16_bf16 v[112:127], a[92:95], v[164:167], v[112:127]
  buffer_load_dwordx4 v20, s[12:15], s48 offen offset:3072 nt lds
  s_nop 1
  v_permlane32_swap_b32 v168, v169
  v_max_f32 v168, v168, v169
  v_cmp_lt_f32 vcc, s50, v168
  s_cbranch_vccnz L_resc_52
L_back_53:
  s_waitcnt vmcnt(17) lgkmcnt(0)
  s_barrier
  v_mfma_f32_32x32x16_bf16 v[128:143], a[32:35], v[176:179], v[208:223]
  ds_read_b64_tr_b16 a[64:65], v44 offset:0
  ds_read_b64_tr_b16 a[66:67], v44 offset:2048
  ds_read_b64_tr_b16 a[68:69], v45 offset:0
  ds_read_b64_tr_b16 a[70:71], v45 offset:2048
  v_exp_f32 v144, v144
  s_add_u32 m0, s29, 49152
  v_exp_f32 v145, v145
  v_mfma_f32_32x32x16_bf16 v[128:143], a[36:39], v[180:183], v[128:143]
  ds_read_b64_tr_b16 a[72:73], v46 offset:0
  ds_read_b64_tr_b16 a[74:75], v46 offset:2048
  ds_read_b64_tr_b16 a[76:77], v47 offset:0
  ds_read_b64_tr_b16 a[78:79], v47 offset:2048
  v_exp_f32 v146, v146
  v_mfma_f32_32x32x16_bf16 v[128:143], a[40:43], v[184:187], v[128:143]
  ds_read_b64_tr_b16 a[80:81], v44 offset:4096
  ds_read_b64_tr_b16 a[82:83], v44 offset:6144
  ds_read_b64_tr_b16 a[84:85], v45 offset:4096
  ds_read_b64_tr_b16 a[86:87], v45 offset:6144
  v_exp_f32 v147, v147
  v_cvt_pk_bf16_f32 v160, v144, v145
  v_exp_f32 v148, v148
  v_mfma_f32_32x32x16_bf16 v[128:143], a[44:47], v[188:191], v[128:143]
  s_waitcnt lgkmcnt(8)
  ds_read_b64_tr_b16 a[88:89], v46 offset:4096
  ds_read_b64_tr_b16 a[90:91], v46 offset:6144
  ds_read_b64_tr_b16 a[92:93], v47 offset:4096
  ds_read_b64_tr_b16 a[94:95], v47 offset:6144
  v_exp_f32 v149, v149
  v_mfma_f32_32x32x16_bf16 v[128:143], a[48:51], v[192:195], v[128:143]
  v_cvt_pk_bf16_f32 v161, v146, v147
  v_exp_f32 v150, v150
  s_add_u32 s48, s48, 8192
  v_exp_f32 v151, v151
  v_cvt_pk_bf16_f32 v162, v148, v149
  v_exp_f32 v152, v152
  v_mfma_f32_32x32x16_bf16 v[128:143], a[52:55], v[196:199], v[128:143]
  v_exp_f32 v153, v153
  v_cvt_pk_bf16_f32 v163, v150, v151
  v_exp_f32 v154, v154
  v_exp_f32 v155, v155
  v_mfma_f32_32x32x16_bf16 v[128:143], a[56:59], v[200:203], v[128:143]
  v_cvt_pk_bf16_f32 v164, v152, v153
  buffer_load_dwordx4 v20, s[12:15], s48 offen offset:0 nt lds
  v_exp_f32 v156, v156
  v_exp_f32 v157, v157
  v_cvt_pk_bf16_f32 v165, v154, v155
  v_mfma_f32_32x32x16_bf16 v[128:143], a[60:63], v[204:207], v[128:143]
  v_exp_f32 v158, v158
  v_exp_f32 v159, v159
  v_cvt_pk_bf16_f32 v166, v156, v157
  s_nop 0
  v_cvt_pk_bf16_f32 v167, v158, v159
  s_waitcnt lgkmcnt(8)
  v_mfma_f32_32x32x16_bf16 v[64:79], a[64:67], v[160:163], v[64:79]
  ds_read_b128 a[32:35], v36 offset:0
  ds_read_b128 a[36:39], v37 offset:0
  v_add_f32 v10, v10, v144
  v_add_f32 v10, v10, v145
  buffer_load_dwordx4 v20, s[12:15], s48 offen offset:1024 nt lds
  v_mfma_f32_32x32x16_bf16 v[80:95], a[68:71], v[160:163], v[80:95]
  ds_read_b128 a[40:43], v38 offset:0
  ds_read_b128 a[44:47], v39 offset:0
  v_add_f32 v10, v10, v146
  v_add_f32 v10, v10, v147
  v_add_f32 v10, v10, v148
  v_mfma_f32_32x32x16_bf16 v[96:111], a[72:75], v[160:163], v[96:111]
  v_add_f32 v10, v10, v149
  v_add_f32 v10, v10, v150
  v_add_f32 v10, v10, v151
  v_add_f32 v10, v10, v152
  buffer_load_dwordx4 v20, s[12:15], s48 offen offset:2048 nt lds
  v_mfma_f32_32x32x16_bf16 v[112:127], a[76:79], v[160:163], v[112:127]
  v_add_f32 v10, v10, v153
  v_max3_f32 v168, v128, v129, v130
  v_add_f32 v10, v10, v154
  v_max3_f32 v169, v131, v132, v133
  v_add_f32 v10, v10, v155
  s_waitcnt lgkmcnt(4)
  v_mfma_f32_32x32x16_bf16 v[64:79], a[80:83], v[164:167], v[64:79]
  ds_read_b128 a[48:51], v40 offset:0
  ds_read_b128 a[52:55], v41 offset:0
  v_add_f32 v10, v10, v156
  v_add_f32 v10, v10, v157
  v_add_f32 v10, v10, v158
  v_add_f32 v10, v10, v159
  v_mfma_f32_32x32x16_bf16 v[80:95], a[84:87], v[164:167], v[80:95]
  ds_read_b128 a[56:59], v42 offset:0
  ds_read_b128 a[60:63], v43 offset:0
  v_max3_f32 v170, v134, v135, v136
  v_max3_f32 v171, v137, v138, v139
  v_mfma_f32_32x32x16_bf16 v[96:111], a[88:91], v[164:167], v[96:111]
  v_max3_f32 v172, v140, v141, v142
  v_max3_f32 v168, v168, v169, v170
  v_max3_f32 v171, v171, v172, v143
  v_max_f32 v168, v168, v171
  buffer_load_dwordx4 v20, s[12:15], s48 offen offset:3072 nt lds
  v_mfma_f32_32x32x16_bf16 v[112:127], a[92:95], v[164:167], v[112:127]
  v_mov_b32 v169, v168
  s_nop 1
  v_permlane32_swap_b32 v168, v169
  v_max_f32 v168, v168, v169
  v_cmp_lt_f32 vcc, s50, v168
  s_cbranch_vccnz L_resc_54
L_back_55:
  s_waitcnt vmcnt(13) lgkmcnt(0)
  s_barrier
  v_mfma_f32_32x32x16_bf16 v[144:159], a[32:35], v[176:179], v[208:223]
  ds_read_b64_tr_b16 a[64:65], v44 offset:40960
  ds_read_b64_tr_b16 a[66:67], v44 offset:43008
  ds_read_b64_tr_b16 a[68:69], v45 offset:40960
  ds_read_b64_tr_b16 a[70:71], v45 offset:43008
  v_exp_f32 v128, v128
  s_add_u32 m0, s29, 90112
  v_exp_f32 v129, v129
  v_mfma_f32_32x32x16_bf16 v[144:159], a[36:39], v[180:183], v[144:159]
  ds_read_b64_tr_b16 a[72:73], v46 offset:40960
  ds_read_b64_tr_b16 a[74:75], v46 offset:43008
  ds_read_b64_tr_b16 a[76:77], v47 offset:40960
  ds_read_b64_tr_b16 a[78:79], v47 offset:43008
  v_exp_f32 v130, v130
  v_mfma_f32_32x32x16_bf16 v[144:159], a[40:43], v[184:187], v[144:159]
  ds_read_b64_tr_b16 a[80:81], v44 offset:45056
  ds_read_b64_tr_b16 a[82:83], v44 offset:47104
  ds_read_b64_tr_b16 a[84:85], v45 offset:45056
  ds_read_b64_tr_b16 a[86:87], v45 offset:47104
  v_exp_f32 v131, v131
  v_cvt_pk_bf16_f32 v160, v128, v129
  v_exp_f32 v132, v132
  v_mfma_f32_32x32x16_bf16 v[144:159], a[44:47], v[188:191], v[144:159]
  s_waitcnt lgkmcnt(8)
  ds_read_b64_tr_b16 a[88:89], v46 offset:45056
  ds_read_b64_tr_b16 a[90:91], v46 offset:47104
  ds_read_b64_tr_b16 a[92:93], v47 offset:45056
  ds_read_b64_tr_b16 a[94:95], v47 offset:47104
  v_exp_f32 v133, v133
  v_mfma_f32_32x32x16_bf16 v[144:159], a[48:51], v[192:195], v[144:159]
  v_cvt_pk_bf16_f32 v161, v130, v131
  v_exp_f32 v134, v134
  s_add_u32 s48, s48, 8192
  v_exp_f32 v135, v135
  v_cvt_pk_bf16_f32 v162, v132, v133
  v_exp_f32 v136, v136
  v_mfma_f32_32x32x16_bf16 v[144:159], a[52:55], v[196:199], v[144:159]
  v_exp_f32 v137, v137
  v_cvt_pk_bf16_f32 v163, v134, v135
  v_exp_f32 v138, v138
  v_exp_f32 v139, v139
  v_mfma_f32_32x32x16_bf16 v[144:159], a[56:59], v[200:203], v[144:159]
  v_cvt_pk_bf16_f32 v164, v136, v137
  buffer_load_dwordx4 v20, s[12:15], s48 offen offset:0 nt lds
  v_exp_f32 v140, v140
  v_exp_f32 v141, v141
  v_cvt_pk_bf16_f32 v165, v138, v139
  v_mfma_f32_32x32x16_bf16 v[144:159], a[60:63], v[204:207], v[144:159]
  v_exp_f32 v142, v142
  v_exp_f32 v143, v143
  v_cvt_pk_bf16_f32 v166, v140, v141
  s_nop 0
  v_cvt_pk_bf16_f32 v167, v142, v143
  s_waitcnt lgkmcnt(8)
  v_mfma_f32_32x32x16_bf16 v[64:79], a[64:67], v[160:163], v[64:79]
  ds_read_b128 a[32:35], v36 offset:40960
  ds_read_b128 a[36:39], v37 offset:40960
  v_add_f32 v10, v10, v128
  v_add_f32 v10, v10, v129
  buffer_load_dwordx4 v20, s[12:15], s48 offen offset:1024 nt lds
  v_mfma_f32_32x32x16_bf16 v[80:95], a[68:71], v[160:163], v[80:95]
  ds_read_b128 a[40:43], v38 offset:40960
  ds_read_b128 a[44:47], v39 offset:40960
  v_add_f32 v10, v10, v130
  v_add_f32 v10, v10, v131
  v_add_f32 v10, v10, v132
  v_mfma_f32_32x32x16_bf16 v[96:111], a[72:75], v[160:163], v[96:111]
  v_add_f32 v10, v10, v133
  v_add_f32 v10, v10, v134
  v_add_f32 v10, v10, v135
  v_add_f32 v10, v10, v136
  buffer_load_dwordx4 v20, s[12:15], s48 offen offset:2048 nt lds
  v_mfma_f32_32x32x16_bf16 v[112:127], a[76:79], v[160:163], v[112:127]
  v_add_f32 v10, v10, v137
  v_max3_f32 v168, v144, v145, v146
  v_add_f32 v10, v10, v138
  v_max3_f32 v169, v147, v148, v149
  v_add_f32 v10, v10, v139
  s_waitcnt lgkmcnt(4)
  v_mfma_f32_32x32x16_bf16 v[64:79], a[80:83], v[164:167], v[64:79]
  ds_read_b128 a[48:51], v40 offset:40960
  ds_read_b128 a[52:55], v41 offset:40960
  v_add_f32 v10, v10, v140
  v_add_f32 v10, v10, v141
  v_add_f32 v10, v10, v142
  v_add_f32 v10, v10, v143
  v_mfma_f32_32x32x16_bf16 v[80:95], a[84:87], v[164:167], v[80:95]
  ds_read_b128 a[56:59], v42 offset:40960
  ds_read_b128 a[60:63], v43 offset:40960
  v_max3_f32 v170, v150, v151, v152
  v_max3_f32 v171, v153, v154, v155
  v_mfma_f32_32x32x16_bf16 v[96:111], a[88:91], v[164:167], v[96:111]
  v_max3_f32 v172, v156, v157, v158
  v_max3_f32 v168, v168, v169, v170
  v_max3_f32 v171, v171, v172, v159
  v_max_f32 v168, v168, v171
  buffer_load_dwordx4 v20, s[12:15], s48 offen offset:3072 nt lds
  v_mfma_f32_32x32x16_bf16 v[112:127], a[92:95], v[164:167], v[112:127]
  v_mov_b32 v169, v168
  s_nop 1
  v_permlane32_swap_b32 v168, v169
  v_max_f32 v168, v168, v169
  v_cmp_lt_f32 vcc, s50, v168
  s_cbranch_vccnz L_resc_56
L_back_57:
  s_waitcnt vmcnt(8) lgkmcnt(0)
  s_barrier
  v_mfma_f32_32x32x16_bf16 v[128:143], a[32:35], v[176:179], v[208:223]
  ds_read_b64_tr_b16 a[64:65], v32 offset:0
  ds_read_b64_tr_b16 a[66:67], v32 offset:2048
  ds_read_b64_tr_b16 a[68:69], v33 offset:0
  ds_read_b64_tr_b16 a[70:71], v33 offset:2048
  v_exp_f32 v144, v144
  v_exp_f32 v145, v145
  v_mfma_f32_32x32x16_bf16 v[128:143], a[36:39], v[180:183], v[128:143]
  ds_read_b64_tr_b16 a[72:73], v34 offset:0
  ds_read_b64_tr_b16 a[74:75], v34 offset:2048
  ds_read_b64_tr_b16 a[76:77], v35 offset:0
  ds_read_b64_tr_b16 a[78:79], v35 offset:2048
  v_exp_f32 v146, v146
  v_exp_f32 v147, v147
  v_mfma_f32_32x32x16_bf16 v[128:143], a[40:43], v[184:187], v[128:143]
  ds_read_b64_tr_b16 a[80:81], v32 offset:4096
  ds_read_b64_tr_b16 a[82:83], v32 offset:6144
  ds_read_b64_tr_b16 a[84:85], v33 offset:4096
  ds_read_b64_tr_b16 a[86:87], v33 offset:6144
  v_cvt_pk_bf16_f32 v160, v144, v145
  v_exp_f32 v148, v148
  v_mfma_f32_32x32x16_bf16 v[128:143], a[44:47], v[188:191], v[128:143]
  s_waitcnt lgkmcnt(8)
  ds_read_b64_tr_b16 a[88:89], v34 offset:4096
  ds_read_b64_tr_b16 a[90:91], v34 offset:6144
  ds_read_b64_tr_b16 a[92:93], v35 offset:4096
  ds_read_b64_tr_b16 a[94:95], v35 offset:6144
  v_exp_f32 v149, v149
  v_mfma_f32_32x32x16_bf16 v[128:143], a[48:51], v[192:195], v[128:143]
  v_cvt_pk_bf16_f32 v161, v146, v147
  v_exp_f32 v150, v150
  v_exp_f32 v151, v151
  v_cvt_pk_bf16_f32 v162, v148, v149
  v_exp_f32 v152, v152
  v_mfma_f32_32x32x16_bf16 v[128:143], a[52:55], v[196:199], v[128:143]
  v_exp_f32 v153, v153
  v_cvt_pk_bf16_f32 v163, v150, v151
  v_exp_f32 v154, v154
  v_exp_f32 v155, v155
  v_mfma_f32_32x32x16_bf16 v[128:143], a[56:59], v[200:203], v[128:143]
  v_cvt_pk_bf16_f32 v164, v152, v153
  v_exp_f32 v156, v156
  v_exp_f32 v157, v157
  v_cvt_pk_bf16_f32 v165, v154, v155
  v_mfma_f32_32x32x16_bf16 v[128:143], a[60:63], v[204:207], v[128:143]
  v_exp_f32 v158, v158
  v_exp_f32 v159, v159
  v_cvt_pk_bf16_f32 v166, v156, v157
  s_nop 0
  v_cvt_pk_bf16_f32 v167, v158, v159
  s_waitcnt lgkmcnt(8)
  v_mfma_f32_32x32x16_bf16 v[64:79], a[64:67], v[160:163], v[64:79]
  ds_read_b128 a[32:35], v24 offset:0
  ds_read_b128 a[36:39], v25 offset:0
  v_add_f32 v10, v10, v144
  v_add_f32 v10, v10, v145
  v_add_f32 v10, v10, v146
  v_mfma_f32_32x32x16_bf16 v[80:95], a[68:71], v[160:163], v[80:95]
  ds_read_b128 a[40:43], v26 offset:0
  ds_read_b128 a[44:47], v27 offset:0
  v_add_f32 v10, v10, v147
  v_add_f32 v10, v10, v148
  v_mfma_f32_32x32x16_bf16 v[96:111], a[72:75], v[160:163], v[96:111]
  v_add_f32 v10, v10, v149
  v_add_f32 v10, v10, v150
  v_add_f32 v10, v10, v151
  v_add_f32 v10, v10, v152
  v_add_f32 v10, v10, v153
  v_mfma_f32_32x32x16_bf16 v[112:127], a[76:79], v[160:163], v[112:127]
  v_max3_f32 v168, v128, v129, v130
  v_add_f32 v10, v10, v154
  v_max3_f32 v169, v131, v132, v133
  v_add_f32 v10, v10, v155
  v_add_f32 v10, v10, v156
  s_waitcnt lgkmcnt(4)
  v_mfma_f32_32x32x16_bf16 v[64:79], a[80:83], v[164:167], v[64:79]
  ds_read_b128 a[48:51], v28 offset:0
  ds_read_b128 a[52:55], v29 offset:0
  v_add_f32 v10, v10, v157
  v_add_f32 v10, v10, v158
  v_add_f32 v10, v10, v159
  v_mfma_f32_32x32x16_bf16 v[80:95], a[84:87], v[164:167], v[80:95]
  ds_read_b128 a[56:59], v30 offset:0
  ds_read_b128 a[60:63], v31 offset:0
  v_max3_f32 v170, v134, v135, v136
  v_max3_f32 v171, v137, v138, v139
  v_mfma_f32_32x32x16_bf16 v[96:111], a[88:91], v[164:167], v[96:111]
  v_max3_f32 v172, v140, v141, v142
  v_max3_f32 v168, v168, v169, v170
  v_max3_f32 v171, v171, v172, v143
  v_max_f32 v168, v168, v171
  v_mov_b32 v169, v168
  v_mfma_f32_32x32x16_bf16 v[112:127], a[92:95], v[164:167], v[112:127]
  s_nop 1
  v_permlane32_swap_b32 v168, v169
  v_max_f32 v168, v168, v169
  v_cmp_lt_f32 vcc, s50, v168
  s_cbranch_vccnz L_resc_58
L_back_59:
  s_waitcnt vmcnt(4) lgkmcnt(0)
  s_barrier
  v_mfma_f32_32x32x16_bf16 v[144:159], a[32:35], v[176:179], v[208:223]
  ds_read_b64_tr_b16 a[64:65], v32 offset:40960
  ds_read_b64_tr_b16 a[66:67], v32 offset:43008
  ds_read_b64_tr_b16 a[68:69], v33 offset:40960
  ds_read_b64_tr_b16 a[70:71], v33 offset:43008
  v_exp_f32 v128, v128
  v_exp_f32 v129, v129
  v_mfma_f32_32x32x16_bf16 v[144:159], a[36:39], v[180:183], v[144:159]
  ds_read_b64_tr_b16 a[72:73], v34 offset:40960
  ds_read_b64_tr_b16 a[74:75], v34 offset:43008
  ds_read_b64_tr_b16 a[76:77], v35 offset:40960
  ds_read_b64_tr_b16 a[78:79], v35 offset:43008
  v_exp_f32 v130, v130
  v_exp_f32 v131, v131
  v_mfma_f32_32x32x16_bf16 v[144:159], a[40:43], v[184:187], v[144:159]
  ds_read_b64_tr_b16 a[80:81], v32 offset:45056
  ds_read_b64_tr_b16 a[82:83], v32 offset:47104
  ds_read_b64_tr_b16 a[84:85], v33 offset:45056
  ds_read_b64_tr_b16 a[86:87], v33 offset:47104
  v_cvt_pk_bf16_f32 v160, v128, v129
  v_exp_f32 v132, v132
  v_mfma_f32_32x32x16_bf16 v[144:159], a[44:47], v[188:191], v[144:159]
  s_waitcnt lgkmcnt(8)
  ds_read_b64_tr_b16 a[88:89], v34 offset:45056
  ds_read_b64_tr_b16 a[90:91], v34 offset:47104
  ds_read_b64_tr_b16 a[92:93], v35 offset:45056
  ds_read_b64_tr_b16 a[94:95], v35 offset:47104
  v_exp_f32 v133, v133
  v_mfma_f32_32x32x16_bf16 v[144:159], a[48:51], v[192:195], v[144:159]
  v_cvt_pk_bf16_f32 v161, v130, v131
  v_exp_f32 v134, v134
  v_exp_f32 v135, v135
  v_cvt_pk_bf16_f32 v162, v132, v133
  v_exp_f32 v136, v136
  v_mfma_f32_32x32x16_bf16 v[144:159], a[52:55], v[196:199], v[144:159]
  v_exp_f32 v137, v137
  v_cvt_pk_bf16_f32 v163, v134, v135
  v_exp_f32 v138, v138
  v_exp_f32 v139, v139
  v_mfma_f32_32x32x16_bf16 v[144:159], a[56:59], v[200:203], v[144:159]
  v_cvt_pk_bf16_f32 v164, v136, v137
  v_exp_f32 v140, v140
  v_exp_f32 v141, v141
  v_cvt_pk_bf16_f32 v165, v138, v139
  v_mfma_f32_32x32x16_bf16 v[144:159], a[60:63], v[204:207], v[144:159]
  v_exp_f32 v142, v142
  v_exp_f32 v143, v143
  v_cvt_pk_bf16_f32 v166, v140, v141
  s_nop 0
  v_cvt_pk_bf16_f32 v167, v142, v143
  s_waitcnt lgkmcnt(8)
  v_mfma_f32_32x32x16_bf16 v[64:79], a[64:67], v[160:163], v[64:79]
  v_add_f32 v10, v10, v128
  v_add_f32 v10, v10, v129
  v_add_f32 v10, v10, v130
  v_add_f32 v10, v10, v131
  v_mfma_f32_32x32x16_bf16 v[80:95], a[68:71], v[160:163], v[80:95]
  v_add_f32 v10, v10, v132
  v_add_f32 v10, v10, v133
  v_add_f32 v10, v10, v134
  v_mfma_f32_32x32x16_bf16 v[96:111], a[72:75], v[160:163], v[96:111]
  v_add_f32 v10, v10, v135
  v_add_f32 v10, v10, v136
  v_add_f32 v10, v10, v137
  v_add_f32 v10, v10, v138
  v_mfma_f32_32x32x16_bf16 v[112:127], a[76:79], v[160:163], v[112:127]
  v_max3_f32 v168, v144, v145, v146
  v_max3_f32 v169, v147, v148, v149
  v_add_f32 v10, v10, v139
  v_add_f32 v10, v10, v140
  s_waitcnt lgkmcnt(0)
  v_mfma_f32_32x32x16_bf16 v[64:79], a[80:83], v[164:167], v[64:79]
  v_add_f32 v10, v10, v141
  v_add_f32 v10, v10, v142
  v_add_f32 v10, v10, v143
  v_mfma_f32_32x32x16_bf16 v[80:95], a[84:87], v[164:167], v[80:95]
  v_max3_f32 v170, v150, v151, v152
  v_max3_f32 v171, v153, v154, v155
  v_max3_f32 v172, v156, v157, v158
  v_max3_f32 v168, v168, v169, v170
  v_mfma_f32_32x32x16_bf16 v[96:111], a[88:91], v[164:167], v[96:111]
  v_max3_f32 v171, v171, v172, v159
  v_max_f32 v168, v168, v171
  v_mov_b32 v169, v168
  s_nop 1
  v_mfma_f32_32x32x16_bf16 v[112:127], a[92:95], v[164:167], v[112:127]
  v_permlane32_swap_b32 v168, v169
  v_max_f32 v168, v168, v169
  v_cmp_lt_f32 vcc, s50, v168
  s_cbranch_vccnz L_resc_60
L_back_61:
  s_waitcnt vmcnt(0) lgkmcnt(0)
  s_barrier
  ds_read_b64_tr_b16 a[64:65], v44 offset:0
  ds_read_b64_tr_b16 a[66:67], v44 offset:2048
  ds_read_b64_tr_b16 a[68:69], v45 offset:0
  ds_read_b64_tr_b16 a[70:71], v45 offset:2048
  ds_read_b64_tr_b16 a[72:73], v46 offset:0
  ds_read_b64_tr_b16 a[74:75], v46 offset:2048
  ds_read_b64_tr_b16 a[76:77], v47 offset:0
  ds_read_b64_tr_b16 a[78:79], v47 offset:2048
  ds_read_b64_tr_b16 a[80:81], v44 offset:4096
  ds_read_b64_tr_b16 a[82:83], v44 offset:6144
  ds_read_b64_tr_b16 a[84:85], v45 offset:4096
  ds_read_b64_tr_b16 a[86:87], v45 offset:6144
  s_waitcnt lgkmcnt(8)
  ds_read_b64_tr_b16 a[88:89], v46 offset:4096
  ds_read_b64_tr_b16 a[90:91], v46 offset:6144
  ds_read_b64_tr_b16 a[92:93], v47 offset:4096
  ds_read_b64_tr_b16 a[94:95], v47 offset:6144
  v_exp_f32 v144, v144
  v_exp_f32 v145, v145
  v_exp_f32 v146, v146
  v_exp_f32 v147, v147
  v_cvt_pk_bf16_f32 v160, v144, v145
  v_exp_f32 v148, v148
  v_exp_f32 v149, v149
  v_cvt_pk_bf16_f32 v161, v146, v147
  v_exp_f32 v150, v150
  v_exp_f32 v151, v151
  v_cvt_pk_bf16_f32 v162, v148, v149
  v_exp_f32 v152, v152
  v_exp_f32 v153, v153
  v_cvt_pk_bf16_f32 v163, v150, v151
  v_exp_f32 v154, v154
  v_exp_f32 v155, v155
  v_cvt_pk_bf16_f32 v164, v152, v153
  v_exp_f32 v156, v156
  v_exp_f32 v157, v157
  v_cvt_pk_bf16_f32 v165, v154, v155
  v_exp_f32 v158, v158
  v_exp_f32 v159, v159
  v_cvt_pk_bf16_f32 v166, v156, v157
  s_nop 0
  v_cvt_pk_bf16_f32 v167, v158, v159
  s_waitcnt lgkmcnt(8)
  v_mfma_f32_32x32x16_bf16 v[64:79], a[64:67], v[160:163], v[64:79]
  v_add_f32 v10, v10, v144
  v_add_f32 v10, v10, v145
  v_mfma_f32_32x32x16_bf16 v[80:95], a[68:71], v[160:163], v[80:95]
  v_add_f32 v10, v10, v146
  v_add_f32 v10, v10, v147
  v_mfma_f32_32x32x16_bf16 v[96:111], a[72:75], v[160:163], v[96:111]
  v_add_f32 v10, v10, v148
  v_add_f32 v10, v10, v149
  v_mfma_f32_32x32x16_bf16 v[112:127], a[76:79], v[160:163], v[112:127]
  v_add_f32 v10, v10, v150
  v_add_f32 v10, v10, v151
  s_waitcnt lgkmcnt(0)
  v_mfma_f32_32x32x16_bf16 v[64:79], a[80:83], v[164:167], v[64:79]
  v_add_f32 v10, v10, v152
  v_add_f32 v10, v10, v153
  v_add_f32 v10, v10, v154
  v_add_f32 v10, v10, v155
  v_add_f32 v10, v10, v156
  v_add_f32 v10, v10, v157
  v_add_f32 v10, v10, v158
  v_add_f32 v10, v10, v159
  v_mfma_f32_32x32x16_bf16 v[80:95], a[84:87], v[164:167], v[80:95]
  v_mfma_f32_32x32x16_bf16 v[96:111], a[88:91], v[164:167], v[96:111]
  v_mfma_f32_32x32x16_bf16 v[112:127], a[92:95], v[164:167], v[112:127]
  v_mov_b32 v2, v10
  s_nop 1
  v_permlane32_swap_b32 v10, v2
  v_add_f32 v10, v10, v2
  v_rcp_f32 v12, v10
  v_lshlrev_b32 v2, 4, v1
  s_add_u32 s51, s52, 1048576
  s_nop 7
  v_mov_b32 v13, v12
  s_nop 1
  v_pk_mul_f32 v[64:65], v[64:65], v[12:13]
  v_pk_mul_f32 v[66:67], v[66:67], v[12:13]
  v_pk_mul_f32 v[68:69], v[68:69], v[12:13]
  v_pk_mul_f32 v[70:71], v[70:71], v[12:13]
  v_cvt_pk_bf16_f32 v128, v64, v65
  v_cvt_pk_bf16_f32 v129, v66, v67
  v_cvt_pk_bf16_f32 v130, v68, v69
  v_cvt_pk_bf16_f32 v131, v70, v71
  s_add_u32 s55, s51, 0
  buffer_store_dwordx4 v[128:131], v2, s[24:27], s55 offen sc1
  v_pk_mul_f32 v[72:73], v[72:73], v[12:13]
  v_pk_mul_f32 v[74:75], v[74:75], v[12:13]
  v_pk_mul_f32 v[76:77], v[76:77], v[12:13]
  v_pk_mul_f32 v[78:79], v[78:79], v[12:13]
  v_cvt_pk_bf16_f32 v132, v72, v73
  v_cvt_pk_bf16_f32 v133, v74, v75
  v_cvt_pk_bf16_f32 v134, v76, v77
  v_cvt_pk_bf16_f32 v135, v78, v79
  s_add_u32 s55, s51, 1024
  buffer_store_dwordx4 v[132:135], v2, s[24:27], s55 offen sc1
  v_pk_mul_f32 v[80:81], v[80:81], v[12:13]
  v_pk_mul_f32 v[82:83], v[82:83], v[12:13]
  v_pk_mul_f32 v[84:85], v[84:85], v[12:13]
  v_pk_mul_f32 v[86:87], v[86:87], v[12:13]
  v_cvt_pk_bf16_f32 v136, v80, v81
  v_cvt_pk_bf16_f32 v137, v82, v83
  v_cvt_pk_bf16_f32 v138, v84, v85
  v_cvt_pk_bf16_f32 v139, v86, v87
  s_add_u32 s55, s51, 2048
  buffer_store_dwordx4 v[136:139], v2, s[24:27], s55 offen sc1
  v_pk_mul_f32 v[88:89], v[88:89], v[12:13]
  v_pk_mul_f32 v[90:91], v[90:91], v[12:13]
  v_pk_mul_f32 v[92:93], v[92:93], v[12:13]
  v_pk_mul_f32 v[94:95], v[94:95], v[12:13]
  v_cvt_pk_bf16_f32 v140, v88, v89
  v_cvt_pk_bf16_f32 v141, v90, v91
  v_cvt_pk_bf16_f32 v142, v92, v93
  v_cvt_pk_bf16_f32 v143, v94, v95
  s_add_u32 s55, s51, 3072
  buffer_store_dwordx4 v[140:143], v2, s[24:27], s55 offen sc1
  v_pk_mul_f32 v[96:97], v[96:97], v[12:13]
  v_pk_mul_f32 v[98:99], v[98:99], v[12:13]
  v_pk_mul_f32 v[100:101], v[100:101], v[12:13]
  v_pk_mul_f32 v[102:103], v[102:103], v[12:13]
  v_cvt_pk_bf16_f32 v144, v96, v97
  v_cvt_pk_bf16_f32 v145, v98, v99
  v_cvt_pk_bf16_f32 v146, v100, v101
  v_cvt_pk_bf16_f32 v147, v102, v103
  s_add_u32 s55, s51, 4096
  buffer_store_dwordx4 v[144:147], v2, s[24:27], s55 offen sc1
  v_pk_mul_f32 v[104:105], v[104:105], v[12:13]
  v_pk_mul_f32 v[106:107], v[106:107], v[12:13]
  v_pk_mul_f32 v[108:109], v[108:109], v[12:13]
  v_pk_mul_f32 v[110:111], v[110:111], v[12:13]
  v_cvt_pk_bf16_f32 v148, v104, v105
  v_cvt_pk_bf16_f32 v149, v106, v107
  v_cvt_pk_bf16_f32 v150, v108, v109
  v_cvt_pk_bf16_f32 v151, v110, v111
  s_add_u32 s55, s51, 5120
  buffer_store_dwordx4 v[148:151], v2, s[24:27], s55 offen sc1
  v_pk_mul_f32 v[112:113], v[112:113], v[12:13]
  v_pk_mul_f32 v[114:115], v[114:115], v[12:13]
  v_pk_mul_f32 v[116:117], v[116:117], v[12:13]
  v_pk_mul_f32 v[118:119], v[118:119], v[12:13]
  v_cvt_pk_bf16_f32 v152, v112, v113
  v_cvt_pk_bf16_f32 v153, v114, v115
  v_cvt_pk_bf16_f32 v154, v116, v117
  v_cvt_pk_bf16_f32 v155, v118, v119
  s_add_u32 s55, s51, 6144
  buffer_store_dwordx4 v[152:155], v2, s[24:27], s55 offen sc1
  v_pk_mul_f32 v[120:121], v[120:121], v[12:13]
  v_pk_mul_f32 v[122:123], v[122:123], v[12:13]
  v_pk_mul_f32 v[124:125], v[124:125], v[12:13]
  v_pk_mul_f32 v[126:127], v[126:127], v[12:13]
  v_cvt_pk_bf16_f32 v156, v120, v121
  v_cvt_pk_bf16_f32 v157, v122, v123
  v_cvt_pk_bf16_f32 v158, v124, v125
  v_cvt_pk_bf16_f32 v159, v126, v127
  s_add_u32 s55, s51, 7168
  buffer_store_dwordx4 v[156:159], v2, s[24:27], s55 offen sc1
  s_and_b32 s55, s5, 3
  s_lshl_b32 s55, s55, 1
  s_add_u32 s55, s55, s54
  s_lshl_b32 s55, s55, 3
  s_and_b32 s56, s5, 12
  s_lshl_b32 s56, s56, 4
  s_add_u32 s56, s56, s4
  s_lshl_b32 s57, s53, 3
  s_add_u32 s56, s56, s57
  s_lshl_b32 s56, s56, 9
  s_add_u32 s55, s55, s56
  s_add_u32 s55, s55, 524544
  v_lshlrev_b32 v3, 13, v1
  v_add_u32 v3, s55, v3
  s_and_b32 s56, s5, 3
  s_mul_i32 s56, s56, 288
  s_mul_i32 s57, s6, 36864
  s_add_u32 s56, s56, s57
  s_add_u32 s58, s5, 0
  s_and_b32 s58, s58, 3
  s_lshl_b32 s57, s58, 3
  s_add_u32 s57, s57, s4
  s_mul_i32 s57, s57, 147456
  s_add_u32 s97, s57, s56
  s_add_u32 s58, s5, 1
  s_and_b32 s58, s58, 3
  s_lshl_b32 s57, s58, 3
  s_add_u32 s57, s57, s4
  s_mul_i32 s57, s57, 147456
  s_add_u32 s98, s57, s56
  s_add_u32 s58, s5, 2
  s_and_b32 s58, s58, 3
  s_lshl_b32 s57, s58, 3
  s_add_u32 s57, s57, s4
  s_mul_i32 s57, s57, 147456
  s_add_u32 s99, s57, s56
  s_add_u32 s58, s5, 3
  s_and_b32 s58, s58, 3
  s_lshl_b32 s57, s58, 3
  s_add_u32 s57, s57, s4
  s_mul_i32 s57, s57, 147456
  s_add_u32 s100, s57, s56
  s_waitcnt vmcnt(0)
  s_mov_b32 s57, 0x40000
L_non_62:
  v_or_b32 v6, v4, v5
  v_cmp_eq_u32 vcc, 0, v6
  s_cbranch_vccz L_nond_63
  s_sleep 2
  global_load_dwordx2 v[4:5], v14, s[34:35] sc1
  s_waitcnt vmcnt(0)
  s_sub_u32 s57, s57, 1
  s_cmp_lg_u32 s57, 0
  s_cbranch_scc1 L_non_62
L_nond_63:
  v_readfirstlane_b32 s88, v4
  v_readfirstlane_b32 s89, v5
  v_mov_b32 v6, v4
  v_mov_b32 v7, v5
  s_mov_b64 exec, 15
  buffer_store_dwordx2 v[6:7], v3, s[24:27], 0 offen sc1
  s_mov_b64 exec, -1
  s_barrier
  v_and_b32 v2, 3, v1
  v_lshlrev_b32 v2, 1, v2
  v_add_u32 v2, s53, v2
  v_lshlrev_b32 v2, 3, v2
  s_lshl_b32 s56, s2, 9
  s_add_u32 s56, s56, 524544
  v_add_u32 v2, s56, v2
  v_lshrrev_b32 v3, 5, v1
  v_bfe_u32 v10, v1, 4, 1
  v_and_b32 v11, 15, v1
  v_lshlrev_b32 v12, 10, v3
  v_lshl_add_u32 v12, v10, 9, v12
  v_lshl_add_u32 v26, v11, 4, v12
  v_bfe_u32 v11, v1, 2, 2
  v_and_b32 v12, 3, v1
  v_lshlrev_b32 v3, 4, v3
  v_lshl_add_u32 v3, v10, 2, v3
  v_add_u32 v3, v3, v11
  v_mul_u32_u24 v3, 288, v3
  v_lshl_add_u32 v27, v12, 3, v3
  v_add_u32 v28, 0, v27
  v_add_u32 v29, 36864, v27
  v_add_u32 v30, 73728, v27
  v_add_u32 v31, 110592, v27
  s_lshr_b32 s56, s5, 2
  s_lshl_b32 s56, s56, 1
  s_add_u32 s56, s56, s90
  s_add_u32 s56, s56, 8
  s_lshl_b32 s56, s56, 19
  s_lshl_b32 s57, s53, 13
  s_add_u32 s56, s56, s57
  s_lshl_b32 s57, s54, 8
  s_add_u32 s56, s56, s57
  s_add_u32 s56, s56, 1048576
  s_add_u32 s58, s5, 0
  s_and_b32 s58, s58, 3
  s_lshl_b32 s57, s58, 3
  s_add_u32 s57, s57, s4
  s_lshl_b32 s57, s57, 14
  s_add_u32 s84, s57, s56
  s_add_u32 s58, s5, 1
  s_and_b32 s58, s58, 3
  s_lshl_b32 s57, s58, 3
  s_add_u32 s57, s57, s4
  s_lshl_b32 s57, s57, 14
  s_add_u32 s85, s57, s56
  s_add_u32 s58, s5, 2
  s_and_b32 s58, s58, 3
  s_lshl_b32 s57, s58, 3
  s_add_u32 s57, s57, s4
  s_lshl_b32 s57, s57, 14
  s_add_u32 s86, s57, s56
  s_add_u32 s58, s5, 3
  s_and_b32 s58, s58, 3
  s_lshl_b32 s57, s58, 3
  s_add_u32 s57, s57, s4
  s_lshl_b32 s57, s57, 14
  s_add_u32 s87, s57, s56
  s_mul_i32 s51, s6, 9216
  s_add_u32 m0, s51, 0
  s_nop 0
  buffer_load_dwordx4 v224, s[16:19], s97 offen lds
  s_add_u32 m0, s51, 1024
  s_nop 0
  buffer_load_dwordx4 v225, s[16:19], s97 offen lds
  s_add_u32 m0, s51, 2048
  s_nop 0
  buffer_load_dwordx4 v226, s[16:19], s97 offen lds
  s_add_u32 m0, s51, 3072
  s_nop 0
  buffer_load_dwordx4 v227, s[16:19], s97 offen lds
  s_add_u32 m0, s51, 4096
  s_nop 0
  buffer_load_dwordx4 v228, s[16:19], s97 offen lds
  s_add_u32 m0, s51, 5120
  s_nop 0
  buffer_load_dwordx4 v229, s[16:19], s97 offen lds
  s_add_u32 m0, s51, 6144
  s_nop 0
  buffer_load_dwordx4 v230, s[16:19], s97 offen lds
  s_add_u32 m0, s51, 7168
  s_nop 0
  buffer_load_dwordx4 v231, s[16:19], s97 offen lds
  s_add_u32 m0, s51, 8192
  s_nop 0
  buffer_load_dwordx4 v232, s[16:19], s97 offen lds
  s_mov_b32 s55, 0x20000
  buffer_load_dwordx2 v[240:241], v2, s[24:27], 0 offen sc1
L_spin_64:
  s_waitcnt vmcnt(0)
  v_cmp_ne_u64 vcc, s[88:89], v[240:241]
  s_cbranch_vccz L_spun_65
  s_sleep 1
  buffer_load_dwordx2 v[240:241], v2, s[24:27], 0 offen sc1
  s_sub_u32 s55, s55, 1
  s_cmp_lg_u32 s55, 0
  s_cbranch_scc1 L_spin_64
L_spun_65:
  s_add_u32 s55, s84, 0
  buffer_load_dwordx4 a[0:3], v26, s[24:27], s55 offen offset:0 sc1
  s_add_u32 s55, s84, 2048
  buffer_load_dwordx4 a[4:7], v26, s[24:27], s55 offen offset:0 sc1
  s_add_u32 s55, s84, 4096
  buffer_load_dwordx4 a[8:11], v26, s[24:27], s55 offen offset:0 sc1
  s_add_u32 s55, s84, 6144
  buffer_load_dwordx4 a[12:15], v26, s[24:27], s55 offen offset:0 sc1
  s_mul_i32 s51, s6, 9216
  s_add_u32 m0, s51, 36864
  s_nop 0
  buffer_load_dwordx4 v224, s[16:19], s98 offen lds
  s_add_u32 m0, s51, 37888
  s_nop 0
  buffer_load_dwordx4 v225, s[16:19], s98 offen lds
  s_add_u32 m0, s51, 38912
  s_nop 0
  buffer_load_dwordx4 v226, s[16:19], s98 offen lds
  s_add_u32 m0, s51, 39936
  s_nop 0
  buffer_load_dwordx4 v227, s[16:19], s98 offen lds
  s_add_u32 m0, s51, 40960
  s_nop 0
  buffer_load_dwordx4 v228, s[16:19], s98 offen lds
  s_add_u32 m0, s51, 41984
  s_nop 0
  buffer_load_dwordx4 v229, s[16:19], s98 offen lds
  s_add_u32 m0, s51, 43008
  s_nop 0
  buffer_load_dwordx4 v230, s[16:19], s98 offen lds
  s_add_u32 m0, s51, 44032
  s_nop 0
  buffer_load_dwordx4 v231, s[16:19], s98 offen lds
  s_add_u32 m0, s51, 45056
  s_nop 0
  buffer_load_dwordx4 v232, s[16:19], s98 offen lds
  s_add_u32 s55, s85, 0
  buffer_load_dwordx4 a[16:19], v26, s[24:27], s55 offen offset:0 sc1
  s_add_u32 s55, s85, 2048
  buffer_load_dwordx4 a[20:23], v26, s[24:27], s55 offen offset:0 sc1
  s_add_u32 s55, s85, 4096
  buffer_load_dwordx4 a[24:27], v26, s[24:27], s55 offen offset:0 sc1
  s_add_u32 s55, s85, 6144
  buffer_load_dwordx4 a[28:31], v26, s[24:27], s55 offen offset:0 sc1
  s_waitcnt vmcnt(13)
  s_barrier
  ds_read_b64_tr_b16 v[32:33], v28 offset:0
  ds_read_b64_tr_b16 v[34:35], v28 offset:2304
  ds_read_b64_tr_b16 v[36:37], v28 offset:32
  ds_read_b64_tr_b16 v[38:39], v28 offset:2336
  ds_read_b64_tr_b16 v[40:41], v28 offset:64
  ds_read_b64_tr_b16 v[42:43], v28 offset:2368
  ds_read_b64_tr_b16 v[44:45], v28 offset:96
  ds_read_b64_tr_b16 v[46:47], v28 offset:2400
  ds_read_b64_tr_b16 v[48:49], v28 offset:128
  ds_read_b64_tr_b16 v[50:51], v28 offset:2432
  ds_read_b64_tr_b16 v[52:53], v28 offset:160
  ds_read_b64_tr_b16 v[54:55], v28 offset:2464
  ds_read_b64_tr_b16 v[56:57], v28 offset:192
  ds_read_b64_tr_b16 v[58:59], v28 offset:2496
  s_waitcnt lgkmcnt(10)
  v_mfma_f32_16x16x32_bf16 v[64:67], v[32:35], a[0:3], 0
  s_mul_i32 s51, s6, 9216
  s_add_u32 m0, s51, 73728
  ds_read_b64_tr_b16 v[60:61], v28 offset:224
  ds_read_b64_tr_b16 v[62:63], v28 offset:2528
  v_mfma_f32_16x16x32_bf16 v[68:71], v[36:39], a[0:3], 0
  s_nop 0
  buffer_load_dwordx4 v224, s[16:19], s99 offen lds
  ds_read_b64_tr_b16 v[32:33], v28 offset:256
  ds_read_b64_tr_b16 v[34:35], v28 offset:2560
  s_waitcnt lgkmcnt(10)
  v_mfma_f32_16x16x32_bf16 v[72:75], v[40:43], a[0:3], 0
  s_add_u32 m0, s51, 74752
  s_nop 0
  ds_read_b64_tr_b16 v[36:37], v28 offset:9216
  ds_read_b64_tr_b16 v[38:39], v28 offset:11520
  v_mfma_f32_16x16x32_bf16 v[76:79], v[44:47], a[0:3], 0
  buffer_load_dwordx4 v225, s[16:19], s99 offen lds
  s_add_u32 m0, s51, 75776
  ds_read_b64_tr_b16 v[40:41], v28 offset:9248
  ds_read_b64_tr_b16 v[42:43], v28 offset:11552
  s_waitcnt lgkmcnt(10)
  v_mfma_f32_16x16x32_bf16 v[80:83], v[48:51], a[0:3], 0
  s_nop 0
  buffer_load_dwordx4 v226, s[16:19], s99 offen lds
  ds_read_b64_tr_b16 v[44:45], v28 offset:9280
  ds_read_b64_tr_b16 v[46:47], v28 offset:11584
  v_mfma_f32_16x16x32_bf16 v[84:87], v[52:55], a[0:3], 0
  s_add_u32 m0, s51, 76800
  s_nop 0
  ds_read_b64_tr_b16 v[48:49], v28 offset:9312
  ds_read_b64_tr_b16 v[50:51], v28 offset:11616
  s_waitcnt lgkmcnt(10)
  v_mfma_f32_16x16x32_bf16 v[88:91], v[56:59], a[0:3], 0
  buffer_load_dwordx4 v227, s[16:19], s99 offen lds
  ds_read_b64_tr_b16 v[52:53], v28 offset:9344
  ds_read_b64_tr_b16 v[54:55], v28 offset:11648
  v_mfma_f32_16x16x32_bf16 v[92:95], v[60:63], a[0:3], 0
  s_add_u32 m0, s51, 77824
  ds_read_b64_tr_b16 v[56:57], v28 offset:9376
  ds_read_b64_tr_b16 v[58:59], v28 offset:11680
  s_waitcnt lgkmcnt(10)
  v_mfma_f32_16x16x32_bf16 v[96:99], v[32:35], a[0:3], 0
  s_nop 0
  ds_read_b64_tr_b16 v[60:61], v28 offset:9408
  ds_read_b64_tr_b16 v[62:63], v28 offset:11712
  v_mfma_f32_16x16x32_bf16 v[64:67], v[36:39], a[4:7], v[64:67]
  buffer_load_dwordx4 v228, s[16:19], s99 offen lds
  ds_read_b64_tr_b16 v[32:33], v28 offset:9440
  ds_read_b64_tr_b16 v[34:35], v28 offset:11744
  s_waitcnt lgkmcnt(10)
  v_mfma_f32_16x16x32_bf16 v[68:71], v[40:43], a[4:7], v[68:71]
  s_add_u32 m0, s51, 78848
  ds_read_b64_tr_b16 v[36:37], v28 offset:9472
  ds_read_b64_tr_b16 v[38:39], v28 offset:11776
  v_mfma_f32_16x16x32_bf16 v[72:75], v[44:47], a[4:7], v[72:75]
  s_nop 0
  ds_read_b64_tr_b16 v[40:41], v28 offset:18432
  ds_read_b64_tr_b16 v[42:43], v28 offset:20736
  s_waitcnt lgkmcnt(10)
  v_mfma_f32_16x16x32_bf16 v[76:79], v[48:51], a[4:7], v[76:79]
  buffer_load_dwordx4 v229, s[16:19], s99 offen lds
  ds_read_b64_tr_b16 v[44:45], v28 offset:18464
  ds_read_b64_tr_b16 v[46:47], v28 offset:20768
  v_mfma_f32_16x16x32_bf16 v[80:83], v[52:55], a[4:7], v[80:83]
  s_add_u32 m0, s51, 79872
  ds_read_b64_tr_b16 v[48:49], v28 offset:18496
  ds_read_b64_tr_b16 v[50:51], v28 offset:20800
  s_waitcnt lgkmcnt(10)
  v_mfma_f32_16x16x32_bf16 v[84:87], v[56:59], a[4:7], v[84:87]
  s_nop 0
  ds_read_b64_tr_b16 v[52:53], v28 offset:18528
  ds_read_b64_tr_b16 v[54:55], v28 offset:20832
  v_mfma_f32_16x16x32_bf16 v[88:91], v[60:63], a[4:7], v[88:91]
  buffer_load_dwordx4 v230, s[16:19], s99 offen lds
  ds_read_b64_tr_b16 v[56:57], v28 offset:18560
  ds_read_b64_tr_b16 v[58:59], v28 offset:20864
  s_waitcnt lgkmcnt(10)
  v_mfma_f32_16x16x32_bf16 v[92:95], v[32:35], a[4:7], v[92:95]
  s_add_u32 m0, s51, 80896
  ds_read_b64_tr_b16 v[60:61], v28 offset:18592
  ds_read_b64_tr_b16 v[62:63], v28 offset:20896
  v_mfma_f32_16x16x32_bf16 v[96:99], v[36:39], a[4:7], v[96:99]
  s_nop 0
  ds_read_b64_tr_b16 v[32:33], v28 offset:18624
  ds_read_b64_tr_b16 v[34:35], v28 offset:20928
  s_waitcnt lgkmcnt(10)
  v_mfma_f32_16x16x32_bf16 v[64:67], v[40:43], a[8:11], v[64:67]
  buffer_load_dwordx4 v231, s[16:19], s99 offen lds
  ds_read_b64_tr_b16 v[36:37], v28 offset:18656
  ds_read_b64_tr_b16 v[38:39], v28 offset:20960
  v_mfma_f32_16x16x32_bf16 v[68:71], v[44:47], a[8:11], v[68:71]
  s_add_u32 m0, s51, 81920
  ds_read_b64_tr_b16 v[40:41], v28 offset:18688
  ds_read_b64_tr_b16 v[42:43], v28 offset:20992
  s_waitcnt lgkmcnt(10)
  v_mfma_f32_16x16x32_bf16 v[72:75], v[48:51], a[8:11], v[72:75]
  s_nop 0
  ds_read_b64_tr_b16 v[44:45], v28 offset:27648
  ds_read_b64_tr_b16 v[46:47], v28 offset:29952
  v_mfma_f32_16x16x32_bf16 v[76:79], v[52:55], a[8:11], v[76:79]
  buffer_load_dwordx4 v232, s[16:19], s99 offen lds
  ds_read_b64_tr_b16 v[48:49], v28 offset:27680
  ds_read_b64_tr_b16 v[50:51], v28 offset:29984
  s_waitcnt lgkmcnt(10)
  v_mfma_f32_16x16x32_bf16 v[80:83], v[56:59], a[8:11], v[80:83]
  s_add_u32 s55, s86, 0
  ds_read_b64_tr_b16 v[52:53], v28 offset:27712
  ds_read_b64_tr_b16 v[54:55], v28 offset:30016
  v_mfma_f32_16x16x32_bf16 v[84:87], v[60:63], a[8:11], v[84:87]
  buffer_load_dwordx4 a[32:35], v26, s[24:27], s55 offen offset:0 sc1
  ds_read_b64_tr_b16 v[56:57], v28 offset:27744
  ds_read_b64_tr_b16 v[58:59], v28 offset:30048
  s_waitcnt lgkmcnt(10)
  v_mfma_f32_16x16x32_bf16 v[88:91], v[32:35], a[8:11], v[88:91]
  s_add_u32 s55, s86, 2048
  ds_read_b64_tr_b16 v[60:61], v28 offset:27776
  ds_read_b64_tr_b16 v[62:63], v28 offset:30080
  v_mfma_f32_16x16x32_bf16 v[92:95], v[36:39], a[8:11], v[92:95]
  buffer_load_dwordx4 a[36:39], v26, s[24:27], s55 offen offset:0 sc1
  ds_read_b64_tr_b16 v[32:33], v28 offset:27808
  ds_read_b64_tr_b16 v[34:35], v28 offset:30112
  s_waitcnt lgkmcnt(10)
  v_mfma_f32_16x16x32_bf16 v[96:99], v[40:43], a[8:11], v[96:99]
  s_add_u32 s55, s86, 4096
  ds_read_b64_tr_b16 v[36:37], v28 offset:27840
  ds_read_b64_tr_b16 v[38:39], v28 offset:30144
  v_mfma_f32_16x16x32_bf16 v[64:67], v[44:47], a[12:15], v[64:67]
  buffer_load_dwordx4 a[40:43], v26, s[24:27], s55 offen offset:0 sc1
  ds_read_b64_tr_b16 v[40:41], v28 offset:27872
  ds_read_b64_tr_b16 v[42:43], v28 offset:30176
  s_waitcnt lgkmcnt(10)
  v_mfma_f32_16x16x32_bf16 v[68:71], v[48:51], a[12:15], v[68:71]
  s_add_u32 s55, s86, 6144
  ds_read_b64_tr_b16 v[44:45], v28 offset:27904
  ds_read_b64_tr_b16 v[46:47], v28 offset:30208
  v_mfma_f32_16x16x32_bf16 v[72:75], v[52:55], a[12:15], v[72:75]
  buffer_load_dwordx4 a[44:47], v26, s[24:27], s55 offen offset:0 sc1
  s_waitcnt lgkmcnt(8)
  v_mfma_f32_16x16x32_bf16 v[76:79], v[56:59], a[12:15], v[76:79]
  v_mfma_f32_16x16x32_bf16 v[80:83], v[60:63], a[12:15], v[80:83]
  s_waitcnt lgkmcnt(4)
  v_mfma_f32_16x16x32_bf16 v[84:87], v[32:35], a[12:15], v[84:87]
  v_mfma_f32_16x16x32_bf16 v[88:91], v[36:39], a[12:15], v[88:91]
  s_waitcnt lgkmcnt(0)
  v_mfma_f32_16x16x32_bf16 v[92:95], v[40:43], a[12:15], v[92:95]
  v_mfma_f32_16x16x32_bf16 v[96:99], v[44:47], a[12:15], v[96:99]
  s_waitcnt vmcnt(13)
  s_barrier
  ds_read_b64_tr_b16 v[48:49], v29 offset:0
  ds_read_b64_tr_b16 v[50:51], v29 offset:2304
  ds_read_b64_tr_b16 v[52:53], v29 offset:32
  ds_read_b64_tr_b16 v[54:55], v29 offset:2336
  ds_read_b64_tr_b16 v[56:57], v29 offset:64
  ds_read_b64_tr_b16 v[58:59], v29 offset:2368
  ds_read_b64_tr_b16 v[60:61], v29 offset:96
  ds_read_b64_tr_b16 v[62:63], v29 offset:2400
  ds_read_b64_tr_b16 v[32:33], v29 offset:128
  ds_read_b64_tr_b16 v[34:35], v29 offset:2432
  ds_read_b64_tr_b16 v[36:37], v29 offset:160
  ds_read_b64_tr_b16 v[38:39], v29 offset:2464
  ds_read_b64_tr_b16 v[40:41], v29 offset:192
  ds_read_b64_tr_b16 v[42:43], v29 offset:2496
  s_waitcnt lgkmcnt(10)
  v_mfma_f32_16x16x32_bf16 v[64:67], v[48:51], a[16:19], v[64:67]
  s_mul_i32 s51, s6, 9216
  s_add_u32 m0, s51, 110592
  ds_read_b64_tr_b16 v[44:45], v29 offset:224
  ds_read_b64_tr_b16 v[46:47], v29 offset:2528
  v_mfma_f32_16x16x32_bf16 v[68:71], v[52:55], a[16:19], v[68:71]
  s_nop 0
  buffer_load_dwordx4 v224, s[16:19], s100 offen lds
  ds_read_b64_tr_b16 v[48:49], v29 offset:256
  ds_read_b64_tr_b16 v[50:51], v29 offset:2560
  s_waitcnt lgkmcnt(10)
  v_mfma_f32_16x16x32_bf16 v[72:75], v[56:59], a[16:19], v[72:75]
  s_add_u32 m0, s51, 111616
  s_nop 0
  ds_read_b64_tr_b16 v[52:53], v29 offset:9216
  ds_read_b64_tr_b16 v[54:55], v29 offset:11520
  v_mfma_f32_16x16x32_bf16 v[76:79], v[60:63], a[16:19], v[76:79]
  buffer_load_dwordx4 v225, s[16:19], s100 offen lds
  s_add_u32 m0, s51, 112640
  ds_read_b64_tr_b16 v[56:57], v29 offset:9248
  ds_read_b64_tr_b16 v[58:59], v29 offset:11552
  s_waitcnt lgkmcnt(10)
  v_mfma_f32_16x16x32_bf16 v[80:83], v[32:35], a[16:19], v[80:83]
  s_nop 0
  buffer_load_dwordx4 v226, s[16:19], s100 offen lds
  ds_read_b64_tr_b16 v[60:61], v29 offset:9280
  ds_read_b64_tr_b16 v[62:63], v29 offset:11584
  v_mfma_f32_16x16x32_bf16 v[84:87], v[36:39], a[16:19], v[84:87]
  s_add_u32 m0, s51, 113664
  s_nop 0
  ds_read_b64_tr_b16 v[32:33], v29 offset:9312
  ds_read_b64_tr_b16 v[34:35], v29 offset:11616
  s_waitcnt lgkmcnt(10)
  v_mfma_f32_16x16x32_bf16 v[88:91], v[40:43], a[16:19], v[88:91]
  buffer_load_dwordx4 v227, s[16:19], s100 offen lds
  ds_read_b64_tr_b16 v[36:37], v29 offset:9344
  ds_read_b64_tr_b16 v[38:39], v29 offset:11648
  v_mfma_f32_16x16x32_bf16 v[92:95], v[44:47], a[16:19], v[92:95]
  s_add_u32 m0, s51, 114688
  ds_read_b64_tr_b16 v[40:41], v29 offset:9376
  ds_read_b64_tr_b16 v[42:43], v29 offset:11680
  s_waitcnt lgkmcnt(10)
  v_mfma_f32_16x16x32_bf16 v[96:99], v[48:51], a[16:19], v[96:99]
  s_nop 0
  ds_read_b64_tr_b16 v[44:45], v29 offset:9408
  ds_read_b64_tr_b16 v[46:47], v29 offset:11712
  v_mfma_f32_16x16x32_bf16 v[64:67], v[52:55], a[20:23], v[64:67]
  buffer_load_dwordx4 v228, s[16:19], s100 offen lds
  ds_read_b64_tr_b16 v[48:49], v29 offset:9440
  ds_read_b64_tr_b16 v[50:51], v29 offset:11744
  s_waitcnt lgkmcnt(10)
  v_mfma_f32_16x16x32_bf16 v[68:71], v[56:59], a[20:23], v[68:71]
  s_add_u32 m0, s51, 115712
  ds_read_b64_tr_b16 v[52:53], v29 offset:9472
  ds_read_b64_tr_b16 v[54:55], v29 offset:11776
  v_mfma_f32_16x16x32_bf16 v[72:75], v[60:63], a[20:23], v[72:75]
  s_nop 0
  ds_read_b64_tr_b16 v[56:57], v29 offset:18432
  ds_read_b64_tr_b16 v[58:59], v29 offset:20736
  s_waitcnt lgkmcnt(10)
  v_mfma_f32_16x16x32_bf16 v[76:79], v[32:35], a[20:23], v[76:79]
  buffer_load_dwordx4 v229, s[16:19], s100 offen lds
  ds_read_b64_tr_b16 v[60:61], v29 offset:18464
  ds_read_b64_tr_b16 v[62:63], v29 offset:20768
  v_mfma_f32_16x16x32_bf16 v[80:83], v[36:39], a[20:23], v[80:83]
  s_add_u32 m0, s51, 116736
  ds_read_b64_tr_b16 v[32:33], v29 offset:18496
  ds_read_b64_tr_b16 v[34:35], v29 offset:20800
  s_waitcnt lgkmcnt(10)
  v_mfma_f32_16x16x32_bf16 v[84:87], v[40:43], a[20:23], v[84:87]
  s_nop 0
  ds_read_b64_tr_b16 v[36:37], v29 offset:18528
  ds_read_b64_tr_b16 v[38:39], v29 offset:20832
  v_mfma_f32_16x16x32_bf16 v[88:91], v[44:47], a[20:23], v[88:91]
  buffer_load_dwordx4 v230, s[16:19], s100 offen lds
  ds_read_b64_tr_b16 v[40:41], v29 offset:18560
  ds_read_b64_tr_b16 v[42:43], v29 offset:20864
  s_waitcnt lgkmcnt(10)
  v_mfma_f32_16x16x32_bf16 v[92:95], v[48:51], a[20:23], v[92:95]
  s_add_u32 m0, s51, 117760
  ds_read_b64_tr_b16 v[44:45], v29 offset:18592
  ds_read_b64_tr_b16 v[46:47], v29 offset:20896
  v_mfma_f32_16x16x32_bf16 v[96:99], v[52:55], a[20:23], v[96:99]
  s_nop 0
  ds_read_b64_tr_b16 v[48:49], v29 offset:18624
  ds_read_b64_tr_b16 v[50:51], v29 offset:20928
  s_waitcnt lgkmcnt(10)
  v_mfma_f32_16x16x32_bf16 v[64:67], v[56:59], a[24:27], v[64:67]
  buffer_load_dwordx4 v231, s[16:19], s100 offen lds
  ds_read_b64_tr_b16 v[52:53], v29 offset:18656
  ds_read_b64_tr_b16 v[54:55], v29 offset:20960
  v_mfma_f32_16x16x32_bf16 v[68:71], v[60:63], a[24:27], v[68:71]
  s_add_u32 m0, s51, 118784
  ds_read_b64_tr_b16 v[56:57], v29 offset:18688
  ds_read_b64_tr_b16 v[58:59], v29 offset:20992
  s_waitcnt lgkmcnt(10)
  v_mfma_f32_16x16x32_bf16 v[72:75], v[32:35], a[24:27], v[72:75]
  s_nop 0
  ds_read_b64_tr_b16 v[60:61], v29 offset:27648
  ds_read_b64_tr_b16 v[62:63], v29 offset:29952
  v_mfma_f32_16x16x32_bf16 v[76:79], v[36:39], a[24:27], v[76:79]
  buffer_load_dwordx4 v232, s[16:19], s100 offen lds
  ds_read_b64_tr_b16 v[32:33], v29 offset:27680
  ds_read_b64_tr_b16 v[34:35], v29 offset:29984
  s_waitcnt lgkmcnt(10)
  v_mfma_f32_16x16x32_bf16 v[80:83], v[40:43], a[24:27], v[80:83]
  s_add_u32 s55, s87, 0
  ds_read_b64_tr_b16 v[36:37], v29 offset:27712
  ds_read_b64_tr_b16 v[38:39], v29 offset:30016
  v_mfma_f32_16x16x32_bf16 v[84:87], v[44:47], a[24:27], v[84:87]
  buffer_load_dwordx4 a[48:51], v26, s[24:27], s55 offen offset:0 sc1
  ds_read_b64_tr_b16 v[40:41], v29 offset:27744
  ds_read_b64_tr_b16 v[42:43], v29 offset:30048
  s_waitcnt lgkmcnt(10)
  v_mfma_f32_16x16x32_bf16 v[88:91], v[48:51], a[24:27], v[88:91]
  s_add_u32 s55, s87, 2048
  ds_read_b64_tr_b16 v[44:45], v29 offset:27776
  ds_read_b64_tr_b16 v[46:47], v29 offset:30080
  v_mfma_f32_16x16x32_bf16 v[92:95], v[52:55], a[24:27], v[92:95]
  buffer_load_dwordx4 a[52:55], v26, s[24:27], s55 offen offset:0 sc1
  ds_read_b64_tr_b16 v[48:49], v29 offset:27808
  ds_read_b64_tr_b16 v[50:51], v29 offset:30112
  s_waitcnt lgkmcnt(10)
  v_mfma_f32_16x16x32_bf16 v[96:99], v[56:59], a[24:27], v[96:99]
  s_add_u32 s55, s87, 4096
  ds_read_b64_tr_b16 v[52:53], v29 offset:27840
  ds_read_b64_tr_b16 v[54:55], v29 offset:30144
  v_mfma_f32_16x16x32_bf16 v[64:67], v[60:63], a[28:31], v[64:67]
  buffer_load_dwordx4 a[56:59], v26, s[24:27], s55 offen offset:0 sc1
  ds_read_b64_tr_b16 v[56:57], v29 offset:27872
  ds_read_b64_tr_b16 v[58:59], v29 offset:30176
  s_waitcnt lgkmcnt(10)
  v_mfma_f32_16x16x32_bf16 v[68:71], v[32:35], a[28:31], v[68:71]
  s_add_u32 s55, s87, 6144
  ds_read_b64_tr_b16 v[60:61], v29 offset:27904
  ds_read_b64_tr_b16 v[62:63], v29 offset:30208
  v_mfma_f32_16x16x32_bf16 v[72:75], v[36:39], a[28:31], v[72:75]
  buffer_load_dwordx4 a[60:63], v26, s[24:27], s55 offen offset:0 sc1
  s_waitcnt lgkmcnt(8)
  v_mfma_f32_16x16x32_bf16 v[76:79], v[40:43], a[28:31], v[76:79]
  v_mfma_f32_16x16x32_bf16 v[80:83], v[44:47], a[28:31], v[80:83]
  s_waitcnt lgkmcnt(4)
  v_mfma_f32_16x16x32_bf16 v[84:87], v[48:51], a[28:31], v[84:87]
  v_mfma_f32_16x16x32_bf16 v[88:91], v[52:55], a[28:31], v[88:91]
  s_waitcnt lgkmcnt(0)
  v_mfma_f32_16x16x32_bf16 v[92:95], v[56:59], a[28:31], v[92:95]
  v_mfma_f32_16x16x32_bf16 v[96:99], v[60:63], a[28:31], v[96:99]
  s_waitcnt vmcnt(13)
  s_barrier
  ds_read_b64_tr_b16 v[32:33], v30 offset:0
  ds_read_b64_tr_b16 v[34:35], v30 offset:2304
  ds_read_b64_tr_b16 v[36:37], v30 offset:32
  ds_read_b64_tr_b16 v[38:39], v30 offset:2336
  ds_read_b64_tr_b16 v[40:41], v30 offset:64
  ds_read_b64_tr_b16 v[42:43], v30 offset:2368
  ds_read_b64_tr_b16 v[44:45], v30 offset:96
  ds_read_b64_tr_b16 v[46:47], v30 offset:2400
  ds_read_b64_tr_b16 v[48:49], v30 offset:128
  ds_read_b64_tr_b16 v[50:51], v30 offset:2432
  ds_read_b64_tr_b16 v[52:53], v30 offset:160
  ds_read_b64_tr_b16 v[54:55], v30 offset:2464
  ds_read_b64_tr_b16 v[56:57], v30 offset:192
  ds_read_b64_tr_b16 v[58:59], v30 offset:2496
  s_waitcnt lgkmcnt(10)
  v_mfma_f32_16x16x32_bf16 v[64:67], v[32:35], a[32:35], v[64:67]
  ds_read_b64_tr_b16 v[60:61], v30 offset:224
  ds_read_b64_tr_b16 v[62:63], v30 offset:2528
  v_mfma_f32_16x16x32_bf16 v[68:71], v[36:39], a[32:35], v[68:71]
  ds_read_b64_tr_b16 v[32:33], v30 offset:256
  ds_read_b64_tr_b16 v[34:35], v30 offset:2560
  s_waitcnt lgkmcnt(10)
  v_mfma_f32_16x16x32_bf16 v[72:75], v[40:43], a[32:35], v[72:75]
  ds_read_b64_tr_b16 v[36:37], v30 offset:9216
  ds_read_b64_tr_b16 v[38:39], v30 offset:11520
  v_mfma_f32_16x16x32_bf16 v[76:79], v[44:47], a[32:35], v[76:79]
  ds_read_b64_tr_b16 v[40:41], v30 offset:9248
  ds_read_b64_tr_b16 v[42:43], v30 offset:11552
  s_waitcnt lgkmcnt(10)
  v_mfma_f32_16x16x32_bf16 v[80:83], v[48:51], a[32:35], v[80:83]
  ds_read_b64_tr_b16 v[44:45], v30 offset:9280
  ds_read_b64_tr_b16 v[46:47], v30 offset:11584
  v_mfma_f32_16x16x32_bf16 v[84:87], v[52:55], a[32:35], v[84:87]
  ds_read_b64_tr_b16 v[48:49], v30 offset:9312
  ds_read_b64_tr_b16 v[50:51], v30 offset:11616
  s_waitcnt lgkmcnt(10)
  v_mfma_f32_16x16x32_bf16 v[88:91], v[56:59], a[32:35], v[88:91]
  ds_read_b64_tr_b16 v[52:53], v30 offset:9344
  ds_read_b64_tr_b16 v[54:55], v30 offset:11648
  v_mfma_f32_16x16x32_bf16 v[92:95], v[60:63], a[32:35], v[92:95]
  ds_read_b64_tr_b16 v[56:57], v30 offset:9376
  ds_read_b64_tr_b16 v[58:59], v30 offset:11680
  s_waitcnt lgkmcnt(10)
  v_mfma_f32_16x16x32_bf16 v[96:99], v[32:35], a[32:35], v[96:99]
  ds_read_b64_tr_b16 v[60:61], v30 offset:9408
  ds_read_b64_tr_b16 v[62:63], v30 offset:11712
  v_mfma_f32_16x16x32_bf16 v[64:67], v[36:39], a[36:39], v[64:67]
  ds_read_b64_tr_b16 v[32:33], v30 offset:9440
  ds_read_b64_tr_b16 v[34:35], v30 offset:11744
  s_waitcnt lgkmcnt(10)
  v_mfma_f32_16x16x32_bf16 v[68:71], v[40:43], a[36:39], v[68:71]
  ds_read_b64_tr_b16 v[36:37], v30 offset:9472
  ds_read_b64_tr_b16 v[38:39], v30 offset:11776
  v_mfma_f32_16x16x32_bf16 v[72:75], v[44:47], a[36:39], v[72:75]
  ds_read_b64_tr_b16 v[40:41], v30 offset:18432
  ds_read_b64_tr_b16 v[42:43], v30 offset:20736
  s_waitcnt lgkmcnt(10)
  v_mfma_f32_16x16x32_bf16 v[76:79], v[48:51], a[36:39], v[76:79]
  ds_read_b64_tr_b16 v[44:45], v30 offset:18464
  ds_read_b64_tr_b16 v[46:47], v30 offset:20768
  v_mfma_f32_16x16x32_bf16 v[80:83], v[52:55], a[36:39], v[80:83]
  ds_read_b64_tr_b16 v[48:49], v30 offset:18496
  ds_read_b64_tr_b16 v[50:51], v30 offset:20800
  s_waitcnt lgkmcnt(10)
  v_mfma_f32_16x16x32_bf16 v[84:87], v[56:59], a[36:39], v[84:87]
  ds_read_b64_tr_b16 v[52:53], v30 offset:18528
  ds_read_b64_tr_b16 v[54:55], v30 offset:20832
  v_mfma_f32_16x16x32_bf16 v[88:91], v[60:63], a[36:39], v[88:91]
  ds_read_b64_tr_b16 v[56:57], v30 offset:18560
  ds_read_b64_tr_b16 v[58:59], v30 offset:20864
  s_waitcnt lgkmcnt(10)
  v_mfma_f32_16x16x32_bf16 v[92:95], v[32:35], a[36:39], v[92:95]
  ds_read_b64_tr_b16 v[60:61], v30 offset:18592
  ds_read_b64_tr_b16 v[62:63], v30 offset:20896
  v_mfma_f32_16x16x32_bf16 v[96:99], v[36:39], a[36:39], v[96:99]
  ds_read_b64_tr_b16 v[32:33], v30 offset:18624
  ds_read_b64_tr_b16 v[34:35], v30 offset:20928
  s_waitcnt lgkmcnt(10)
  v_mfma_f32_16x16x32_bf16 v[64:67], v[40:43], a[40:43], v[64:67]
  ds_read_b64_tr_b16 v[36:37], v30 offset:18656
  ds_read_b64_tr_b16 v[38:39], v30 offset:20960
  v_mfma_f32_16x16x32_bf16 v[68:71], v[44:47], a[40:43], v[68:71]
  ds_read_b64_tr_b16 v[40:41], v30 offset:18688
  ds_read_b64_tr_b16 v[42:43], v30 offset:20992
  s_waitcnt lgkmcnt(10)
  v_mfma_f32_16x16x32_bf16 v[72:75], v[48:51], a[40:43], v[72:75]
  ds_read_b64_tr_b16 v[44:45], v30 offset:27648
  ds_read_b64_tr_b16 v[46:47], v30 offset:29952
  v_mfma_f32_16x16x32_bf16 v[76:79], v[52:55], a[40:43], v[76:79]
  ds_read_b64_tr_b16 v[48:49], v30 offset:27680
  ds_read_b64_tr_b16 v[50:51], v30 offset:29984
  s_waitcnt lgkmcnt(10)
  v_mfma_f32_16x16x32_bf16 v[80:83], v[56:59], a[40:43], v[80:83]
  ds_read_b64_tr_b16 v[52:53], v30 offset:27712
  ds_read_b64_tr_b16 v[54:55], v30 offset:30016
  v_mfma_f32_16x16x32_bf16 v[84:87], v[60:63], a[40:43], v[84:87]
  ds_read_b64_tr_b16 v[56:57], v30 offset:27744
  ds_read_b64_tr_b16 v[58:59], v30 offset:30048
  s_waitcnt lgkmcnt(10)
  v_mfma_f32_16x16x32_bf16 v[88:91], v[32:35], a[40:43], v[88:91]
  ds_read_b64_tr_b16 v[60:61], v30 offset:27776
  ds_read_b64_tr_b16 v[62:63], v30 offset:30080
  v_mfma_f32_16x16x32_bf16 v[92:95], v[36:39], a[40:43], v[92:95]
  ds_read_b64_tr_b16 v[32:33], v30 offset:27808
  ds_read_b64_tr_b16 v[34:35], v30 offset:30112
  s_waitcnt lgkmcnt(10)
  v_mfma_f32_16x16x32_bf16 v[96:99], v[40:43], a[40:43], v[96:99]
  ds_read_b64_tr_b16 v[36:37], v30 offset:27840
  ds_read_b64_tr_b16 v[38:39], v30 offset:30144
  v_mfma_f32_16x16x32_bf16 v[64:67], v[44:47], a[44:47], v[64:67]
  ds_read_b64_tr_b16 v[40:41], v30 offset:27872
  ds_read_b64_tr_b16 v[42:43], v30 offset:30176
  s_waitcnt lgkmcnt(10)
  v_mfma_f32_16x16x32_bf16 v[68:71], v[48:51], a[44:47], v[68:71]
  ds_read_b64_tr_b16 v[44:45], v30 offset:27904
  ds_read_b64_tr_b16 v[46:47], v30 offset:30208
  v_mfma_f32_16x16x32_bf16 v[72:75], v[52:55], a[44:47], v[72:75]
  s_waitcnt lgkmcnt(8)
  v_mfma_f32_16x16x32_bf16 v[76:79], v[56:59], a[44:47], v[76:79]
  v_mfma_f32_16x16x32_bf16 v[80:83], v[60:63], a[44:47], v[80:83]
  s_waitcnt lgkmcnt(4)
  v_mfma_f32_16x16x32_bf16 v[84:87], v[32:35], a[44:47], v[84:87]
  v_mfma_f32_16x16x32_bf16 v[88:91], v[36:39], a[44:47], v[88:91]
  s_waitcnt lgkmcnt(0)
  v_mfma_f32_16x16x32_bf16 v[92:95], v[40:43], a[44:47], v[92:95]
  v_mfma_f32_16x16x32_bf16 v[96:99], v[44:47], a[44:47], v[96:99]
  s_waitcnt vmcnt(0)
  s_barrier
  s_lshl_b32 s56, s90, 4
  s_add_u32 s56, s56, s5
  s_lshl_b32 s56, s56, 3
  s_add_u32 s56, s56, s4
  s_mul_i32 s56, s56, 18432
  s_mul_i32 s57, s6, 4608
  s_add_u32 s56, s56, s57
  s_add_u32 s58, s56, 14680064
  v_lshlrev_b32 v2, 3, v1
  ds_read_b64_tr_b16 v[48:49], v31 offset:0
  ds_read_b64_tr_b16 v[50:51], v31 offset:2304
  ds_read_b64_tr_b16 v[52:53], v31 offset:9216
  ds_read_b64_tr_b16 v[54:55], v31 offset:11520
  ds_read_b64_tr_b16 v[56:57], v31 offset:18432
  ds_read_b64_tr_b16 v[58:59], v31 offset:20736
  ds_read_b64_tr_b16 v[60:61], v31 offset:27648
  ds_read_b64_tr_b16 v[62:63], v31 offset:29952
  ds_read_b64_tr_b16 v[32:33], v31 offset:32
  ds_read_b64_tr_b16 v[34:35], v31 offset:2336
  ds_read_b64_tr_b16 v[36:37], v31 offset:9248
  ds_read_b64_tr_b16 v[38:39], v31 offset:11552
  ds_read_b64_tr_b16 v[40:41], v31 offset:18464
  ds_read_b64_tr_b16 v[42:43], v31 offset:20768
  s_waitcnt lgkmcnt(10)
  v_mfma_f32_16x16x32_bf16 v[64:67], v[48:51], a[48:51], v[64:67]
  ds_read_b64_tr_b16 v[44:45], v31 offset:27680
  ds_read_b64_tr_b16 v[46:47], v31 offset:29984
  v_mfma_f32_16x16x32_bf16 v[64:67], v[52:55], a[52:55], v[64:67]
  ds_read_b64_tr_b16 v[48:49], v31 offset:64
  ds_read_b64_tr_b16 v[50:51], v31 offset:2368
  s_waitcnt lgkmcnt(10)
  v_mfma_f32_16x16x32_bf16 v[64:67], v[56:59], a[56:59], v[64:67]
  ds_read_b64_tr_b16 v[52:53], v31 offset:9280
  ds_read_b64_tr_b16 v[54:55], v31 offset:11584
  v_mfma_f32_16x16x32_bf16 v[64:67], v[60:63], a[60:63], v[64:67]
  ds_read_b64_tr_b16 v[56:57], v31 offset:18496
  ds_read_b64_tr_b16 v[58:59], v31 offset:20800
  s_waitcnt lgkmcnt(10)
  v_mfma_f32_16x16x32_bf16 v[68:71], v[32:35], a[48:51], v[68:71]
  ds_read_b64_tr_b16 v[60:61], v31 offset:27712
  ds_read_b64_tr_b16 v[62:63], v31 offset:30016
  v_mfma_f32_16x16x32_bf16 v[68:71], v[36:39], a[52:55], v[68:71]
  ds_read_b64_tr_b16 v[32:33], v31 offset:96
  ds_read_b64_tr_b16 v[34:35], v31 offset:2400
  s_waitcnt lgkmcnt(10)
  v_mfma_f32_16x16x32_bf16 v[68:71], v[40:43], a[56:59], v[68:71]
  ds_read_b64_tr_b16 v[36:37], v31 offset:9312
  ds_read_b64_tr_b16 v[38:39], v31 offset:11616
  v_mfma_f32_16x16x32_bf16 v[68:71], v[44:47], a[60:63], v[68:71]
  v_cvt_pk_bf16_f32 v160, v64, v65
  v_cvt_pk_bf16_f32 v161, v66, v67
  s_add_u32 s57, s58, 0
  buffer_store_dwordx2 v[160:161], v2, s[24:27], s57 offen sc1
  ds_read_b64_tr_b16 v[40:41], v31 offset:18528
  ds_read_b64_tr_b16 v[42:43], v31 offset:20832
  s_waitcnt lgkmcnt(10)
  v_mfma_f32_16x16x32_bf16 v[72:75], v[48:51], a[48:51], v[72:75]
  ds_read_b64_tr_b16 v[44:45], v31 offset:27744
  ds_read_b64_tr_b16 v[46:47], v31 offset:30048
  v_mfma_f32_16x16x32_bf16 v[72:75], v[52:55], a[52:55], v[72:75]
  ds_read_b64_tr_b16 v[48:49], v31 offset:128
  ds_read_b64_tr_b16 v[50:51], v31 offset:2432
  s_waitcnt lgkmcnt(10)
  v_mfma_f32_16x16x32_bf16 v[72:75], v[56:59], a[56:59], v[72:75]
  ds_read_b64_tr_b16 v[52:53], v31 offset:9344
  ds_read_b64_tr_b16 v[54:55], v31 offset:11648
  v_mfma_f32_16x16x32_bf16 v[72:75], v[60:63], a[60:63], v[72:75]
  v_cvt_pk_bf16_f32 v162, v68, v69
  v_cvt_pk_bf16_f32 v163, v70, v71
  s_add_u32 s57, s58, 512
  buffer_store_dwordx2 v[162:163], v2, s[24:27], s57 offen sc1
  ds_read_b64_tr_b16 v[56:57], v31 offset:18560
  ds_read_b64_tr_b16 v[58:59], v31 offset:20864
  s_waitcnt lgkmcnt(10)
  v_mfma_f32_16x16x32_bf16 v[76:79], v[32:35], a[48:51], v[76:79]
  ds_read_b64_tr_b16 v[60:61], v31 offset:27776
  ds_read_b64_tr_b16 v[62:63], v31 offset:30080
  v_mfma_f32_16x16x32_bf16 v[76:79], v[36:39], a[52:55], v[76:79]
  ds_read_b64_tr_b16 v[32:33], v31 offset:160
  ds_read_b64_tr_b16 v[34:35], v31 offset:2464
  s_waitcnt lgkmcnt(10)
  v_mfma_f32_16x16x32_bf16 v[76:79], v[40:43], a[56:59], v[76:79]
  ds_read_b64_tr_b16 v[36:37], v31 offset:9376
  ds_read_b64_tr_b16 v[38:39], v31 offset:11680
  v_mfma_f32_16x16x32_bf16 v[76:79], v[44:47], a[60:63], v[76:79]
  v_cvt_pk_bf16_f32 v164, v72, v73
  v_cvt_pk_bf16_f32 v165, v74, v75
  s_add_u32 s57, s58, 1024
  buffer_store_dwordx2 v[164:165], v2, s[24:27], s57 offen sc1
  ds_read_b64_tr_b16 v[40:41], v31 offset:18592
  ds_read_b64_tr_b16 v[42:43], v31 offset:20896
  s_waitcnt lgkmcnt(10)
  v_mfma_f32_16x16x32_bf16 v[80:83], v[48:51], a[48:51], v[80:83]
  ds_read_b64_tr_b16 v[44:45], v31 offset:27808
  ds_read_b64_tr_b16 v[46:47], v31 offset:30112
  v_mfma_f32_16x16x32_bf16 v[80:83], v[52:55], a[52:55], v[80:83]
  ds_read_b64_tr_b16 v[48:49], v31 offset:192
  ds_read_b64_tr_b16 v[50:51], v31 offset:2496
  s_waitcnt lgkmcnt(10)
  v_mfma_f32_16x16x32_bf16 v[80:83], v[56:59], a[56:59], v[80:83]
  ds_read_b64_tr_b16 v[52:53], v31 offset:9408
  ds_read_b64_tr_b16 v[54:55], v31 offset:11712
  v_mfma_f32_16x16x32_bf16 v[80:83], v[60:63], a[60:63], v[80:83]
  v_cvt_pk_bf16_f32 v166, v76, v77
  v_cvt_pk_bf16_f32 v167, v78, v79
  s_add_u32 s57, s58, 1536
  buffer_store_dwordx2 v[166:167], v2, s[24:27], s57 offen sc1
  ds_read_b64_tr_b16 v[56:57], v31 offset:18624
  ds_read_b64_tr_b16 v[58:59], v31 offset:20928
  s_waitcnt lgkmcnt(10)
  v_mfma_f32_16x16x32_bf16 v[84:87], v[32:35], a[48:51], v[84:87]
  ds_read_b64_tr_b16 v[60:61], v31 offset:27840
  ds_read_b64_tr_b16 v[62:63], v31 offset:30144
  v_mfma_f32_16x16x32_bf16 v[84:87], v[36:39], a[52:55], v[84:87]
  ds_read_b64_tr_b16 v[32:33], v31 offset:224
  ds_read_b64_tr_b16 v[34:35], v31 offset:2528
  s_waitcnt lgkmcnt(10)
  v_mfma_f32_16x16x32_bf16 v[84:87], v[40:43], a[56:59], v[84:87]
  ds_read_b64_tr_b16 v[36:37], v31 offset:9440
  ds_read_b64_tr_b16 v[38:39], v31 offset:11744
  v_mfma_f32_16x16x32_bf16 v[84:87], v[44:47], a[60:63], v[84:87]
  v_cvt_pk_bf16_f32 v168, v80, v81
  v_cvt_pk_bf16_f32 v169, v82, v83
  s_add_u32 s57, s58, 2048
  buffer_store_dwordx2 v[168:169], v2, s[24:27], s57 offen sc1
  ds_read_b64_tr_b16 v[40:41], v31 offset:18656
  ds_read_b64_tr_b16 v[42:43], v31 offset:20960
  s_waitcnt lgkmcnt(10)
  v_mfma_f32_16x16x32_bf16 v[88:91], v[48:51], a[48:51], v[88:91]
  ds_read_b64_tr_b16 v[44:45], v31 offset:27872
  ds_read_b64_tr_b16 v[46:47], v31 offset:30176
  v_mfma_f32_16x16x32_bf16 v[88:91], v[52:55], a[52:55], v[88:91]
  ds_read_b64_tr_b16 v[48:49], v31 offset:256
  ds_read_b64_tr_b16 v[50:51], v31 offset:2560
  s_waitcnt lgkmcnt(10)
  v_mfma_f32_16x16x32_bf16 v[88:91], v[56:59], a[56:59], v[88:91]
  ds_read_b64_tr_b16 v[52:53], v31 offset:9472
  ds_read_b64_tr_b16 v[54:55], v31 offset:11776
  v_mfma_f32_16x16x32_bf16 v[88:91], v[60:63], a[60:63], v[88:91]
  v_cvt_pk_bf16_f32 v170, v84, v85
  v_cvt_pk_bf16_f32 v171, v86, v87
  s_add_u32 s57, s58, 2560
  buffer_store_dwordx2 v[170:171], v2, s[24:27], s57 offen sc1
  ds_read_b64_tr_b16 v[56:57], v31 offset:18688
  ds_read_b64_tr_b16 v[58:59], v31 offset:20992
  s_waitcnt lgkmcnt(10)
  v_mfma_f32_16x16x32_bf16 v[92:95], v[32:35], a[48:51], v[92:95]
  ds_read_b64_tr_b16 v[60:61], v31 offset:27904
  ds_read_b64_tr_b16 v[62:63], v31 offset:30208
  v_mfma_f32_16x16x32_bf16 v[92:95], v[36:39], a[52:55], v[92:95]
  s_waitcnt lgkmcnt(8)
  v_mfma_f32_16x16x32_bf16 v[92:95], v[40:43], a[56:59], v[92:95]
  v_mfma_f32_16x16x32_bf16 v[92:95], v[44:47], a[60:63], v[92:95]
  v_cvt_pk_bf16_f32 v172, v88, v89
  v_cvt_pk_bf16_f32 v173, v90, v91
  s_add_u32 s57, s58, 3072
  buffer_store_dwordx2 v[172:173], v2, s[24:27], s57 offen sc1
  s_waitcnt lgkmcnt(4)
  v_mfma_f32_16x16x32_bf16 v[96:99], v[48:51], a[48:51], v[96:99]
  v_mfma_f32_16x16x32_bf16 v[96:99], v[52:55], a[52:55], v[96:99]
  s_waitcnt lgkmcnt(0)
  v_mfma_f32_16x16x32_bf16 v[96:99], v[56:59], a[56:59], v[96:99]
  v_mfma_f32_16x16x32_bf16 v[96:99], v[60:63], a[60:63], v[96:99]
  v_cvt_pk_bf16_f32 v174, v92, v93
  v_cvt_pk_bf16_f32 v175, v94, v95
  s_add_u32 s57, s58, 3584
  buffer_store_dwordx2 v[174:175], v2, s[24:27], s57 offen sc1
  s_nop 7
  v_cvt_pk_bf16_f32 v176, v96, v97
  v_cvt_pk_bf16_f32 v177, v98, v99
  s_add_u32 s57, s58, 4096
  buffer_store_dwordx2 v[176:177], v2, s[24:27], s57 offen sc1
  s_lshl_b32 s56, s6, 1
  s_lshl_b32 s57, s5, 4
  s_add_u32 s56, s56, s57
  s_lshl_b32 s57, s90, 3
  s_add_u32 s56, s56, s57
  v_add_u32 v3, s56, v1
  s_lshl_b32 s57, s4, 3
  s_add_u32 s57, s57, 524672
  v_lshlrev_b32 v3, 9, v3
  v_add_u32 v3, s57, v3
  v_mov_b32 v6, s88
  v_mov_b32 v7, s89
  s_waitcnt vmcnt(0)
  s_mov_b64 exec, 3
  buffer_store_dwordx2 v[6:7], v3, s[24:27], 0 offen sc1
  s_mov_b64 exec, -1
  v_and_b32 v2, 7, v1
  v_lshlrev_b32 v2, 3, v2
  s_lshl_b32 s56, s2, 9
  s_add_u32 s56, s56, 524672
  v_add_u32 v2, s56, v2
  s_mul_i32 s56, s4, 288
  v_add_u32 v25, s56, v0
  v_lshlrev_b32 v16, 3, v25
  v_lshrrev_b32 v20, 6, v25
  v_and_b32 v21, 63, v25
  s_movk_i32 s57, 7282
  v_mul_lo_u32 v22, v20, s57
  v_lshrrev_b32 v22, 16, v22
  v_mul_u32_u24 v23, 9, v22
  v_sub_u32 v23, v20, v23
  v_lshlrev_b32 v22, 4, v22
  s_lshr_b32 s57, s5, 2
  s_lshl_b32 s57, s57, 1
  s_add_u32 s57, s57, s90
  s_lshl_b32 s57, s57, 6
  v_and_b32 v24, 15, v21
  v_add_u32 v22, v22, v24
  v_add_u32 v22, s57, v22
  v_mul_u32_u24 v22, 2304, v22
  v_lshrrev_b32 v21, 4, v21
  v_lshlrev_b32 v21, 2, v21
  v_lshl_add_u32 v21, v23, 4, v21
  s_and_b32 s57, s5, 3
  s_mul_i32 s57, s57, 144
  s_add_u32 s57, s57, 576
  v_add_u32 v21, s57, v21
  v_lshl_add_u32 v13, v21, 1, v22
  v_add_u32 v25, s56, v0
  v_add_u32 v25, 256, v25
  v_lshlrev_b32 v17, 3, v25
  v_lshrrev_b32 v20, 6, v25
  v_and_b32 v21, 63, v25
  s_movk_i32 s57, 7282
  v_mul_lo_u32 v22, v20, s57
  v_lshrrev_b32 v22, 16, v22
  v_mul_u32_u24 v23, 9, v22
  v_sub_u32 v23, v20, v23
  v_lshlrev_b32 v22, 4, v22
  s_lshr_b32 s57, s5, 2
  s_lshl_b32 s57, s57, 1
  s_add_u32 s57, s57, s90
  s_lshl_b32 s57, s57, 6
  v_and_b32 v24, 15, v21
  v_add_u32 v22, v22, v24
  v_add_u32 v22, s57, v22
  v_mul_u32_u24 v22, 2304, v22
  v_lshrrev_b32 v21, 4, v21
  v_lshlrev_b32 v21, 2, v21
  v_lshl_add_u32 v21, v23, 4, v21
  s_and_b32 s57, s5, 3
  s_mul_i32 s57, s57, 144
  s_add_u32 s57, s57, 576
  v_add_u32 v21, s57, v21
  v_lshl_add_u32 v14, v21, 1, v22
  s_lshl_b32 s56, s90, 4
  s_add_u32 s56, s56, s5
  s_lshl_b32 s56, s56, 3
  s_mul_i32 s56, s56, 18432
  s_add_u32 s56, s56, 14680064
  s_mov_b32 s55, 0x20000
  buffer_load_dwordx2 v[240:241], v2, s[24:27], 0 offen sc1
L_spin_67:
  s_waitcnt vmcnt(0)
  v_cmp_ne_u64 vcc, s[88:89], v[240:241]
  s_cbranch_vccz L_spun_68
  s_sleep 1
  buffer_load_dwordx2 v[240:241], v2, s[24:27], 0 offen sc1
  s_sub_u32 s55, s55, 1
  s_cmp_lg_u32 s55, 0
  s_cbranch_scc1 L_spin_67
L_spun_68:
  s_cmp_eq_u32 s6, 0
  s_cbranch_scc1 L_rx_69
  s_add_u32 s57, s56, 0
  buffer_load_dwordx2 v[32:33], v16, s[24:27], s57 offen sc1
  s_add_u32 s57, s56, 18432
  buffer_load_dwordx2 v[36:37], v16, s[24:27], s57 offen sc1
  s_add_u32 s57, s56, 36864
  buffer_load_dwordx2 v[40:41], v16, s[24:27], s57 offen sc1
  s_add_u32 s57, s56, 55296
  buffer_load_dwordx2 v[44:45], v16, s[24:27], s57 offen sc1
  s_add_u32 s57, s56, 73728
  buffer_load_dwordx2 v[48:49], v16, s[24:27], s57 offen sc1
  s_add_u32 s57, s56, 92160
  buffer_load_dwordx2 v[52:53], v16, s[24:27], s57 offen sc1
  s_add_u32 s57, s56, 110592
  buffer_load_dwordx2 v[56:57], v16, s[24:27], s57 offen sc1
  s_add_u32 s57, s56, 129024
  buffer_load_dwordx2 v[60:61], v16, s[24:27], s57 offen sc1
  s_waitcnt vmcnt(0)
  v_lshlrev_b32 v160, 16, v32
  v_lshlrev_b32 v169, 16, v36
  v_add_f32 v160, v160, v169
  v_lshlrev_b32 v168, 16, v40
  v_add_f32 v160, v160, v168
  v_lshlrev_b32 v169, 16, v44
  v_add_f32 v160, v160, v169
  v_lshlrev_b32 v168, 16, v48
  v_add_f32 v160, v160, v168
  v_lshlrev_b32 v169, 16, v52
  v_add_f32 v160, v160, v169
  v_lshlrev_b32 v168, 16, v56
  v_add_f32 v160, v160, v168
  v_lshlrev_b32 v169, 16, v60
  v_add_f32 v160, v160, v169
  v_and_b32 v161, 0xffff0000, v32
  v_and_b32 v169, 0xffff0000, v36
  v_add_f32 v161, v161, v169
  v_and_b32 v168, 0xffff0000, v40
  v_add_f32 v161, v161, v168
  v_and_b32 v169, 0xffff0000, v44
  v_add_f32 v161, v161, v169
  v_and_b32 v168, 0xffff0000, v48
  v_add_f32 v161, v161, v168
  v_and_b32 v169, 0xffff0000, v52
  v_add_f32 v161, v161, v169
  v_and_b32 v168, 0xffff0000, v56
  v_add_f32 v161, v161, v168
  v_and_b32 v169, 0xffff0000, v60
  v_add_f32 v161, v161, v169
  v_lshlrev_b32 v162, 16, v33
  v_lshlrev_b32 v169, 16, v37
  v_add_f32 v162, v162, v169
  v_lshlrev_b32 v168, 16, v41
  v_add_f32 v162, v162, v168
  v_lshlrev_b32 v169, 16, v45
  v_add_f32 v162, v162, v169
  v_lshlrev_b32 v168, 16, v49
  v_add_f32 v162, v162, v168
  v_lshlrev_b32 v169, 16, v53
  v_add_f32 v162, v162, v169
  v_lshlrev_b32 v168, 16, v57
  v_add_f32 v162, v162, v168
  v_lshlrev_b32 v169, 16, v61
  v_add_f32 v162, v162, v169
  v_and_b32 v163, 0xffff0000, v33
  v_and_b32 v169, 0xffff0000, v37
  v_add_f32 v163, v163, v169
  v_and_b32 v168, 0xffff0000, v41
  v_add_f32 v163, v163, v168
  v_and_b32 v169, 0xffff0000, v45
  v_add_f32 v163, v163, v169
  v_and_b32 v168, 0xffff0000, v49
  v_add_f32 v163, v163, v168
  v_and_b32 v169, 0xffff0000, v53
  v_add_f32 v163, v163, v169
  v_and_b32 v168, 0xffff0000, v57
  v_add_f32 v163, v163, v168
  v_and_b32 v169, 0xffff0000, v61
  v_add_f32 v163, v163, v169
  v_cvt_pk_bf16_f32 v172, v160, v161
  v_cvt_pk_bf16_f32 v173, v162, v163
  buffer_store_dwordx2 v[172:173], v13, s[20:23], 0 offen
  s_branch L_rx2_70
L_rx_69:
  s_add_u32 s57, s56, 0
  buffer_load_dwordx2 v[32:33], v16, s[24:27], s57 offen sc1
  s_add_u32 s57, s56, 18432
  buffer_load_dwordx2 v[36:37], v16, s[24:27], s57 offen sc1
  s_add_u32 s57, s56, 36864
  buffer_load_dwordx2 v[40:41], v16, s[24:27], s57 offen sc1
  s_add_u32 s57, s56, 55296
  buffer_load_dwordx2 v[44:45], v16, s[24:27], s57 offen sc1
  s_add_u32 s57, s56, 73728
  buffer_load_dwordx2 v[48:49], v16, s[24:27], s57 offen sc1
  s_add_u32 s57, s56, 92160
  buffer_load_dwordx2 v[52:53], v16, s[24:27], s57 offen sc1
  s_add_u32 s57, s56, 110592
  buffer_load_dwordx2 v[56:57], v16, s[24:27], s57 offen sc1
  s_add_u32 s57, s56, 129024
  buffer_load_dwordx2 v[60:61], v16, s[24:27], s57 offen sc1
  s_mov_b32 exec_hi, 0
  s_add_u32 s57, s56, 0
  buffer_load_dwordx2 v[96:97], v17, s[24:27], s57 offen sc1
  s_add_u32 s57, s56, 18432
  buffer_load_dwordx2 v[100:101], v17, s[24:27], s57 offen sc1
  s_add_u32 s57, s56, 36864
  buffer_load_dwordx2 v[104:105], v17, s[24:27], s57 offen sc1
  s_add_u32 s57, s56, 55296
  buffer_load_dwordx2 v[108:109], v17, s[24:27], s57 offen sc1
  s_add_u32 s57, s56, 73728
  buffer_load_dwordx2 v[112:113], v17, s[24:27], s57 offen sc1
  s_add_u32 s57, s56, 92160
  buffer_load_dwordx2 v[116:117], v17, s[24:27], s57 offen sc1
  s_add_u32 s57, s56, 110592
  buffer_load_dwordx2 v[120:121], v17, s[24:27], s57 offen sc1
  s_add_u32 s57, s56, 129024
  buffer_load_dwordx2 v[124:125], v17, s[24:27], s57 offen sc1
  s_mov_b64 exec, -1
  s_waitcnt vmcnt(8)
  v_lshlrev_b32 v160, 16, v32
  v_lshlrev_b32 v169, 16, v36
  v_add_f32 v160, v160, v169
  v_lshlrev_b32 v168, 16, v40
  v_add_f32 v160, v160, v168
  v_lshlrev_b32 v169, 16, v44
  v_add_f32 v160, v160, v169
  v_lshlrev_b32 v168, 16, v48
  v_add_f32 v160, v160, v168
  v_lshlrev_b32 v169, 16, v52
  v_add_f32 v160, v160, v169
  v_lshlrev_b32 v168, 16, v56
  v_add_f32 v160, v160, v168
  v_lshlrev_b32 v169, 16, v60
  v_add_f32 v160, v160, v169
  v_and_b32 v161, 0xffff0000, v32
  v_and_b32 v169, 0xffff0000, v36
  v_add_f32 v161, v161, v169
  v_and_b32 v168, 0xffff0000, v40
  v_add_f32 v161, v161, v168
  v_and_b32 v169, 0xffff0000, v44
  v_add_f32 v161, v161, v169
  v_and_b32 v168, 0xffff0000, v48
  v_add_f32 v161, v161, v168
  v_and_b32 v169, 0xffff0000, v52
  v_add_f32 v161, v161, v169
  v_and_b32 v168, 0xffff0000, v56
  v_add_f32 v161, v161, v168
  v_and_b32 v169, 0xffff0000, v60
  v_add_f32 v161, v161, v169
  v_lshlrev_b32 v162, 16, v33
  v_lshlrev_b32 v169, 16, v37
  v_add_f32 v162, v162, v169
  v_lshlrev_b32 v168, 16, v41
  v_add_f32 v162, v162, v168
  v_lshlrev_b32 v169, 16, v45
  v_add_f32 v162, v162, v169
  v_lshlrev_b32 v168, 16, v49
  v_add_f32 v162, v162, v168
  v_lshlrev_b32 v169, 16, v53
  v_add_f32 v162, v162, v169
  v_lshlrev_b32 v168, 16, v57
  v_add_f32 v162, v162, v168
  v_lshlrev_b32 v169, 16, v61
  v_add_f32 v162, v162, v169
  v_and_b32 v163, 0xffff0000, v33
  v_and_b32 v169, 0xffff0000, v37
  v_add_f32 v163, v163, v169
  v_and_b32 v168, 0xffff0000, v41
  v_add_f32 v163, v163, v168
  v_and_b32 v169, 0xffff0000, v45
  v_add_f32 v163, v163, v169
  v_and_b32 v168, 0xffff0000, v49
  v_add_f32 v163, v163, v168
  v_and_b32 v169, 0xffff0000, v53
  v_add_f32 v163, v163, v169
  v_and_b32 v168, 0xffff0000, v57
  v_add_f32 v163, v163, v168
  v_and_b32 v169, 0xffff0000, v61
  v_add_f32 v163, v163, v169
  v_cvt_pk_bf16_f32 v172, v160, v161
  v_cvt_pk_bf16_f32 v173, v162, v163
  buffer_store_dwordx2 v[172:173], v13, s[20:23], 0 offen
  s_mov_b32 exec_hi, 0
  s_waitcnt vmcnt(1)
  v_lshlrev_b32 v160, 16, v96
  v_lshlrev_b32 v169, 16, v100
  v_add_f32 v160, v160, v169
  v_lshlrev_b32 v168, 16, v104
  v_add_f32 v160, v160, v168
  v_lshlrev_b32 v169, 16, v108
  v_add_f32 v160, v160, v169
  v_lshlrev_b32 v168, 16, v112
  v_add_f32 v160, v160, v168
  v_lshlrev_b32 v169, 16, v116
  v_add_f32 v160, v160, v169
  v_lshlrev_b32 v168, 16, v120
  v_add_f32 v160, v160, v168
  v_lshlrev_b32 v169, 16, v124
  v_add_f32 v160, v160, v169
  v_and_b32 v161, 0xffff0000, v96
  v_and_b32 v169, 0xffff0000, v100
  v_add_f32 v161, v161, v169
  v_and_b32 v168, 0xffff0000, v104
  v_add_f32 v161, v161, v168
  v_and_b32 v169, 0xffff0000, v108
  v_add_f32 v161, v161, v169
  v_and_b32 v168, 0xffff0000, v112
  v_add_f32 v161, v161, v168
  v_and_b32 v169, 0xffff0000, v116
  v_add_f32 v161, v161, v169
  v_and_b32 v168, 0xffff0000, v120
  v_add_f32 v161, v161, v168
  v_and_b32 v169, 0xffff0000, v124
  v_add_f32 v161, v161, v169
  v_lshlrev_b32 v162, 16, v97
  v_lshlrev_b32 v169, 16, v101
  v_add_f32 v162, v162, v169
  v_lshlrev_b32 v168, 16, v105
  v_add_f32 v162, v162, v168
  v_lshlrev_b32 v169, 16, v109
  v_add_f32 v162, v162, v169
  v_lshlrev_b32 v168, 16, v113
  v_add_f32 v162, v162, v168
  v_lshlrev_b32 v169, 16, v117
  v_add_f32 v162, v162, v169
  v_lshlrev_b32 v168, 16, v121
  v_add_f32 v162, v162, v168
  v_lshlrev_b32 v169, 16, v125
  v_add_f32 v162, v162, v169
  v_and_b32 v163, 0xffff0000, v97
  v_and_b32 v169, 0xffff0000, v101
  v_add_f32 v163, v163, v169
  v_and_b32 v168, 0xffff0000, v105
  v_add_f32 v163, v163, v168
  v_and_b32 v169, 0xffff0000, v109
  v_add_f32 v163, v163, v169
  v_and_b32 v168, 0xffff0000, v113
  v_add_f32 v163, v163, v168
  v_and_b32 v169, 0xffff0000, v117
  v_add_f32 v163, v163, v169
  v_and_b32 v168, 0xffff0000, v121
  v_add_f32 v163, v163, v168
  v_and_b32 v169, 0xffff0000, v125
  v_add_f32 v163, v163, v169
  v_cvt_pk_bf16_f32 v172, v160, v161
  v_cvt_pk_bf16_f32 v173, v162, v163
  buffer_store_dwordx2 v[172:173], v14, s[20:23], 0 offen
  s_mov_b64 exec, -1
L_rx2_70:
  s_endpgm
L_resc_40:
  v_max_f32 v168, 0, v168
  v_sub_f32 v12, 0, v168
  v_exp_f32 v12, v12
  v_sub_f32 v208, v208, v168
  v_sub_f32 v144, v144, v168
  v_sub_f32 v145, v145, v168
  v_sub_f32 v146, v146, v168
  v_sub_f32 v147, v147, v168
  v_sub_f32 v148, v148, v168
  v_sub_f32 v149, v149, v168
  v_sub_f32 v150, v150, v168
  v_sub_f32 v151, v151, v168
  v_sub_f32 v152, v152, v168
  v_sub_f32 v153, v153, v168
  v_sub_f32 v154, v154, v168
  v_sub_f32 v155, v155, v168
  v_sub_f32 v156, v156, v168
  v_sub_f32 v157, v157, v168
  v_sub_f32 v158, v158, v168
  v_sub_f32 v159, v159, v168
  v_mov_b32 v209, v208
  v_mov_b32 v210, v208
  v_mov_b32 v211, v208
  v_mov_b32 v212, v208
  v_mov_b32 v213, v208
  v_mov_b32 v214, v208
  v_mov_b32 v215, v208
  v_mov_b32 v216, v208
  v_mov_b32 v217, v208
  v_mov_b32 v218, v208
  v_mov_b32 v219, v208
  v_mov_b32 v220, v208
  v_mov_b32 v221, v208
  v_mov_b32 v222, v208
  v_mov_b32 v223, v208
  v_mul_f32 v10, v10, v12
  v_mul_f32 v64, v64, v12
  v_mul_f32 v65, v65, v12
  v_mul_f32 v66, v66, v12
  v_mul_f32 v67, v67, v12
  v_mul_f32 v68, v68, v12
  v_mul_f32 v69, v69, v12
  v_mul_f32 v70, v70, v12
  v_mul_f32 v71, v71, v12
  v_mul_f32 v72, v72, v12
  v_mul_f32 v73, v73, v12
  v_mul_f32 v74, v74, v12
  v_mul_f32 v75, v75, v12
  v_mul_f32 v76, v76, v12
  v_mul_f32 v77, v77, v12
  v_mul_f32 v78, v78, v12
  v_mul_f32 v79, v79, v12
  v_mul_f32 v80, v80, v12
  v_mul_f32 v81, v81, v12
  v_mul_f32 v82, v82, v12
  v_mul_f32 v83, v83, v12
  v_mul_f32 v84, v84, v12
  v_mul_f32 v85, v85, v12
  v_mul_f32 v86, v86, v12
  v_mul_f32 v87, v87, v12
  v_mul_f32 v88, v88, v12
  v_mul_f32 v89, v89, v12
  v_mul_f32 v90, v90, v12
  v_mul_f32 v91, v91, v12
  v_mul_f32 v92, v92, v12
  v_mul_f32 v93, v93, v12
  v_mul_f32 v94, v94, v12
  v_mul_f32 v95, v95, v12
  v_mul_f32 v96, v96, v12
  v_mul_f32 v97, v97, v12
  v_mul_f32 v98, v98, v12
  v_mul_f32 v99, v99, v12
  v_mul_f32 v100, v100, v12
  v_mul_f32 v101, v101, v12
  v_mul_f32 v102, v102, v12
  v_mul_f32 v103, v103, v12
  v_mul_f32 v104, v104, v12
  v_mul_f32 v105, v105, v12
  v_mul_f32 v106, v106, v12
  v_mul_f32 v107, v107, v12
  v_mul_f32 v108, v108, v12
  v_mul_f32 v109, v109, v12
  v_mul_f32 v110, v110, v12
  v_mul_f32 v111, v111, v12
  v_mul_f32 v112, v112, v12
  v_mul_f32 v113, v113, v12
  v_mul_f32 v114, v114, v12
  v_mul_f32 v115, v115, v12
  v_mul_f32 v116, v116, v12
  v_mul_f32 v117, v117, v12
  v_mul_f32 v118, v118, v12
  v_mul_f32 v119, v119, v12
  v_mul_f32 v120, v120, v12
  v_mul_f32 v121, v121, v12
  v_mul_f32 v122, v122, v12
  v_mul_f32 v123, v123, v12
  v_mul_f32 v124, v124, v12
  v_mul_f32 v125, v125, v12
  v_mul_f32 v126, v126, v12
  v_mul_f32 v127, v127, v12
  s_nop 1
  s_branch L_back_41
L_resc_42:
  v_max_f32 v168, 0, v168
  v_sub_f32 v12, 0, v168
  v_exp_f32 v12, v12
  v_sub_f32 v208, v208, v168
  v_sub_f32 v128, v128, v168
  v_sub_f32 v129, v129, v168
  v_sub_f32 v130, v130, v168
  v_sub_f32 v131, v131, v168
  v_sub_f32 v132, v132, v168
  v_sub_f32 v133, v133, v168
  v_sub_f32 v134, v134, v168
  v_sub_f32 v135, v135, v168
  v_sub_f32 v136, v136, v168
  v_sub_f32 v137, v137, v168
  v_sub_f32 v138, v138, v168
  v_sub_f32 v139, v139, v168
  v_sub_f32 v140, v140, v168
  v_sub_f32 v141, v141, v168
  v_sub_f32 v142, v142, v168
  v_sub_f32 v143, v143, v168
  v_mov_b32 v209, v208
  v_mov_b32 v210, v208
  v_mov_b32 v211, v208
  v_mov_b32 v212, v208
  v_mov_b32 v213, v208
  v_mov_b32 v214, v208
  v_mov_b32 v215, v208
  v_mov_b32 v216, v208
  v_mov_b32 v217, v208
  v_mov_b32 v218, v208
  v_mov_b32 v219, v208
  v_mov_b32 v220, v208
  v_mov_b32 v221, v208
  v_mov_b32 v222, v208
  v_mov_b32 v223, v208
  v_mul_f32 v10, v10, v12
  v_mul_f32 v64, v64, v12
  v_mul_f32 v65, v65, v12
  v_mul_f32 v66, v66, v12
  v_mul_f32 v67, v67, v12
  v_mul_f32 v68, v68, v12
  v_mul_f32 v69, v69, v12
  v_mul_f32 v70, v70, v12
  v_mul_f32 v71, v71, v12
  v_mul_f32 v72, v72, v12
  v_mul_f32 v73, v73, v12
  v_mul_f32 v74, v74, v12
  v_mul_f32 v75, v75, v12
  v_mul_f32 v76, v76, v12
  v_mul_f32 v77, v77, v12
  v_mul_f32 v78, v78, v12
  v_mul_f32 v79, v79, v12
  v_mul_f32 v80, v80, v12
  v_mul_f32 v81, v81, v12
  v_mul_f32 v82, v82, v12
  v_mul_f32 v83, v83, v12
  v_mul_f32 v84, v84, v12
  v_mul_f32 v85, v85, v12
  v_mul_f32 v86, v86, v12
  v_mul_f32 v87, v87, v12
  v_mul_f32 v88, v88, v12
  v_mul_f32 v89, v89, v12
  v_mul_f32 v90, v90, v12
  v_mul_f32 v91, v91, v12
  v_mul_f32 v92, v92, v12
  v_mul_f32 v93, v93, v12
  v_mul_f32 v94, v94, v12
  v_mul_f32 v95, v95, v12
  v_mul_f32 v96, v96, v12
  v_mul_f32 v97, v97, v12
  v_mul_f32 v98, v98, v12
  v_mul_f32 v99, v99, v12
  v_mul_f32 v100, v100, v12
  v_mul_f32 v101, v101, v12
  v_mul_f32 v102, v102, v12
  v_mul_f32 v103, v103, v12
  v_mul_f32 v104, v104, v12
  v_mul_f32 v105, v105, v12
  v_mul_f32 v106, v106, v12
  v_mul_f32 v107, v107, v12
  v_mul_f32 v108, v108, v12
  v_mul_f32 v109, v109, v12
  v_mul_f32 v110, v110, v12
  v_mul_f32 v111, v111, v12
  v_mul_f32 v112, v112, v12
  v_mul_f32 v113, v113, v12
  v_mul_f32 v114, v114, v12
  v_mul_f32 v115, v115, v12
  v_mul_f32 v116, v116, v12
  v_mul_f32 v117, v117, v12
  v_mul_f32 v118, v118, v12
  v_mul_f32 v119, v119, v12
  v_mul_f32 v120, v120, v12
  v_mul_f32 v121, v121, v12
  v_mul_f32 v122, v122, v12
  v_mul_f32 v123, v123, v12
  v_mul_f32 v124, v124, v12
  v_mul_f32 v125, v125, v12
  v_mul_f32 v126, v126, v12
  v_mul_f32 v127, v127, v12
  s_nop 1
  s_branch L_back_43
L_resc_44:
  v_max_f32 v168, 0, v168
  v_sub_f32 v12, 0, v168
  v_exp_f32 v12, v12
  v_sub_f32 v208, v208, v168
  v_sub_f32 v144, v144, v168
  v_sub_f32 v145, v145, v168
  v_sub_f32 v146, v146, v168
  v_sub_f32 v147, v147, v168
  v_sub_f32 v148, v148, v168
  v_sub_f32 v149, v149, v168
  v_sub_f32 v150, v150, v168
  v_sub_f32 v151, v151, v168
  v_sub_f32 v152, v152, v168
  v_sub_f32 v153, v153, v168
  v_sub_f32 v154, v154, v168
  v_sub_f32 v155, v155, v168
  v_sub_f32 v156, v156, v168
  v_sub_f32 v157, v157, v168
  v_sub_f32 v158, v158, v168
  v_sub_f32 v159, v159, v168
  v_mov_b32 v209, v208
  v_mov_b32 v210, v208
  v_mov_b32 v211, v208
  v_mov_b32 v212, v208
  v_mov_b32 v213, v208
  v_mov_b32 v214, v208
  v_mov_b32 v215, v208
  v_mov_b32 v216, v208
  v_mov_b32 v217, v208
  v_mov_b32 v218, v208
  v_mov_b32 v219, v208
  v_mov_b32 v220, v208
  v_mov_b32 v221, v208
  v_mov_b32 v222, v208
  v_mov_b32 v223, v208
  v_mul_f32 v10, v10, v12
  v_mul_f32 v64, v64, v12
  v_mul_f32 v65, v65, v12
  v_mul_f32 v66, v66, v12
  v_mul_f32 v67, v67, v12
  v_mul_f32 v68, v68, v12
  v_mul_f32 v69, v69, v12
  v_mul_f32 v70, v70, v12
  v_mul_f32 v71, v71, v12
  v_mul_f32 v72, v72, v12
  v_mul_f32 v73, v73, v12
  v_mul_f32 v74, v74, v12
  v_mul_f32 v75, v75, v12
  v_mul_f32 v76, v76, v12
  v_mul_f32 v77, v77, v12
  v_mul_f32 v78, v78, v12
  v_mul_f32 v79, v79, v12
  v_mul_f32 v80, v80, v12
  v_mul_f32 v81, v81, v12
  v_mul_f32 v82, v82, v12
  v_mul_f32 v83, v83, v12
  v_mul_f32 v84, v84, v12
  v_mul_f32 v85, v85, v12
  v_mul_f32 v86, v86, v12
  v_mul_f32 v87, v87, v12
  v_mul_f32 v88, v88, v12
  v_mul_f32 v89, v89, v12
  v_mul_f32 v90, v90, v12
  v_mul_f32 v91, v91, v12
  v_mul_f32 v92, v92, v12
  v_mul_f32 v93, v93, v12
  v_mul_f32 v94, v94, v12
  v_mul_f32 v95, v95, v12
  v_mul_f32 v96, v96, v12
  v_mul_f32 v97, v97, v12
  v_mul_f32 v98, v98, v12
  v_mul_f32 v99, v99, v12
  v_mul_f32 v100, v100, v12
  v_mul_f32 v101, v101, v12
  v_mul_f32 v102, v102, v12
  v_mul_f32 v103, v103, v12
  v_mul_f32 v104, v104, v12
  v_mul_f32 v105, v105, v12
  v_mul_f32 v106, v106, v12
  v_mul_f32 v107, v107, v12
  v_mul_f32 v108, v108, v12
  v_mul_f32 v109, v109, v12
  v_mul_f32 v110, v110, v12
  v_mul_f32 v111, v111, v12
  v_mul_f32 v112, v112, v12
  v_mul_f32 v113, v113, v12
  v_mul_f32 v114, v114, v12
  v_mul_f32 v115, v115, v12
  v_mul_f32 v116, v116, v12
  v_mul_f32 v117, v117, v12
  v_mul_f32 v118, v118, v12
  v_mul_f32 v119, v119, v12
  v_mul_f32 v120, v120, v12
  v_mul_f32 v121, v121, v12
  v_mul_f32 v122, v122, v12
  v_mul_f32 v123, v123, v12
  v_mul_f32 v124, v124, v12
  v_mul_f32 v125, v125, v12
  v_mul_f32 v126, v126, v12
  v_mul_f32 v127, v127, v12
  s_nop 1
  s_branch L_back_45
L_resc_46:
  v_max_f32 v168, 0, v168
  v_sub_f32 v12, 0, v168
  v_exp_f32 v12, v12
  v_sub_f32 v208, v208, v168
  v_sub_f32 v128, v128, v168
  v_sub_f32 v129, v129, v168
  v_sub_f32 v130, v130, v168
  v_sub_f32 v131, v131, v168
  v_sub_f32 v132, v132, v168
  v_sub_f32 v133, v133, v168
  v_sub_f32 v134, v134, v168
  v_sub_f32 v135, v135, v168
  v_sub_f32 v136, v136, v168
  v_sub_f32 v137, v137, v168
  v_sub_f32 v138, v138, v168
  v_sub_f32 v139, v139, v168
  v_sub_f32 v140, v140, v168
  v_sub_f32 v141, v141, v168
  v_sub_f32 v142, v142, v168
  v_sub_f32 v143, v143, v168
  v_mov_b32 v209, v208
  v_mov_b32 v210, v208
  v_mov_b32 v211, v208
  v_mov_b32 v212, v208
  v_mov_b32 v213, v208
  v_mov_b32 v214, v208
  v_mov_b32 v215, v208
  v_mov_b32 v216, v208
  v_mov_b32 v217, v208
  v_mov_b32 v218, v208
  v_mov_b32 v219, v208
  v_mov_b32 v220, v208
  v_mov_b32 v221, v208
  v_mov_b32 v222, v208
  v_mov_b32 v223, v208
  v_mul_f32 v10, v10, v12
  v_mul_f32 v64, v64, v12
  v_mul_f32 v65, v65, v12
  v_mul_f32 v66, v66, v12
  v_mul_f32 v67, v67, v12
  v_mul_f32 v68, v68, v12
  v_mul_f32 v69, v69, v12
  v_mul_f32 v70, v70, v12
  v_mul_f32 v71, v71, v12
  v_mul_f32 v72, v72, v12
  v_mul_f32 v73, v73, v12
  v_mul_f32 v74, v74, v12
  v_mul_f32 v75, v75, v12
  v_mul_f32 v76, v76, v12
  v_mul_f32 v77, v77, v12
  v_mul_f32 v78, v78, v12
  v_mul_f32 v79, v79, v12
  v_mul_f32 v80, v80, v12
  v_mul_f32 v81, v81, v12
  v_mul_f32 v82, v82, v12
  v_mul_f32 v83, v83, v12
  v_mul_f32 v84, v84, v12
  v_mul_f32 v85, v85, v12
  v_mul_f32 v86, v86, v12
  v_mul_f32 v87, v87, v12
  v_mul_f32 v88, v88, v12
  v_mul_f32 v89, v89, v12
  v_mul_f32 v90, v90, v12
  v_mul_f32 v91, v91, v12
  v_mul_f32 v92, v92, v12
  v_mul_f32 v93, v93, v12
  v_mul_f32 v94, v94, v12
  v_mul_f32 v95, v95, v12
  v_mul_f32 v96, v96, v12
  v_mul_f32 v97, v97, v12
  v_mul_f32 v98, v98, v12
  v_mul_f32 v99, v99, v12
  v_mul_f32 v100, v100, v12
  v_mul_f32 v101, v101, v12
  v_mul_f32 v102, v102, v12
  v_mul_f32 v103, v103, v12
  v_mul_f32 v104, v104, v12
  v_mul_f32 v105, v105, v12
  v_mul_f32 v106, v106, v12
  v_mul_f32 v107, v107, v12
  v_mul_f32 v108, v108, v12
  v_mul_f32 v109, v109, v12
  v_mul_f32 v110, v110, v12
  v_mul_f32 v111, v111, v12
  v_mul_f32 v112, v112, v12
  v_mul_f32 v113, v113, v12
  v_mul_f32 v114, v114, v12
  v_mul_f32 v115, v115, v12
  v_mul_f32 v116, v116, v12
  v_mul_f32 v117, v117, v12
  v_mul_f32 v118, v118, v12
  v_mul_f32 v119, v119, v12
  v_mul_f32 v120, v120, v12
  v_mul_f32 v121, v121, v12
  v_mul_f32 v122, v122, v12
  v_mul_f32 v123, v123, v12
  v_mul_f32 v124, v124, v12
  v_mul_f32 v125, v125, v12
  v_mul_f32 v126, v126, v12
  v_mul_f32 v127, v127, v12
  s_nop 1
  s_branch L_back_47
L_resc_48:
  v_max_f32 v168, 0, v168
  v_sub_f32 v12, 0, v168
  v_exp_f32 v12, v12
  v_sub_f32 v208, v208, v168
  v_sub_f32 v144, v144, v168
  v_sub_f32 v145, v145, v168
  v_sub_f32 v146, v146, v168
  v_sub_f32 v147, v147, v168
  v_sub_f32 v148, v148, v168
  v_sub_f32 v149, v149, v168
  v_sub_f32 v150, v150, v168
  v_sub_f32 v151, v151, v168
  v_sub_f32 v152, v152, v168
  v_sub_f32 v153, v153, v168
  v_sub_f32 v154, v154, v168
  v_sub_f32 v155, v155, v168
  v_sub_f32 v156, v156, v168
  v_sub_f32 v157, v157, v168
  v_sub_f32 v158, v158, v168
  v_sub_f32 v159, v159, v168
  v_mov_b32 v209, v208
  v_mov_b32 v210, v208
  v_mov_b32 v211, v208
  v_mov_b32 v212, v208
  v_mov_b32 v213, v208
  v_mov_b32 v214, v208
  v_mov_b32 v215, v208
  v_mov_b32 v216, v208
  v_mov_b32 v217, v208
  v_mov_b32 v218, v208
  v_mov_b32 v219, v208
  v_mov_b32 v220, v208
  v_mov_b32 v221, v208
  v_mov_b32 v222, v208
  v_mov_b32 v223, v208
  v_mul_f32 v10, v10, v12
  v_mul_f32 v64, v64, v12
  v_mul_f32 v65, v65, v12
  v_mul_f32 v66, v66, v12
  v_mul_f32 v67, v67, v12
  v_mul_f32 v68, v68, v12
  v_mul_f32 v69, v69, v12
  v_mul_f32 v70, v70, v12
  v_mul_f32 v71, v71, v12
  v_mul_f32 v72, v72, v12
  v_mul_f32 v73, v73, v12
  v_mul_f32 v74, v74, v12
  v_mul_f32 v75, v75, v12
  v_mul_f32 v76, v76, v12
  v_mul_f32 v77, v77, v12
  v_mul_f32 v78, v78, v12
  v_mul_f32 v79, v79, v12
  v_mul_f32 v80, v80, v12
  v_mul_f32 v81, v81, v12
  v_mul_f32 v82, v82, v12
  v_mul_f32 v83, v83, v12
  v_mul_f32 v84, v84, v12
  v_mul_f32 v85, v85, v12
  v_mul_f32 v86, v86, v12
  v_mul_f32 v87, v87, v12
  v_mul_f32 v88, v88, v12
  v_mul_f32 v89, v89, v12
  v_mul_f32 v90, v90, v12
  v_mul_f32 v91, v91, v12
  v_mul_f32 v92, v92, v12
  v_mul_f32 v93, v93, v12
  v_mul_f32 v94, v94, v12
  v_mul_f32 v95, v95, v12
  v_mul_f32 v96, v96, v12
  v_mul_f32 v97, v97, v12
  v_mul_f32 v98, v98, v12
  v_mul_f32 v99, v99, v12
  v_mul_f32 v100, v100, v12
  v_mul_f32 v101, v101, v12
  v_mul_f32 v102, v102, v12
  v_mul_f32 v103, v103, v12
  v_mul_f32 v104, v104, v12
  v_mul_f32 v105, v105, v12
  v_mul_f32 v106, v106, v12
  v_mul_f32 v107, v107, v12
  v_mul_f32 v108, v108, v12
  v_mul_f32 v109, v109, v12
  v_mul_f32 v110, v110, v12
  v_mul_f32 v111, v111, v12
  v_mul_f32 v112, v112, v12
  v_mul_f32 v113, v113, v12
  v_mul_f32 v114, v114, v12
  v_mul_f32 v115, v115, v12
  v_mul_f32 v116, v116, v12
  v_mul_f32 v117, v117, v12
  v_mul_f32 v118, v118, v12
  v_mul_f32 v119, v119, v12
  v_mul_f32 v120, v120, v12
  v_mul_f32 v121, v121, v12
  v_mul_f32 v122, v122, v12
  v_mul_f32 v123, v123, v12
  v_mul_f32 v124, v124, v12
  v_mul_f32 v125, v125, v12
  v_mul_f32 v126, v126, v12
  v_mul_f32 v127, v127, v12
  s_nop 1
  s_branch L_back_49
L_resc_50:
  v_max_f32 v168, 0, v168
  v_sub_f32 v12, 0, v168
  v_exp_f32 v12, v12
  v_sub_f32 v208, v208, v168
  v_sub_f32 v128, v128, v168
  v_sub_f32 v129, v129, v168
  v_sub_f32 v130, v130, v168
  v_sub_f32 v131, v131, v168
  v_sub_f32 v132, v132, v168
  v_sub_f32 v133, v133, v168
  v_sub_f32 v134, v134, v168
  v_sub_f32 v135, v135, v168
  v_sub_f32 v136, v136, v168
  v_sub_f32 v137, v137, v168
  v_sub_f32 v138, v138, v168
  v_sub_f32 v139, v139, v168
  v_sub_f32 v140, v140, v168
  v_sub_f32 v141, v141, v168
  v_sub_f32 v142, v142, v168
  v_sub_f32 v143, v143, v168
  v_mov_b32 v209, v208
  v_mov_b32 v210, v208
  v_mov_b32 v211, v208
  v_mov_b32 v212, v208
  v_mov_b32 v213, v208
  v_mov_b32 v214, v208
  v_mov_b32 v215, v208
  v_mov_b32 v216, v208
  v_mov_b32 v217, v208
  v_mov_b32 v218, v208
  v_mov_b32 v219, v208
  v_mov_b32 v220, v208
  v_mov_b32 v221, v208
  v_mov_b32 v222, v208
  v_mov_b32 v223, v208
  v_mul_f32 v10, v10, v12
  v_mul_f32 v64, v64, v12
  v_mul_f32 v65, v65, v12
  v_mul_f32 v66, v66, v12
  v_mul_f32 v67, v67, v12
  v_mul_f32 v68, v68, v12
  v_mul_f32 v69, v69, v12
  v_mul_f32 v70, v70, v12
  v_mul_f32 v71, v71, v12
  v_mul_f32 v72, v72, v12
  v_mul_f32 v73, v73, v12
  v_mul_f32 v74, v74, v12
  v_mul_f32 v75, v75, v12
  v_mul_f32 v76, v76, v12
  v_mul_f32 v77, v77, v12
  v_mul_f32 v78, v78, v12
  v_mul_f32 v79, v79, v12
  v_mul_f32 v80, v80, v12
  v_mul_f32 v81, v81, v12
  v_mul_f32 v82, v82, v12
  v_mul_f32 v83, v83, v12
  v_mul_f32 v84, v84, v12
  v_mul_f32 v85, v85, v12
  v_mul_f32 v86, v86, v12
  v_mul_f32 v87, v87, v12
  v_mul_f32 v88, v88, v12
  v_mul_f32 v89, v89, v12
  v_mul_f32 v90, v90, v12
  v_mul_f32 v91, v91, v12
  v_mul_f32 v92, v92, v12
  v_mul_f32 v93, v93, v12
  v_mul_f32 v94, v94, v12
  v_mul_f32 v95, v95, v12
  v_mul_f32 v96, v96, v12
  v_mul_f32 v97, v97, v12
  v_mul_f32 v98, v98, v12
  v_mul_f32 v99, v99, v12
  v_mul_f32 v100, v100, v12
  v_mul_f32 v101, v101, v12
  v_mul_f32 v102, v102, v12
  v_mul_f32 v103, v103, v12
  v_mul_f32 v104, v104, v12
  v_mul_f32 v105, v105, v12
  v_mul_f32 v106, v106, v12
  v_mul_f32 v107, v107, v12
  v_mul_f32 v108, v108, v12
  v_mul_f32 v109, v109, v12
  v_mul_f32 v110, v110, v12
  v_mul_f32 v111, v111, v12
  v_mul_f32 v112, v112, v12
  v_mul_f32 v113, v113, v12
  v_mul_f32 v114, v114, v12
  v_mul_f32 v115, v115, v12
  v_mul_f32 v116, v116, v12
  v_mul_f32 v117, v117, v12
  v_mul_f32 v118, v118, v12
  v_mul_f32 v119, v119, v12
  v_mul_f32 v120, v120, v12
  v_mul_f32 v121, v121, v12
  v_mul_f32 v122, v122, v12
  v_mul_f32 v123, v123, v12
  v_mul_f32 v124, v124, v12
  v_mul_f32 v125, v125, v12
  v_mul_f32 v126, v126, v12
  v_mul_f32 v127, v127, v12
  s_nop 1
  s_branch L_back_51
L_resc_52:
  v_max_f32 v168, 0, v168
  v_sub_f32 v12, 0, v168
  v_exp_f32 v12, v12
  v_sub_f32 v208, v208, v168
  v_sub_f32 v144, v144, v168
  v_sub_f32 v145, v145, v168
  v_sub_f32 v146, v146, v168
  v_sub_f32 v147, v147, v168
  v_sub_f32 v148, v148, v168
  v_sub_f32 v149, v149, v168
  v_sub_f32 v150, v150, v168
  v_sub_f32 v151, v151, v168
  v_sub_f32 v152, v152, v168
  v_sub_f32 v153, v153, v168
  v_sub_f32 v154, v154, v168
  v_sub_f32 v155, v155, v168
  v_sub_f32 v156, v156, v168
  v_sub_f32 v157, v157, v168
  v_sub_f32 v158, v158, v168
  v_sub_f32 v159, v159, v168
  v_mov_b32 v209, v208
  v_mov_b32 v210, v208
  v_mov_b32 v211, v208
  v_mov_b32 v212, v208
  v_mov_b32 v213, v208
  v_mov_b32 v214, v208
  v_mov_b32 v215, v208
  v_mov_b32 v216, v208
  v_mov_b32 v217, v208
  v_mov_b32 v218, v208
  v_mov_b32 v219, v208
  v_mov_b32 v220, v208
  v_mov_b32 v221, v208
  v_mov_b32 v222, v208
  v_mov_b32 v223, v208
  v_mul_f32 v10, v10, v12
  v_mul_f32 v64, v64, v12
  v_mul_f32 v65, v65, v12
  v_mul_f32 v66, v66, v12
  v_mul_f32 v67, v67, v12
  v_mul_f32 v68, v68, v12
  v_mul_f32 v69, v69, v12
  v_mul_f32 v70, v70, v12
  v_mul_f32 v71, v71, v12
  v_mul_f32 v72, v72, v12
  v_mul_f32 v73, v73, v12
  v_mul_f32 v74, v74, v12
  v_mul_f32 v75, v75, v12
  v_mul_f32 v76, v76, v12
  v_mul_f32 v77, v77, v12
  v_mul_f32 v78, v78, v12
  v_mul_f32 v79, v79, v12
  v_mul_f32 v80, v80, v12
  v_mul_f32 v81, v81, v12
  v_mul_f32 v82, v82, v12
  v_mul_f32 v83, v83, v12
  v_mul_f32 v84, v84, v12
  v_mul_f32 v85, v85, v12
  v_mul_f32 v86, v86, v12
  v_mul_f32 v87, v87, v12
  v_mul_f32 v88, v88, v12
  v_mul_f32 v89, v89, v12
  v_mul_f32 v90, v90, v12
  v_mul_f32 v91, v91, v12
  v_mul_f32 v92, v92, v12
  v_mul_f32 v93, v93, v12
  v_mul_f32 v94, v94, v12
  v_mul_f32 v95, v95, v12
  v_mul_f32 v96, v96, v12
  v_mul_f32 v97, v97, v12
  v_mul_f32 v98, v98, v12
  v_mul_f32 v99, v99, v12
  v_mul_f32 v100, v100, v12
  v_mul_f32 v101, v101, v12
  v_mul_f32 v102, v102, v12
  v_mul_f32 v103, v103, v12
  v_mul_f32 v104, v104, v12
  v_mul_f32 v105, v105, v12
  v_mul_f32 v106, v106, v12
  v_mul_f32 v107, v107, v12
  v_mul_f32 v108, v108, v12
  v_mul_f32 v109, v109, v12
  v_mul_f32 v110, v110, v12
  v_mul_f32 v111, v111, v12
  v_mul_f32 v112, v112, v12
  v_mul_f32 v113, v113, v12
  v_mul_f32 v114, v114, v12
  v_mul_f32 v115, v115, v12
  v_mul_f32 v116, v116, v12
  v_mul_f32 v117, v117, v12
  v_mul_f32 v118, v118, v12
  v_mul_f32 v119, v119, v12
  v_mul_f32 v120, v120, v12
  v_mul_f32 v121, v121, v12
  v_mul_f32 v122, v122, v12
  v_mul_f32 v123, v123, v12
  v_mul_f32 v124, v124, v12
  v_mul_f32 v125, v125, v12
  v_mul_f32 v126, v126, v12
  v_mul_f32 v127, v127, v12
  s_nop 1
  s_branch L_back_53
L_resc_54:
  v_max_f32 v168, 0, v168
  v_sub_f32 v12, 0, v168
  v_exp_f32 v12, v12
  v_sub_f32 v208, v208, v168
  v_sub_f32 v128, v128, v168
  v_sub_f32 v129, v129, v168
  v_sub_f32 v130, v130, v168
  v_sub_f32 v131, v131, v168
  v_sub_f32 v132, v132, v168
  v_sub_f32 v133, v133, v168
  v_sub_f32 v134, v134, v168
  v_sub_f32 v135, v135, v168
  v_sub_f32 v136, v136, v168
  v_sub_f32 v137, v137, v168
  v_sub_f32 v138, v138, v168
  v_sub_f32 v139, v139, v168
  v_sub_f32 v140, v140, v168
  v_sub_f32 v141, v141, v168
  v_sub_f32 v142, v142, v168
  v_sub_f32 v143, v143, v168
  v_mov_b32 v209, v208
  v_mov_b32 v210, v208
  v_mov_b32 v211, v208
  v_mov_b32 v212, v208
  v_mov_b32 v213, v208
  v_mov_b32 v214, v208
  v_mov_b32 v215, v208
  v_mov_b32 v216, v208
  v_mov_b32 v217, v208
  v_mov_b32 v218, v208
  v_mov_b32 v219, v208
  v_mov_b32 v220, v208
  v_mov_b32 v221, v208
  v_mov_b32 v222, v208
  v_mov_b32 v223, v208
  v_mul_f32 v10, v10, v12
  v_mul_f32 v64, v64, v12
  v_mul_f32 v65, v65, v12
  v_mul_f32 v66, v66, v12
  v_mul_f32 v67, v67, v12
  v_mul_f32 v68, v68, v12
  v_mul_f32 v69, v69, v12
  v_mul_f32 v70, v70, v12
  v_mul_f32 v71, v71, v12
  v_mul_f32 v72, v72, v12
  v_mul_f32 v73, v73, v12
  v_mul_f32 v74, v74, v12
  v_mul_f32 v75, v75, v12
  v_mul_f32 v76, v76, v12
  v_mul_f32 v77, v77, v12
  v_mul_f32 v78, v78, v12
  v_mul_f32 v79, v79, v12
  v_mul_f32 v80, v80, v12
  v_mul_f32 v81, v81, v12
  v_mul_f32 v82, v82, v12
  v_mul_f32 v83, v83, v12
  v_mul_f32 v84, v84, v12
  v_mul_f32 v85, v85, v12
  v_mul_f32 v86, v86, v12
  v_mul_f32 v87, v87, v12
  v_mul_f32 v88, v88, v12
  v_mul_f32 v89, v89, v12
  v_mul_f32 v90, v90, v12
  v_mul_f32 v91, v91, v12
  v_mul_f32 v92, v92, v12
  v_mul_f32 v93, v93, v12
  v_mul_f32 v94, v94, v12
  v_mul_f32 v95, v95, v12
  v_mul_f32 v96, v96, v12
  v_mul_f32 v97, v97, v12
  v_mul_f32 v98, v98, v12
  v_mul_f32 v99, v99, v12
  v_mul_f32 v100, v100, v12
  v_mul_f32 v101, v101, v12
  v_mul_f32 v102, v102, v12
  v_mul_f32 v103, v103, v12
  v_mul_f32 v104, v104, v12
  v_mul_f32 v105, v105, v12
  v_mul_f32 v106, v106, v12
  v_mul_f32 v107, v107, v12
  v_mul_f32 v108, v108, v12
  v_mul_f32 v109, v109, v12
  v_mul_f32 v110, v110, v12
  v_mul_f32 v111, v111, v12
  v_mul_f32 v112, v112, v12
  v_mul_f32 v113, v113, v12
  v_mul_f32 v114, v114, v12
  v_mul_f32 v115, v115, v12
  v_mul_f32 v116, v116, v12
  v_mul_f32 v117, v117, v12
  v_mul_f32 v118, v118, v12
  v_mul_f32 v119, v119, v12
  v_mul_f32 v120, v120, v12
  v_mul_f32 v121, v121, v12
  v_mul_f32 v122, v122, v12
  v_mul_f32 v123, v123, v12
  v_mul_f32 v124, v124, v12
  v_mul_f32 v125, v125, v12
  v_mul_f32 v126, v126, v12
  v_mul_f32 v127, v127, v12
  s_nop 1
  s_branch L_back_55
L_resc_56:
  v_max_f32 v168, 0, v168
  v_sub_f32 v12, 0, v168
  v_exp_f32 v12, v12
  v_sub_f32 v208, v208, v168
  v_sub_f32 v144, v144, v168
  v_sub_f32 v145, v145, v168
  v_sub_f32 v146, v146, v168
  v_sub_f32 v147, v147, v168
  v_sub_f32 v148, v148, v168
  v_sub_f32 v149, v149, v168
  v_sub_f32 v150, v150, v168
  v_sub_f32 v151, v151, v168
  v_sub_f32 v152, v152, v168
  v_sub_f32 v153, v153, v168
  v_sub_f32 v154, v154, v168
  v_sub_f32 v155, v155, v168
  v_sub_f32 v156, v156, v168
  v_sub_f32 v157, v157, v168
  v_sub_f32 v158, v158, v168
  v_sub_f32 v159, v159, v168
  v_mov_b32 v209, v208
  v_mov_b32 v210, v208
  v_mov_b32 v211, v208
  v_mov_b32 v212, v208
  v_mov_b32 v213, v208
  v_mov_b32 v214, v208
  v_mov_b32 v215, v208
  v_mov_b32 v216, v208
  v_mov_b32 v217, v208
  v_mov_b32 v218, v208
  v_mov_b32 v219, v208
  v_mov_b32 v220, v208
  v_mov_b32 v221, v208
  v_mov_b32 v222, v208
  v_mov_b32 v223, v208
  v_mul_f32 v10, v10, v12
  v_mul_f32 v64, v64, v12
  v_mul_f32 v65, v65, v12
  v_mul_f32 v66, v66, v12
  v_mul_f32 v67, v67, v12
  v_mul_f32 v68, v68, v12
  v_mul_f32 v69, v69, v12
  v_mul_f32 v70, v70, v12
  v_mul_f32 v71, v71, v12
  v_mul_f32 v72, v72, v12
  v_mul_f32 v73, v73, v12
  v_mul_f32 v74, v74, v12
  v_mul_f32 v75, v75, v12
  v_mul_f32 v76, v76, v12
  v_mul_f32 v77, v77, v12
  v_mul_f32 v78, v78, v12
  v_mul_f32 v79, v79, v12
  v_mul_f32 v80, v80, v12
  v_mul_f32 v81, v81, v12
  v_mul_f32 v82, v82, v12
  v_mul_f32 v83, v83, v12
  v_mul_f32 v84, v84, v12
  v_mul_f32 v85, v85, v12
  v_mul_f32 v86, v86, v12
  v_mul_f32 v87, v87, v12
  v_mul_f32 v88, v88, v12
  v_mul_f32 v89, v89, v12
  v_mul_f32 v90, v90, v12
  v_mul_f32 v91, v91, v12
  v_mul_f32 v92, v92, v12
  v_mul_f32 v93, v93, v12
  v_mul_f32 v94, v94, v12
  v_mul_f32 v95, v95, v12
  v_mul_f32 v96, v96, v12
  v_mul_f32 v97, v97, v12
  v_mul_f32 v98, v98, v12
  v_mul_f32 v99, v99, v12
  v_mul_f32 v100, v100, v12
  v_mul_f32 v101, v101, v12
  v_mul_f32 v102, v102, v12
  v_mul_f32 v103, v103, v12
  v_mul_f32 v104, v104, v12
  v_mul_f32 v105, v105, v12
  v_mul_f32 v106, v106, v12
  v_mul_f32 v107, v107, v12
  v_mul_f32 v108, v108, v12
  v_mul_f32 v109, v109, v12
  v_mul_f32 v110, v110, v12
  v_mul_f32 v111, v111, v12
  v_mul_f32 v112, v112, v12
  v_mul_f32 v113, v113, v12
  v_mul_f32 v114, v114, v12
  v_mul_f32 v115, v115, v12
  v_mul_f32 v116, v116, v12
  v_mul_f32 v117, v117, v12
  v_mul_f32 v118, v118, v12
  v_mul_f32 v119, v119, v12
  v_mul_f32 v120, v120, v12
  v_mul_f32 v121, v121, v12
  v_mul_f32 v122, v122, v12
  v_mul_f32 v123, v123, v12
  v_mul_f32 v124, v124, v12
  v_mul_f32 v125, v125, v12
  v_mul_f32 v126, v126, v12
  v_mul_f32 v127, v127, v12
  s_nop 1
  s_branch L_back_57
L_resc_58:
  v_max_f32 v168, 0, v168
  v_sub_f32 v12, 0, v168
  v_exp_f32 v12, v12
  v_sub_f32 v208, v208, v168
  v_sub_f32 v128, v128, v168
  v_sub_f32 v129, v129, v168
  v_sub_f32 v130, v130, v168
  v_sub_f32 v131, v131, v168
  v_sub_f32 v132, v132, v168
  v_sub_f32 v133, v133, v168
  v_sub_f32 v134, v134, v168
  v_sub_f32 v135, v135, v168
  v_sub_f32 v136, v136, v168
  v_sub_f32 v137, v137, v168
  v_sub_f32 v138, v138, v168
  v_sub_f32 v139, v139, v168
  v_sub_f32 v140, v140, v168
  v_sub_f32 v141, v141, v168
  v_sub_f32 v142, v142, v168
  v_sub_f32 v143, v143, v168
  v_mov_b32 v209, v208
  v_mov_b32 v210, v208
  v_mov_b32 v211, v208
  v_mov_b32 v212, v208
  v_mov_b32 v213, v208
  v_mov_b32 v214, v208
  v_mov_b32 v215, v208
  v_mov_b32 v216, v208
  v_mov_b32 v217, v208
  v_mov_b32 v218, v208
  v_mov_b32 v219, v208
  v_mov_b32 v220, v208
  v_mov_b32 v221, v208
  v_mov_b32 v222, v208
  v_mov_b32 v223, v208
  v_mul_f32 v10, v10, v12
  v_mul_f32 v64, v64, v12
  v_mul_f32 v65, v65, v12
  v_mul_f32 v66, v66, v12
  v_mul_f32 v67, v67, v12
  v_mul_f32 v68, v68, v12
  v_mul_f32 v69, v69, v12
  v_mul_f32 v70, v70, v12
  v_mul_f32 v71, v71, v12
  v_mul_f32 v72, v72, v12
  v_mul_f32 v73, v73, v12
  v_mul_f32 v74, v74, v12
  v_mul_f32 v75, v75, v12
  v_mul_f32 v76, v76, v12
  v_mul_f32 v77, v77, v12
  v_mul_f32 v78, v78, v12
  v_mul_f32 v79, v79, v12
  v_mul_f32 v80, v80, v12
  v_mul_f32 v81, v81, v12
  v_mul_f32 v82, v82, v12
  v_mul_f32 v83, v83, v12
  v_mul_f32 v84, v84, v12
  v_mul_f32 v85, v85, v12
  v_mul_f32 v86, v86, v12
  v_mul_f32 v87, v87, v12
  v_mul_f32 v88, v88, v12
  v_mul_f32 v89, v89, v12
  v_mul_f32 v90, v90, v12
  v_mul_f32 v91, v91, v12
  v_mul_f32 v92, v92, v12
  v_mul_f32 v93, v93, v12
  v_mul_f32 v94, v94, v12
  v_mul_f32 v95, v95, v12
  v_mul_f32 v96, v96, v12
  v_mul_f32 v97, v97, v12
  v_mul_f32 v98, v98, v12
  v_mul_f32 v99, v99, v12
  v_mul_f32 v100, v100, v12
  v_mul_f32 v101, v101, v12
  v_mul_f32 v102, v102, v12
  v_mul_f32 v103, v103, v12
  v_mul_f32 v104, v104, v12
  v_mul_f32 v105, v105, v12
  v_mul_f32 v106, v106, v12
  v_mul_f32 v107, v107, v12
  v_mul_f32 v108, v108, v12
  v_mul_f32 v109, v109, v12
  v_mul_f32 v110, v110, v12
  v_mul_f32 v111, v111, v12
  v_mul_f32 v112, v112, v12
  v_mul_f32 v113, v113, v12
  v_mul_f32 v114, v114, v12
  v_mul_f32 v115, v115, v12
  v_mul_f32 v116, v116, v12
  v_mul_f32 v117, v117, v12
  v_mul_f32 v118, v118, v12
  v_mul_f32 v119, v119, v12
  v_mul_f32 v120, v120, v12
  v_mul_f32 v121, v121, v12
  v_mul_f32 v122, v122, v12
  v_mul_f32 v123, v123, v12
  v_mul_f32 v124, v124, v12
  v_mul_f32 v125, v125, v12
  v_mul_f32 v126, v126, v12
  v_mul_f32 v127, v127, v12
  s_nop 1
  s_branch L_back_59
L_resc_60:
  v_max_f32 v168, 0, v168
  v_sub_f32 v12, 0, v168
  v_exp_f32 v12, v12
  v_sub_f32 v208, v208, v168
  v_sub_f32 v144, v144, v168
  v_sub_f32 v145, v145, v168
  v_sub_f32 v146, v146, v168
  v_sub_f32 v147, v147, v168
  v_sub_f32 v148, v148, v168
  v_sub_f32 v149, v149, v168
  v_sub_f32 v150, v150, v168
  v_sub_f32 v151, v151, v168
  v_sub_f32 v152, v152, v168
  v_sub_f32 v153, v153, v168
  v_sub_f32 v154, v154, v168
  v_sub_f32 v155, v155, v168
  v_sub_f32 v156, v156, v168
  v_sub_f32 v157, v157, v168
  v_sub_f32 v158, v158, v168
  v_sub_f32 v159, v159, v168
  v_mov_b32 v209, v208
  v_mov_b32 v210, v208
  v_mov_b32 v211, v208
  v_mov_b32 v212, v208
  v_mov_b32 v213, v208
  v_mov_b32 v214, v208
  v_mov_b32 v215, v208
  v_mov_b32 v216, v208
  v_mov_b32 v217, v208
  v_mov_b32 v218, v208
  v_mov_b32 v219, v208
  v_mov_b32 v220, v208
  v_mov_b32 v221, v208
  v_mov_b32 v222, v208
  v_mov_b32 v223, v208
  v_mul_f32 v10, v10, v12
  v_mul_f32 v64, v64, v12
  v_mul_f32 v65, v65, v12
  v_mul_f32 v66, v66, v12
  v_mul_f32 v67, v67, v12
  v_mul_f32 v68, v68, v12
  v_mul_f32 v69, v69, v12
  v_mul_f32 v70, v70, v12
  v_mul_f32 v71, v71, v12
  v_mul_f32 v72, v72, v12
  v_mul_f32 v73, v73, v12
  v_mul_f32 v74, v74, v12
  v_mul_f32 v75, v75, v12
  v_mul_f32 v76, v76, v12
  v_mul_f32 v77, v77, v12
  v_mul_f32 v78, v78, v12
  v_mul_f32 v79, v79, v12
  v_mul_f32 v80, v80, v12
  v_mul_f32 v81, v81, v12
  v_mul_f32 v82, v82, v12
  v_mul_f32 v83, v83, v12
  v_mul_f32 v84, v84, v12
  v_mul_f32 v85, v85, v12
  v_mul_f32 v86, v86, v12
  v_mul_f32 v87, v87, v12
  v_mul_f32 v88, v88, v12
  v_mul_f32 v89, v89, v12
  v_mul_f32 v90, v90, v12
  v_mul_f32 v91, v91, v12
  v_mul_f32 v92, v92, v12
  v_mul_f32 v93, v93, v12
  v_mul_f32 v94, v94, v12
  v_mul_f32 v95, v95, v12
  v_mul_f32 v96, v96, v12
  v_mul_f32 v97, v97, v12
  v_mul_f32 v98, v98, v12
  v_mul_f32 v99, v99, v12
  v_mul_f32 v100, v100, v12
  v_mul_f32 v101, v101, v12
  v_mul_f32 v102, v102, v12
  v_mul_f32 v103, v103, v12
  v_mul_f32 v104, v104, v12
  v_mul_f32 v105, v105, v12
  v_mul_f32 v106, v106, v12
  v_mul_f32 v107, v107, v12
  v_mul_f32 v108, v108, v12
  v_mul_f32 v109, v109, v12
  v_mul_f32 v110, v110, v12
  v_mul_f32 v111, v111, v12
  v_mul_f32 v112, v112, v12
  v_mul_f32 v113, v113, v12
  v_mul_f32 v114, v114, v12
  v_mul_f32 v115, v115, v12
  v_mul_f32 v116, v116, v12
  v_mul_f32 v117, v117, v12
  v_mul_f32 v118, v118, v12
  v_mul_f32 v119, v119, v12
  v_mul_f32 v120, v120, v12
  v_mul_f32 v121, v121, v12
  v_mul_f32 v122, v122, v12
  v_mul_f32 v123, v123, v12
  v_mul_f32 v124, v124, v12
  v_mul_f32 v125, v125, v12
  v_mul_f32 v126, v126, v12
  v_mul_f32 v127, v127, v12
  s_nop 1
  s_branch L_back_61
L_end:
  s_endpgm
.section .rodata,"a"
.p2align 6
.amdhsa_kernel concat_heads__gqa_block_cached__mha_block_cached__near_ridge_kernel
    .amdhsa_next_free_vgpr 512
    .amdhsa_next_free_sgpr 102
    .amdhsa_accum_offset 256
    .amdhsa_group_segment_fixed_size 0
    .amdhsa_kernarg_size 104
    .amdhsa_user_sgpr_count 2
    .amdhsa_user_sgpr_kernarg_segment_ptr 1
    .amdhsa_system_sgpr_workgroup_id_x 1
.end_amdhsa_kernel
.text
```
